```python
import torch

def _softmax(x, axis=-1):
    return torch.softmax(x, dim=axis)
def _gelu(x):
    return torch.nn.functional.gelu(x, approximate="tanh")
def _silu(x):
    return torch.nn.functional.silu(x)
def _sigmoid(x):
    return torch.sigmoid(x)
def _layernorm(x, axis=-1, eps=1e-5):
    m = x.mean(dim=axis, keepdim=True)
    v = x.var(dim=axis, keepdim=True, unbiased=False)
    return (x - m) / torch.sqrt(v + eps)
def _scatter_add(tgt, idx, src, axis=0):
    return tgt.clone().index_add_(axis, idx, src)
def _segment_sum(src, seg, n):
    out = torch.zeros((n,) + src.shape[1:], dtype=src.dtype)
    return out.index_add_(0, seg, src)
def _pad(x, pw):
    flat = tuple(v for pair in reversed(pw) for v in pair)
    return torch.nn.functional.pad(x, flat)

kernel_name = 'sequential_preLN__mha_block__mixer_s_mlp__prompt'

def setup_inputs():

    _w = (lambda a: (lambda t: t.to(torch.bfloat16) if t.is_floating_point() else t)(torch.as_tensor(a)))
    def _A_setup():
        B, S, D, H = 1, 2048, 512, 32
        return {
            "x": _w((lambda *s: torch.randn(*s, dtype=torch.bfloat16) * 0.05)(B, S, D)),
            "wqkv": _w((lambda *s: torch.randn(*s, dtype=torch.bfloat16) * 0.05)(D, 3 * D)),
            "wo": _w((lambda *s: torch.randn(*s, dtype=torch.bfloat16) * 0.05)(D, D)),
        }
    _A_in = _A_setup()

    def _B_setup():
        B, S, D, F = 1, 2048, 512, 1376
        return {
            "x":  _w((lambda *s: torch.randn(*s, dtype=torch.bfloat16) * 0.05)(B, S, D)),
            "w1": _w((lambda *s: torch.randn(*s, dtype=torch.bfloat16) * 3.2)(D, D) * (D ** -0.5)),
            "w2": _w((lambda *s: torch.randn(*s, dtype=torch.bfloat16) * 3.2)(D, D) * (D ** -0.5)),
            "w3": _w((lambda *s: torch.randn(*s, dtype=torch.bfloat16) * 3.2)(D, F) * (D ** -0.5)),
            "w4": _w((lambda *s: torch.randn(*s, dtype=torch.bfloat16) * 3.2)(F, D) * (F ** -0.5)),
        }
    _B_in = _B_setup()

    return {
        "A_x": _A_in["x"],
        "A_wqkv": _A_in["wqkv"],
        "A_wo": _A_in["wo"],
        "B_x": _B_in["x"],
        "B_w1": _B_in["w1"],
        "B_w2": _B_in["w2"],
        "B_w3": _B_in["w3"],
        "B_w4": _B_in["w4"],
    }

def reference(A_x, A_wqkv, A_wo, B_x, B_w1, B_w2, B_w3, B_w4):
    def _A_ref(x, wqkv, wo):
        B, S, D = x.shape
        H = 32
        Dh = D // H
        qkv = (lambda x, *d: x.permute(*d))((x @ wqkv).reshape(B, S, 3, H, Dh), 2, 0, 3, 1, 4)
        q, k, v = qkv[0], qkv[1], qkv[2]
        scores = torch.einsum("bhqd,bhkd->bhqk", q, k) * (Dh ** -0.5)
        p = _softmax(scores, axis=-1)
        o = torch.einsum("bhqk,bhkd->bhqd", p, v)
        return (lambda x, *d: x.permute(*d))(o, 0, 2, 1, 3).reshape(B, S, D) @ wo

    def _B_ref(x, w1, w2, w3, w4):
        B, S, D = x.shape
        h = _gelu(_layernorm(x, axis=-1) @ w1)
        c = D // 4
        g0 = _pad(h[:, :, 0*c:1*c], ((0, 0), (1, 0), (0, 0)))[:, :S, :]
        g1 = _pad(h[:, :, 1*c:2*c], ((0, 0), (0, 1), (0, 0)))[:, 1:, :]
        g2 = _pad(h[:, :, 2*c:3*c], ((0, 0), (2, 0), (0, 0)))[:, :S, :]
        g3 = _pad(h[:, :, 3*c:   ], ((0, 0), (0, 2), (0, 0)))[:, 2:, :]
        hs = torch.concatenate([g0, g1, g2, g3], axis=-1) @ w2
        x1 = x + hs
        h2 = _gelu(_layernorm(x1, axis=-1) @ w3) @ w4
        return x1 + h2

    x = A_x
    h = x + _A_ref(_layernorm(x, axis=-1), A_wqkv, A_wo)
    h2 = h + _B_ref(_layernorm(h, axis=-1), B_w1, B_w2, B_w3, B_w4)
    return h2
```

```asm
; @launch kernel=qkv_kernel grid=(256,1,1) block=(512,1,1) lds=163840
; @launch kernel=main_kernel grid=(256,1,1) block=(256,1,1) lds=163840
.amdgcn_target "amdgcn-amd-amdhsa--gfx950"
.text
.p2align 12
.globl qkv_kernel
.p2align 8
.type qkv_kernel,@function
qkv_kernel:
L_hop_qkv_kernel_0:
    s_cbranch_execz L_hopb_qkv_kernel
    s_cmp_ge_u32 s2, 256
    s_cbranch_scc1 L_k1_done
    s_load_dwordx16 s[32:47], s[0:1], 0
    s_load_dwordx2 s[4:5], s[0:1], 80
    v_lshrrev_b32 v2, 6, v0
    v_and_b32 v1, 63, v0
    s_mov_b32 s6, 0x2000000
    s_mov_b32 s7, 0x00020000
    s_and_b32 s16, s2, 6
    s_lshl_b32 s16, s16, 1
    s_lshr_b32 s19, s2, 3
    s_and_b32 s18, s19, 3
    s_add_u32 s16, s16, s18
    s_and_b32 s17, s2, 1
    s_lshl_b32 s17, s17, 3
    s_lshr_b32 s18, s19, 2
    s_add_u32 s17, s17, s18
    v_readfirstlane_b32 s23, v2
    s_xor_b32 s96, s17, 8
    s_add_u32 s97, s17, 4
    s_and_b32 s97, s97, 15
    s_mov_b32 s96, s17
    v_lshrrev_b32 v9, 2, v1
    v_and_b32 v10, 3, v1
    v_lshlrev_b32 v3, 4, v1
    s_and_b32 s18, s23, 3
    s_lshl_b32 s22, s16, 2
    s_add_u32 s22, s22, s18
    s_mul_i32 s26, s18, 3072
    s_mul_i32 s27, s18, 4160
    s_add_u32 s27, s27, 12288
    s_and_b32 s28, s2, 7
    s_lshl_b32 s28, s28, 5
    s_add_u32 s28, s28, s19
    s_lshl_b32 s29, s28, 2
    s_add_u32 s29, s29, s18
    s_lshl_b32 s99, s18, 8
    s_add_u32 s99, s99, s2
    s_lshl_b32 s67, s18, 12
    s_add_u32 s67, s67, 144640
    s_add_u32 s68, s67, 2048
    s_mov_b32 s69, 161024
    s_cmp_lt_u32 s23, 4
    s_cbranch_scc1 L_k1_comp
    s_mov_b32 s10, 0x200000
    s_mov_b32 s11, 0x00020000
    s_mov_b32 s14, 0x180000
    s_mov_b32 s15, 0x00020000
    v_mul_u32_u24 v8, 3072, v9
    v_lshl_add_u32 v8, v10, 4, v8
    s_lshl_b32 s98, s96, 6
    v_add_u32 v16, s98, v8
    s_lshl_b32 s98, s97, 6
    v_add_u32 v17, s98, v8
    s_lshl_b32 s98, s96, 7
    v_add_u32 v8, s98, v8
    v_lshrrev_b32 v11, 3, v1
    v_and_b32 v12, 7, v1
    v_and_b32 v13, 2, v11
    v_lshlrev_b32 v13, 1, v13
    v_xor_b32 v12, v12, v13
    v_lshlrev_b32 v4, 10, v11
    v_lshl_add_u32 v4, v12, 4, v4
    v_add_u32 v5, 0x2000, v4
    v_add_u32 v6, 0x4000, v4
    v_add_u32 v7, 0x6000, v4
    s_lshl_b32 s24, s22, 15
    s_mul_i32 s25, s18, 49152
    s_lshl_b32 s20, s16, 1
    s_add_u32 s20, s20, s17
    s_and_b32 s20, s20, 7
    s_mul_i32 s21, s20, 196608
    s_add_u32 m0, s26, 0
    s_add_u32 s21, s25, s21
    s_waitcnt lgkmcnt(0)
    s_mov_b32 s12, s34
    s_mov_b32 s13, s35
    s_mov_b32 s8, s32
    s_mov_b32 s9, s33
    buffer_load_dwordx4 v17, s[12:15], s21 offen offset:2048 lds
    buffer_load_dwordx4 v8, s[12:15], s21 offen lds
    s_add_u32 m0, s26, 960
    s_nop 0
    buffer_load_dwordx4 v8, s[12:15], s21 offen offset:64 lds
    s_lshl_b32 s21, s20, 7
    s_add_u32 s21, s24, s21
    s_add_u32 m0, s27, 0
    s_nop 0
    buffer_load_dwordx4 v4, s[8:11], s21 offen lds
    s_add_u32 m0, s27, 1040
    s_nop 0
    buffer_load_dwordx4 v5, s[8:11], s21 offen lds
    s_add_u32 m0, s27, 2080
    s_nop 0
    buffer_load_dwordx4 v6, s[8:11], s21 offen lds
    s_add_u32 m0, s27, 3120
    s_nop 0
    buffer_load_dwordx4 v7, s[8:11], s21 offen lds
    s_add_u32 s20, s20, 1
    s_and_b32 s20, s20, 7
    s_mul_i32 s21, s20, 196608
    s_add_u32 m0, s26, 28928
    s_add_u32 s21, s25, s21
    buffer_load_dwordx4 v17, s[12:15], s21 offen offset:2048 lds
    buffer_load_dwordx4 v8, s[12:15], s21 offen lds
    s_add_u32 m0, s26, 29888
    s_nop 0
    buffer_load_dwordx4 v8, s[12:15], s21 offen offset:64 lds
    s_lshl_b32 s21, s20, 7
    s_add_u32 s21, s24, s21
    s_add_u32 m0, s27, 28928
    s_nop 0
    buffer_load_dwordx4 v4, s[8:11], s21 offen lds
    s_add_u32 m0, s27, 29968
    s_nop 0
    buffer_load_dwordx4 v5, s[8:11], s21 offen lds
    s_add_u32 m0, s27, 31008
    s_nop 0
    buffer_load_dwordx4 v6, s[8:11], s21 offen lds
    s_add_u32 m0, s27, 32048
    s_nop 0
    buffer_load_dwordx4 v7, s[8:11], s21 offen lds
    s_mov_b32 s51, 0x00020000
    s_cmp_ge_u32 s29, 768
    s_cbranch_scc1 L_qkv_kernel_2
    s_lshr_b32 s66, s29, 8
    s_cmp_eq_u32 s66, 1
    s_cselect_b32 s48, s40, s36
    s_cselect_b32 s49, s41, s37
    s_cmp_eq_u32 s66, 2
    s_cselect_b32 s48, s42, s48
    s_cselect_b32 s49, s43, s49
    s_mov_b32 s50, 0x80000
    s_and_b32 s65, s29, 255
    s_lshl_b32 s66, s66, 19
    s_add_u32 s66, s66, 0x1400000
    s_lshr_b32 s30, s65, 4
    s_and_b32 s31, s65, 15
    s_lshl_b32 s84, s30, 15
    s_lshl_b32 s86, s31, 6
    s_add_u32 s84, s84, s86
    s_lshr_b32 s85, s31, 1
    s_mul_i32 s85, s85, 65536
    s_lshl_b32 s30, s30, 12
    s_add_u32 s85, s85, s30
    s_and_b32 s31, s31, 1
    s_lshl_b32 s31, s31, 11
    s_add_u32 s85, s85, s31
    s_add_u32 s85, s85, s66
    s_mov_b32 s86, 1024
    s_mov_b32 s87, 1024
    s_branch L_qkv_kernel_1
L_qkv_kernel_2:
    s_mov_b32 s48, s46
    s_mov_b32 s49, s47
    s_mov_b32 s50, 0x158000
    s_add_u32 s65, s29, 0xfffffd00
    s_lshr_b32 s30, s65, 4
    s_and_b32 s31, s65, 15
    s_lshl_b32 s84, s30, 15
    s_lshl_b32 s86, s31, 6
    s_add_u32 s84, s84, s86
    s_lshr_b32 s85, s31, 1
    s_mul_i32 s85, s85, 176128
    s_lshl_b32 s30, s30, 12
    s_add_u32 s85, s85, s30
    s_and_b32 s31, s31, 1
    s_lshl_b32 s31, s31, 11
    s_add_u32 s85, s85, s31
    s_add_u32 s85, s85, 0x1700000
    s_mov_b32 s86, 1024
    s_mov_b32 s87, 1024
L_qkv_kernel_1:
    s_mov_b32 s55, 0x00020000
    s_cmp_ge_u32 s29, 432
    s_cbranch_scc1 L_qkv_kernel_4
    s_mov_b32 s52, s46
    s_mov_b32 s53, s47
    s_mov_b32 s54, 0x158000
    s_add_u32 s65, s29, 0x100
    s_lshr_b32 s30, s65, 4
    s_and_b32 s31, s65, 15
    s_lshl_b32 s88, s30, 15
    s_lshl_b32 s90, s31, 6
    s_add_u32 s88, s88, s90
    s_lshr_b32 s89, s31, 1
    s_mul_i32 s89, s89, 176128
    s_lshl_b32 s30, s30, 12
    s_add_u32 s89, s89, s30
    s_and_b32 s31, s31, 1
    s_lshl_b32 s31, s31, 11
    s_add_u32 s89, s89, s31
    s_add_u32 s89, s89, 0x1700000
    s_mov_b32 s90, 1024
    s_mov_b32 s91, 1024
    s_branch L_qkv_kernel_3
L_qkv_kernel_4:
    s_mov_b32 s52, s44
    s_mov_b32 s53, s45
    s_mov_b32 s54, 0x158000
    s_add_u32 s65, s29, 0xfffffe50
    s_mul_i32 s30, s65, 1525
    s_lshr_b32 s30, s30, 16
    s_mul_i32 s31, s30, 43
    s_sub_u32 s31, s65, s31
    s_mul_i32 s88, s30, 88064
    s_lshl_b32 s90, s31, 6
    s_add_u32 s88, s88, s90
    s_lshl_b32 s89, s31, 15
    s_lshl_b32 s30, s30, 10
    s_add_u32 s89, s89, s30
    s_add_u32 s89, s89, 0x1580000
    s_mov_b32 s90, 16384
    s_mov_b32 s91, 2752
L_qkv_kernel_3:
    s_mov_b32 s59, 0x00020000
    s_mov_b32 s56, s44
    s_mov_b32 s57, s45
    s_mov_b32 s58, 0x158000
    s_add_u32 s65, s2, 0x250
    s_mul_i32 s30, s65, 1525
    s_lshr_b32 s30, s30, 16
    s_mul_i32 s31, s30, 43
    s_sub_u32 s31, s65, s31
    s_mul_i32 s92, s30, 88064
    s_lshl_b32 s94, s31, 6
    s_add_u32 s92, s92, s94
    s_lshl_b32 s93, s31, 15
    s_lshl_b32 s30, s30, 10
    s_add_u32 s93, s93, s30
    s_add_u32 s93, s93, 0x1580000
    s_mov_b32 s94, 16384
    s_mov_b32 s95, 2752
L_qkv_kernel_5:
    s_cmp_ge_u32 s99, 96
    s_cselect_b32 s58, 0, s58
    s_cselect_b32 s69, s67, s69
    v_lshrrev_b32 v13, 4, v1
    v_lshlrev_b32 v13, 3, v13
    v_and_b32 v14, 3, v9
    v_add_u32 v13, v13, v14
    v_lshlrev_b32 v13, 6, v13
    v_lshl_add_u32 v13, v10, 4, v13
    v_and_b32 v14, 31, v1
    v_lshrrev_b32 v15, 5, v1
    v_and_b32 v20, 3, v9
    v_lshl_add_u32 v20, v15, 3, v20
    v_lshlrev_b32 v20, 6, v20
    v_and_b32 v28, 16, v1
    v_lshl_add_u32 v20, v28, 1, v20
    v_and_b32 v28, 1, v1
    v_lshl_add_u32 v20, v28, 4, v20
    v_and_b32 v28, 2, v1
    v_lshl_add_u32 v20, v28, 2, v20
    v_lshrrev_b32 v29, 4, v1
    v_xor_b32 v28, v9, v29
    v_and_b32 v28, 1, v28
    v_add_u32 v28, -1, v28
    v_and_b32 v112, 0x3f803f80, v28
    v_mov_b32 v113, v112
    v_mov_b32 v114, v112
    v_mov_b32 v115, v112
    v_add_u32 v20, s26, v20
    v_add_u32 v21, 0xe200, v20
    v_add_u32 v22, 0x1c400, v20
    s_lshl_b32 s30, s18, 2
    s_add_u32 s30, s30, 162048
    v_lshlrev_b32 v28, 4, v14
    v_add_u32 v28, s30, v28
    s_waitcnt vmcnt(7)
    s_barrier
    ds_read_b64_tr_b16 v[32:33], v20 offset:0
    ds_read_b64_tr_b16 v[34:35], v20 offset:256
    ds_read_b64_tr_b16 v[36:37], v20 offset:1024
    ds_read_b64_tr_b16 v[38:39], v20 offset:1280
    ds_read_b64_tr_b16 v[40:41], v20 offset:2048
    ds_read_b64_tr_b16 v[42:43], v20 offset:2304
    s_add_u32 s20, s20, 1
    s_and_b32 s20, s20, 7
    s_mul_i32 s21, s20, 196608
    s_add_u32 m0, s26, 57856
    s_add_u32 s21, s25, s21
    buffer_load_dwordx4 v17, s[12:15], s21 offen offset:2048 lds
    buffer_load_dwordx4 v8, s[12:15], s21 offen lds
    s_add_u32 m0, s26, 58816
    s_nop 0
    buffer_load_dwordx4 v8, s[12:15], s21 offen offset:64 lds
    s_lshl_b32 s21, s20, 7
    s_add_u32 s21, s24, s21
    s_add_u32 m0, s27, 57856
    s_nop 0
    buffer_load_dwordx4 v4, s[8:11], s21 offen lds
    s_add_u32 m0, s27, 58896
    s_nop 0
    buffer_load_dwordx4 v5, s[8:11], s21 offen lds
    s_add_u32 m0, s27, 59936
    s_nop 0
    buffer_load_dwordx4 v6, s[8:11], s21 offen lds
    s_add_u32 m0, s27, 60976
    s_nop 0
    buffer_load_dwordx4 v7, s[8:11], s21 offen lds
    s_add_u32 s20, s20, 1
    s_and_b32 s20, s20, 7
    s_mul_i32 s21, s20, 196608
    s_add_u32 m0, s26, 86784
    s_add_u32 s21, s25, s21
    buffer_load_dwordx4 v17, s[12:15], s21 offen offset:2048 lds
    buffer_load_dwordx4 v8, s[12:15], s21 offen lds
    s_add_u32 m0, s26, 87744
    s_nop 0
    buffer_load_dwordx4 v8, s[12:15], s21 offen offset:64 lds
    s_lshl_b32 s21, s20, 7
    s_add_u32 s21, s24, s21
    s_add_u32 m0, s27, 86784
    s_nop 0
    buffer_load_dwordx4 v4, s[8:11], s21 offen lds
    s_add_u32 m0, s27, 87824
    s_nop 0
    buffer_load_dwordx4 v5, s[8:11], s21 offen lds
    s_add_u32 m0, s27, 88864
    s_nop 0
    buffer_load_dwordx4 v6, s[8:11], s21 offen lds
    s_add_u32 m0, s27, 89904
    s_nop 0
    buffer_load_dwordx4 v7, s[8:11], s21 offen lds
    s_waitcnt lgkmcnt(0)
    v_mfma_f32_16x16x32_bf16 v[168:171], v[112:115], v[32:35], 0
    v_mfma_f32_16x16x32_bf16 v[172:175], v[112:115], v[36:39], 0
    v_mfma_f32_16x16x32_bf16 v[176:179], v[112:115], v[40:43], 0
    s_waitcnt vmcnt(14)
    s_barrier
    ds_read_b64_tr_b16 v[32:33], v20 offset:28928
    ds_read_b64_tr_b16 v[34:35], v20 offset:29184
    ds_read_b64_tr_b16 v[36:37], v20 offset:29952
    ds_read_b64_tr_b16 v[38:39], v20 offset:30208
    ds_read_b64_tr_b16 v[40:41], v20 offset:30976
    ds_read_b64_tr_b16 v[42:43], v20 offset:31232
    s_add_u32 s20, s20, 1
    s_and_b32 s20, s20, 7
    s_mul_i32 s21, s20, 196608
    s_add_u32 m0, s26, 115712
    s_add_u32 s21, s25, s21
    buffer_load_dwordx4 v17, s[12:15], s21 offen offset:2048 lds
    buffer_load_dwordx4 v8, s[12:15], s21 offen lds
    s_add_u32 m0, s26, 116672
    s_nop 0
    buffer_load_dwordx4 v8, s[12:15], s21 offen offset:64 lds
    s_lshl_b32 s21, s20, 7
    s_add_u32 s21, s24, s21
    s_add_u32 m0, s27, 115712
    s_nop 0
    buffer_load_dwordx4 v4, s[8:11], s21 offen lds
    s_add_u32 m0, s27, 116752
    s_nop 0
    buffer_load_dwordx4 v5, s[8:11], s21 offen lds
    s_add_u32 m0, s27, 117792
    s_nop 0
    buffer_load_dwordx4 v6, s[8:11], s21 offen lds
    s_add_u32 m0, s27, 118832
    s_nop 0
    buffer_load_dwordx4 v7, s[8:11], s21 offen lds
    v_mul_u32_u24 v12, s95, v9
    v_lshl_add_u32 v12, v10, 4, v12
    s_add_u32 m0, s69, 0
    s_nop 0
    buffer_load_dwordx4 v12, s[56:59], s92 offen lds
    s_lshl_b32 s30, s95, 4
    s_add_u32 s30, s30, s92
    s_add_u32 m0, s69, 1024
    s_nop 0
    buffer_load_dwordx4 v12, s[56:59], s30 offen lds
    v_mul_u32_u24 v12, s87, v9
    v_lshl_add_u32 v12, v10, 4, v12
    s_add_u32 m0, s67, 0
    s_nop 0
    buffer_load_dwordx4 v12, s[48:51], s84 offen lds
    s_lshl_b32 s30, s87, 4
    s_add_u32 s30, s30, s84
    s_add_u32 m0, s67, 1024
    s_nop 0
    buffer_load_dwordx4 v12, s[48:51], s30 offen lds
    v_mul_u32_u24 v12, s91, v9
    v_lshl_add_u32 v12, v10, 4, v12
    s_add_u32 m0, s68, 0
    s_nop 0
    buffer_load_dwordx4 v12, s[52:55], s88 offen lds
    s_lshl_b32 s30, s91, 4
    s_add_u32 s30, s30, s88
    s_add_u32 m0, s68, 1024
    s_nop 0
    buffer_load_dwordx4 v12, s[52:55], s30 offen lds
    s_waitcnt lgkmcnt(0)
    v_mfma_f32_16x16x32_bf16 v[168:171], v[112:115], v[32:35], v[168:171]
    v_mfma_f32_16x16x32_bf16 v[172:175], v[112:115], v[36:39], v[172:175]
    v_mfma_f32_16x16x32_bf16 v[176:179], v[112:115], v[40:43], v[176:179]
    s_waitcnt vmcnt(20)
    s_barrier
    ds_read_b64_tr_b16 v[32:33], v21 offset:0
    ds_read_b64_tr_b16 v[34:35], v21 offset:256
    ds_read_b64_tr_b16 v[36:37], v21 offset:1024
    ds_read_b64_tr_b16 v[38:39], v21 offset:1280
    ds_read_b64_tr_b16 v[40:41], v21 offset:2048
    ds_read_b64_tr_b16 v[42:43], v21 offset:2304
    s_waitcnt lgkmcnt(0)
    v_mfma_f32_16x16x32_bf16 v[168:171], v[112:115], v[32:35], v[168:171]
    v_mfma_f32_16x16x32_bf16 v[172:175], v[112:115], v[36:39], v[172:175]
    v_mfma_f32_16x16x32_bf16 v[176:179], v[112:115], v[40:43], v[176:179]
    s_waitcnt vmcnt(13)
    s_barrier
    ds_read_b64_tr_b16 v[32:33], v21 offset:28928
    ds_read_b64_tr_b16 v[34:35], v21 offset:29184
    ds_read_b64_tr_b16 v[36:37], v21 offset:29952
    ds_read_b64_tr_b16 v[38:39], v21 offset:30208
    ds_read_b64_tr_b16 v[40:41], v21 offset:30976
    ds_read_b64_tr_b16 v[42:43], v21 offset:31232
    s_waitcnt lgkmcnt(0)
    v_mfma_f32_16x16x32_bf16 v[168:171], v[112:115], v[32:35], v[168:171]
    v_mfma_f32_16x16x32_bf16 v[172:175], v[112:115], v[36:39], v[172:175]
    v_mfma_f32_16x16x32_bf16 v[176:179], v[112:115], v[40:43], v[176:179]
    s_waitcnt vmcnt(6)
    s_barrier
    ds_read_b64_tr_b16 v[32:33], v22 offset:0
    ds_read_b64_tr_b16 v[34:35], v22 offset:256
    ds_read_b64_tr_b16 v[36:37], v22 offset:1024
    ds_read_b64_tr_b16 v[38:39], v22 offset:1280
    ds_read_b64_tr_b16 v[40:41], v22 offset:2048
    ds_read_b64_tr_b16 v[42:43], v22 offset:2304
    s_add_u32 s20, s20, 1
    s_and_b32 s20, s20, 7
    s_mul_i32 s21, s20, 196608
    s_add_u32 m0, s26, 0
    s_add_u32 s21, s25, s21
    buffer_load_dwordx4 v17, s[12:15], s21 offen offset:2048 lds
    buffer_load_dwordx4 v8, s[12:15], s21 offen lds
    s_add_u32 m0, s26, 960
    s_nop 0
    buffer_load_dwordx4 v8, s[12:15], s21 offen offset:64 lds
    s_lshl_b32 s21, s20, 7
    s_add_u32 s21, s24, s21
    s_add_u32 m0, s27, 0
    s_nop 0
    buffer_load_dwordx4 v4, s[8:11], s21 offen lds
    s_add_u32 m0, s27, 1040
    s_nop 0
    buffer_load_dwordx4 v5, s[8:11], s21 offen lds
    s_add_u32 m0, s27, 2080
    s_nop 0
    buffer_load_dwordx4 v6, s[8:11], s21 offen lds
    s_add_u32 m0, s27, 3120
    s_nop 0
    buffer_load_dwordx4 v7, s[8:11], s21 offen lds
    s_add_u32 s20, s20, 1
    s_and_b32 s20, s20, 7
    s_mul_i32 s21, s20, 196608
    s_add_u32 m0, s26, 28928
    s_add_u32 s21, s25, s21
    buffer_load_dwordx4 v17, s[12:15], s21 offen offset:2048 lds
    buffer_load_dwordx4 v8, s[12:15], s21 offen lds
    s_add_u32 m0, s26, 29888
    s_nop 0
    buffer_load_dwordx4 v8, s[12:15], s21 offen offset:64 lds
    s_lshl_b32 s21, s20, 7
    s_add_u32 s21, s24, s21
    s_add_u32 m0, s27, 28928
    s_nop 0
    buffer_load_dwordx4 v4, s[8:11], s21 offen lds
    s_add_u32 m0, s27, 29968
    s_nop 0
    buffer_load_dwordx4 v5, s[8:11], s21 offen lds
    s_add_u32 m0, s27, 31008
    s_nop 0
    buffer_load_dwordx4 v6, s[8:11], s21 offen lds
    s_add_u32 m0, s27, 32048
    s_nop 0
    buffer_load_dwordx4 v7, s[8:11], s21 offen lds
    s_waitcnt lgkmcnt(0)
    v_mfma_f32_16x16x32_bf16 v[168:171], v[112:115], v[32:35], v[168:171]
    v_mfma_f32_16x16x32_bf16 v[172:175], v[112:115], v[36:39], v[172:175]
    v_mfma_f32_16x16x32_bf16 v[176:179], v[112:115], v[40:43], v[176:179]
    s_waitcnt vmcnt(7)
    s_barrier
    ds_read_b64_tr_b16 v[32:33], v20 offset:0
    ds_read_b64_tr_b16 v[34:35], v20 offset:256
    ds_read_b64_tr_b16 v[36:37], v20 offset:1024
    ds_read_b64_tr_b16 v[38:39], v20 offset:1280
    ds_read_b64_tr_b16 v[40:41], v20 offset:2048
    ds_read_b64_tr_b16 v[42:43], v20 offset:2304
    s_add_u32 s20, s20, 1
    s_and_b32 s20, s20, 7
    s_mul_i32 s21, s20, 196608
    s_add_u32 m0, s26, 57856
    s_add_u32 s21, s25, s21
    buffer_load_dwordx4 v17, s[12:15], s21 offen offset:2048 lds
    buffer_load_dwordx4 v8, s[12:15], s21 offen lds
    s_add_u32 m0, s26, 58816
    s_nop 0
    buffer_load_dwordx4 v8, s[12:15], s21 offen offset:64 lds
    s_lshl_b32 s21, s20, 7
    s_add_u32 s21, s24, s21
    s_add_u32 m0, s27, 57856
    s_nop 0
    buffer_load_dwordx4 v4, s[8:11], s21 offen lds
    s_add_u32 m0, s27, 58896
    s_nop 0
    buffer_load_dwordx4 v5, s[8:11], s21 offen lds
    s_add_u32 m0, s27, 59936
    s_nop 0
    buffer_load_dwordx4 v6, s[8:11], s21 offen lds
    s_add_u32 m0, s27, 60976
    s_nop 0
    buffer_load_dwordx4 v7, s[8:11], s21 offen lds
    v_add_u32 v12, s67, v13
    ds_read_b64_tr_b16 v[44:45], v12 offset:0
    ds_read_b64_tr_b16 v[46:47], v12 offset:256
    ds_read_b64_tr_b16 v[48:49], v12 offset:8
    ds_read_b64_tr_b16 v[50:51], v12 offset:264
    v_add_u32 v12, s68, v13
    ds_read_b64_tr_b16 v[52:53], v12 offset:0
    ds_read_b64_tr_b16 v[54:55], v12 offset:256
    ds_read_b64_tr_b16 v[56:57], v12 offset:8
    ds_read_b64_tr_b16 v[58:59], v12 offset:264
    v_add_u32 v12, s69, v13
    ds_read_b64_tr_b16 v[68:69], v12 offset:0
    ds_read_b64_tr_b16 v[70:71], v12 offset:256
    ds_read_b64_tr_b16 v[72:73], v12 offset:8
    ds_read_b64_tr_b16 v[74:75], v12 offset:264
    s_waitcnt lgkmcnt(0)
    v_mfma_f32_16x16x32_bf16 v[168:171], v[112:115], v[32:35], v[168:171]
    v_mfma_f32_16x16x32_bf16 v[172:175], v[112:115], v[36:39], v[172:175]
    v_mfma_f32_16x16x32_bf16 v[176:179], v[112:115], v[40:43], v[176:179]
    s_add_u32 s30, s85, s86
    buffer_store_dwordx4 v[44:47], v3, s[4:7], s85 offen sc1
    buffer_store_dwordx4 v[48:51], v3, s[4:7], s30 offen sc1
    s_add_u32 s30, s89, s90
    buffer_store_dwordx4 v[52:55], v3, s[4:7], s89 offen sc1
    buffer_store_dwordx4 v[56:59], v3, s[4:7], s30 offen sc1
    s_add_u32 s30, s93, s94
    s_cmp_ge_u32 s99, 96
    s_cselect_b32 s31, 0x80000000, 0
    v_add_u32 v12, s31, v3
    buffer_store_dwordx4 v[68:71], v12, s[4:7], s93 offen sc1
    buffer_store_dwordx4 v[72:75], v12, s[4:7], s30 offen sc1
    s_waitcnt vmcnt(13)
    s_barrier
    ds_read_b64_tr_b16 v[32:33], v20 offset:28928
    ds_read_b64_tr_b16 v[34:35], v20 offset:29184
    ds_read_b64_tr_b16 v[36:37], v20 offset:29952
    ds_read_b64_tr_b16 v[38:39], v20 offset:30208
    ds_read_b64_tr_b16 v[40:41], v20 offset:30976
    ds_read_b64_tr_b16 v[42:43], v20 offset:31232
    s_waitcnt lgkmcnt(0)
    v_mfma_f32_16x16x32_bf16 v[168:171], v[112:115], v[32:35], v[168:171]
    v_mfma_f32_16x16x32_bf16 v[172:175], v[112:115], v[36:39], v[172:175]
    v_mfma_f32_16x16x32_bf16 v[176:179], v[112:115], v[40:43], v[176:179]
    s_waitcnt vmcnt(6)
    s_barrier
    ds_read_b64_tr_b16 v[32:33], v21 offset:0
    ds_read_b64_tr_b16 v[34:35], v21 offset:256
    ds_read_b64_tr_b16 v[36:37], v21 offset:1024
    ds_read_b64_tr_b16 v[38:39], v21 offset:1280
    ds_read_b64_tr_b16 v[40:41], v21 offset:2048
    ds_read_b64_tr_b16 v[42:43], v21 offset:2304
    s_waitcnt lgkmcnt(0)
    v_mfma_f32_16x16x32_bf16 v[168:171], v[112:115], v[32:35], v[168:171]
    v_mfma_f32_16x16x32_bf16 v[172:175], v[112:115], v[36:39], v[172:175]
    v_mfma_f32_16x16x32_bf16 v[176:179], v[112:115], v[40:43], v[176:179]
    s_nop 5
    ds_write_b32 v28, v168 offset:0
    ds_write_b32 v28, v172 offset:512
    ds_write_b32 v28, v176 offset:1024
    s_waitcnt lgkmcnt(0)
    s_barrier
    s_getpc_b64 s[20:21]
L_qkv_kernel_6:
    s_add_u32 s20, s20, L_qkv_kernel_7-L_qkv_kernel_6
    s_addc_u32 s21, s21, 0
    s_mov_b64 exec, 0
    s_cmp_eq_u32 s18, 0
    s_cbranch_scc1 L_hop_main_kernel_0
    s_cmp_eq_u32 s18, 1
    s_cbranch_scc1 L_hop_main_kernel_1
    s_cmp_eq_u32 s18, 2
    s_cbranch_scc1 L_hop_main_kernel_2
    s_branch L_hop_main_kernel_3
L_qkv_kernel_7:
    s_mov_b64 exec, -1
    s_endpgm
L_k1_comp:
    s_lshl_b32 s28, s19, 2
    s_add_u32 s28, s28, s18
    s_lshl_b32 s64, s28, 13
    s_cmp_ge_u32 s64, L_code_end-qkv_kernel
    s_cbranch_scc1 L_qkv_kernel_8
    s_getpc_b64 s[62:63]
L_qkv_kernel_9:
    s_sub_u32 s62, s62, L_qkv_kernel_9-qkv_kernel
    s_subb_u32 s63, s63, 0
    v_lshlrev_b32 v196, 7, v1
    v_add_u32 v196, s64, v196
    v_min_u32 v196, L_code_end-qkv_kernel-4, v196
    v_mov_b32 v197, s63
    v_add_co_u32 v196, vcc, s62, v196
    s_nop 1
    v_addc_co_u32 v197, vcc, 0, v197, vcc
    global_load_dword v198, v[196:197], off
L_qkv_kernel_8:
    s_getpc_b64 s[20:21]
L_qkv_kernel_10:
    s_add_u32 s20, s20, L_qkv_kernel_11-L_qkv_kernel_10
    s_addc_u32 s21, s21, 0
    s_mov_b64 exec, 0
    s_cmp_eq_u32 s18, 0
    s_cbranch_scc1 L_hop_qkv_kernel_1
    s_cmp_eq_u32 s18, 1
    s_cbranch_scc1 L_hop_qkv_kernel_2
    s_cmp_eq_u32 s18, 2
    s_cbranch_scc1 L_hop_qkv_kernel_3
    s_branch L_hop_qkv_kernel_4
L_qkv_kernel_11:
    s_mov_b64 exec, -1
    v_and_b32 v14, 31, v1
    v_lshrrev_b32 v15, 5, v1
    v_and_b32 v22, 3, v9
    v_lshl_add_u32 v22, v15, 3, v22
    v_lshlrev_b32 v22, 6, v22
    v_and_b32 v28, 16, v1
    v_lshl_add_u32 v22, v28, 1, v22
    v_and_b32 v28, 1, v1
    v_lshl_add_u32 v22, v28, 4, v22
    v_and_b32 v28, 2, v1
    v_lshl_add_u32 v22, v28, 2, v22
    v_lshrrev_b32 v29, 4, v1
    v_xor_b32 v28, v9, v29
    v_and_b32 v28, 1, v28
    v_add_u32 v28, -1, v28
    v_and_b32 v112, 0x3f803f80, v28
    v_mov_b32 v113, v112
    v_mov_b32 v114, v112
    v_mov_b32 v115, v112
    v_lshrrev_b32 v25, 3, v14
    v_mul_u32_u24 v25, 1040, v25
    v_and_b32 v26, 7, v14
    v_lshl_add_u32 v25, v26, 7, v25
    v_lshl_add_u32 v25, v15, 4, v25
    v_add_u32 v25, s27, v25
    v_and_b32 v26, 2, v14
    v_lshlrev_b32 v26, 5, v26
    v_add_u32 v16, v25, v26
    v_xor_b32 v26, 64, v26
    v_add_u32 v19, v25, v26
    v_add_u32 v17, 0xe200, v16
    v_add_u32 v18, 0x1c400, v16
    v_add_u32 v20, 0xe200, v19
    v_add_u32 v21, 0x1c400, v19
    v_add_u32 v23, 0xe200, v22
    v_add_u32 v24, 0x1c400, v22
    v_lshlrev_b32 v29, 4, v14
    v_add_u32 v29, 162048, v29
    s_lshl_b32 s30, s18, 8
    s_add_u32 s30, s30, 161024
    v_lshlrev_b32 v30, 2, v14
    v_add_u32 v30, s30, v30
    v_lshlrev_b32 v31, 4, v15
    v_add_u32 v31, s30, v31
    s_lshl_b32 s31, s17, 17
    s_lshl_b32 s30, s22, 10
    s_add_u32 s31, s31, s30
    s_add_u32 s65, s31, 0x10000
    s_lshl_b32 s30, s30, 1
    s_add_u32 s30, s30, 0x200000
    s_lshl_b32 s66, s96, 18
    s_add_u32 s66, s66, s30
    s_add_u32 s67, s66, 0x20000
    s_lshl_b32 s68, s97, 18
    s_add_u32 s68, s68, s30
    s_lshl_b32 s31, s96, 18
    s_lshl_b32 s65, s22, 10
    s_add_u32 s31, s31, s65
    s_and_b32 s65, s96, 7
    s_lshl_b32 s65, s65, 19
    s_add_u32 s65, s65, s30
    s_cmp_lt_u32 s96, 8
    s_cselect_b32 s31, s31, s65
    s_cselect_b32 s30, 1, 2
    s_cselect_b32 s69, 0x3eb8aa3b, 1.0
    s_lshl_b32 s30, s30, 16
    s_add_u32 s65, s31, s30
    s_add_u32 s66, s65, s30
    s_add_u32 s67, s66, s30
    v_lshrrev_b32 v26, 4, v14
    v_lshlrev_b32 v26, 17, v26
    v_and_b32 v27, 15, v14
    v_lshl_add_u32 v26, v27, 4, v26
    v_lshl_add_u32 v26, v15, 8, v26
    s_lshl_b32 s24, s29, 11
    s_add_u32 s24, s24, 0x600000
    v_mov_b32 v192, -1
    v_mov_b32 v193, -1
    v_mov_b32 v194, -1
    v_mov_b32 v195, -1
    s_cmp_gt_u32 s29, 287
    s_cselect_b32 s25, 0x80000000, 0
    v_add_u32 v12, s25, v3
    s_lshl_b32 s25, s29, 10
    s_add_u32 s25, s25, 0x18c0000
    s_waitcnt lgkmcnt(0)
    v_cmp_eq_u32 s[40:41], 1, v10
    v_cmp_eq_u32 s[42:43], 2, v10
    v_cmp_eq_u32 s[44:45], 3, v10
    s_barrier
    ds_read_b128 v[116:119], v16 offset:0
    ds_read_b64_tr_b16 v[128:129], v22 offset:0
    ds_read_b64_tr_b16 v[130:131], v22 offset:256
L_hop_qkv_kernel_1:
    s_cbranch_execz L_hopb_qkv_kernel
    ds_read_b64_tr_b16 v[132:133], v22 offset:1024
    ds_read_b64_tr_b16 v[134:135], v22 offset:1280
    ds_read_b64_tr_b16 v[136:137], v22 offset:2048
    ds_read_b64_tr_b16 v[138:139], v22 offset:2304
    ds_read_b128 v[120:123], v16 offset:32
    ds_read_b64_tr_b16 v[140:141], v22 offset:3072
    ds_read_b64_tr_b16 v[142:143], v22 offset:3328
    ds_read_b64_tr_b16 v[144:145], v22 offset:4096
    ds_read_b64_tr_b16 v[146:147], v22 offset:4352
    ds_read_b64_tr_b16 v[148:149], v22 offset:5120
    ds_read_b64_tr_b16 v[150:151], v22 offset:5376
    s_waitcnt lgkmcnt(7)
    v_mfma_f32_16x16x32_bf16 v[164:167], v[112:115], v[116:119], 0
    v_mfma_f32_4x4x4_16b_bf16 v[180:183], v[116:117], v[116:117], 0
    v_mfma_f32_4x4x4_16b_bf16 v[184:187], v[118:119], v[118:119], 0
    v_mfma_f32_32x32x16_bf16 v[48:63], v[132:135], v[116:119], 0
    ds_read_b128 v[124:127], v19 offset:0
    ds_read_b64_tr_b16 v[152:153], v22 offset:6144
    ds_read_b64_tr_b16 v[154:155], v22 offset:6400
    v_mfma_f32_32x32x16_bf16 v[32:47], v[128:131], v[116:119], 0
    ds_read_b64_tr_b16 v[156:157], v22 offset:7168
    ds_read_b64_tr_b16 v[158:159], v22 offset:7424
    v_mfma_f32_32x32x16_bf16 v[64:79], v[116:119], v[136:139], 0
    ds_read_b64_tr_b16 v[160:161], v22 offset:8192
    ds_read_b64_tr_b16 v[162:163], v22 offset:8448
    s_waitcnt lgkmcnt(7)
    v_mfma_f32_16x16x32_bf16 v[164:167], v[112:115], v[120:123], v[164:167]
    v_mfma_f32_4x4x4_16b_bf16 v[180:183], v[120:121], v[120:121], v[180:183]
    v_mfma_f32_4x4x4_16b_bf16 v[184:187], v[122:123], v[122:123], v[184:187]
    v_mfma_f32_32x32x16_bf16 v[48:63], v[144:147], v[120:123], v[48:63]
    ds_read_b128 v[116:119], v19 offset:32
    ds_read_b64_tr_b16 v[128:129], v22 offset:9216
    ds_read_b64_tr_b16 v[130:131], v22 offset:9472
    v_mfma_f32_32x32x16_bf16 v[32:47], v[140:143], v[120:123], v[32:47]
    ds_read_b64_tr_b16 v[132:133], v22 offset:10240
    ds_read_b64_tr_b16 v[134:135], v22 offset:10496
    v_mfma_f32_32x32x16_bf16 v[64:79], v[120:123], v[148:151], v[64:79]
    ds_read_b64_tr_b16 v[136:137], v22 offset:11264
    ds_read_b64_tr_b16 v[138:139], v22 offset:11520
    s_waitcnt lgkmcnt(7)
    v_mfma_f32_16x16x32_bf16 v[164:167], v[112:115], v[124:127], v[164:167]
    v_mfma_f32_4x4x4_16b_bf16 v[180:183], v[124:125], v[124:125], v[180:183]
    v_mfma_f32_4x4x4_16b_bf16 v[184:187], v[126:127], v[126:127], v[184:187]
    v_mfma_f32_32x32x16_bf16 v[48:63], v[156:159], v[124:127], v[48:63]
    s_waitcnt lgkmcnt(0)
    s_barrier
    ds_read_b128 v[120:123], v16 offset:28928
    ds_read_b64_tr_b16 v[140:141], v22 offset:28928
    ds_read_b64_tr_b16 v[142:143], v22 offset:29184
    v_mfma_f32_32x32x16_bf16 v[32:47], v[152:155], v[124:127], v[32:47]
    ds_read_b64_tr_b16 v[144:145], v22 offset:29952
    ds_read_b64_tr_b16 v[146:147], v22 offset:30208
    v_mfma_f32_32x32x16_bf16 v[64:79], v[124:127], v[160:163], v[64:79]
    ds_read_b64_tr_b16 v[148:149], v22 offset:30976
    ds_read_b64_tr_b16 v[150:151], v22 offset:31232
    s_waitcnt lgkmcnt(7)
    v_mfma_f32_16x16x32_bf16 v[164:167], v[112:115], v[116:119], v[164:167]
    v_mfma_f32_4x4x4_16b_bf16 v[180:183], v[116:117], v[116:117], v[180:183]
    v_mfma_f32_4x4x4_16b_bf16 v[184:187], v[118:119], v[118:119], v[184:187]
    v_mfma_f32_32x32x16_bf16 v[48:63], v[132:135], v[116:119], v[48:63]
    ds_read_b128 v[124:127], v16 offset:28960
    ds_read_b64_tr_b16 v[152:153], v22 offset:32000
    ds_read_b64_tr_b16 v[154:155], v22 offset:32256
    v_mfma_f32_32x32x16_bf16 v[32:47], v[128:131], v[116:119], v[32:47]
    ds_read_b64_tr_b16 v[156:157], v22 offset:33024
    ds_read_b64_tr_b16 v[158:159], v22 offset:33280
    v_mfma_f32_32x32x16_bf16 v[64:79], v[116:119], v[136:139], v[64:79]
    ds_read_b64_tr_b16 v[160:161], v22 offset:34048
    ds_read_b64_tr_b16 v[162:163], v22 offset:34304
    s_waitcnt lgkmcnt(7)
    v_mfma_f32_16x16x32_bf16 v[164:167], v[112:115], v[120:123], v[164:167]
    v_mfma_f32_4x4x4_16b_bf16 v[180:183], v[120:121], v[120:121], v[180:183]
    v_mfma_f32_4x4x4_16b_bf16 v[184:187], v[122:123], v[122:123], v[184:187]
    v_mfma_f32_32x32x16_bf16 v[48:63], v[144:147], v[120:123], v[48:63]
    ds_read_b128 v[116:119], v19 offset:28928
    ds_read_b64_tr_b16 v[128:129], v22 offset:35072
    ds_read_b64_tr_b16 v[130:131], v22 offset:35328
    v_mfma_f32_32x32x16_bf16 v[32:47], v[140:143], v[120:123], v[32:47]
    ds_read_b64_tr_b16 v[132:133], v22 offset:36096
    ds_read_b64_tr_b16 v[134:135], v22 offset:36352
    v_mfma_f32_32x32x16_bf16 v[64:79], v[120:123], v[148:151], v[64:79]
    ds_read_b64_tr_b16 v[136:137], v22 offset:37120
    ds_read_b64_tr_b16 v[138:139], v22 offset:37376
    s_waitcnt lgkmcnt(7)
    v_mfma_f32_16x16x32_bf16 v[164:167], v[112:115], v[124:127], v[164:167]
    v_mfma_f32_4x4x4_16b_bf16 v[180:183], v[124:125], v[124:125], v[180:183]
    v_mfma_f32_4x4x4_16b_bf16 v[184:187], v[126:127], v[126:127], v[184:187]
    v_mfma_f32_32x32x16_bf16 v[48:63], v[156:159], v[124:127], v[48:63]
    ds_read_b128 v[120:123], v19 offset:28960
    ds_read_b64_tr_b16 v[140:141], v22 offset:38144
    ds_read_b64_tr_b16 v[142:143], v22 offset:38400
    v_mfma_f32_32x32x16_bf16 v[32:47], v[152:155], v[124:127], v[32:47]
    ds_read_b64_tr_b16 v[144:145], v22 offset:39168
    ds_read_b64_tr_b16 v[146:147], v22 offset:39424
    v_mfma_f32_32x32x16_bf16 v[64:79], v[124:127], v[160:163], v[64:79]
    ds_read_b64_tr_b16 v[148:149], v22 offset:40192
    ds_read_b64_tr_b16 v[150:151], v22 offset:40448
    s_waitcnt lgkmcnt(7)
    v_mfma_f32_16x16x32_bf16 v[164:167], v[112:115], v[116:119], v[164:167]
    v_mfma_f32_4x4x4_16b_bf16 v[180:183], v[116:117], v[116:117], v[180:183]
    v_mfma_f32_4x4x4_16b_bf16 v[184:187], v[118:119], v[118:119], v[184:187]
    v_mfma_f32_32x32x16_bf16 v[48:63], v[132:135], v[116:119], v[48:63]
    s_waitcnt lgkmcnt(0)
    s_barrier
    ds_read_b128 v[124:127], v17 offset:0
    ds_read_b64_tr_b16 v[152:153], v23 offset:0
    ds_read_b64_tr_b16 v[154:155], v23 offset:256
    v_mfma_f32_32x32x16_bf16 v[32:47], v[128:131], v[116:119], v[32:47]
    ds_read_b64_tr_b16 v[156:157], v23 offset:1024
    ds_read_b64_tr_b16 v[158:159], v23 offset:1280
    v_mfma_f32_32x32x16_bf16 v[64:79], v[116:119], v[136:139], v[64:79]
    ds_read_b64_tr_b16 v[160:161], v23 offset:2048
    ds_read_b64_tr_b16 v[162:163], v23 offset:2304
    s_waitcnt lgkmcnt(7)
    v_mfma_f32_16x16x32_bf16 v[164:167], v[112:115], v[120:123], v[164:167]
    v_mfma_f32_4x4x4_16b_bf16 v[180:183], v[120:121], v[120:121], v[180:183]
    v_mfma_f32_4x4x4_16b_bf16 v[184:187], v[122:123], v[122:123], v[184:187]
    v_mfma_f32_32x32x16_bf16 v[48:63], v[144:147], v[120:123], v[48:63]
    ds_read_b128 v[116:119], v17 offset:32
    ds_read_b64_tr_b16 v[128:129], v23 offset:3072
    ds_read_b64_tr_b16 v[130:131], v23 offset:3328
    v_mfma_f32_32x32x16_bf16 v[32:47], v[140:143], v[120:123], v[32:47]
    ds_read_b64_tr_b16 v[132:133], v23 offset:4096
    ds_read_b64_tr_b16 v[134:135], v23 offset:4352
    v_mfma_f32_32x32x16_bf16 v[64:79], v[120:123], v[148:151], v[64:79]
    ds_read_b64_tr_b16 v[136:137], v23 offset:5120
    ds_read_b64_tr_b16 v[138:139], v23 offset:5376
    s_waitcnt lgkmcnt(7)
    v_mfma_f32_16x16x32_bf16 v[164:167], v[112:115], v[124:127], v[164:167]
    v_mfma_f32_4x4x4_16b_bf16 v[180:183], v[124:125], v[124:125], v[180:183]
    v_mfma_f32_4x4x4_16b_bf16 v[184:187], v[126:127], v[126:127], v[184:187]
    v_mfma_f32_32x32x16_bf16 v[48:63], v[156:159], v[124:127], v[48:63]
    ds_read_b128 v[120:123], v20 offset:0
    ds_read_b64_tr_b16 v[140:141], v23 offset:6144
    ds_read_b64_tr_b16 v[142:143], v23 offset:6400
    v_mfma_f32_32x32x16_bf16 v[32:47], v[152:155], v[124:127], v[32:47]
    ds_read_b64_tr_b16 v[144:145], v23 offset:7168
    ds_read_b64_tr_b16 v[146:147], v23 offset:7424
    v_mfma_f32_32x32x16_bf16 v[64:79], v[124:127], v[160:163], v[64:79]
    ds_read_b64_tr_b16 v[148:149], v23 offset:8192
    ds_read_b64_tr_b16 v[150:151], v23 offset:8448
    s_waitcnt lgkmcnt(7)
    v_mfma_f32_16x16x32_bf16 v[164:167], v[112:115], v[116:119], v[164:167]
    v_mfma_f32_4x4x4_16b_bf16 v[180:183], v[116:117], v[116:117], v[180:183]
    v_mfma_f32_4x4x4_16b_bf16 v[184:187], v[118:119], v[118:119], v[184:187]
    v_mfma_f32_32x32x16_bf16 v[48:63], v[132:135], v[116:119], v[48:63]
    ds_read_b128 v[124:127], v20 offset:32
    ds_read_b64_tr_b16 v[152:153], v23 offset:9216
    ds_read_b64_tr_b16 v[154:155], v23 offset:9472
    v_mfma_f32_32x32x16_bf16 v[32:47], v[128:131], v[116:119], v[32:47]
    ds_read_b64_tr_b16 v[156:157], v23 offset:10240
    ds_read_b64_tr_b16 v[158:159], v23 offset:10496
    v_mfma_f32_32x32x16_bf16 v[64:79], v[116:119], v[136:139], v[64:79]
    ds_read_b64_tr_b16 v[160:161], v23 offset:11264
    ds_read_b64_tr_b16 v[162:163], v23 offset:11520
    s_waitcnt lgkmcnt(7)
    v_mfma_f32_16x16x32_bf16 v[164:167], v[112:115], v[120:123], v[164:167]
    v_mfma_f32_4x4x4_16b_bf16 v[180:183], v[120:121], v[120:121], v[180:183]
    v_mfma_f32_4x4x4_16b_bf16 v[184:187], v[122:123], v[122:123], v[184:187]
    v_mfma_f32_32x32x16_bf16 v[48:63], v[144:147], v[120:123], v[48:63]
    s_waitcnt lgkmcnt(0)
    s_barrier
    ds_read_b128 v[116:119], v17 offset:28928
    ds_read_b64_tr_b16 v[128:129], v23 offset:28928
    ds_read_b64_tr_b16 v[130:131], v23 offset:29184
    v_mfma_f32_32x32x16_bf16 v[32:47], v[140:143], v[120:123], v[32:47]
    ds_read_b64_tr_b16 v[132:133], v23 offset:29952
    ds_read_b64_tr_b16 v[134:135], v23 offset:30208
    v_mfma_f32_32x32x16_bf16 v[64:79], v[120:123], v[148:151], v[64:79]
    ds_read_b64_tr_b16 v[136:137], v23 offset:30976
    ds_read_b64_tr_b16 v[138:139], v23 offset:31232
    s_waitcnt lgkmcnt(7)
    v_mfma_f32_16x16x32_bf16 v[164:167], v[112:115], v[124:127], v[164:167]
    v_mfma_f32_4x4x4_16b_bf16 v[180:183], v[124:125], v[124:125], v[180:183]
    v_mfma_f32_4x4x4_16b_bf16 v[184:187], v[126:127], v[126:127], v[184:187]
    v_mfma_f32_32x32x16_bf16 v[48:63], v[156:159], v[124:127], v[48:63]
    ds_read_b128 v[120:123], v17 offset:28960
    ds_read_b64_tr_b16 v[140:141], v23 offset:32000
    ds_read_b64_tr_b16 v[142:143], v23 offset:32256
    v_mfma_f32_32x32x16_bf16 v[32:47], v[152:155], v[124:127], v[32:47]
    ds_read_b64_tr_b16 v[144:145], v23 offset:33024
    ds_read_b64_tr_b16 v[146:147], v23 offset:33280
    v_mfma_f32_32x32x16_bf16 v[64:79], v[124:127], v[160:163], v[64:79]
    ds_read_b64_tr_b16 v[148:149], v23 offset:34048
    ds_read_b64_tr_b16 v[150:151], v23 offset:34304
    s_waitcnt lgkmcnt(7)
    v_mfma_f32_16x16x32_bf16 v[164:167], v[112:115], v[116:119], v[164:167]
    v_mfma_f32_4x4x4_16b_bf16 v[180:183], v[116:117], v[116:117], v[180:183]
    v_mfma_f32_4x4x4_16b_bf16 v[184:187], v[118:119], v[118:119], v[184:187]
    v_mfma_f32_32x32x16_bf16 v[48:63], v[132:135], v[116:119], v[48:63]
    ds_read_b128 v[124:127], v20 offset:28928
    ds_read_b64_tr_b16 v[152:153], v23 offset:35072
    ds_read_b64_tr_b16 v[154:155], v23 offset:35328
    v_mfma_f32_32x32x16_bf16 v[32:47], v[128:131], v[116:119], v[32:47]
    ds_read_b64_tr_b16 v[156:157], v23 offset:36096
    ds_read_b64_tr_b16 v[158:159], v23 offset:36352
    v_mfma_f32_32x32x16_bf16 v[64:79], v[116:119], v[136:139], v[64:79]
    ds_read_b64_tr_b16 v[160:161], v23 offset:37120
    ds_read_b64_tr_b16 v[162:163], v23 offset:37376
    s_waitcnt lgkmcnt(7)
    v_mfma_f32_16x16x32_bf16 v[164:167], v[112:115], v[120:123], v[164:167]
    v_mfma_f32_4x4x4_16b_bf16 v[180:183], v[120:121], v[120:121], v[180:183]
    v_mfma_f32_4x4x4_16b_bf16 v[184:187], v[122:123], v[122:123], v[184:187]
    v_mfma_f32_32x32x16_bf16 v[48:63], v[144:147], v[120:123], v[48:63]
    ds_read_b128 v[116:119], v20 offset:28960
    ds_read_b64_tr_b16 v[128:129], v23 offset:38144
    ds_read_b64_tr_b16 v[130:131], v23 offset:38400
    v_mfma_f32_32x32x16_bf16 v[32:47], v[140:143], v[120:123], v[32:47]
    ds_read_b64_tr_b16 v[132:133], v23 offset:39168
    ds_read_b64_tr_b16 v[134:135], v23 offset:39424
    v_mfma_f32_32x32x16_bf16 v[64:79], v[120:123], v[148:151], v[64:79]
    ds_read_b64_tr_b16 v[136:137], v23 offset:40192
    ds_read_b64_tr_b16 v[138:139], v23 offset:40448
    s_waitcnt lgkmcnt(7)
    v_mfma_f32_16x16x32_bf16 v[164:167], v[112:115], v[124:127], v[164:167]
    v_mfma_f32_4x4x4_16b_bf16 v[180:183], v[124:125], v[124:125], v[180:183]
    v_mfma_f32_4x4x4_16b_bf16 v[184:187], v[126:127], v[126:127], v[184:187]
    v_mfma_f32_32x32x16_bf16 v[48:63], v[156:159], v[124:127], v[48:63]
    s_waitcnt lgkmcnt(0)
    s_barrier
    ds_read_b128 v[120:123], v18 offset:0
    ds_read_b64_tr_b16 v[140:141], v24 offset:0
    ds_read_b64_tr_b16 v[142:143], v24 offset:256
    v_mfma_f32_32x32x16_bf16 v[32:47], v[152:155], v[124:127], v[32:47]
    ds_read_b64_tr_b16 v[144:145], v24 offset:1024
    ds_read_b64_tr_b16 v[146:147], v24 offset:1280
    v_mfma_f32_32x32x16_bf16 v[64:79], v[124:127], v[160:163], v[64:79]
    ds_read_b64_tr_b16 v[148:149], v24 offset:2048
    ds_read_b64_tr_b16 v[150:151], v24 offset:2304
    s_waitcnt lgkmcnt(7)
    v_mfma_f32_16x16x32_bf16 v[164:167], v[112:115], v[116:119], v[164:167]
    v_mfma_f32_4x4x4_16b_bf16 v[180:183], v[116:117], v[116:117], v[180:183]
    v_mfma_f32_4x4x4_16b_bf16 v[184:187], v[118:119], v[118:119], v[184:187]
    v_mfma_f32_32x32x16_bf16 v[48:63], v[132:135], v[116:119], v[48:63]
    ds_read_b128 v[124:127], v18 offset:32
    ds_read_b64_tr_b16 v[152:153], v24 offset:3072
    ds_read_b64_tr_b16 v[154:155], v24 offset:3328
    v_mfma_f32_32x32x16_bf16 v[32:47], v[128:131], v[116:119], v[32:47]
    ds_read_b64_tr_b16 v[156:157], v24 offset:4096
    ds_read_b64_tr_b16 v[158:159], v24 offset:4352
    v_mfma_f32_32x32x16_bf16 v[64:79], v[116:119], v[136:139], v[64:79]
    ds_read_b64_tr_b16 v[160:161], v24 offset:5120
    ds_read_b64_tr_b16 v[162:163], v24 offset:5376
    s_waitcnt lgkmcnt(7)
    v_mfma_f32_16x16x32_bf16 v[164:167], v[112:115], v[120:123], v[164:167]
    v_mfma_f32_4x4x4_16b_bf16 v[180:183], v[120:121], v[120:121], v[180:183]
    v_mfma_f32_4x4x4_16b_bf16 v[184:187], v[122:123], v[122:123], v[184:187]
    v_mfma_f32_32x32x16_bf16 v[48:63], v[144:147], v[120:123], v[48:63]
    ds_read_b128 v[116:119], v21 offset:0
    ds_read_b64_tr_b16 v[128:129], v24 offset:6144
    ds_read_b64_tr_b16 v[130:131], v24 offset:6400
    v_mfma_f32_32x32x16_bf16 v[32:47], v[140:143], v[120:123], v[32:47]
    ds_read_b64_tr_b16 v[132:133], v24 offset:7168
    ds_read_b64_tr_b16 v[134:135], v24 offset:7424
    v_mfma_f32_32x32x16_bf16 v[64:79], v[120:123], v[148:151], v[64:79]
    ds_read_b64_tr_b16 v[136:137], v24 offset:8192
    ds_read_b64_tr_b16 v[138:139], v24 offset:8448
    s_waitcnt lgkmcnt(7)
    v_mfma_f32_16x16x32_bf16 v[164:167], v[112:115], v[124:127], v[164:167]
    v_mfma_f32_4x4x4_16b_bf16 v[180:183], v[124:125], v[124:125], v[180:183]
    v_mfma_f32_4x4x4_16b_bf16 v[184:187], v[126:127], v[126:127], v[184:187]
    v_mfma_f32_32x32x16_bf16 v[48:63], v[156:159], v[124:127], v[48:63]
    ds_read_b128 v[120:123], v21 offset:32
    ds_read_b64_tr_b16 v[140:141], v24 offset:9216
    ds_read_b64_tr_b16 v[142:143], v24 offset:9472
    v_mfma_f32_32x32x16_bf16 v[32:47], v[152:155], v[124:127], v[32:47]
    ds_read_b64_tr_b16 v[144:145], v24 offset:10240
    ds_read_b64_tr_b16 v[146:147], v24 offset:10496
    v_mfma_f32_32x32x16_bf16 v[64:79], v[124:127], v[160:163], v[64:79]
    ds_read_b64_tr_b16 v[148:149], v24 offset:11264
    ds_read_b64_tr_b16 v[150:151], v24 offset:11520
    s_waitcnt lgkmcnt(7)
    v_mfma_f32_16x16x32_bf16 v[164:167], v[112:115], v[116:119], v[164:167]
    v_mfma_f32_4x4x4_16b_bf16 v[180:183], v[116:117], v[116:117], v[180:183]
    v_mfma_f32_4x4x4_16b_bf16 v[184:187], v[118:119], v[118:119], v[184:187]
    v_mfma_f32_32x32x16_bf16 v[48:63], v[132:135], v[116:119], v[48:63]
    s_barrier
    ds_read_b128 v[124:127], v16 offset:0
    ds_read_b64_tr_b16 v[152:153], v22 offset:0
    ds_read_b64_tr_b16 v[154:155], v22 offset:256
    v_mfma_f32_32x32x16_bf16 v[32:47], v[128:131], v[116:119], v[32:47]
    ds_read_b64_tr_b16 v[156:157], v22 offset:1024
    ds_read_b64_tr_b16 v[158:159], v22 offset:1280
    v_mfma_f32_32x32x16_bf16 v[64:79], v[116:119], v[136:139], v[64:79]
    ds_read_b64_tr_b16 v[160:161], v22 offset:2048
    ds_read_b64_tr_b16 v[162:163], v22 offset:2304
    s_waitcnt lgkmcnt(7)
    v_mfma_f32_16x16x32_bf16 v[164:167], v[112:115], v[120:123], v[164:167]
    v_mfma_f32_4x4x4_16b_bf16 v[180:183], v[120:121], v[120:121], v[180:183]
    v_mfma_f32_4x4x4_16b_bf16 v[184:187], v[122:123], v[122:123], v[184:187]
    v_mfma_f32_32x32x16_bf16 v[48:63], v[144:147], v[120:123], v[48:63]
    ds_read_b128 v[116:119], v16 offset:32
    ds_read_b64_tr_b16 v[128:129], v22 offset:3072
    ds_read_b64_tr_b16 v[130:131], v22 offset:3328
    v_mfma_f32_32x32x16_bf16 v[32:47], v[140:143], v[120:123], v[32:47]
    ds_read_b64_tr_b16 v[132:133], v22 offset:4096
    ds_read_b64_tr_b16 v[134:135], v22 offset:4352
    v_mfma_f32_32x32x16_bf16 v[64:79], v[120:123], v[148:151], v[64:79]
    ds_read_b64_tr_b16 v[136:137], v22 offset:5120
    ds_read_b64_tr_b16 v[138:139], v22 offset:5376
    s_waitcnt lgkmcnt(7)
    v_mfma_f32_16x16x32_bf16 v[164:167], v[112:115], v[124:127], v[164:167]
    v_mfma_f32_4x4x4_16b_bf16 v[180:183], v[124:125], v[124:125], v[180:183]
    v_mfma_f32_4x4x4_16b_bf16 v[184:187], v[126:127], v[126:127], v[184:187]
    v_mfma_f32_32x32x16_bf16 v[48:63], v[156:159], v[124:127], v[48:63]
    ds_read_b128 v[120:123], v19 offset:0
    ds_read_b64_tr_b16 v[140:141], v22 offset:6144
    ds_read_b64_tr_b16 v[142:143], v22 offset:6400
    v_mfma_f32_32x32x16_bf16 v[32:47], v[152:155], v[124:127], v[32:47]
    ds_read_b64_tr_b16 v[144:145], v22 offset:7168
    ds_read_b64_tr_b16 v[146:147], v22 offset:7424
    v_mfma_f32_32x32x16_bf16 v[64:79], v[124:127], v[160:163], v[64:79]
    ds_read_b64_tr_b16 v[148:149], v22 offset:8192
    ds_read_b64_tr_b16 v[150:151], v22 offset:8448
    s_waitcnt lgkmcnt(7)
    v_mfma_f32_16x16x32_bf16 v[164:167], v[112:115], v[116:119], v[164:167]
    v_mfma_f32_4x4x4_16b_bf16 v[180:183], v[116:117], v[116:117], v[180:183]
    v_mfma_f32_4x4x4_16b_bf16 v[184:187], v[118:119], v[118:119], v[184:187]
    v_mfma_f32_32x32x16_bf16 v[48:63], v[132:135], v[116:119], v[48:63]
    ds_read_b128 v[124:127], v19 offset:32
    ds_read_b64_tr_b16 v[152:153], v22 offset:9216
    ds_read_b64_tr_b16 v[154:155], v22 offset:9472
    v_mfma_f32_32x32x16_bf16 v[32:47], v[128:131], v[116:119], v[32:47]
    ds_read_b64_tr_b16 v[156:157], v22 offset:10240
    ds_read_b64_tr_b16 v[158:159], v22 offset:10496
    v_mfma_f32_32x32x16_bf16 v[64:79], v[116:119], v[136:139], v[64:79]
    ds_read_b64_tr_b16 v[160:161], v22 offset:11264
    ds_read_b64_tr_b16 v[162:163], v22 offset:11520
    s_waitcnt lgkmcnt(7)
    v_mfma_f32_16x16x32_bf16 v[164:167], v[112:115], v[120:123], v[164:167]
    v_mfma_f32_4x4x4_16b_bf16 v[180:183], v[120:121], v[120:121], v[180:183]
    v_mfma_f32_4x4x4_16b_bf16 v[184:187], v[122:123], v[122:123], v[184:187]
    v_mfma_f32_32x32x16_bf16 v[48:63], v[144:147], v[120:123], v[48:63]
    s_barrier
    ds_read_b128 v[116:119], v16 offset:28928
    ds_read_b64_tr_b16 v[128:129], v22 offset:28928
    ds_read_b64_tr_b16 v[130:131], v22 offset:29184
    v_mfma_f32_32x32x16_bf16 v[32:47], v[140:143], v[120:123], v[32:47]
    ds_read_b64_tr_b16 v[132:133], v22 offset:29952
    ds_read_b64_tr_b16 v[134:135], v22 offset:30208
    v_mfma_f32_32x32x16_bf16 v[64:79], v[120:123], v[148:151], v[64:79]
    ds_read_b64_tr_b16 v[136:137], v22 offset:30976
    ds_read_b64_tr_b16 v[138:139], v22 offset:31232
    s_waitcnt lgkmcnt(7)
    v_mfma_f32_16x16x32_bf16 v[164:167], v[112:115], v[124:127], v[164:167]
    v_mfma_f32_4x4x4_16b_bf16 v[180:183], v[124:125], v[124:125], v[180:183]
    v_mfma_f32_4x4x4_16b_bf16 v[184:187], v[126:127], v[126:127], v[184:187]
    v_mfma_f32_32x32x16_bf16 v[48:63], v[156:159], v[124:127], v[48:63]
    ds_read_b128 v[120:123], v16 offset:28960
    ds_read_b64_tr_b16 v[140:141], v22 offset:32000
    ds_read_b64_tr_b16 v[142:143], v22 offset:32256
    v_mfma_f32_32x32x16_bf16 v[32:47], v[152:155], v[124:127], v[32:47]
    ds_read_b64_tr_b16 v[144:145], v22 offset:33024
    ds_read_b64_tr_b16 v[146:147], v22 offset:33280
    v_mfma_f32_32x32x16_bf16 v[64:79], v[124:127], v[160:163], v[64:79]
    ds_read_b64_tr_b16 v[148:149], v22 offset:34048
    ds_read_b64_tr_b16 v[150:151], v22 offset:34304
    s_waitcnt lgkmcnt(7)
    v_mfma_f32_16x16x32_bf16 v[164:167], v[112:115], v[116:119], v[164:167]
    v_mfma_f32_4x4x4_16b_bf16 v[180:183], v[116:117], v[116:117], v[180:183]
    v_mfma_f32_4x4x4_16b_bf16 v[184:187], v[118:119], v[118:119], v[184:187]
    v_mfma_f32_32x32x16_bf16 v[48:63], v[132:135], v[116:119], v[48:63]
    ds_read_b128 v[124:127], v19 offset:28928
    ds_read_b64_tr_b16 v[152:153], v22 offset:35072
    ds_read_b64_tr_b16 v[154:155], v22 offset:35328
    v_mfma_f32_32x32x16_bf16 v[32:47], v[128:131], v[116:119], v[32:47]
    ds_read_b64_tr_b16 v[156:157], v22 offset:36096
    ds_read_b64_tr_b16 v[158:159], v22 offset:36352
    v_mfma_f32_32x32x16_bf16 v[64:79], v[116:119], v[136:139], v[64:79]
    ds_read_b64_tr_b16 v[160:161], v22 offset:37120
    ds_read_b64_tr_b16 v[162:163], v22 offset:37376
    s_waitcnt lgkmcnt(7)
    v_mfma_f32_16x16x32_bf16 v[164:167], v[112:115], v[120:123], v[164:167]
    v_mfma_f32_4x4x4_16b_bf16 v[180:183], v[120:121], v[120:121], v[180:183]
    v_mfma_f32_4x4x4_16b_bf16 v[184:187], v[122:123], v[122:123], v[184:187]
    v_mfma_f32_32x32x16_bf16 v[48:63], v[144:147], v[120:123], v[48:63]
    ds_read_b128 v[116:119], v19 offset:28960
    ds_read_b64_tr_b16 v[128:129], v22 offset:38144
    ds_read_b64_tr_b16 v[130:131], v22 offset:38400
    v_mfma_f32_32x32x16_bf16 v[32:47], v[140:143], v[120:123], v[32:47]
    ds_read_b64_tr_b16 v[132:133], v22 offset:39168
    ds_read_b64_tr_b16 v[134:135], v22 offset:39424
    v_mfma_f32_32x32x16_bf16 v[64:79], v[120:123], v[148:151], v[64:79]
    ds_read_b64_tr_b16 v[136:137], v22 offset:40192
    ds_read_b64_tr_b16 v[138:139], v22 offset:40448
    s_waitcnt lgkmcnt(7)
    v_mfma_f32_16x16x32_bf16 v[164:167], v[112:115], v[124:127], v[164:167]
    v_mfma_f32_4x4x4_16b_bf16 v[180:183], v[124:125], v[124:125], v[180:183]
    v_mfma_f32_4x4x4_16b_bf16 v[184:187], v[126:127], v[126:127], v[184:187]
    v_mfma_f32_32x32x16_bf16 v[48:63], v[156:159], v[124:127], v[48:63]
    s_barrier
    ds_read_b128 v[120:123], v17 offset:0
    ds_read_b64_tr_b16 v[140:141], v23 offset:0
    ds_read_b64_tr_b16 v[142:143], v23 offset:256
    v_mfma_f32_32x32x16_bf16 v[32:47], v[152:155], v[124:127], v[32:47]
    ds_read_b64_tr_b16 v[144:145], v23 offset:1024
    ds_read_b64_tr_b16 v[146:147], v23 offset:1280
    v_mfma_f32_32x32x16_bf16 v[64:79], v[124:127], v[160:163], v[64:79]
    ds_read_b64_tr_b16 v[148:149], v23 offset:2048
    ds_read_b64_tr_b16 v[150:151], v23 offset:2304
    s_waitcnt lgkmcnt(7)
    v_mfma_f32_16x16x32_bf16 v[164:167], v[112:115], v[116:119], v[164:167]
    v_mfma_f32_4x4x4_16b_bf16 v[180:183], v[116:117], v[116:117], v[180:183]
    v_mfma_f32_4x4x4_16b_bf16 v[184:187], v[118:119], v[118:119], v[184:187]
    v_mfma_f32_32x32x16_bf16 v[48:63], v[132:135], v[116:119], v[48:63]
    ds_read_b128 v[124:127], v17 offset:32
    ds_read_b64_tr_b16 v[152:153], v23 offset:3072
    ds_read_b64_tr_b16 v[154:155], v23 offset:3328
    v_mfma_f32_32x32x16_bf16 v[32:47], v[128:131], v[116:119], v[32:47]
    ds_read_b64_tr_b16 v[156:157], v23 offset:4096
    ds_read_b64_tr_b16 v[158:159], v23 offset:4352
    v_mfma_f32_32x32x16_bf16 v[64:79], v[116:119], v[136:139], v[64:79]
    ds_read_b64_tr_b16 v[160:161], v23 offset:5120
    ds_read_b64_tr_b16 v[162:163], v23 offset:5376
    buffer_store_dwordx4 v[192:195], v12, s[4:7], s25 offen sc1
    s_waitcnt lgkmcnt(7)
    v_mfma_f32_16x16x32_bf16 v[164:167], v[112:115], v[120:123], v[164:167]
    v_mfma_f32_4x4x4_16b_bf16 v[180:183], v[120:121], v[120:121], v[180:183]
    v_mfma_f32_4x4x4_16b_bf16 v[184:187], v[122:123], v[122:123], v[184:187]
    v_mfma_f32_32x32x16_bf16 v[48:63], v[144:147], v[120:123], v[48:63]
    ds_read_b128 v[116:119], v20 offset:0
    ds_read_b64_tr_b16 v[128:129], v23 offset:6144
    ds_read_b64_tr_b16 v[130:131], v23 offset:6400
    v_mfma_f32_32x32x16_bf16 v[32:47], v[140:143], v[120:123], v[32:47]
    ds_read_b64_tr_b16 v[132:133], v23 offset:7168
    ds_read_b64_tr_b16 v[134:135], v23 offset:7424
    v_mfma_f32_32x32x16_bf16 v[64:79], v[120:123], v[148:151], v[64:79]
    ds_read_b64_tr_b16 v[136:137], v23 offset:8192
    ds_read_b64_tr_b16 v[138:139], v23 offset:8448
    s_waitcnt lgkmcnt(7)
    v_mfma_f32_16x16x32_bf16 v[164:167], v[112:115], v[124:127], v[164:167]
    v_mfma_f32_4x4x4_16b_bf16 v[180:183], v[124:125], v[124:125], v[180:183]
    v_mfma_f32_4x4x4_16b_bf16 v[184:187], v[126:127], v[126:127], v[184:187]
    v_mfma_f32_32x32x16_bf16 v[48:63], v[156:159], v[124:127], v[48:63]
    ds_read_b128 v[120:123], v20 offset:32
    ds_read_b64_tr_b16 v[140:141], v23 offset:9216
    ds_read_b64_tr_b16 v[142:143], v23 offset:9472
    s_barrier
    ds_read_b128 v[168:171], v29 offset:0
    ds_read_b128 v[172:175], v29 offset:512
    ds_read_b128 v[176:179], v29 offset:1024
    v_mfma_f32_32x32x16_bf16 v[32:47], v[152:155], v[124:127], v[32:47]
    ds_read_b64_tr_b16 v[144:145], v23 offset:10240
    ds_read_b64_tr_b16 v[146:147], v23 offset:10496
    v_mfma_f32_32x32x16_bf16 v[64:79], v[124:127], v[160:163], v[64:79]
    ds_read_b64_tr_b16 v[148:149], v23 offset:11264
    ds_read_b64_tr_b16 v[150:151], v23 offset:11520
    s_waitcnt lgkmcnt(10)
    v_mfma_f32_16x16x32_bf16 v[164:167], v[112:115], v[116:119], v[164:167]
    v_mfma_f32_4x4x4_16b_bf16 v[180:183], v[116:117], v[116:117], v[180:183]
    v_mfma_f32_4x4x4_16b_bf16 v[184:187], v[118:119], v[118:119], v[184:187]
    v_mfma_f32_32x32x16_bf16 v[48:63], v[132:135], v[116:119], v[48:63]
    s_waitcnt lgkmcnt(4)
    v_add_f32 v168, v168, v169
    v_add_f32 v170, v170, v171
    v_add_f32 v172, v172, v173
    v_add_f32 v174, v174, v175
    v_mfma_f32_32x32x16_bf16 v[32:47], v[128:131], v[116:119], v[32:47]
    v_add_f32 v168, v168, v170
    v_add_f32 v172, v172, v174
    v_add_f32 v176, v176, v177
    v_add_f32 v178, v178, v179
    v_mfma_f32_32x32x16_bf16 v[64:79], v[116:119], v[136:139], v[64:79]
    ds_write_b32 v30, v168 offset:0
    ds_write_b32 v30, v172 offset:128
    v_add_f32 v188, v176, v178
    s_waitcnt lgkmcnt(2)
    v_mfma_f32_16x16x32_bf16 v[164:167], v[112:115], v[120:123], v[164:167]
    v_mfma_f32_4x4x4_16b_bf16 v[180:183], v[120:121], v[120:121], v[180:183]
    v_mfma_f32_4x4x4_16b_bf16 v[184:187], v[122:123], v[122:123], v[184:187]
    v_mfma_f32_32x32x16_bf16 v[48:63], v[144:147], v[120:123], v[48:63]
    ds_read_b128 v[96:99], v31 offset:128
    ds_read_b128 v[100:103], v31 offset:160
    ds_read_b128 v[104:107], v31 offset:192
    ds_read_b128 v[108:111], v31 offset:224
    v_mfma_f32_32x32x16_bf16 v[32:47], v[140:143], v[120:123], v[32:47]
    ds_read_b128 v[80:83], v31 offset:0
    ds_read_b128 v[84:87], v31 offset:32
    ds_read_b128 v[88:91], v31 offset:64
    ds_read_b128 v[92:95], v31 offset:96
    v_add_f32 v180, v180, v184
    v_add_f32 v181, v181, v185
    v_add_f32 v182, v182, v186
    v_add_f32 v183, v183, v187
    v_cndmask_b32 v180, v180, v181, s[40:41]
    v_cndmask_b32 v180, v180, v182, s[42:43]
    v_cndmask_b32 v180, v180, v183, s[44:45]
    v_mov_b32 v25, v180
    s_nop 1
    v_permlane32_swap_b32 v180, v25
    v_add_f32 v180, v180, v25
    v_mfma_f32_32x32x16_bf16 v[64:79], v[120:123], v[148:151], v[64:79]
    v_mul_f32 v16, 0x3b000000, v164
    v_mul_f32 v180, 0x3b000000, v180
    v_fma_f32 v180, -v16, v16, v180
    v_max_f32 v180, 0, v180
    v_add_f32 v25, 0x3727c5ac, v180
    v_rsq_f32 v18, v25
    s_waitcnt lgkmcnt(0)
    ds_write_b32 v30, v16
    ds_write_b32 v30, v18 offset:128
    v_mul_f32 v20, s69, v18
    ds_read_b128 v[128:131], v31 offset:0
    ds_read_b128 v[144:147], v31 offset:128
    ds_read_b128 v[132:135], v31 offset:32
    ds_read_b128 v[148:151], v31 offset:160
    ds_read_b128 v[136:139], v31 offset:64
    ds_read_b128 v[152:155], v31 offset:192
    ds_read_b128 v[140:143], v31 offset:96
    ds_read_b128 v[156:159], v31 offset:224
    v_pk_fma_f32 v[48:49], v[16:17], v[96:97], v[48:49] op_sel_hi:[0,1,1] neg_lo:[1,0,0] neg_hi:[1,0,0]
    v_pk_fma_f32 v[50:51], v[16:17], v[98:99], v[50:51] op_sel_hi:[0,1,1] neg_lo:[1,0,0] neg_hi:[1,0,0]
    v_pk_fma_f32 v[52:53], v[16:17], v[100:101], v[52:53] op_sel_hi:[0,1,1] neg_lo:[1,0,0] neg_hi:[1,0,0]
    v_pk_fma_f32 v[54:55], v[16:17], v[102:103], v[54:55] op_sel_hi:[0,1,1] neg_lo:[1,0,0] neg_hi:[1,0,0]
    v_pk_mul_f32 v[48:49], v[20:21], v[48:49] op_sel_hi:[0,1]
    v_pk_mul_f32 v[50:51], v[20:21], v[50:51] op_sel_hi:[0,1]
    v_pk_mul_f32 v[52:53], v[20:21], v[52:53] op_sel_hi:[0,1]
    v_pk_mul_f32 v[54:55], v[20:21], v[54:55] op_sel_hi:[0,1]
    v_cvt_pk_bf16_f32 v172, v48, v49
    v_cvt_pk_bf16_f32 v173, v50, v51
    v_cvt_pk_bf16_f32 v174, v52, v53
    v_cvt_pk_bf16_f32 v175, v54, v55
    buffer_store_dwordx4 v[172:175], v3, s[4:7], s66 offen sc1
    v_pk_fma_f32 v[56:57], v[16:17], v[104:105], v[56:57] op_sel_hi:[0,1,1] neg_lo:[1,0,0] neg_hi:[1,0,0]
    v_pk_fma_f32 v[58:59], v[16:17], v[106:107], v[58:59] op_sel_hi:[0,1,1] neg_lo:[1,0,0] neg_hi:[1,0,0]
    v_pk_fma_f32 v[60:61], v[16:17], v[108:109], v[60:61] op_sel_hi:[0,1,1] neg_lo:[1,0,0] neg_hi:[1,0,0]
    v_pk_fma_f32 v[62:63], v[16:17], v[110:111], v[62:63] op_sel_hi:[0,1,1] neg_lo:[1,0,0] neg_hi:[1,0,0]
    v_pk_mul_f32 v[56:57], v[20:21], v[56:57] op_sel_hi:[0,1]
    v_pk_mul_f32 v[58:59], v[20:21], v[58:59] op_sel_hi:[0,1]
    v_pk_mul_f32 v[60:61], v[20:21], v[60:61] op_sel_hi:[0,1]
    v_pk_mul_f32 v[62:63], v[20:21], v[62:63] op_sel_hi:[0,1]
    v_cvt_pk_bf16_f32 v176, v56, v57
    v_cvt_pk_bf16_f32 v177, v58, v59
    v_cvt_pk_bf16_f32 v178, v60, v61
    v_cvt_pk_bf16_f32 v179, v62, v63
    buffer_store_dwordx4 v[176:179], v3, s[4:7], s67 offen sc1
    s_waitcnt lgkmcnt(0)
    v_pk_fma_f32 v[64:65], v[128:129], v[188:189], v[64:65] op_sel_hi:[1,0,1] neg_lo:[1,0,0] neg_hi:[1,0,0]
    v_pk_fma_f32 v[66:67], v[130:131], v[188:189], v[66:67] op_sel_hi:[1,0,1] neg_lo:[1,0,0] neg_hi:[1,0,0]
    v_pk_fma_f32 v[68:69], v[132:133], v[188:189], v[68:69] op_sel_hi:[1,0,1] neg_lo:[1,0,0] neg_hi:[1,0,0]
    v_pk_fma_f32 v[70:71], v[134:135], v[188:189], v[70:71] op_sel_hi:[1,0,1] neg_lo:[1,0,0] neg_hi:[1,0,0]
    v_pk_mul_f32 v[64:65], v[144:145], v[64:65]
    v_pk_mul_f32 v[66:67], v[146:147], v[66:67]
    v_pk_mul_f32 v[68:69], v[148:149], v[68:69]
    v_pk_mul_f32 v[70:71], v[150:151], v[70:71]
L_hop_qkv_kernel_2:
    s_cbranch_execz L_hopb_qkv_kernel
    v_cvt_pk_bf16_f32 v180, v64, v65
    v_cvt_pk_bf16_f32 v181, v66, v67
    v_cvt_pk_bf16_f32 v182, v68, v69
    v_cvt_pk_bf16_f32 v183, v70, v71
    buffer_store_dwordx4 v[180:183], v26, s[4:7], s68 offen offset:1024 sc1
    v_pk_fma_f32 v[72:73], v[136:137], v[188:189], v[72:73] op_sel_hi:[1,0,1] neg_lo:[1,0,0] neg_hi:[1,0,0]
    v_pk_fma_f32 v[74:75], v[138:139], v[188:189], v[74:75] op_sel_hi:[1,0,1] neg_lo:[1,0,0] neg_hi:[1,0,0]
    v_pk_fma_f32 v[76:77], v[140:141], v[188:189], v[76:77] op_sel_hi:[1,0,1] neg_lo:[1,0,0] neg_hi:[1,0,0]
    v_pk_fma_f32 v[78:79], v[142:143], v[188:189], v[78:79] op_sel_hi:[1,0,1] neg_lo:[1,0,0] neg_hi:[1,0,0]
    v_pk_mul_f32 v[72:73], v[152:153], v[72:73]
    v_pk_mul_f32 v[74:75], v[154:155], v[74:75]
    v_pk_mul_f32 v[76:77], v[156:157], v[76:77]
    v_pk_mul_f32 v[78:79], v[158:159], v[78:79]
    v_cvt_pk_bf16_f32 v184, v72, v73
    v_cvt_pk_bf16_f32 v185, v74, v75
    v_cvt_pk_bf16_f32 v186, v76, v77
    v_cvt_pk_bf16_f32 v187, v78, v79
    buffer_store_dwordx4 v[184:187], v26, s[4:7], s68 offen offset:1536 sc1
    v_pk_fma_f32 v[32:33], v[16:17], v[80:81], v[32:33] op_sel_hi:[0,1,1] neg_lo:[1,0,0] neg_hi:[1,0,0]
    v_pk_fma_f32 v[34:35], v[16:17], v[82:83], v[34:35] op_sel_hi:[0,1,1] neg_lo:[1,0,0] neg_hi:[1,0,0]
    v_pk_fma_f32 v[36:37], v[16:17], v[84:85], v[36:37] op_sel_hi:[0,1,1] neg_lo:[1,0,0] neg_hi:[1,0,0]
    v_pk_fma_f32 v[38:39], v[16:17], v[86:87], v[38:39] op_sel_hi:[0,1,1] neg_lo:[1,0,0] neg_hi:[1,0,0]
    v_pk_mul_f32 v[32:33], v[20:21], v[32:33] op_sel_hi:[0,1]
    v_pk_mul_f32 v[34:35], v[20:21], v[34:35] op_sel_hi:[0,1]
    v_pk_mul_f32 v[36:37], v[20:21], v[36:37] op_sel_hi:[0,1]
    v_pk_mul_f32 v[38:39], v[20:21], v[38:39] op_sel_hi:[0,1]
    v_cvt_pk_bf16_f32 v164, v32, v33
    v_cvt_pk_bf16_f32 v165, v34, v35
    v_cvt_pk_bf16_f32 v166, v36, v37
    v_cvt_pk_bf16_f32 v167, v38, v39
    buffer_store_dwordx4 v[164:167], v3, s[4:7], s31 offen sc1
    v_pk_fma_f32 v[40:41], v[16:17], v[88:89], v[40:41] op_sel_hi:[0,1,1] neg_lo:[1,0,0] neg_hi:[1,0,0]
    v_pk_fma_f32 v[42:43], v[16:17], v[90:91], v[42:43] op_sel_hi:[0,1,1] neg_lo:[1,0,0] neg_hi:[1,0,0]
    v_pk_fma_f32 v[44:45], v[16:17], v[92:93], v[44:45] op_sel_hi:[0,1,1] neg_lo:[1,0,0] neg_hi:[1,0,0]
    v_pk_fma_f32 v[46:47], v[16:17], v[94:95], v[46:47] op_sel_hi:[0,1,1] neg_lo:[1,0,0] neg_hi:[1,0,0]
    v_pk_mul_f32 v[40:41], v[20:21], v[40:41] op_sel_hi:[0,1]
    v_pk_mul_f32 v[42:43], v[20:21], v[42:43] op_sel_hi:[0,1]
    v_pk_mul_f32 v[44:45], v[20:21], v[44:45] op_sel_hi:[0,1]
    v_pk_mul_f32 v[46:47], v[20:21], v[46:47] op_sel_hi:[0,1]
    v_cvt_pk_bf16_f32 v168, v40, v41
    v_cvt_pk_bf16_f32 v169, v42, v43
    v_cvt_pk_bf16_f32 v170, v44, v45
    v_cvt_pk_bf16_f32 v171, v46, v47
    buffer_store_dwordx4 v[168:171], v3, s[4:7], s65 offen sc1
L_k1_done:
    s_endpgm
L_hop_qkv_kernel_3:
L_hop_qkv_kernel_4:
L_hopb_qkv_kernel:
    s_setpc_b64 s[20:21]
L_k1_end:
.p2align 12
.globl main_kernel
.p2align 8
.type main_kernel,@function
main_kernel:
L_code_begin:
L_hop_main_kernel_0:
    s_cbranch_execz L_hop_main_kernel_4
    s_cmp_ge_u32 s2, 256
    s_cbranch_scc1 L_k2_done
    s_load_dwordx2 s[4:5], s[0:1], 80
    s_load_dwordx2 s[8:9], s[0:1], 0
    s_load_dwordx2 s[12:13], s[0:1], 64
    s_mov_b32 s6, 0x2000000
    s_mov_b32 s7, 0x00020000
    s_mov_b32 s10, 0x200000
    s_mov_b32 s11, 0x00020000
    s_mov_b32 s14, 0x200000
    s_mov_b32 s15, 0x00020000
    v_lshrrev_b32 v2, 6, v0
    v_and_b32 v1, 63, v0
    s_and_b32 s16, s2, 7
    s_lshr_b32 s17, s2, 3
    v_readfirstlane_b32 s18, v2
    v_lshlrev_b32 v3, 4, v1
    v_add_u32 v4, 0x1000, v3
    v_add_u32 v5, 0x2000, v3
    v_add_u32 v6, 0x3000, v3
    s_lshl_b32 s22, s17, 16
    s_lshl_b32 s19, s16, 13
    s_add_u32 s22, s22, s19
    s_lshl_b32 s19, s18, 11
    s_add_u32 s22, s22, s19
    s_lshl_b32 s23, s17, 17
    s_add_u32 s23, s23, s19
    s_add_u32 s23, s23, 0x200000
    s_mul_i32 s24, s18, 2064
    s_add_u32 s24, s24, 0x20000
    s_mov_b32 m0, s24
    s_waitcnt lgkmcnt(0)
    buffer_load_dwordx4 v3, s[4:7], s23 offen lds
    buffer_load_dwordx4 v[16:19], v3, s[4:7], s22 offen
    buffer_load_dwordx4 v[20:23], v3, s[4:7], s22 offen offset:1024
    buffer_load_dwordx4 v3, s[4:7], s23 offen offset:1024 lds
    s_add_u32 m0, s24, 8256
    s_nop 0
    buffer_load_dwordx4 v5, s[4:7], s23 offen offset:0 lds
    buffer_load_dwordx4 v5, s[4:7], s23 offen offset:1024 lds
    s_add_u32 m0, s24, 16512
    s_add_u32 s23, s23, 16384
    buffer_load_dwordx4 v3, s[4:7], s23 offen offset:0 lds
    buffer_load_dwordx4 v3, s[4:7], s23 offen offset:1024 lds
    s_lshr_b32 s3, s17, 3
    s_and_b32 s25, s17, 7
    s_lshl_b32 s26, s16, 4
    s_lshl_b32 s19, s3, 2
    s_add_u32 s26, s26, s19
    s_add_u32 s27, s26, s18
    s_lshl_b32 s28, s25, 2
    s_add_u32 s28, s28, s18
    s_lshl_b32 s29, s18, 14
    s_lshl_b32 s30, s27, 14
    s_mov_b32 s31, 0x3f803f80
    s_mov_b32 s32, -2
    s_mov_b32 s33, 0
    s_getreg_b32 s34, hwreg(HW_REG_XCC_ID, 0, 4)
    v_accvgpr_write_b32 a168, -1
    v_accvgpr_write_b32 a169, -1
    v_accvgpr_write_b32 a170, -1
    v_accvgpr_write_b32 a171, -1
    v_and_b32 v10, 31, v1
    v_lshrrev_b32 v11, 5, v1
    v_and_b32 v12, 15, v1
    v_lshrrev_b32 v13, 4, v1
    s_lshl_b32 s35, s16, 12
    s_add_u32 s35, s35, 0x1900000
    s_lshl_b32 s19, s17, 7
    s_add_u32 s19, s19, s35
    v_sub_u32 v14, 0, v0
    v_and_b32 v14, 0x80000000, v14
    v_mov_b32 v15, s34
    v_add_u32 v141, s19, v14
    v_mov_b32 v142, s34
    s_lshl_b32 s19, s16, 5
    s_add_u32 s19, s19, s17
    s_lshl_b32 s19, s19, 2
    s_add_u32 s19, s19, s18
    s_lshl_b32 s19, s19, 11
    s_add_u32 s19, s19, 0x600000
    v_add_u32 v143, s19, v3
    s_mul_i32 s37, s16, 0x180000
    s_add_u32 s37, s37, 0x800000
    s_lshl_b32 s19, s17, 2
    s_add_u32 s19, s19, s18
    s_mul_i32 s19, s19, 12288
    s_add_u32 s36, s37, s19
    v_lshlrev_b32 v132, 10, v12
    v_lshl_add_u32 v132, v13, 4, v132
    s_lshl_b32 s38, s25, 7
    s_add_u32 s38, s38, s30
    s_and_b32 s19, s27, 15
    s_lshl_b32 s19, s19, 10
    s_add_u32 s41, s37, s19
    s_add_u32 s41, s41, 0xc0000
    s_add_u32 s42, s41, 0x4000
    s_lshl_b32 s22, s25, 16
    s_add_u32 s43, s22, s29
    s_add_u32 s44, s43, 0x1480000
    s_add_u32 s43, s43, 0x1400000
    s_mul_i32 s20, s18, 6144
    s_mul_i32 s45, s18, 10240
    s_add_u32 s45, s45, 24576
    s_add_u32 s22, s22, 0x1500000
    s_add_u32 s39, s22, s20
    s_add_u32 s40, s22, s45
    s_cmp_ge_u32 s18, 3
    s_cselect_b32 s19, 26832, 0
    s_sub_u32 s46, s24, s19
    s_add_u32 s46, s46, 20640
    s_cmp_ge_u32 s18, 2
    s_cselect_b32 s19, 26832, 0
    s_sub_u32 s47, s24, s19
    s_add_u32 s47, s47, 22704
    s_cmp_ge_u32 s18, 1
    s_cselect_b32 s19, 26832, 0
    s_sub_u32 s48, s24, s19
    s_add_u32 s48, s48, 24768
    s_lshl_b32 s49, s28, 15
    s_add_u32 s49, s49, 0x1580000
    s_add_u32 s50, s49, 16384
    s_add_u32 s51, s28, 64
    s_min_u32 s51, s51, 85
    s_lshl_b32 s51, s51, 14
    s_add_u32 s51, s51, 0x1580000
    s_mul_i32 s52, s25, 43
    s_mul_i32 s19, s18, 11
    s_add_u32 s52, s52, s19
    s_lshl_b32 s52, s52, 12
    s_add_u32 s52, s52, 0x1700000
    s_add_u32 s53, s52, 16384
    s_add_u32 s54, s52, 32768
    s_lshl_b32 s55, s16, 18
    s_lshl_b32 s19, s18, 16
    s_add_u32 s55, s55, s19
    s_lshl_b32 s19, s17, 9
    s_add_u32 s55, s55, s19
    s_add_u32 s55, s55, 0x600000
    s_add_u32 s56, s55, 0x8000
    s_add_u32 s57, s30, 0x600000
    s_and_b32 s30, s30, 0x3ffff
    s_add_u32 s30, s30, s37
    s_add_u32 s58, s30, 0x40000
    s_add_u32 s62, s30, 0x80000
    s_sub_u32 s60, s30, 0x4000
    s_lshl_b32 s19, s25, 11
    s_add_u32 s59, s58, s19
    s_add_u32 s63, s62, s19
    s_sub_u32 s61, s59, 0x44000
    s_add_u32 s68, s57, s19
    v_lshlrev_b32 v134, 5, v1
    s_lshl_b32 s22, s16, 15
    s_add_u32 s66, s22, s19
    s_add_u32 s66, s66, 0x18c0000
    s_sub_u32 s22, s22, s30
    s_add_u32 s22, s22, 0x18c4000
    s_add_u32 s64, s22, 0xffffc000
    s_add_u32 s65, s22, 32768
    s_cmp_eq_u32 s16, 0
    s_cselect_b32 s64, 0x80000000, s64
    s_cmp_eq_u32 s16, 7
    s_cselect_b32 s65, 0x80000000, s65
    s_and_b32 s19, s27, 15
    s_cmp_eq_u32 s19, 0
    s_cselect_b32 s64, s64, 16384
    s_cmp_eq_u32 s19, 15
    s_cselect_b32 s65, s65, 16384
    s_cselect_b32 s22, 16384, 0
    s_add_u32 s66, s66, s22
    s_lshr_b32 s69, s25, 2
    s_add_u32 s69, s69, 1
    s_sub_u32 s22, 0, s69
    s_mov_b32 s70, 256
    s_bitcmp1_b32 s25, 1
    s_cselect_b32 s69, s22, s69
    s_cselect_b32 s70, s70, 32512
    s_cselect_b32 s22, s70, 0xffffff00
    s_add_u32 s66, s66, s22
    s_lshl_b32 s22, s69, 4
    s_add_u32 s66, s66, s22
    s_add_u32 s61, s61, s22
    s_bitcmp1_b32 s25, 1
    s_cselect_b32 s22, 0, 15
    s_cmp_eq_u32 s19, s22
    s_cselect_b32 s66, s66, 0
    s_cselect_b32 s70, 0x80000000, s70
    s_lshr_b32 s67, s25, 1
    s_lshl_b32 s67, s67, 8
    s_and_b32 s19, s25, 1
    s_lshl_b32 s19, s19, 3
    s_add_u32 s67, s67, s19
    s_cmp_le_u32 s18, 0
    s_cselect_b32 s71, 1, 0
    s_cmp_le_u32 s18, 1
    s_cselect_b32 s72, 2, 1
    s_cmp_le_u32 s18, 2
    s_cselect_b32 s73, 3, 2
    s_mul_i32 s22, s3, 176128
    s_add_u32 s37, s37, s22
    s_add_u32 s37, s37, 0xc8000
    s_lshl_b32 s19, s28, 10
    s_add_u32 s19, s19, s37
    s_mul_i32 s74, s18, 44032
    s_add_u32 s74, s74, s19
    s_mul_i32 s75, s71, 44032
    s_add_u32 s75, s75, s19
    s_mul_i32 s76, s72, 44032
    s_add_u32 s76, s76, s19
    s_mul_i32 s77, s73, 44032
    s_add_u32 s77, s77, s19
    s_lshr_b32 s19, s28, 1
    s_add_u32 s19, s19, 32
    s_sub_u32 s19, s19, s28
    s_lshl_b32 s19, s19, 10
    s_and_b32 s22, s28, 1
    s_lshl_b32 s22, s22, 3
    s_add_u32 s19, s19, s22
    s_cmp_lt_u32 s28, 22
    s_cselect_b32 s3, s19, 0x80000000
    s_mul_i32 s19, s18, 11264
    s_add_u32 s37, s37, s19
    s_add_u32 s30, s37, 44032
    s_add_u32 s78, s37, 88064
    s_add_u32 s79, s37, 132096
    s_lshr_b32 s19, s18, 1
    s_add_u32 s19, s19, s26
    s_lshl_b32 s28, s19, 14
    s_lshl_b32 s19, s25, 7
    s_add_u32 s28, s28, s19
    s_and_b32 s19, s18, 1
    s_lshl_b32 s19, s19, 6
    s_add_u32 s28, s28, s19
    s_add_u32 s27, s28, 0x8000
    v_add_u32 v7, 0x20000, v3
    v_lshlrev_b32 v14, 4, v12
    v_lshl_add_u32 v14, v11, 8, v14
    v_add_u32 v8, 0x20400, v14
    v_add_u32 v9, 0x20600, v14
    v_mov_b32 v15, 0x20800
    v_cmp_gt_u32 vcc, 16, v10
    s_nop 1
    v_cndmask_b32 v8, v15, v8, vcc
    v_cndmask_b32 v9, v15, v9, vcc
    v_lshrrev_b32 v2, 4, v10
    v_lshl_add_u32 v2, v2, 14, v14
    v_lshlrev_b32 v133, 7, v10
    v_min_u32 v15, 12, v1
    v_mul_u32_u24 v15, 2064, v15
    v_add_u32 v15, 0x20800, v15
    v_mov_b32 v124, s31
    v_mov_b32 v125, s31
    v_mov_b32 v126, s31
    v_mov_b32 v127, s31
    ds_write_b128 v15, v[124:127]
    v_accvgpr_write_b32 a172, v124
    v_accvgpr_write_b32 a173, v124
    v_accvgpr_write_b32 a174, v124
    v_accvgpr_write_b32 a175, v124
    v_mov_b32 v88, 0
    v_mov_b32 v89, 0
    v_mov_b32 v90, 0
    v_mov_b32 v91, 0
    v_mov_b32 v92, 0
    v_mov_b32 v93, 0
    v_mov_b32 v94, 0
    v_mov_b32 v95, 0
    v_mov_b32 v96, 0
    v_mov_b32 v97, 0
    v_mov_b32 v98, 0
    v_mov_b32 v99, 0
    v_mov_b32 v100, 0
    v_mov_b32 v101, 0
    v_mov_b32 v102, 0
    v_mov_b32 v103, 0
    v_mov_b32 v104, 0
    v_mov_b32 v105, 0
    v_mov_b32 v106, 0
    v_mov_b32 v107, 0
    v_mov_b32 v108, 0
    v_mov_b32 v109, 0
    v_mov_b32 v110, 0
    v_mov_b32 v111, 0
    v_mov_b32 v112, 0
    v_mov_b32 v113, 0
    v_mov_b32 v114, 0
    v_mov_b32 v115, 0
    v_mov_b32 v116, 0
    v_mov_b32 v117, 0
    v_mov_b32 v118, 0
    v_mov_b32 v119, 0
    v_mov_b32 v84, 0
    v_mov_b32 v85, 0
    v_mov_b32 v86, 0
    v_mov_b32 v87, 0
    v_mov_b32 v128, 0
    v_mov_b32 v129, 0
    v_mov_b32 v130, 0
    v_mov_b32 v131, 0
    s_lshl_b32 s19, s18, 10
    s_add_u32 s19, s19, 0x10000
    v_add_u32 v10, s19, v3
    s_lshl_b32 s19, s18, 6
    s_add_u32 s19, s19, 0x26900
    v_lshlrev_b32 v11, 4, v13
    v_add_u32 v11, s19, v11
    v_add_u32 v15, s20, v7
    s_getpc_b64 s[20:21]
L_main_kernel_1:
    s_add_u32 s20, s20, L_attn_fin-L_main_kernel_1
    s_addc_u32 s21, s21, 0
    s_lshl_b32 s19, s18, 13
    s_lshl_b32 s19, s17, 2
    s_add_u32 s19, s19, s18
    s_lshl_b32 s19, s19, 8
    v_lshlrev_b32 v136, 6, v13
    v_add_u32 v136, s19, v136
    v_min_u32 v136, L_code_end-L_attn_fin-4, v136
    v_mov_b32 v137, s21
    v_add_co_u32 v136, vcc, s20, v136
    s_nop 1
    v_addc_co_u32 v137, vcc, 0, v137, vcc
    s_mul_i32 s19, s16, 0x180000
    s_lshl_b32 s22, s17, 2
    s_add_u32 s22, s22, s18
    s_mul_i32 s22, s22, 6400
    s_add_u32 s19, s19, s22
    s_add_u32 s19, s19, 0x800000
    v_sub_u32 v139, 24, v1
    v_and_b32 v139, 0x80000000, v139
    v_lshl_add_u32 v138, v1, 7, v139
    v_add_u32 v138, s19, v138
    v_add_u32 v139, 3200, v138
    s_mul_i32 s22, s22, 43
    s_mul_i32 s19, s16, 0x180000
    s_add_u32 s19, s19, 0x8c8000
    s_lshl_b32 s22, s17, 2
    s_add_u32 s22, s22, s18
    s_mul_i32 s22, s22, 5504
    s_add_u32 s19, s19, s22
    v_sub_u32 v140, 42, v1
    v_and_b32 v140, 0x80000000, v140
    v_lshl_add_u32 v140, v1, 7, v140
    v_add_u32 v140, s19, v140
    s_waitcnt vmcnt(4) lgkmcnt(0)
    s_barrier
    ds_read_b128 v[120:123], v7
    ds_read_b128 v[124:127], v8
    s_waitcnt lgkmcnt(1)
    v_mfma_f32_32x32x16_bf16 v[40:55], v[120:123], v[16:19], 0
    v_mfma_f32_32x32x16_bf16 v[56:71], v[120:123], v[20:23], 0
    s_nop 10
    v_max_f32 v24, v40, v41
    v_max3_f32 v24, v24, v42, v43
    v_max3_f32 v24, v24, v44, v45
    v_max3_f32 v24, v24, v46, v47
    v_max3_f32 v24, v24, v48, v49
    v_max3_f32 v24, v24, v50, v51
    v_max3_f32 v24, v24, v52, v53
    v_max3_f32 v24, v24, v54, v55
    v_max3_f32 v24, v24, v56, v57
    v_max3_f32 v24, v24, v58, v59
    v_max3_f32 v24, v24, v60, v61
    v_max3_f32 v24, v24, v62, v63
    v_max3_f32 v24, v24, v64, v65
    v_max3_f32 v24, v24, v66, v67
    v_max3_f32 v24, v24, v68, v69
    v_max3_f32 v24, v24, v70, v71
    v_mov_b32 v25, v24
    s_nop 1
    v_permlane32_swap_b32 v24, v25
    v_max_f32 v24, v24, v25
    v_sub_f32 v24, 0, v24
    v_mov_b32 v25, v24
    v_mov_b32 v26, v24
    v_mov_b32 v27, v24
    v_mov_b32 v28, v24
    v_mov_b32 v29, v24
    v_mov_b32 v30, v24
    v_mov_b32 v31, v24
    v_mov_b32 v32, v24
    v_mov_b32 v33, v24
    v_mov_b32 v34, v24
    v_mov_b32 v35, v24
    v_mov_b32 v36, v24
    v_mov_b32 v37, v24
    v_mov_b32 v38, v24
    v_mov_b32 v39, v24
    v_pk_add_f32 v[40:41], v[40:41], v[24:25]
    v_pk_add_f32 v[42:43], v[42:43], v[24:25]
    v_pk_add_f32 v[44:45], v[44:45], v[24:25]
    v_pk_add_f32 v[46:47], v[46:47], v[24:25]
    v_pk_add_f32 v[48:49], v[48:49], v[24:25]
    v_pk_add_f32 v[50:51], v[50:51], v[24:25]
    v_pk_add_f32 v[52:53], v[52:53], v[24:25]
    v_pk_add_f32 v[54:55], v[54:55], v[24:25]
    v_mov_b32 v70, 0
    v_mov_b32 v71, 0
    v_exp_f32 v40, v40
    v_cvt_pk_bf16_f32 v87, v70, v71
    v_mfma_f32_32x32x16_bf16 v[56:71], v[120:123], v[20:23], v[24:39]
    ds_read_b128 v[120:123], v7 offset:2064
    v_exp_f32 v41, v41
    v_exp_f32 v42, v42
    v_exp_f32 v43, v43
    v_cvt_pk_bf16_f32 v72, v40, v41
    v_mfma_f32_32x32x16_bf16 v[104:119], v[128:131], v[84:87], v[104:119]
    s_waitcnt lgkmcnt(1)
    ds_read_b128 v[128:131], v9 offset:0
    v_exp_f32 v44, v44
    v_exp_f32 v45, v45
    v_cvt_pk_bf16_f32 v73, v42, v43
    v_exp_f32 v46, v46
    v_exp_f32 v47, v47
    v_cvt_pk_bf16_f32 v74, v44, v45
    v_exp_f32 v48, v48
    v_exp_f32 v49, v49
    v_cvt_pk_bf16_f32 v75, v46, v47
    v_exp_f32 v50, v50
    v_exp_f32 v51, v51
    v_cvt_pk_bf16_f32 v76, v48, v49
    v_mfma_f32_32x32x16_bf16 v[88:103], v[124:127], v[72:75], v[88:103]
    s_waitcnt lgkmcnt(1)
    v_exp_f32 v52, v52
    v_exp_f32 v53, v53
    v_cvt_pk_bf16_f32 v77, v50, v51
    v_exp_f32 v54, v54
    v_exp_f32 v55, v55
    v_cvt_pk_bf16_f32 v78, v52, v53
    v_exp_f32 v56, v56
    v_cvt_pk_bf16_f32 v79, v54, v55
    v_mfma_f32_32x32x16_bf16 v[40:55], v[120:123], v[16:19], v[24:39]
    s_waitcnt lgkmcnt(0)
    v_exp_f32 v57, v57
    v_exp_f32 v58, v58
    v_exp_f32 v59, v59
    v_cvt_pk_bf16_f32 v80, v56, v57
    v_mfma_f32_32x32x16_bf16 v[88:103], v[128:131], v[76:79], v[88:103]
    v_exp_f32 v60, v60
    v_exp_f32 v61, v61
    v_cvt_pk_bf16_f32 v81, v58, v59
    v_exp_f32 v62, v62
    v_exp_f32 v63, v63
    v_cvt_pk_bf16_f32 v82, v60, v61
    v_exp_f32 v64, v64
    v_exp_f32 v65, v65
    v_cvt_pk_bf16_f32 v83, v62, v63
    v_exp_f32 v66, v66
    v_exp_f32 v67, v67
    v_cvt_pk_bf16_f32 v84, v64, v65
    v_mfma_f32_32x32x16_bf16 v[104:119], v[124:127], v[80:83], v[104:119]
    ds_read_b128 v[124:127], v8 offset:2064
    v_exp_f32 v68, v68
    v_exp_f32 v69, v69
    v_cvt_pk_bf16_f32 v85, v66, v67
    v_exp_f32 v70, v70
    v_exp_f32 v71, v71
    v_cvt_pk_bf16_f32 v86, v68, v69
    v_exp_f32 v40, v40
    v_cvt_pk_bf16_f32 v87, v70, v71
    v_mfma_f32_32x32x16_bf16 v[56:71], v[120:123], v[20:23], v[24:39]
    ds_read_b128 v[120:123], v7 offset:4128
    v_exp_f32 v41, v41
    v_exp_f32 v42, v42
    v_exp_f32 v43, v43
    v_cvt_pk_bf16_f32 v72, v40, v41
    v_mfma_f32_32x32x16_bf16 v[104:119], v[128:131], v[84:87], v[104:119]
    s_waitcnt lgkmcnt(1)
    ds_read_b128 v[128:131], v9 offset:2064
    v_exp_f32 v44, v44
    v_exp_f32 v45, v45
    v_cvt_pk_bf16_f32 v73, v42, v43
    v_exp_f32 v46, v46
    v_exp_f32 v47, v47
    v_cvt_pk_bf16_f32 v74, v44, v45
    v_exp_f32 v48, v48
    v_exp_f32 v49, v49
    v_cvt_pk_bf16_f32 v75, v46, v47
    v_exp_f32 v50, v50
    v_exp_f32 v51, v51
    v_cvt_pk_bf16_f32 v76, v48, v49
    v_mfma_f32_32x32x16_bf16 v[88:103], v[124:127], v[72:75], v[88:103]
    s_waitcnt lgkmcnt(1)
    v_exp_f32 v52, v52
    v_exp_f32 v53, v53
    v_cvt_pk_bf16_f32 v77, v50, v51
    v_exp_f32 v54, v54
    v_exp_f32 v55, v55
    v_cvt_pk_bf16_f32 v78, v52, v53
    v_exp_f32 v56, v56
    v_cvt_pk_bf16_f32 v79, v54, v55
    v_mfma_f32_32x32x16_bf16 v[40:55], v[120:123], v[16:19], v[24:39]
    s_waitcnt lgkmcnt(0)
    v_exp_f32 v57, v57
    v_exp_f32 v58, v58
    v_exp_f32 v59, v59
    v_cvt_pk_bf16_f32 v80, v56, v57
    v_mfma_f32_32x32x16_bf16 v[88:103], v[128:131], v[76:79], v[88:103]
    buffer_store_dwordx4 a[168:171], v143, s[4:7], 0 offen offset:0 sc1
    v_exp_f32 v60, v60
    v_exp_f32 v61, v61
    v_cvt_pk_bf16_f32 v81, v58, v59
    v_exp_f32 v62, v62
    v_exp_f32 v63, v63
    v_cvt_pk_bf16_f32 v82, v60, v61
    v_exp_f32 v64, v64
    v_exp_f32 v65, v65
    v_cvt_pk_bf16_f32 v83, v62, v63
    v_exp_f32 v66, v66
    v_exp_f32 v67, v67
    v_cvt_pk_bf16_f32 v84, v64, v65
    v_mfma_f32_32x32x16_bf16 v[104:119], v[124:127], v[80:83], v[104:119]
    ds_read_b128 v[124:127], v8 offset:4128
    v_exp_f32 v68, v68
    v_exp_f32 v69, v69
    v_cvt_pk_bf16_f32 v85, v66, v67
    v_exp_f32 v70, v70
    v_exp_f32 v71, v71
    v_cvt_pk_bf16_f32 v86, v68, v69
    v_exp_f32 v40, v40
    v_cvt_pk_bf16_f32 v87, v70, v71
    v_mfma_f32_32x32x16_bf16 v[56:71], v[120:123], v[20:23], v[24:39]
    ds_read_b128 v[120:123], v7 offset:6192
    v_exp_f32 v41, v41
    v_exp_f32 v42, v42
    v_exp_f32 v43, v43
    v_cvt_pk_bf16_f32 v72, v40, v41
    v_mfma_f32_32x32x16_bf16 v[104:119], v[128:131], v[84:87], v[104:119]
    s_waitcnt lgkmcnt(1)
    ds_read_b128 v[128:131], v9 offset:4128
    v_exp_f32 v44, v44
    v_exp_f32 v45, v45
    v_cvt_pk_bf16_f32 v73, v42, v43
    v_exp_f32 v46, v46
    v_exp_f32 v47, v47
    v_cvt_pk_bf16_f32 v74, v44, v45
    v_exp_f32 v48, v48
    v_exp_f32 v49, v49
    v_cvt_pk_bf16_f32 v75, v46, v47
    v_exp_f32 v50, v50
    v_exp_f32 v51, v51
    v_cvt_pk_bf16_f32 v76, v48, v49
    v_mfma_f32_32x32x16_bf16 v[88:103], v[124:127], v[72:75], v[88:103]
    s_waitcnt lgkmcnt(1)
    v_exp_f32 v52, v52
    v_exp_f32 v53, v53
    v_cvt_pk_bf16_f32 v77, v50, v51
    v_exp_f32 v54, v54
    v_exp_f32 v55, v55
    v_cvt_pk_bf16_f32 v78, v52, v53
    v_exp_f32 v56, v56
    v_cvt_pk_bf16_f32 v79, v54, v55
    v_mfma_f32_32x32x16_bf16 v[40:55], v[120:123], v[16:19], v[24:39]
    s_waitcnt lgkmcnt(0)
    v_exp_f32 v57, v57
    v_exp_f32 v58, v58
    v_exp_f32 v59, v59
    v_cvt_pk_bf16_f32 v80, v56, v57
    v_mfma_f32_32x32x16_bf16 v[88:103], v[128:131], v[76:79], v[88:103]
    buffer_store_dwordx4 a[168:171], v143, s[4:7], 0 offen offset:1024 sc1
    v_exp_f32 v60, v60
    v_exp_f32 v61, v61
    v_cvt_pk_bf16_f32 v81, v58, v59
    v_exp_f32 v62, v62
    v_exp_f32 v63, v63
    v_cvt_pk_bf16_f32 v82, v60, v61
    v_exp_f32 v64, v64
    v_exp_f32 v65, v65
    v_cvt_pk_bf16_f32 v83, v62, v63
    v_exp_f32 v66, v66
    v_exp_f32 v67, v67
    v_cvt_pk_bf16_f32 v84, v64, v65
    v_mfma_f32_32x32x16_bf16 v[104:119], v[124:127], v[80:83], v[104:119]
    s_mov_b32 m0, s48
    ds_read_b128 v[124:127], v8 offset:6192
    v_exp_f32 v68, v68
    v_exp_f32 v69, v69
    v_cvt_pk_bf16_f32 v85, v66, v67
    v_exp_f32 v70, v70
    v_exp_f32 v71, v71
    v_cvt_pk_bf16_f32 v86, v68, v69
    v_exp_f32 v40, v40
    v_cvt_pk_bf16_f32 v87, v70, v71
    v_mfma_f32_32x32x16_bf16 v[56:71], v[120:123], v[20:23], v[24:39]
    s_waitcnt vmcnt(4)
    s_barrier
    ds_read_b128 v[120:123], v7 offset:8256
    v_exp_f32 v41, v41
    v_exp_f32 v42, v42
    v_exp_f32 v43, v43
    v_cvt_pk_bf16_f32 v72, v40, v41
    v_mfma_f32_32x32x16_bf16 v[104:119], v[128:131], v[84:87], v[104:119]
    s_waitcnt lgkmcnt(1)
    ds_read_b128 v[128:131], v9 offset:6192
    v_exp_f32 v44, v44
    v_exp_f32 v45, v45
    v_cvt_pk_bf16_f32 v73, v42, v43
    v_exp_f32 v46, v46
    v_exp_f32 v47, v47
    v_cvt_pk_bf16_f32 v74, v44, v45
    v_exp_f32 v48, v48
    v_exp_f32 v49, v49
    v_cvt_pk_bf16_f32 v75, v46, v47
    v_exp_f32 v50, v50
    v_exp_f32 v51, v51
    v_cvt_pk_bf16_f32 v76, v48, v49
    v_mfma_f32_32x32x16_bf16 v[88:103], v[124:127], v[72:75], v[88:103]
    s_waitcnt lgkmcnt(1)
    buffer_load_dwordx4 v5, s[4:7], s23 offen offset:0 lds
    buffer_load_dwordx4 v5, s[4:7], s23 offen offset:1024 lds
    v_exp_f32 v52, v52
    v_exp_f32 v53, v53
    v_cvt_pk_bf16_f32 v77, v50, v51
    v_exp_f32 v54, v54
    v_exp_f32 v55, v55
    v_cvt_pk_bf16_f32 v78, v52, v53
    v_exp_f32 v56, v56
    v_cvt_pk_bf16_f32 v79, v54, v55
    v_mfma_f32_32x32x16_bf16 v[40:55], v[120:123], v[16:19], v[24:39]
    s_waitcnt lgkmcnt(0)
    v_exp_f32 v57, v57
    v_exp_f32 v58, v58
    v_exp_f32 v59, v59
    v_cvt_pk_bf16_f32 v80, v56, v57
    v_mfma_f32_32x32x16_bf16 v[88:103], v[128:131], v[76:79], v[88:103]
    s_add_u32 m0, s29, 0x0
    v_exp_f32 v60, v60
    v_exp_f32 v61, v61
    v_cvt_pk_bf16_f32 v81, v58, v59
    v_exp_f32 v62, v62
    v_exp_f32 v63, v63
    v_cvt_pk_bf16_f32 v82, v60, v61
    v_exp_f32 v64, v64
    v_exp_f32 v65, v65
    v_cvt_pk_bf16_f32 v83, v62, v63
    v_exp_f32 v66, v66
    v_exp_f32 v67, v67
    v_cvt_pk_bf16_f32 v84, v64, v65
    v_mfma_f32_32x32x16_bf16 v[104:119], v[124:127], v[80:83], v[104:119]
    ds_read_b128 v[124:127], v8 offset:8256
    v_exp_f32 v68, v68
    v_exp_f32 v69, v69
    v_cvt_pk_bf16_f32 v85, v66, v67
    v_exp_f32 v70, v70
    v_exp_f32 v71, v71
    v_cvt_pk_bf16_f32 v86, v68, v69
    v_exp_f32 v40, v40
    v_cvt_pk_bf16_f32 v87, v70, v71
    v_mfma_f32_32x32x16_bf16 v[56:71], v[120:123], v[20:23], v[24:39]
    ds_read_b128 v[120:123], v7 offset:10320
    v_exp_f32 v41, v41
    v_exp_f32 v42, v42
    v_exp_f32 v43, v43
    v_cvt_pk_bf16_f32 v72, v40, v41
    v_mfma_f32_32x32x16_bf16 v[104:119], v[128:131], v[84:87], v[104:119]
    s_waitcnt lgkmcnt(1)
    ds_read_b128 v[128:131], v9 offset:8256
    v_exp_f32 v44, v44
    v_exp_f32 v45, v45
    v_cvt_pk_bf16_f32 v73, v42, v43
    v_exp_f32 v46, v46
    v_exp_f32 v47, v47
    v_cvt_pk_bf16_f32 v74, v44, v45
    v_exp_f32 v48, v48
    v_exp_f32 v49, v49
    v_cvt_pk_bf16_f32 v75, v46, v47
    v_exp_f32 v50, v50
    v_exp_f32 v51, v51
    v_cvt_pk_bf16_f32 v76, v48, v49
    v_mfma_f32_32x32x16_bf16 v[88:103], v[124:127], v[72:75], v[88:103]
    s_waitcnt lgkmcnt(1)
    buffer_load_dwordx4 v3, s[4:7], s43 offen offset:0 lds
    buffer_load_dwordx4 v3, s[4:7], s43 offen offset:1024 lds
    v_exp_f32 v52, v52
    v_exp_f32 v53, v53
    v_cvt_pk_bf16_f32 v77, v50, v51
    v_exp_f32 v54, v54
    v_exp_f32 v55, v55
    v_cvt_pk_bf16_f32 v78, v52, v53
    v_exp_f32 v56, v56
    v_cvt_pk_bf16_f32 v79, v54, v55
    v_mfma_f32_32x32x16_bf16 v[40:55], v[120:123], v[16:19], v[24:39]
    s_waitcnt lgkmcnt(0)
    v_exp_f32 v57, v57
    v_exp_f32 v58, v58
    v_exp_f32 v59, v59
    v_cvt_pk_bf16_f32 v80, v56, v57
    v_mfma_f32_32x32x16_bf16 v[88:103], v[128:131], v[76:79], v[88:103]
    buffer_load_dwordx4 a[160:163], v132, s[8:11], s38 offen
    buffer_load_dwordx4 a[164:167], v132, s[8:11], s38 offen offset:64
    v_exp_f32 v60, v60
    v_exp_f32 v61, v61
    v_cvt_pk_bf16_f32 v81, v58, v59
    v_exp_f32 v62, v62
    v_exp_f32 v63, v63
    v_cvt_pk_bf16_f32 v82, v60, v61
    v_exp_f32 v64, v64
    v_exp_f32 v65, v65
    v_cvt_pk_bf16_f32 v83, v62, v63
    v_exp_f32 v66, v66
    v_exp_f32 v67, v67
    v_cvt_pk_bf16_f32 v84, v64, v65
    v_mfma_f32_32x32x16_bf16 v[104:119], v[124:127], v[80:83], v[104:119]
    ds_read_b128 v[124:127], v8 offset:10320
    v_exp_f32 v68, v68
    v_exp_f32 v69, v69
    v_cvt_pk_bf16_f32 v85, v66, v67
    v_exp_f32 v70, v70
    v_exp_f32 v71, v71
    v_cvt_pk_bf16_f32 v86, v68, v69
    v_exp_f32 v40, v40
    v_cvt_pk_bf16_f32 v87, v70, v71
    v_mfma_f32_32x32x16_bf16 v[56:71], v[120:123], v[20:23], v[24:39]
    ds_read_b128 v[120:123], v7 offset:12384
    v_exp_f32 v41, v41
    v_exp_f32 v42, v42
    v_exp_f32 v43, v43
    v_cvt_pk_bf16_f32 v72, v40, v41
    v_mfma_f32_32x32x16_bf16 v[104:119], v[128:131], v[84:87], v[104:119]
    s_waitcnt lgkmcnt(1)
    ds_read_b128 v[128:131], v9 offset:10320
    v_exp_f32 v44, v44
    v_exp_f32 v45, v45
    v_cvt_pk_bf16_f32 v73, v42, v43
    v_exp_f32 v46, v46
    v_exp_f32 v47, v47
    v_cvt_pk_bf16_f32 v74, v44, v45
    v_exp_f32 v48, v48
    v_exp_f32 v49, v49
    v_cvt_pk_bf16_f32 v75, v46, v47
    v_exp_f32 v50, v50
    v_exp_f32 v51, v51
    v_cvt_pk_bf16_f32 v76, v48, v49
L_hop_main_kernel_1:
    s_cbranch_execz L_hop_main_kernel_5
    v_mfma_f32_32x32x16_bf16 v[88:103], v[124:127], v[72:75], v[88:103]
    s_waitcnt lgkmcnt(1)
    buffer_load_dwordx4 v3, s[4:7], s43 offen offset:2048 lds
    buffer_load_dwordx4 v3, s[4:7], s43 offen offset:3072 lds
    v_exp_f32 v52, v52
    v_exp_f32 v53, v53
    v_cvt_pk_bf16_f32 v77, v50, v51
    v_exp_f32 v54, v54
    v_exp_f32 v55, v55
    v_cvt_pk_bf16_f32 v78, v52, v53
    v_exp_f32 v56, v56
    v_cvt_pk_bf16_f32 v79, v54, v55
    v_mfma_f32_32x32x16_bf16 v[40:55], v[120:123], v[16:19], v[24:39]
    s_waitcnt lgkmcnt(0)
    v_exp_f32 v57, v57
    v_exp_f32 v58, v58
    v_exp_f32 v59, v59
    v_cvt_pk_bf16_f32 v80, v56, v57
    v_mfma_f32_32x32x16_bf16 v[88:103], v[128:131], v[76:79], v[88:103]
    v_exp_f32 v60, v60
    v_exp_f32 v61, v61
    v_cvt_pk_bf16_f32 v81, v58, v59
    v_exp_f32 v62, v62
    v_exp_f32 v63, v63
    v_cvt_pk_bf16_f32 v82, v60, v61
    v_exp_f32 v64, v64
    v_exp_f32 v65, v65
    v_cvt_pk_bf16_f32 v83, v62, v63
    v_exp_f32 v66, v66
    v_exp_f32 v67, v67
    v_cvt_pk_bf16_f32 v84, v64, v65
    v_mfma_f32_32x32x16_bf16 v[104:119], v[124:127], v[80:83], v[104:119]
    ds_read_b128 v[124:127], v8 offset:12384
    v_exp_f32 v68, v68
    v_exp_f32 v69, v69
    v_cvt_pk_bf16_f32 v85, v66, v67
    v_exp_f32 v70, v70
    v_exp_f32 v71, v71
    v_cvt_pk_bf16_f32 v86, v68, v69
    v_exp_f32 v40, v40
    v_cvt_pk_bf16_f32 v87, v70, v71
    v_mfma_f32_32x32x16_bf16 v[56:71], v[120:123], v[20:23], v[24:39]
    ds_read_b128 v[120:123], v7 offset:14448
    v_exp_f32 v41, v41
    v_exp_f32 v42, v42
    v_exp_f32 v43, v43
    v_cvt_pk_bf16_f32 v72, v40, v41
    v_mfma_f32_32x32x16_bf16 v[104:119], v[128:131], v[84:87], v[104:119]
    s_waitcnt lgkmcnt(1)
    ds_read_b128 v[128:131], v9 offset:12384
    v_exp_f32 v44, v44
    v_exp_f32 v45, v45
    v_cvt_pk_bf16_f32 v73, v42, v43
    v_exp_f32 v46, v46
    v_exp_f32 v47, v47
    v_cvt_pk_bf16_f32 v74, v44, v45
    v_exp_f32 v48, v48
    v_exp_f32 v49, v49
    v_cvt_pk_bf16_f32 v75, v46, v47
    v_exp_f32 v50, v50
    v_exp_f32 v51, v51
    v_cvt_pk_bf16_f32 v76, v48, v49
    v_mfma_f32_32x32x16_bf16 v[88:103], v[124:127], v[72:75], v[88:103]
    s_waitcnt lgkmcnt(1)
    buffer_load_dwordx4 a[0:3], v3, s[4:7], s39 offen offset:0
    buffer_load_dwordx4 a[4:7], v3, s[4:7], s39 offen offset:1024
    v_exp_f32 v52, v52
    v_exp_f32 v53, v53
    v_cvt_pk_bf16_f32 v77, v50, v51
    v_exp_f32 v54, v54
    v_exp_f32 v55, v55
    v_cvt_pk_bf16_f32 v78, v52, v53
    v_exp_f32 v56, v56
    v_cvt_pk_bf16_f32 v79, v54, v55
    v_mfma_f32_32x32x16_bf16 v[40:55], v[120:123], v[16:19], v[24:39]
    s_waitcnt lgkmcnt(0)
    v_exp_f32 v57, v57
    v_exp_f32 v58, v58
    v_exp_f32 v59, v59
    v_cvt_pk_bf16_f32 v80, v56, v57
    v_mfma_f32_32x32x16_bf16 v[88:103], v[128:131], v[76:79], v[88:103]
    s_add_u32 s23, s23, 16384
    buffer_load_dwordx4 a[8:11], v3, s[4:7], s39 offen offset:2048
    buffer_load_dwordx4 a[12:15], v3, s[4:7], s39 offen offset:3072
    v_exp_f32 v60, v60
    v_exp_f32 v61, v61
    v_cvt_pk_bf16_f32 v81, v58, v59
    v_exp_f32 v62, v62
    v_exp_f32 v63, v63
    v_cvt_pk_bf16_f32 v82, v60, v61
    v_exp_f32 v64, v64
    v_exp_f32 v65, v65
    v_cvt_pk_bf16_f32 v83, v62, v63
    v_exp_f32 v66, v66
    v_exp_f32 v67, v67
    v_cvt_pk_bf16_f32 v84, v64, v65
    v_mfma_f32_32x32x16_bf16 v[104:119], v[124:127], v[80:83], v[104:119]
    s_add_u32 m0, s24, 6192
    ds_read_b128 v[124:127], v8 offset:14448
    v_exp_f32 v68, v68
    v_exp_f32 v69, v69
    v_cvt_pk_bf16_f32 v85, v66, v67
    v_exp_f32 v70, v70
    v_exp_f32 v71, v71
    v_cvt_pk_bf16_f32 v86, v68, v69
    v_exp_f32 v40, v40
    v_cvt_pk_bf16_f32 v87, v70, v71
    v_mfma_f32_32x32x16_bf16 v[56:71], v[120:123], v[20:23], v[24:39]
    s_waitcnt vmcnt(14)
    s_barrier
    ds_read_b128 v[120:123], v7 offset:16512
    v_exp_f32 v41, v41
    v_exp_f32 v42, v42
    v_exp_f32 v43, v43
    v_cvt_pk_bf16_f32 v72, v40, v41
    v_mfma_f32_32x32x16_bf16 v[104:119], v[128:131], v[84:87], v[104:119]
    s_waitcnt lgkmcnt(1)
    ds_read_b128 v[128:131], v9 offset:14448
    v_exp_f32 v44, v44
    v_exp_f32 v45, v45
    v_cvt_pk_bf16_f32 v73, v42, v43
    v_exp_f32 v46, v46
    v_exp_f32 v47, v47
    v_cvt_pk_bf16_f32 v74, v44, v45
    v_exp_f32 v48, v48
    v_exp_f32 v49, v49
    v_cvt_pk_bf16_f32 v75, v46, v47
    v_exp_f32 v50, v50
    v_exp_f32 v51, v51
    v_cvt_pk_bf16_f32 v76, v48, v49
    v_mfma_f32_32x32x16_bf16 v[88:103], v[124:127], v[72:75], v[88:103]
    s_waitcnt lgkmcnt(1)
    buffer_load_dwordx4 v3, s[4:7], s23 offen offset:0 lds
    buffer_load_dwordx4 v3, s[4:7], s23 offen offset:1024 lds
    v_exp_f32 v52, v52
    v_exp_f32 v53, v53
    v_cvt_pk_bf16_f32 v77, v50, v51
    v_exp_f32 v54, v54
    v_exp_f32 v55, v55
    v_cvt_pk_bf16_f32 v78, v52, v53
    v_exp_f32 v56, v56
    v_cvt_pk_bf16_f32 v79, v54, v55
    v_mfma_f32_32x32x16_bf16 v[40:55], v[120:123], v[16:19], v[24:39]
    s_waitcnt lgkmcnt(0)
    buffer_load_dwordx4 a[16:19], v4, s[4:7], s39 offen offset:0
    buffer_load_dwordx4 a[20:23], v4, s[4:7], s39 offen offset:1024
    v_exp_f32 v57, v57
    v_exp_f32 v58, v58
    v_exp_f32 v59, v59
    v_cvt_pk_bf16_f32 v80, v56, v57
    v_mfma_f32_32x32x16_bf16 v[88:103], v[128:131], v[76:79], v[88:103]
    s_add_u32 m0, s29, 0x1000
    v_exp_f32 v60, v60
    v_exp_f32 v61, v61
    v_cvt_pk_bf16_f32 v81, v58, v59
    v_exp_f32 v62, v62
    v_exp_f32 v63, v63
    v_cvt_pk_bf16_f32 v82, v60, v61
    v_exp_f32 v64, v64
    v_exp_f32 v65, v65
    v_cvt_pk_bf16_f32 v83, v62, v63
    v_exp_f32 v66, v66
    v_exp_f32 v67, v67
    v_cvt_pk_bf16_f32 v84, v64, v65
    v_mfma_f32_32x32x16_bf16 v[104:119], v[124:127], v[80:83], v[104:119]
    ds_read_b128 v[124:127], v8 offset:16512
    v_exp_f32 v68, v68
    v_exp_f32 v69, v69
    v_cvt_pk_bf16_f32 v85, v66, v67
    v_exp_f32 v70, v70
    v_exp_f32 v71, v71
    v_cvt_pk_bf16_f32 v86, v68, v69
    v_exp_f32 v40, v40
    v_cvt_pk_bf16_f32 v87, v70, v71
    v_mfma_f32_32x32x16_bf16 v[56:71], v[120:123], v[20:23], v[24:39]
    ds_read_b128 v[120:123], v7 offset:18576
    v_exp_f32 v41, v41
    v_exp_f32 v42, v42
    v_exp_f32 v43, v43
    v_cvt_pk_bf16_f32 v72, v40, v41
    v_mfma_f32_32x32x16_bf16 v[104:119], v[128:131], v[84:87], v[104:119]
    s_waitcnt lgkmcnt(1)
    ds_read_b128 v[128:131], v9 offset:16512
    v_exp_f32 v44, v44
    v_exp_f32 v45, v45
    v_cvt_pk_bf16_f32 v73, v42, v43
    v_exp_f32 v46, v46
    v_exp_f32 v47, v47
    v_cvt_pk_bf16_f32 v74, v44, v45
    v_exp_f32 v48, v48
    v_exp_f32 v49, v49
    v_cvt_pk_bf16_f32 v75, v46, v47
    v_exp_f32 v50, v50
    v_exp_f32 v51, v51
    v_cvt_pk_bf16_f32 v76, v48, v49
    v_mfma_f32_32x32x16_bf16 v[88:103], v[124:127], v[72:75], v[88:103]
    s_waitcnt lgkmcnt(1)
    buffer_load_dwordx4 v4, s[4:7], s43 offen offset:0 lds
    buffer_load_dwordx4 v4, s[4:7], s43 offen offset:1024 lds
    v_exp_f32 v52, v52
    v_exp_f32 v53, v53
    v_cvt_pk_bf16_f32 v77, v50, v51
    v_exp_f32 v54, v54
    v_exp_f32 v55, v55
    v_cvt_pk_bf16_f32 v78, v52, v53
    v_exp_f32 v56, v56
    v_cvt_pk_bf16_f32 v79, v54, v55
    v_mfma_f32_32x32x16_bf16 v[40:55], v[120:123], v[16:19], v[24:39]
    s_waitcnt lgkmcnt(0)
    v_exp_f32 v57, v57
    v_exp_f32 v58, v58
    v_exp_f32 v59, v59
    v_cvt_pk_bf16_f32 v80, v56, v57
    v_mfma_f32_32x32x16_bf16 v[88:103], v[128:131], v[76:79], v[88:103]
    v_exp_f32 v60, v60
    v_exp_f32 v61, v61
    v_cvt_pk_bf16_f32 v81, v58, v59
    v_exp_f32 v62, v62
    v_exp_f32 v63, v63
    v_cvt_pk_bf16_f32 v82, v60, v61
    v_exp_f32 v64, v64
    v_exp_f32 v65, v65
    v_cvt_pk_bf16_f32 v83, v62, v63
    v_exp_f32 v66, v66
    v_exp_f32 v67, v67
    v_cvt_pk_bf16_f32 v84, v64, v65
    v_mfma_f32_32x32x16_bf16 v[104:119], v[124:127], v[80:83], v[104:119]
    ds_read_b128 v[124:127], v8 offset:18576
    v_exp_f32 v68, v68
    v_exp_f32 v69, v69
    v_cvt_pk_bf16_f32 v85, v66, v67
    v_exp_f32 v70, v70
    v_exp_f32 v71, v71
    v_cvt_pk_bf16_f32 v86, v68, v69
    v_exp_f32 v40, v40
    v_cvt_pk_bf16_f32 v87, v70, v71
    v_mfma_f32_32x32x16_bf16 v[56:71], v[120:123], v[20:23], v[24:39]
    ds_read_b128 v[120:123], v7 offset:20640
    v_exp_f32 v41, v41
    v_exp_f32 v42, v42
    v_exp_f32 v43, v43
    v_cvt_pk_bf16_f32 v72, v40, v41
    v_mfma_f32_32x32x16_bf16 v[104:119], v[128:131], v[84:87], v[104:119]
    s_waitcnt lgkmcnt(1)
    ds_read_b128 v[128:131], v9 offset:18576
    v_exp_f32 v44, v44
    v_exp_f32 v45, v45
    v_cvt_pk_bf16_f32 v73, v42, v43
    v_exp_f32 v46, v46
    v_exp_f32 v47, v47
    v_cvt_pk_bf16_f32 v74, v44, v45
    v_exp_f32 v48, v48
    v_exp_f32 v49, v49
    v_cvt_pk_bf16_f32 v75, v46, v47
    v_exp_f32 v50, v50
    v_exp_f32 v51, v51
    v_cvt_pk_bf16_f32 v76, v48, v49
    v_mfma_f32_32x32x16_bf16 v[88:103], v[124:127], v[72:75], v[88:103]
    s_waitcnt lgkmcnt(1)
    buffer_load_dwordx4 v4, s[4:7], s43 offen offset:2048 lds
    buffer_load_dwordx4 v4, s[4:7], s43 offen offset:3072 lds
    v_exp_f32 v52, v52
    v_exp_f32 v53, v53
    v_cvt_pk_bf16_f32 v77, v50, v51
    v_exp_f32 v54, v54
    v_exp_f32 v55, v55
    v_cvt_pk_bf16_f32 v78, v52, v53
    v_exp_f32 v56, v56
    v_cvt_pk_bf16_f32 v79, v54, v55
    v_mfma_f32_32x32x16_bf16 v[40:55], v[120:123], v[16:19], v[24:39]
    s_waitcnt lgkmcnt(0)
    v_exp_f32 v57, v57
    v_exp_f32 v58, v58
    v_exp_f32 v59, v59
    v_cvt_pk_bf16_f32 v80, v56, v57
    v_mfma_f32_32x32x16_bf16 v[88:103], v[128:131], v[76:79], v[88:103]
    v_exp_f32 v60, v60
    v_exp_f32 v61, v61
    v_cvt_pk_bf16_f32 v81, v58, v59
    v_exp_f32 v62, v62
    v_exp_f32 v63, v63
    v_cvt_pk_bf16_f32 v82, v60, v61
    v_exp_f32 v64, v64
    v_exp_f32 v65, v65
    v_cvt_pk_bf16_f32 v83, v62, v63
    v_exp_f32 v66, v66
    v_exp_f32 v67, v67
    v_cvt_pk_bf16_f32 v84, v64, v65
    v_mfma_f32_32x32x16_bf16 v[104:119], v[124:127], v[80:83], v[104:119]
    ds_read_b128 v[124:127], v8 offset:20640
    v_exp_f32 v68, v68
    v_exp_f32 v69, v69
    v_cvt_pk_bf16_f32 v85, v66, v67
    v_exp_f32 v70, v70
    v_exp_f32 v71, v71
    v_cvt_pk_bf16_f32 v86, v68, v69
    v_exp_f32 v40, v40
    v_cvt_pk_bf16_f32 v87, v70, v71
    v_mfma_f32_32x32x16_bf16 v[56:71], v[120:123], v[20:23], v[24:39]
    ds_read_b128 v[120:123], v7 offset:22704
    v_exp_f32 v41, v41
    v_exp_f32 v42, v42
    v_exp_f32 v43, v43
    v_cvt_pk_bf16_f32 v72, v40, v41
    v_mfma_f32_32x32x16_bf16 v[104:119], v[128:131], v[84:87], v[104:119]
    s_waitcnt lgkmcnt(1)
    ds_read_b128 v[128:131], v9 offset:20640
    v_exp_f32 v44, v44
    v_exp_f32 v45, v45
    v_cvt_pk_bf16_f32 v73, v42, v43
    v_exp_f32 v46, v46
    v_exp_f32 v47, v47
    v_cvt_pk_bf16_f32 v74, v44, v45
    v_exp_f32 v48, v48
    v_exp_f32 v49, v49
    v_cvt_pk_bf16_f32 v75, v46, v47
    v_exp_f32 v50, v50
    v_exp_f32 v51, v51
    v_cvt_pk_bf16_f32 v76, v48, v49
    v_mfma_f32_32x32x16_bf16 v[88:103], v[124:127], v[72:75], v[88:103]
    s_waitcnt lgkmcnt(1)
    buffer_load_dwordx4 a[24:27], v3, s[4:7], s40 offen offset:0
    buffer_load_dwordx4 a[28:31], v3, s[4:7], s40 offen offset:1024
    v_exp_f32 v52, v52
    v_exp_f32 v53, v53
    v_cvt_pk_bf16_f32 v77, v50, v51
    v_exp_f32 v54, v54
    v_exp_f32 v55, v55
    v_cvt_pk_bf16_f32 v78, v52, v53
    v_exp_f32 v56, v56
    v_cvt_pk_bf16_f32 v79, v54, v55
    v_mfma_f32_32x32x16_bf16 v[40:55], v[120:123], v[16:19], v[24:39]
    s_waitcnt lgkmcnt(0)
    v_exp_f32 v57, v57
    v_exp_f32 v58, v58
    v_exp_f32 v59, v59
    v_cvt_pk_bf16_f32 v80, v56, v57
    v_mfma_f32_32x32x16_bf16 v[88:103], v[128:131], v[76:79], v[88:103]
    buffer_load_dwordx4 a[32:35], v3, s[4:7], s40 offen offset:2048
    buffer_load_dwordx4 a[36:39], v3, s[4:7], s40 offen offset:3072
    v_exp_f32 v60, v60
    v_exp_f32 v61, v61
    v_cvt_pk_bf16_f32 v81, v58, v59
    v_exp_f32 v62, v62
    v_exp_f32 v63, v63
    v_cvt_pk_bf16_f32 v82, v60, v61
    v_exp_f32 v64, v64
    v_exp_f32 v65, v65
    v_cvt_pk_bf16_f32 v83, v62, v63
    v_exp_f32 v66, v66
    v_exp_f32 v67, v67
    v_cvt_pk_bf16_f32 v84, v64, v65
    v_mfma_f32_32x32x16_bf16 v[104:119], v[124:127], v[80:83], v[104:119]
    s_add_u32 m0, s24, 14448
    ds_read_b128 v[124:127], v8 offset:22704
    v_exp_f32 v68, v68
    v_exp_f32 v69, v69
    v_cvt_pk_bf16_f32 v85, v66, v67
    v_exp_f32 v70, v70
    v_exp_f32 v71, v71
    v_cvt_pk_bf16_f32 v86, v68, v69
    v_exp_f32 v40, v40
    v_cvt_pk_bf16_f32 v87, v70, v71
    v_mfma_f32_32x32x16_bf16 v[56:71], v[120:123], v[20:23], v[24:39]
    s_waitcnt vmcnt(22)
    s_waitcnt vmcnt(24)
    s_barrier
    ds_read_b128 v[120:123], v7 offset:24768
    v_exp_f32 v41, v41
    v_exp_f32 v42, v42
    v_exp_f32 v43, v43
    v_cvt_pk_bf16_f32 v72, v40, v41
    v_mfma_f32_32x32x16_bf16 v[104:119], v[128:131], v[84:87], v[104:119]
    s_waitcnt lgkmcnt(1)
    ds_read_b128 v[128:131], v9 offset:22704
    v_exp_f32 v44, v44
    v_exp_f32 v45, v45
    v_cvt_pk_bf16_f32 v73, v42, v43
    v_exp_f32 v46, v46
    v_exp_f32 v47, v47
    v_cvt_pk_bf16_f32 v74, v44, v45
    v_exp_f32 v48, v48
    v_exp_f32 v49, v49
    v_cvt_pk_bf16_f32 v75, v46, v47
    v_exp_f32 v50, v50
    v_exp_f32 v51, v51
    v_cvt_pk_bf16_f32 v76, v48, v49
    v_mfma_f32_32x32x16_bf16 v[88:103], v[124:127], v[72:75], v[88:103]
    s_waitcnt lgkmcnt(1)
    buffer_load_dwordx4 v5, s[4:7], s23 offen offset:0 lds
    buffer_load_dwordx4 v5, s[4:7], s23 offen offset:1024 lds
    v_exp_f32 v52, v52
    v_exp_f32 v53, v53
    v_cvt_pk_bf16_f32 v77, v50, v51
    v_exp_f32 v54, v54
    v_exp_f32 v55, v55
    v_cvt_pk_bf16_f32 v78, v52, v53
    v_exp_f32 v56, v56
    v_cvt_pk_bf16_f32 v79, v54, v55
    v_mfma_f32_32x32x16_bf16 v[40:55], v[120:123], v[16:19], v[24:39]
    s_waitcnt lgkmcnt(0)
    buffer_load_dwordx4 a[40:43], v4, s[4:7], s40 offen offset:0
    buffer_load_dwordx4 a[44:47], v4, s[4:7], s40 offen offset:1024
    v_exp_f32 v57, v57
    v_exp_f32 v58, v58
    v_exp_f32 v59, v59
    v_cvt_pk_bf16_f32 v80, v56, v57
    v_mfma_f32_32x32x16_bf16 v[88:103], v[128:131], v[76:79], v[88:103]
    s_add_u32 m0, s29, 0x2000
    buffer_store_dword v142, v141, s[4:7], 0 offen sc1
    v_exp_f32 v60, v60
    v_exp_f32 v61, v61
    v_cvt_pk_bf16_f32 v81, v58, v59
    v_exp_f32 v62, v62
    v_exp_f32 v63, v63
    v_cvt_pk_bf16_f32 v82, v60, v61
    v_exp_f32 v64, v64
    v_exp_f32 v65, v65
    v_cvt_pk_bf16_f32 v83, v62, v63
    v_exp_f32 v66, v66
    v_exp_f32 v67, v67
    v_cvt_pk_bf16_f32 v84, v64, v65
    v_mfma_f32_32x32x16_bf16 v[104:119], v[124:127], v[80:83], v[104:119]
    ds_read_b128 v[124:127], v8 offset:24768
    v_exp_f32 v68, v68
    v_exp_f32 v69, v69
    v_cvt_pk_bf16_f32 v85, v66, v67
    v_exp_f32 v70, v70
    v_exp_f32 v71, v71
    v_cvt_pk_bf16_f32 v86, v68, v69
    v_exp_f32 v40, v40
    v_cvt_pk_bf16_f32 v87, v70, v71
    v_mfma_f32_32x32x16_bf16 v[56:71], v[120:123], v[20:23], v[24:39]
    ds_read_b128 v[120:123], v7 offset:0
    v_exp_f32 v41, v41
    v_exp_f32 v42, v42
    v_exp_f32 v43, v43
    v_cvt_pk_bf16_f32 v72, v40, v41
    v_mfma_f32_32x32x16_bf16 v[104:119], v[128:131], v[84:87], v[104:119]
    s_waitcnt lgkmcnt(1)
    ds_read_b128 v[128:131], v9 offset:24768
    v_exp_f32 v44, v44
    v_exp_f32 v45, v45
    v_cvt_pk_bf16_f32 v73, v42, v43
    v_exp_f32 v46, v46
    v_exp_f32 v47, v47
    v_cvt_pk_bf16_f32 v74, v44, v45
    v_exp_f32 v48, v48
    v_exp_f32 v49, v49
    v_cvt_pk_bf16_f32 v75, v46, v47
    v_exp_f32 v50, v50
    v_exp_f32 v51, v51
    v_cvt_pk_bf16_f32 v76, v48, v49
    v_mfma_f32_32x32x16_bf16 v[88:103], v[124:127], v[72:75], v[88:103]
    s_waitcnt lgkmcnt(1)
    buffer_load_dwordx4 v5, s[4:7], s43 offen offset:0 lds
    buffer_load_dwordx4 v5, s[4:7], s43 offen offset:1024 lds
    v_exp_f32 v52, v52
    v_exp_f32 v53, v53
    v_cvt_pk_bf16_f32 v77, v50, v51
    v_exp_f32 v54, v54
    v_exp_f32 v55, v55
    v_cvt_pk_bf16_f32 v78, v52, v53
    v_exp_f32 v56, v56
    v_cvt_pk_bf16_f32 v79, v54, v55
    v_mfma_f32_32x32x16_bf16 v[40:55], v[120:123], v[16:19], v[24:39]
    s_waitcnt lgkmcnt(0)
    v_exp_f32 v57, v57
    v_exp_f32 v58, v58
    v_exp_f32 v59, v59
    v_cvt_pk_bf16_f32 v80, v56, v57
    v_mfma_f32_32x32x16_bf16 v[88:103], v[128:131], v[76:79], v[88:103]
    v_exp_f32 v60, v60
    v_exp_f32 v61, v61
    v_cvt_pk_bf16_f32 v81, v58, v59
    v_exp_f32 v62, v62
    v_exp_f32 v63, v63
    v_cvt_pk_bf16_f32 v82, v60, v61
    v_exp_f32 v64, v64
    v_exp_f32 v65, v65
    v_cvt_pk_bf16_f32 v83, v62, v63
    v_exp_f32 v66, v66
    v_exp_f32 v67, v67
    v_cvt_pk_bf16_f32 v84, v64, v65
    v_mfma_f32_32x32x16_bf16 v[104:119], v[124:127], v[80:83], v[104:119]
    ds_read_b128 v[124:127], v8 offset:0
    v_exp_f32 v68, v68
    v_exp_f32 v69, v69
    v_cvt_pk_bf16_f32 v85, v66, v67
    v_exp_f32 v70, v70
    v_exp_f32 v71, v71
    v_cvt_pk_bf16_f32 v86, v68, v69
    v_exp_f32 v40, v40
    v_cvt_pk_bf16_f32 v87, v70, v71
    v_mfma_f32_32x32x16_bf16 v[56:71], v[120:123], v[20:23], v[24:39]
    ds_read_b128 v[120:123], v7 offset:2064
    v_exp_f32 v41, v41
    v_exp_f32 v42, v42
    v_exp_f32 v43, v43
    v_cvt_pk_bf16_f32 v72, v40, v41
    v_mfma_f32_32x32x16_bf16 v[104:119], v[128:131], v[84:87], v[104:119]
    s_waitcnt lgkmcnt(1)
    ds_read_b128 v[128:131], v9 offset:0
    v_exp_f32 v44, v44
    v_exp_f32 v45, v45
    v_cvt_pk_bf16_f32 v73, v42, v43
    v_exp_f32 v46, v46
    v_exp_f32 v47, v47
    v_cvt_pk_bf16_f32 v74, v44, v45
    v_exp_f32 v48, v48
    v_exp_f32 v49, v49
    v_cvt_pk_bf16_f32 v75, v46, v47
    v_exp_f32 v50, v50
    v_exp_f32 v51, v51
    v_cvt_pk_bf16_f32 v76, v48, v49
    v_mfma_f32_32x32x16_bf16 v[88:103], v[124:127], v[72:75], v[88:103]
    s_waitcnt lgkmcnt(1)
    buffer_load_dwordx4 v5, s[4:7], s43 offen offset:2048 lds
    buffer_load_dwordx4 v5, s[4:7], s43 offen offset:3072 lds
    v_exp_f32 v52, v52
    v_exp_f32 v53, v53
    v_cvt_pk_bf16_f32 v77, v50, v51
    v_exp_f32 v54, v54
    v_exp_f32 v55, v55
    v_cvt_pk_bf16_f32 v78, v52, v53
    v_exp_f32 v56, v56
    v_cvt_pk_bf16_f32 v79, v54, v55
    v_mfma_f32_32x32x16_bf16 v[40:55], v[120:123], v[16:19], v[24:39]
    s_waitcnt lgkmcnt(0)
    v_exp_f32 v57, v57
    v_exp_f32 v58, v58
    v_exp_f32 v59, v59
    v_cvt_pk_bf16_f32 v80, v56, v57
    v_mfma_f32_32x32x16_bf16 v[88:103], v[128:131], v[76:79], v[88:103]
    v_exp_f32 v60, v60
    v_exp_f32 v61, v61
    v_cvt_pk_bf16_f32 v81, v58, v59
    v_exp_f32 v62, v62
    v_exp_f32 v63, v63
    v_cvt_pk_bf16_f32 v82, v60, v61
    v_exp_f32 v64, v64
    v_exp_f32 v65, v65
    v_cvt_pk_bf16_f32 v83, v62, v63
    v_exp_f32 v66, v66
    v_exp_f32 v67, v67
    v_cvt_pk_bf16_f32 v84, v64, v65
    v_mfma_f32_32x32x16_bf16 v[104:119], v[124:127], v[80:83], v[104:119]
    ds_read_b128 v[124:127], v8 offset:2064
    v_exp_f32 v68, v68
    v_exp_f32 v69, v69
    v_cvt_pk_bf16_f32 v85, v66, v67
    v_exp_f32 v70, v70
    v_exp_f32 v71, v71
    v_cvt_pk_bf16_f32 v86, v68, v69
    v_exp_f32 v40, v40
    v_cvt_pk_bf16_f32 v87, v70, v71
    v_mfma_f32_32x32x16_bf16 v[56:71], v[120:123], v[20:23], v[24:39]
    ds_read_b128 v[120:123], v7 offset:4128
    v_exp_f32 v41, v41
    v_exp_f32 v42, v42
    v_exp_f32 v43, v43
    v_cvt_pk_bf16_f32 v72, v40, v41
    v_mfma_f32_32x32x16_bf16 v[104:119], v[128:131], v[84:87], v[104:119]
    s_waitcnt lgkmcnt(1)
    ds_read_b128 v[128:131], v9 offset:2064
    v_exp_f32 v44, v44
    v_exp_f32 v45, v45
    v_cvt_pk_bf16_f32 v73, v42, v43
    v_exp_f32 v46, v46
    v_exp_f32 v47, v47
    v_cvt_pk_bf16_f32 v74, v44, v45
    v_exp_f32 v48, v48
    v_exp_f32 v49, v49
    v_cvt_pk_bf16_f32 v75, v46, v47
    v_exp_f32 v50, v50
    v_exp_f32 v51, v51
    v_cvt_pk_bf16_f32 v76, v48, v49
    v_mfma_f32_32x32x16_bf16 v[88:103], v[124:127], v[72:75], v[88:103]
    s_waitcnt lgkmcnt(1)
    buffer_load_dwordx4 a[48:51], v4, s[4:7], s40 offen offset:2048
    buffer_load_dwordx4 a[52:55], v4, s[4:7], s40 offen offset:3072
    v_exp_f32 v52, v52
    v_exp_f32 v53, v53
    v_cvt_pk_bf16_f32 v77, v50, v51
    v_exp_f32 v54, v54
    v_exp_f32 v55, v55
    v_cvt_pk_bf16_f32 v78, v52, v53
    v_exp_f32 v56, v56
    v_cvt_pk_bf16_f32 v79, v54, v55
    v_mfma_f32_32x32x16_bf16 v[40:55], v[120:123], v[16:19], v[24:39]
    s_waitcnt lgkmcnt(0)
    v_exp_f32 v57, v57
    v_exp_f32 v58, v58
    v_exp_f32 v59, v59
    v_cvt_pk_bf16_f32 v80, v56, v57
    v_mfma_f32_32x32x16_bf16 v[88:103], v[128:131], v[76:79], v[88:103]
    s_add_u32 s23, s23, 16384
    buffer_load_dwordx4 a[56:59], v5, s[4:7], s40 offen offset:0
    buffer_load_dwordx4 a[60:63], v5, s[4:7], s40 offen offset:1024
    v_exp_f32 v60, v60
    v_exp_f32 v61, v61
    v_cvt_pk_bf16_f32 v81, v58, v59
    v_exp_f32 v62, v62
    v_exp_f32 v63, v63
    v_cvt_pk_bf16_f32 v82, v60, v61
    v_exp_f32 v64, v64
    v_exp_f32 v65, v65
    v_cvt_pk_bf16_f32 v83, v62, v63
    v_exp_f32 v66, v66
    v_exp_f32 v67, v67
    v_cvt_pk_bf16_f32 v84, v64, v65
    v_mfma_f32_32x32x16_bf16 v[104:119], v[124:127], v[80:83], v[104:119]
    s_mov_b32 m0, s47
    ds_read_b128 v[124:127], v8 offset:4128
    v_exp_f32 v68, v68
    v_exp_f32 v69, v69
    v_cvt_pk_bf16_f32 v85, v66, v67
    v_exp_f32 v70, v70
    v_exp_f32 v71, v71
    v_cvt_pk_bf16_f32 v86, v68, v69
    v_exp_f32 v40, v40
    v_cvt_pk_bf16_f32 v87, v70, v71
    v_mfma_f32_32x32x16_bf16 v[56:71], v[120:123], v[20:23], v[24:39]
    s_waitcnt vmcnt(23)
    s_barrier
    ds_read_b128 v[120:123], v7 offset:6192
    v_exp_f32 v41, v41
    v_exp_f32 v42, v42
    v_exp_f32 v43, v43
    v_cvt_pk_bf16_f32 v72, v40, v41
    v_mfma_f32_32x32x16_bf16 v[104:119], v[128:131], v[84:87], v[104:119]
    s_waitcnt lgkmcnt(1)
    ds_read_b128 v[128:131], v9 offset:4128
    v_exp_f32 v44, v44
    v_exp_f32 v45, v45
    v_cvt_pk_bf16_f32 v73, v42, v43
    v_exp_f32 v46, v46
    v_exp_f32 v47, v47
    v_cvt_pk_bf16_f32 v74, v44, v45
    v_exp_f32 v48, v48
    v_exp_f32 v49, v49
    v_cvt_pk_bf16_f32 v75, v46, v47
    v_exp_f32 v50, v50
    v_exp_f32 v51, v51
    v_cvt_pk_bf16_f32 v76, v48, v49
    v_mfma_f32_32x32x16_bf16 v[88:103], v[124:127], v[72:75], v[88:103]
    s_waitcnt lgkmcnt(1)
    buffer_load_dwordx4 v3, s[4:7], s23 offen offset:0 lds
    buffer_load_dwordx4 v3, s[4:7], s23 offen offset:1024 lds
    v_exp_f32 v52, v52
    v_exp_f32 v53, v53
    v_cvt_pk_bf16_f32 v77, v50, v51
    v_exp_f32 v54, v54
    v_exp_f32 v55, v55
    v_cvt_pk_bf16_f32 v78, v52, v53
    v_exp_f32 v56, v56
    v_cvt_pk_bf16_f32 v79, v54, v55
    v_mfma_f32_32x32x16_bf16 v[40:55], v[120:123], v[16:19], v[24:39]
    s_waitcnt lgkmcnt(0)
    buffer_load_dwordx4 v[144:147], v3, s[4:7], s49 offen offset:0
    buffer_load_dwordx4 v[148:151], v3, s[4:7], s49 offen offset:1024
    v_exp_f32 v57, v57
    v_exp_f32 v58, v58
    v_exp_f32 v59, v59
    v_cvt_pk_bf16_f32 v80, v56, v57
    v_mfma_f32_32x32x16_bf16 v[88:103], v[128:131], v[76:79], v[88:103]
    s_add_u32 m0, s29, 0x3000
    v_exp_f32 v60, v60
    v_exp_f32 v61, v61
    v_cvt_pk_bf16_f32 v81, v58, v59
    v_exp_f32 v62, v62
    v_exp_f32 v63, v63
    v_cvt_pk_bf16_f32 v82, v60, v61
    v_exp_f32 v64, v64
    v_exp_f32 v65, v65
    v_cvt_pk_bf16_f32 v83, v62, v63
    v_exp_f32 v66, v66
    v_exp_f32 v67, v67
    v_cvt_pk_bf16_f32 v84, v64, v65
    v_mfma_f32_32x32x16_bf16 v[104:119], v[124:127], v[80:83], v[104:119]
    ds_read_b128 v[124:127], v8 offset:6192
    v_exp_f32 v68, v68
    v_exp_f32 v69, v69
    v_cvt_pk_bf16_f32 v85, v66, v67
    v_exp_f32 v70, v70
    v_exp_f32 v71, v71
    v_cvt_pk_bf16_f32 v86, v68, v69
    v_exp_f32 v40, v40
    v_cvt_pk_bf16_f32 v87, v70, v71
    v_mfma_f32_32x32x16_bf16 v[56:71], v[120:123], v[20:23], v[24:39]
    ds_read_b128 v[120:123], v7 offset:8256
    v_exp_f32 v41, v41
    v_exp_f32 v42, v42
    v_exp_f32 v43, v43
    v_cvt_pk_bf16_f32 v72, v40, v41
    v_mfma_f32_32x32x16_bf16 v[104:119], v[128:131], v[84:87], v[104:119]
    s_waitcnt lgkmcnt(1)
    ds_read_b128 v[128:131], v9 offset:6192
    v_exp_f32 v44, v44
    v_exp_f32 v45, v45
    v_cvt_pk_bf16_f32 v73, v42, v43
    v_exp_f32 v46, v46
    v_exp_f32 v47, v47
    v_cvt_pk_bf16_f32 v74, v44, v45
    v_exp_f32 v48, v48
    v_exp_f32 v49, v49
    v_cvt_pk_bf16_f32 v75, v46, v47
L_hop_main_kernel_2:
    s_cbranch_execz L_hop_main_kernel_6
    v_exp_f32 v50, v50
    v_exp_f32 v51, v51
    v_cvt_pk_bf16_f32 v76, v48, v49
    v_mfma_f32_32x32x16_bf16 v[88:103], v[124:127], v[72:75], v[88:103]
    s_waitcnt lgkmcnt(1)
    buffer_load_dwordx4 v6, s[4:7], s43 offen offset:0 lds
    buffer_load_dwordx4 v6, s[4:7], s43 offen offset:1024 lds
    v_exp_f32 v52, v52
    v_exp_f32 v53, v53
    v_cvt_pk_bf16_f32 v77, v50, v51
    v_exp_f32 v54, v54
    v_exp_f32 v55, v55
    v_cvt_pk_bf16_f32 v78, v52, v53
    v_exp_f32 v56, v56
    v_cvt_pk_bf16_f32 v79, v54, v55
    v_mfma_f32_32x32x16_bf16 v[40:55], v[120:123], v[16:19], v[24:39]
    s_waitcnt lgkmcnt(0)
    v_exp_f32 v57, v57
    v_exp_f32 v58, v58
    v_exp_f32 v59, v59
    v_cvt_pk_bf16_f32 v80, v56, v57
    v_mfma_f32_32x32x16_bf16 v[88:103], v[128:131], v[76:79], v[88:103]
    v_exp_f32 v60, v60
    v_exp_f32 v61, v61
    v_cvt_pk_bf16_f32 v81, v58, v59
    v_exp_f32 v62, v62
    v_exp_f32 v63, v63
    v_cvt_pk_bf16_f32 v82, v60, v61
    v_exp_f32 v64, v64
    v_exp_f32 v65, v65
    v_cvt_pk_bf16_f32 v83, v62, v63
    v_exp_f32 v66, v66
    v_exp_f32 v67, v67
    v_cvt_pk_bf16_f32 v84, v64, v65
    v_mfma_f32_32x32x16_bf16 v[104:119], v[124:127], v[80:83], v[104:119]
    ds_read_b128 v[124:127], v8 offset:8256
    v_exp_f32 v68, v68
    v_exp_f32 v69, v69
    v_cvt_pk_bf16_f32 v85, v66, v67
    v_exp_f32 v70, v70
    v_exp_f32 v71, v71
    v_cvt_pk_bf16_f32 v86, v68, v69
    v_exp_f32 v40, v40
    v_cvt_pk_bf16_f32 v87, v70, v71
    v_mfma_f32_32x32x16_bf16 v[56:71], v[120:123], v[20:23], v[24:39]
    ds_read_b128 v[120:123], v7 offset:10320
    v_exp_f32 v41, v41
    v_exp_f32 v42, v42
    v_exp_f32 v43, v43
    v_cvt_pk_bf16_f32 v72, v40, v41
    v_mfma_f32_32x32x16_bf16 v[104:119], v[128:131], v[84:87], v[104:119]
    s_waitcnt lgkmcnt(1)
    ds_read_b128 v[128:131], v9 offset:8256
    v_exp_f32 v44, v44
    v_exp_f32 v45, v45
    v_cvt_pk_bf16_f32 v73, v42, v43
    v_exp_f32 v46, v46
    v_exp_f32 v47, v47
    v_cvt_pk_bf16_f32 v74, v44, v45
    v_exp_f32 v48, v48
    v_exp_f32 v49, v49
    v_cvt_pk_bf16_f32 v75, v46, v47
    v_exp_f32 v50, v50
    v_exp_f32 v51, v51
    v_cvt_pk_bf16_f32 v76, v48, v49
    v_mfma_f32_32x32x16_bf16 v[88:103], v[124:127], v[72:75], v[88:103]
    s_waitcnt lgkmcnt(1)
    buffer_load_dwordx4 v6, s[4:7], s43 offen offset:2048 lds
    buffer_load_dwordx4 v6, s[4:7], s43 offen offset:3072 lds
    v_exp_f32 v52, v52
    v_exp_f32 v53, v53
    v_cvt_pk_bf16_f32 v77, v50, v51
    v_exp_f32 v54, v54
    v_exp_f32 v55, v55
    v_cvt_pk_bf16_f32 v78, v52, v53
    v_exp_f32 v56, v56
    v_cvt_pk_bf16_f32 v79, v54, v55
    v_mfma_f32_32x32x16_bf16 v[40:55], v[120:123], v[16:19], v[24:39]
    s_waitcnt lgkmcnt(0)
    v_exp_f32 v57, v57
    v_exp_f32 v58, v58
    v_exp_f32 v59, v59
    v_cvt_pk_bf16_f32 v80, v56, v57
    v_mfma_f32_32x32x16_bf16 v[88:103], v[128:131], v[76:79], v[88:103]
    v_exp_f32 v60, v60
    v_exp_f32 v61, v61
    v_cvt_pk_bf16_f32 v81, v58, v59
    v_exp_f32 v62, v62
    v_exp_f32 v63, v63
    v_cvt_pk_bf16_f32 v82, v60, v61
    v_exp_f32 v64, v64
    v_exp_f32 v65, v65
    v_cvt_pk_bf16_f32 v83, v62, v63
    v_exp_f32 v66, v66
    v_exp_f32 v67, v67
    v_cvt_pk_bf16_f32 v84, v64, v65
    v_mfma_f32_32x32x16_bf16 v[104:119], v[124:127], v[80:83], v[104:119]
    ds_read_b128 v[124:127], v8 offset:10320
    v_exp_f32 v68, v68
    v_exp_f32 v69, v69
    v_cvt_pk_bf16_f32 v85, v66, v67
    v_exp_f32 v70, v70
    v_exp_f32 v71, v71
    v_cvt_pk_bf16_f32 v86, v68, v69
    v_exp_f32 v40, v40
    v_cvt_pk_bf16_f32 v87, v70, v71
    v_mfma_f32_32x32x16_bf16 v[56:71], v[120:123], v[20:23], v[24:39]
    ds_read_b128 v[120:123], v7 offset:12384
    v_exp_f32 v41, v41
    v_exp_f32 v42, v42
    v_exp_f32 v43, v43
    v_cvt_pk_bf16_f32 v72, v40, v41
    v_mfma_f32_32x32x16_bf16 v[104:119], v[128:131], v[84:87], v[104:119]
    s_waitcnt lgkmcnt(1)
    ds_read_b128 v[128:131], v9 offset:10320
    v_exp_f32 v44, v44
    v_exp_f32 v45, v45
    v_cvt_pk_bf16_f32 v73, v42, v43
    v_exp_f32 v46, v46
    v_exp_f32 v47, v47
    v_cvt_pk_bf16_f32 v74, v44, v45
    v_exp_f32 v48, v48
    v_exp_f32 v49, v49
    v_cvt_pk_bf16_f32 v75, v46, v47
    v_exp_f32 v50, v50
    v_exp_f32 v51, v51
    v_cvt_pk_bf16_f32 v76, v48, v49
    v_mfma_f32_32x32x16_bf16 v[88:103], v[124:127], v[72:75], v[88:103]
    s_waitcnt lgkmcnt(1)
    buffer_load_dwordx4 v[152:155], v3, s[4:7], s49 offen offset:2048
    buffer_load_dwordx4 v[156:159], v3, s[4:7], s49 offen offset:3072
    v_exp_f32 v52, v52
    v_exp_f32 v53, v53
    v_cvt_pk_bf16_f32 v77, v50, v51
    v_exp_f32 v54, v54
    v_exp_f32 v55, v55
    v_cvt_pk_bf16_f32 v78, v52, v53
    v_exp_f32 v56, v56
    v_cvt_pk_bf16_f32 v79, v54, v55
    v_mfma_f32_32x32x16_bf16 v[40:55], v[120:123], v[16:19], v[24:39]
    s_waitcnt lgkmcnt(0)
    v_exp_f32 v57, v57
    v_exp_f32 v58, v58
    v_exp_f32 v59, v59
    v_cvt_pk_bf16_f32 v80, v56, v57
    v_mfma_f32_32x32x16_bf16 v[88:103], v[128:131], v[76:79], v[88:103]
    buffer_load_dwordx4 v[160:163], v4, s[4:7], s49 offen offset:0
    buffer_load_dwordx4 v[164:167], v4, s[4:7], s49 offen offset:1024
    v_exp_f32 v60, v60
    v_exp_f32 v61, v61
    v_cvt_pk_bf16_f32 v81, v58, v59
    v_exp_f32 v62, v62
    v_exp_f32 v63, v63
    v_cvt_pk_bf16_f32 v82, v60, v61
    v_exp_f32 v64, v64
    v_exp_f32 v65, v65
    v_cvt_pk_bf16_f32 v83, v62, v63
    v_exp_f32 v66, v66
    v_exp_f32 v67, v67
    v_cvt_pk_bf16_f32 v84, v64, v65
    v_mfma_f32_32x32x16_bf16 v[104:119], v[124:127], v[80:83], v[104:119]
    s_add_u32 m0, s24, 4128
    ds_read_b128 v[124:127], v8 offset:12384
    v_exp_f32 v68, v68
    v_exp_f32 v69, v69
    v_cvt_pk_bf16_f32 v85, v66, v67
    v_exp_f32 v70, v70
    v_exp_f32 v71, v71
    v_cvt_pk_bf16_f32 v86, v68, v69
    v_exp_f32 v40, v40
    v_cvt_pk_bf16_f32 v87, v70, v71
    v_mfma_f32_32x32x16_bf16 v[56:71], v[120:123], v[20:23], v[24:39]
    s_waitcnt vmcnt(23)
    s_barrier
    ds_read_b128 v[120:123], v7 offset:14448
    v_exp_f32 v41, v41
    v_exp_f32 v42, v42
    v_exp_f32 v43, v43
    v_cvt_pk_bf16_f32 v72, v40, v41
    v_mfma_f32_32x32x16_bf16 v[104:119], v[128:131], v[84:87], v[104:119]
    s_waitcnt lgkmcnt(1)
    ds_read_b128 v[128:131], v9 offset:12384
    v_exp_f32 v44, v44
    v_exp_f32 v45, v45
    v_cvt_pk_bf16_f32 v73, v42, v43
    v_exp_f32 v46, v46
    v_exp_f32 v47, v47
    v_cvt_pk_bf16_f32 v74, v44, v45
    v_exp_f32 v48, v48
    v_exp_f32 v49, v49
    v_cvt_pk_bf16_f32 v75, v46, v47
    v_exp_f32 v50, v50
    v_exp_f32 v51, v51
    v_cvt_pk_bf16_f32 v76, v48, v49
    v_mfma_f32_32x32x16_bf16 v[88:103], v[124:127], v[72:75], v[88:103]
    s_waitcnt lgkmcnt(1)
    buffer_load_dwordx4 v5, s[4:7], s23 offen offset:0 lds
    buffer_load_dwordx4 v5, s[4:7], s23 offen offset:1024 lds
    v_exp_f32 v52, v52
    v_exp_f32 v53, v53
    v_cvt_pk_bf16_f32 v77, v50, v51
    v_exp_f32 v54, v54
    v_exp_f32 v55, v55
    v_cvt_pk_bf16_f32 v78, v52, v53
    v_exp_f32 v56, v56
    v_cvt_pk_bf16_f32 v79, v54, v55
    v_mfma_f32_32x32x16_bf16 v[40:55], v[120:123], v[16:19], v[24:39]
    s_waitcnt lgkmcnt(0)
    buffer_load_dwordx4 v[168:171], v4, s[4:7], s49 offen offset:2048
    buffer_load_dwordx4 v[172:175], v4, s[4:7], s49 offen offset:3072
    v_exp_f32 v57, v57
    v_exp_f32 v58, v58
    v_exp_f32 v59, v59
    v_cvt_pk_bf16_f32 v80, v56, v57
    v_mfma_f32_32x32x16_bf16 v[88:103], v[128:131], v[76:79], v[88:103]
    s_add_u32 m0, s29, 0x10000
    v_exp_f32 v60, v60
    v_exp_f32 v61, v61
    v_cvt_pk_bf16_f32 v81, v58, v59
    v_exp_f32 v62, v62
    v_exp_f32 v63, v63
    v_cvt_pk_bf16_f32 v82, v60, v61
    v_exp_f32 v64, v64
    v_exp_f32 v65, v65
    v_cvt_pk_bf16_f32 v83, v62, v63
    v_exp_f32 v66, v66
    v_exp_f32 v67, v67
    v_cvt_pk_bf16_f32 v84, v64, v65
    v_mfma_f32_32x32x16_bf16 v[104:119], v[124:127], v[80:83], v[104:119]
    ds_read_b128 v[124:127], v8 offset:14448
    v_exp_f32 v68, v68
    v_exp_f32 v69, v69
    v_cvt_pk_bf16_f32 v85, v66, v67
    v_exp_f32 v70, v70
    v_exp_f32 v71, v71
    v_cvt_pk_bf16_f32 v86, v68, v69
    v_exp_f32 v40, v40
    v_cvt_pk_bf16_f32 v87, v70, v71
    v_mfma_f32_32x32x16_bf16 v[56:71], v[120:123], v[20:23], v[24:39]
    ds_read_b128 v[120:123], v7 offset:16512
    v_exp_f32 v41, v41
    v_exp_f32 v42, v42
    v_exp_f32 v43, v43
    v_cvt_pk_bf16_f32 v72, v40, v41
    v_mfma_f32_32x32x16_bf16 v[104:119], v[128:131], v[84:87], v[104:119]
    s_waitcnt lgkmcnt(1)
    ds_read_b128 v[128:131], v9 offset:14448
    v_exp_f32 v44, v44
    v_exp_f32 v45, v45
    v_cvt_pk_bf16_f32 v73, v42, v43
    v_exp_f32 v46, v46
    v_exp_f32 v47, v47
    v_cvt_pk_bf16_f32 v74, v44, v45
    v_exp_f32 v48, v48
    v_exp_f32 v49, v49
    v_cvt_pk_bf16_f32 v75, v46, v47
    v_exp_f32 v50, v50
    v_exp_f32 v51, v51
    v_cvt_pk_bf16_f32 v76, v48, v49
    v_mfma_f32_32x32x16_bf16 v[88:103], v[124:127], v[72:75], v[88:103]
    s_waitcnt lgkmcnt(1)
    buffer_load_dwordx4 v3, s[4:7], s44 offen offset:0 lds
    buffer_load_dwordx4 v3, s[4:7], s44 offen offset:1024 lds
    v_exp_f32 v52, v52
    v_exp_f32 v53, v53
    v_cvt_pk_bf16_f32 v77, v50, v51
    v_exp_f32 v54, v54
    v_exp_f32 v55, v55
    v_cvt_pk_bf16_f32 v78, v52, v53
    v_exp_f32 v56, v56
    v_cvt_pk_bf16_f32 v79, v54, v55
    v_mfma_f32_32x32x16_bf16 v[40:55], v[120:123], v[16:19], v[24:39]
    s_waitcnt lgkmcnt(0)
    v_exp_f32 v57, v57
    v_exp_f32 v58, v58
    v_exp_f32 v59, v59
    v_cvt_pk_bf16_f32 v80, v56, v57
    v_mfma_f32_32x32x16_bf16 v[88:103], v[128:131], v[76:79], v[88:103]
    v_exp_f32 v60, v60
    v_exp_f32 v61, v61
    v_cvt_pk_bf16_f32 v81, v58, v59
    v_exp_f32 v62, v62
    v_exp_f32 v63, v63
    v_cvt_pk_bf16_f32 v82, v60, v61
    v_exp_f32 v64, v64
    v_exp_f32 v65, v65
    v_cvt_pk_bf16_f32 v83, v62, v63
    v_exp_f32 v66, v66
    v_exp_f32 v67, v67
    v_cvt_pk_bf16_f32 v84, v64, v65
    v_mfma_f32_32x32x16_bf16 v[104:119], v[124:127], v[80:83], v[104:119]
    ds_read_b128 v[124:127], v8 offset:16512
    v_exp_f32 v68, v68
    v_exp_f32 v69, v69
    v_cvt_pk_bf16_f32 v85, v66, v67
    v_exp_f32 v70, v70
    v_exp_f32 v71, v71
    v_cvt_pk_bf16_f32 v86, v68, v69
    v_exp_f32 v40, v40
    v_cvt_pk_bf16_f32 v87, v70, v71
    v_mfma_f32_32x32x16_bf16 v[56:71], v[120:123], v[20:23], v[24:39]
    ds_read_b128 v[120:123], v7 offset:18576
    v_exp_f32 v41, v41
    v_exp_f32 v42, v42
    v_exp_f32 v43, v43
    v_cvt_pk_bf16_f32 v72, v40, v41
    v_mfma_f32_32x32x16_bf16 v[104:119], v[128:131], v[84:87], v[104:119]
    s_waitcnt lgkmcnt(1)
    ds_read_b128 v[128:131], v9 offset:16512
    v_exp_f32 v44, v44
    v_exp_f32 v45, v45
    v_cvt_pk_bf16_f32 v73, v42, v43
    v_exp_f32 v46, v46
    v_exp_f32 v47, v47
    v_cvt_pk_bf16_f32 v74, v44, v45
    v_exp_f32 v48, v48
    v_exp_f32 v49, v49
    v_cvt_pk_bf16_f32 v75, v46, v47
    v_exp_f32 v50, v50
    v_exp_f32 v51, v51
    v_cvt_pk_bf16_f32 v76, v48, v49
    v_mfma_f32_32x32x16_bf16 v[88:103], v[124:127], v[72:75], v[88:103]
    s_waitcnt lgkmcnt(1)
    buffer_load_dwordx4 v3, s[4:7], s44 offen offset:2048 lds
    buffer_load_dwordx4 v3, s[4:7], s44 offen offset:3072 lds
    v_exp_f32 v52, v52
    v_exp_f32 v53, v53
    v_cvt_pk_bf16_f32 v77, v50, v51
    v_exp_f32 v54, v54
    v_exp_f32 v55, v55
    v_cvt_pk_bf16_f32 v78, v52, v53
    v_exp_f32 v56, v56
    v_cvt_pk_bf16_f32 v79, v54, v55
    v_mfma_f32_32x32x16_bf16 v[40:55], v[120:123], v[16:19], v[24:39]
    s_waitcnt lgkmcnt(0)
    v_exp_f32 v57, v57
    v_exp_f32 v58, v58
    v_exp_f32 v59, v59
    v_cvt_pk_bf16_f32 v80, v56, v57
    v_mfma_f32_32x32x16_bf16 v[88:103], v[128:131], v[76:79], v[88:103]
    v_exp_f32 v60, v60
    v_exp_f32 v61, v61
    v_cvt_pk_bf16_f32 v81, v58, v59
    v_exp_f32 v62, v62
    v_exp_f32 v63, v63
    v_cvt_pk_bf16_f32 v82, v60, v61
    v_exp_f32 v64, v64
    v_exp_f32 v65, v65
    v_cvt_pk_bf16_f32 v83, v62, v63
    v_exp_f32 v66, v66
    v_exp_f32 v67, v67
    v_cvt_pk_bf16_f32 v84, v64, v65
    v_mfma_f32_32x32x16_bf16 v[104:119], v[124:127], v[80:83], v[104:119]
    ds_read_b128 v[124:127], v8 offset:18576
    v_exp_f32 v68, v68
    v_exp_f32 v69, v69
    v_cvt_pk_bf16_f32 v85, v66, v67
    v_exp_f32 v70, v70
    v_exp_f32 v71, v71
    v_cvt_pk_bf16_f32 v86, v68, v69
    v_exp_f32 v40, v40
    v_cvt_pk_bf16_f32 v87, v70, v71
    v_mfma_f32_32x32x16_bf16 v[56:71], v[120:123], v[20:23], v[24:39]
    ds_read_b128 v[120:123], v7 offset:20640
    v_exp_f32 v41, v41
    v_exp_f32 v42, v42
    v_exp_f32 v43, v43
    v_cvt_pk_bf16_f32 v72, v40, v41
    v_mfma_f32_32x32x16_bf16 v[104:119], v[128:131], v[84:87], v[104:119]
    s_waitcnt lgkmcnt(1)
    ds_read_b128 v[128:131], v9 offset:18576
    v_exp_f32 v44, v44
    v_exp_f32 v45, v45
    v_cvt_pk_bf16_f32 v73, v42, v43
    v_exp_f32 v46, v46
    v_exp_f32 v47, v47
    v_cvt_pk_bf16_f32 v74, v44, v45
    v_exp_f32 v48, v48
    v_exp_f32 v49, v49
    v_cvt_pk_bf16_f32 v75, v46, v47
    v_exp_f32 v50, v50
    v_exp_f32 v51, v51
    v_cvt_pk_bf16_f32 v76, v48, v49
    v_mfma_f32_32x32x16_bf16 v[88:103], v[124:127], v[72:75], v[88:103]
    s_waitcnt lgkmcnt(1)
    buffer_load_dwordx4 v[176:179], v5, s[4:7], s49 offen offset:0
    buffer_load_dwordx4 v[180:183], v5, s[4:7], s49 offen offset:1024
    v_exp_f32 v52, v52
    v_exp_f32 v53, v53
    v_cvt_pk_bf16_f32 v77, v50, v51
    v_exp_f32 v54, v54
    v_exp_f32 v55, v55
    v_cvt_pk_bf16_f32 v78, v52, v53
    v_exp_f32 v56, v56
    v_cvt_pk_bf16_f32 v79, v54, v55
    v_mfma_f32_32x32x16_bf16 v[40:55], v[120:123], v[16:19], v[24:39]
    s_waitcnt lgkmcnt(0)
    v_exp_f32 v57, v57
    v_exp_f32 v58, v58
    v_exp_f32 v59, v59
    v_cvt_pk_bf16_f32 v80, v56, v57
    v_mfma_f32_32x32x16_bf16 v[88:103], v[128:131], v[76:79], v[88:103]
    s_add_u32 s23, s23, 16384
    buffer_load_dwordx4 v[184:187], v5, s[4:7], s49 offen offset:2048
    buffer_load_dwordx4 v[188:191], v5, s[4:7], s49 offen offset:3072
    v_exp_f32 v60, v60
    v_exp_f32 v61, v61
    v_cvt_pk_bf16_f32 v81, v58, v59
    v_exp_f32 v62, v62
    v_exp_f32 v63, v63
    v_cvt_pk_bf16_f32 v82, v60, v61
    v_exp_f32 v64, v64
    v_exp_f32 v65, v65
    v_cvt_pk_bf16_f32 v83, v62, v63
    v_exp_f32 v66, v66
    v_exp_f32 v67, v67
    v_cvt_pk_bf16_f32 v84, v64, v65
    v_mfma_f32_32x32x16_bf16 v[104:119], v[124:127], v[80:83], v[104:119]
    s_add_u32 m0, s24, 12384
    ds_read_b128 v[124:127], v8 offset:20640
    v_exp_f32 v68, v68
    v_exp_f32 v69, v69
    v_cvt_pk_bf16_f32 v85, v66, v67
    v_exp_f32 v70, v70
    v_exp_f32 v71, v71
    v_cvt_pk_bf16_f32 v86, v68, v69
    v_exp_f32 v40, v40
    v_cvt_pk_bf16_f32 v87, v70, v71
    v_mfma_f32_32x32x16_bf16 v[56:71], v[120:123], v[20:23], v[24:39]
    s_waitcnt vmcnt(22)
    s_barrier
    ds_read_b128 v[120:123], v7 offset:22704
    v_exp_f32 v41, v41
    v_exp_f32 v42, v42
    v_exp_f32 v43, v43
    v_cvt_pk_bf16_f32 v72, v40, v41
    v_mfma_f32_32x32x16_bf16 v[104:119], v[128:131], v[84:87], v[104:119]
    s_waitcnt lgkmcnt(1)
    ds_read_b128 v[128:131], v9 offset:20640
    v_exp_f32 v44, v44
    v_exp_f32 v45, v45
    v_cvt_pk_bf16_f32 v73, v42, v43
    v_exp_f32 v46, v46
    v_exp_f32 v47, v47
    v_cvt_pk_bf16_f32 v74, v44, v45
    v_exp_f32 v48, v48
    v_exp_f32 v49, v49
    v_cvt_pk_bf16_f32 v75, v46, v47
    v_exp_f32 v50, v50
    v_exp_f32 v51, v51
    v_cvt_pk_bf16_f32 v76, v48, v49
    v_mfma_f32_32x32x16_bf16 v[88:103], v[124:127], v[72:75], v[88:103]
    s_waitcnt lgkmcnt(1)
    buffer_load_dwordx4 v3, s[4:7], s23 offen offset:0 lds
    buffer_load_dwordx4 v3, s[4:7], s23 offen offset:1024 lds
    v_exp_f32 v52, v52
    v_exp_f32 v53, v53
    v_cvt_pk_bf16_f32 v77, v50, v51
    v_exp_f32 v54, v54
    v_exp_f32 v55, v55
    v_cvt_pk_bf16_f32 v78, v52, v53
    v_exp_f32 v56, v56
    v_cvt_pk_bf16_f32 v79, v54, v55
    v_mfma_f32_32x32x16_bf16 v[40:55], v[120:123], v[16:19], v[24:39]
    s_waitcnt lgkmcnt(0)
    buffer_load_dwordx4 v[192:195], v6, s[4:7], s49 offen offset:0
    buffer_load_dwordx4 v[196:199], v6, s[4:7], s49 offen offset:1024
    v_exp_f32 v57, v57
    v_exp_f32 v58, v58
    v_exp_f32 v59, v59
    v_cvt_pk_bf16_f32 v80, v56, v57
    v_mfma_f32_32x32x16_bf16 v[88:103], v[128:131], v[76:79], v[88:103]
    s_add_u32 m0, s29, 0x11000
    buffer_load_dword v133, v133, s[4:7], s35 offen sc1
    v_exp_f32 v60, v60
    v_exp_f32 v61, v61
    v_cvt_pk_bf16_f32 v81, v58, v59
    v_exp_f32 v62, v62
    v_exp_f32 v63, v63
    v_cvt_pk_bf16_f32 v82, v60, v61
    v_exp_f32 v64, v64
    v_exp_f32 v65, v65
    v_cvt_pk_bf16_f32 v83, v62, v63
    v_exp_f32 v66, v66
    v_exp_f32 v67, v67
    v_cvt_pk_bf16_f32 v84, v64, v65
    v_mfma_f32_32x32x16_bf16 v[104:119], v[124:127], v[80:83], v[104:119]
    ds_read_b128 v[124:127], v8 offset:22704
    v_exp_f32 v68, v68
    v_exp_f32 v69, v69
    v_cvt_pk_bf16_f32 v85, v66, v67
    v_exp_f32 v70, v70
    v_exp_f32 v71, v71
    v_cvt_pk_bf16_f32 v86, v68, v69
    v_exp_f32 v40, v40
    v_cvt_pk_bf16_f32 v87, v70, v71
    v_mfma_f32_32x32x16_bf16 v[56:71], v[120:123], v[20:23], v[24:39]
    ds_read_b128 v[120:123], v7 offset:24768
    v_exp_f32 v41, v41
    v_exp_f32 v42, v42
    v_exp_f32 v43, v43
    v_cvt_pk_bf16_f32 v72, v40, v41
    v_mfma_f32_32x32x16_bf16 v[104:119], v[128:131], v[84:87], v[104:119]
    s_waitcnt lgkmcnt(1)
    ds_read_b128 v[128:131], v9 offset:22704
    v_exp_f32 v44, v44
    v_exp_f32 v45, v45
    v_cvt_pk_bf16_f32 v73, v42, v43
    v_exp_f32 v46, v46
    v_exp_f32 v47, v47
    v_cvt_pk_bf16_f32 v74, v44, v45
    v_exp_f32 v48, v48
    v_exp_f32 v49, v49
    v_cvt_pk_bf16_f32 v75, v46, v47
    v_exp_f32 v50, v50
    v_exp_f32 v51, v51
    v_cvt_pk_bf16_f32 v76, v48, v49
    v_mfma_f32_32x32x16_bf16 v[88:103], v[124:127], v[72:75], v[88:103]
    s_waitcnt lgkmcnt(1)
    buffer_load_dwordx4 v4, s[4:7], s44 offen offset:0 lds
    buffer_load_dwordx4 v4, s[4:7], s44 offen offset:1024 lds
    v_exp_f32 v52, v52
    v_exp_f32 v53, v53
    v_cvt_pk_bf16_f32 v77, v50, v51
    v_exp_f32 v54, v54
    v_exp_f32 v55, v55
    v_cvt_pk_bf16_f32 v78, v52, v53
    v_exp_f32 v56, v56
    v_cvt_pk_bf16_f32 v79, v54, v55
    v_mfma_f32_32x32x16_bf16 v[40:55], v[120:123], v[16:19], v[24:39]
    s_waitcnt lgkmcnt(0)
    v_exp_f32 v57, v57
    v_exp_f32 v58, v58
    v_exp_f32 v59, v59
    v_cvt_pk_bf16_f32 v80, v56, v57
    v_mfma_f32_32x32x16_bf16 v[88:103], v[128:131], v[76:79], v[88:103]
    v_exp_f32 v60, v60
    v_exp_f32 v61, v61
    v_cvt_pk_bf16_f32 v81, v58, v59
    v_exp_f32 v62, v62
    v_exp_f32 v63, v63
    v_cvt_pk_bf16_f32 v82, v60, v61
    v_exp_f32 v64, v64
    v_exp_f32 v65, v65
    v_cvt_pk_bf16_f32 v83, v62, v63
    v_exp_f32 v66, v66
    v_exp_f32 v67, v67
    v_cvt_pk_bf16_f32 v84, v64, v65
    v_mfma_f32_32x32x16_bf16 v[104:119], v[124:127], v[80:83], v[104:119]
    ds_read_b128 v[124:127], v8 offset:24768
    v_exp_f32 v68, v68
    v_exp_f32 v69, v69
    v_cvt_pk_bf16_f32 v85, v66, v67
    v_exp_f32 v70, v70
    v_exp_f32 v71, v71
    v_cvt_pk_bf16_f32 v86, v68, v69
    v_exp_f32 v40, v40
    v_cvt_pk_bf16_f32 v87, v70, v71
    v_mfma_f32_32x32x16_bf16 v[56:71], v[120:123], v[20:23], v[24:39]
    ds_read_b128 v[120:123], v7 offset:0
    v_exp_f32 v41, v41
    v_exp_f32 v42, v42
    v_exp_f32 v43, v43
    v_cvt_pk_bf16_f32 v72, v40, v41
    v_mfma_f32_32x32x16_bf16 v[104:119], v[128:131], v[84:87], v[104:119]
    s_waitcnt lgkmcnt(1)
    ds_read_b128 v[128:131], v9 offset:24768
    v_exp_f32 v44, v44
    v_exp_f32 v45, v45
    v_cvt_pk_bf16_f32 v73, v42, v43
    v_exp_f32 v46, v46
    v_exp_f32 v47, v47
    v_cvt_pk_bf16_f32 v74, v44, v45
    v_exp_f32 v48, v48
    v_exp_f32 v49, v49
    v_cvt_pk_bf16_f32 v75, v46, v47
    v_exp_f32 v50, v50
    v_exp_f32 v51, v51
    v_cvt_pk_bf16_f32 v76, v48, v49
    v_mfma_f32_32x32x16_bf16 v[88:103], v[124:127], v[72:75], v[88:103]
    s_waitcnt lgkmcnt(1)
    buffer_load_dwordx4 v4, s[4:7], s44 offen offset:2048 lds
    buffer_load_dwordx4 v4, s[4:7], s44 offen offset:3072 lds
    v_exp_f32 v52, v52
    v_exp_f32 v53, v53
    v_cvt_pk_bf16_f32 v77, v50, v51
    v_exp_f32 v54, v54
    v_exp_f32 v55, v55
    v_cvt_pk_bf16_f32 v78, v52, v53
    v_exp_f32 v56, v56
    v_cvt_pk_bf16_f32 v79, v54, v55
    v_mfma_f32_32x32x16_bf16 v[40:55], v[120:123], v[16:19], v[24:39]
    s_waitcnt lgkmcnt(0)
    v_exp_f32 v57, v57
    v_exp_f32 v58, v58
    v_exp_f32 v59, v59
    v_cvt_pk_bf16_f32 v80, v56, v57
    v_mfma_f32_32x32x16_bf16 v[88:103], v[128:131], v[76:79], v[88:103]
    v_exp_f32 v60, v60
    v_exp_f32 v61, v61
    v_cvt_pk_bf16_f32 v81, v58, v59
    v_exp_f32 v62, v62
    v_exp_f32 v63, v63
    v_cvt_pk_bf16_f32 v82, v60, v61
    v_exp_f32 v64, v64
    v_exp_f32 v65, v65
    v_cvt_pk_bf16_f32 v83, v62, v63
    v_exp_f32 v66, v66
    v_exp_f32 v67, v67
    v_cvt_pk_bf16_f32 v84, v64, v65
    v_mfma_f32_32x32x16_bf16 v[104:119], v[124:127], v[80:83], v[104:119]
    ds_read_b128 v[124:127], v8 offset:0
    v_exp_f32 v68, v68
    v_exp_f32 v69, v69
    v_cvt_pk_bf16_f32 v85, v66, v67
    v_exp_f32 v70, v70
    v_exp_f32 v71, v71
    v_cvt_pk_bf16_f32 v86, v68, v69
    v_exp_f32 v40, v40
    v_cvt_pk_bf16_f32 v87, v70, v71
    v_mfma_f32_32x32x16_bf16 v[56:71], v[120:123], v[20:23], v[24:39]
    ds_read_b128 v[120:123], v7 offset:2064
    v_exp_f32 v41, v41
    v_exp_f32 v42, v42
    v_exp_f32 v43, v43
    v_cvt_pk_bf16_f32 v72, v40, v41
    v_mfma_f32_32x32x16_bf16 v[104:119], v[128:131], v[84:87], v[104:119]
    s_waitcnt lgkmcnt(1)
    ds_read_b128 v[128:131], v9 offset:0
    v_exp_f32 v44, v44
    v_exp_f32 v45, v45
    v_cvt_pk_bf16_f32 v73, v42, v43
    v_exp_f32 v46, v46
    v_exp_f32 v47, v47
    v_cvt_pk_bf16_f32 v74, v44, v45
    v_exp_f32 v48, v48
    v_exp_f32 v49, v49
    v_cvt_pk_bf16_f32 v75, v46, v47
    v_exp_f32 v50, v50
    v_exp_f32 v51, v51
    v_cvt_pk_bf16_f32 v76, v48, v49
    v_mfma_f32_32x32x16_bf16 v[88:103], v[124:127], v[72:75], v[88:103]
    s_waitcnt lgkmcnt(1)
    buffer_load_dwordx4 v[200:203], v6, s[4:7], s49 offen offset:2048
    buffer_load_dwordx4 v[204:207], v6, s[4:7], s49 offen offset:3072
    v_exp_f32 v52, v52
    v_exp_f32 v53, v53
    v_cvt_pk_bf16_f32 v77, v50, v51
    v_exp_f32 v54, v54
    v_exp_f32 v55, v55
    v_cvt_pk_bf16_f32 v78, v52, v53
    v_exp_f32 v56, v56
    v_cvt_pk_bf16_f32 v79, v54, v55
    v_mfma_f32_32x32x16_bf16 v[40:55], v[120:123], v[16:19], v[24:39]
    s_waitcnt lgkmcnt(0)
    v_exp_f32 v57, v57
    v_exp_f32 v58, v58
    v_exp_f32 v59, v59
    v_cvt_pk_bf16_f32 v80, v56, v57
    v_mfma_f32_32x32x16_bf16 v[88:103], v[128:131], v[76:79], v[88:103]
    buffer_load_dwordx4 v[208:211], v3, s[4:7], s50 offen offset:0
    buffer_load_dwordx4 v[212:215], v3, s[4:7], s50 offen offset:1024
    v_exp_f32 v60, v60
    v_exp_f32 v61, v61
    v_cvt_pk_bf16_f32 v81, v58, v59
    v_exp_f32 v62, v62
    v_exp_f32 v63, v63
    v_cvt_pk_bf16_f32 v82, v60, v61
    v_exp_f32 v64, v64
    v_exp_f32 v65, v65
    v_cvt_pk_bf16_f32 v83, v62, v63
    v_exp_f32 v66, v66
    v_exp_f32 v67, v67
    v_cvt_pk_bf16_f32 v84, v64, v65
    v_mfma_f32_32x32x16_bf16 v[104:119], v[124:127], v[80:83], v[104:119]
    s_mov_b32 m0, s46
    ds_read_b128 v[124:127], v8 offset:2064
    v_exp_f32 v68, v68
    v_exp_f32 v69, v69
    v_cvt_pk_bf16_f32 v85, v66, v67
    v_exp_f32 v70, v70
    v_exp_f32 v71, v71
    v_cvt_pk_bf16_f32 v86, v68, v69
    v_exp_f32 v40, v40
    v_cvt_pk_bf16_f32 v87, v70, v71
    v_mfma_f32_32x32x16_bf16 v[56:71], v[120:123], v[20:23], v[24:39]
    s_waitcnt vmcnt(23)
    s_barrier
    ds_read_b128 v[120:123], v7 offset:4128
    v_exp_f32 v41, v41
    v_exp_f32 v42, v42
    v_exp_f32 v43, v43
    v_cvt_pk_bf16_f32 v72, v40, v41
    v_mfma_f32_32x32x16_bf16 v[104:119], v[128:131], v[84:87], v[104:119]
    s_waitcnt lgkmcnt(1)
    ds_read_b128 v[128:131], v9 offset:2064
    v_exp_f32 v44, v44
    v_exp_f32 v45, v45
    v_cvt_pk_bf16_f32 v73, v42, v43
    v_exp_f32 v46, v46
    v_exp_f32 v47, v47
    v_cvt_pk_bf16_f32 v74, v44, v45
    v_exp_f32 v48, v48
    v_exp_f32 v49, v49
    v_cvt_pk_bf16_f32 v75, v46, v47
    v_exp_f32 v50, v50
    v_exp_f32 v51, v51
    v_cvt_pk_bf16_f32 v76, v48, v49
    v_mfma_f32_32x32x16_bf16 v[88:103], v[124:127], v[72:75], v[88:103]
L_hop_main_kernel_3:
    s_cbranch_execz L_hop_main_kernel_7
    s_waitcnt lgkmcnt(1)
    buffer_load_dwordx4 v5, s[4:7], s23 offen offset:0 lds
    buffer_load_dwordx4 v5, s[4:7], s23 offen offset:1024 lds
    v_exp_f32 v52, v52
    v_exp_f32 v53, v53
    v_cvt_pk_bf16_f32 v77, v50, v51
    v_exp_f32 v54, v54
    v_exp_f32 v55, v55
    v_cvt_pk_bf16_f32 v78, v52, v53
    v_exp_f32 v56, v56
    v_cvt_pk_bf16_f32 v79, v54, v55
    v_mfma_f32_32x32x16_bf16 v[40:55], v[120:123], v[16:19], v[24:39]
    s_waitcnt lgkmcnt(0)
    buffer_load_dwordx4 v[216:219], v3, s[4:7], s50 offen offset:2048
    buffer_load_dwordx4 v[220:223], v3, s[4:7], s50 offen offset:3072
    v_exp_f32 v57, v57
    v_exp_f32 v58, v58
    v_exp_f32 v59, v59
    v_cvt_pk_bf16_f32 v80, v56, v57
    v_mfma_f32_32x32x16_bf16 v[88:103], v[128:131], v[76:79], v[88:103]
    s_add_u32 m0, s29, 0x12000
    v_exp_f32 v60, v60
    v_exp_f32 v61, v61
    v_cvt_pk_bf16_f32 v81, v58, v59
    v_exp_f32 v62, v62
    v_exp_f32 v63, v63
    v_cvt_pk_bf16_f32 v82, v60, v61
    v_exp_f32 v64, v64
    v_exp_f32 v65, v65
    v_cvt_pk_bf16_f32 v83, v62, v63
    v_exp_f32 v66, v66
    v_exp_f32 v67, v67
    v_cvt_pk_bf16_f32 v84, v64, v65
    v_mfma_f32_32x32x16_bf16 v[104:119], v[124:127], v[80:83], v[104:119]
    ds_read_b128 v[124:127], v8 offset:4128
    v_exp_f32 v68, v68
    v_exp_f32 v69, v69
    v_cvt_pk_bf16_f32 v85, v66, v67
    v_exp_f32 v70, v70
    v_exp_f32 v71, v71
    v_cvt_pk_bf16_f32 v86, v68, v69
    v_exp_f32 v40, v40
    v_cvt_pk_bf16_f32 v87, v70, v71
    v_mfma_f32_32x32x16_bf16 v[56:71], v[120:123], v[20:23], v[24:39]
    ds_read_b128 v[120:123], v7 offset:6192
    v_exp_f32 v41, v41
    v_exp_f32 v42, v42
    v_exp_f32 v43, v43
    v_cvt_pk_bf16_f32 v72, v40, v41
    v_mfma_f32_32x32x16_bf16 v[104:119], v[128:131], v[84:87], v[104:119]
    s_waitcnt lgkmcnt(1)
    ds_read_b128 v[128:131], v9 offset:4128
    v_exp_f32 v44, v44
    v_exp_f32 v45, v45
    v_cvt_pk_bf16_f32 v73, v42, v43
    v_exp_f32 v46, v46
    v_exp_f32 v47, v47
    v_cvt_pk_bf16_f32 v74, v44, v45
    v_exp_f32 v48, v48
    v_exp_f32 v49, v49
    v_cvt_pk_bf16_f32 v75, v46, v47
    v_exp_f32 v50, v50
    v_exp_f32 v51, v51
    v_cvt_pk_bf16_f32 v76, v48, v49
    v_mfma_f32_32x32x16_bf16 v[88:103], v[124:127], v[72:75], v[88:103]
    s_waitcnt lgkmcnt(1)
    buffer_load_dwordx4 v5, s[4:7], s44 offen offset:0 lds
    buffer_load_dwordx4 v5, s[4:7], s44 offen offset:1024 lds
    v_exp_f32 v52, v52
    v_exp_f32 v53, v53
    v_cvt_pk_bf16_f32 v77, v50, v51
    v_exp_f32 v54, v54
    v_exp_f32 v55, v55
    v_cvt_pk_bf16_f32 v78, v52, v53
    v_exp_f32 v56, v56
    v_cvt_pk_bf16_f32 v79, v54, v55
    v_mfma_f32_32x32x16_bf16 v[40:55], v[120:123], v[16:19], v[24:39]
    s_waitcnt lgkmcnt(0)
    v_exp_f32 v57, v57
    v_exp_f32 v58, v58
    v_exp_f32 v59, v59
    v_cvt_pk_bf16_f32 v80, v56, v57
    v_mfma_f32_32x32x16_bf16 v[88:103], v[128:131], v[76:79], v[88:103]
    v_exp_f32 v60, v60
    v_exp_f32 v61, v61
    v_cvt_pk_bf16_f32 v81, v58, v59
    v_exp_f32 v62, v62
    v_exp_f32 v63, v63
    v_cvt_pk_bf16_f32 v82, v60, v61
    v_exp_f32 v64, v64
    v_exp_f32 v65, v65
    v_cvt_pk_bf16_f32 v83, v62, v63
    v_exp_f32 v66, v66
    v_exp_f32 v67, v67
    v_cvt_pk_bf16_f32 v84, v64, v65
    v_mfma_f32_32x32x16_bf16 v[104:119], v[124:127], v[80:83], v[104:119]
    ds_read_b128 v[124:127], v8 offset:6192
    v_exp_f32 v68, v68
    v_exp_f32 v69, v69
    v_cvt_pk_bf16_f32 v85, v66, v67
    v_exp_f32 v70, v70
    v_exp_f32 v71, v71
    v_cvt_pk_bf16_f32 v86, v68, v69
    v_exp_f32 v40, v40
    v_cvt_pk_bf16_f32 v87, v70, v71
    v_mfma_f32_32x32x16_bf16 v[56:71], v[120:123], v[20:23], v[24:39]
    ds_read_b128 v[120:123], v7 offset:8256
    v_exp_f32 v41, v41
    v_exp_f32 v42, v42
    v_exp_f32 v43, v43
    v_cvt_pk_bf16_f32 v72, v40, v41
    v_mfma_f32_32x32x16_bf16 v[104:119], v[128:131], v[84:87], v[104:119]
    s_waitcnt lgkmcnt(1)
    ds_read_b128 v[128:131], v9 offset:6192
    v_exp_f32 v44, v44
    v_exp_f32 v45, v45
    v_cvt_pk_bf16_f32 v73, v42, v43
    v_exp_f32 v46, v46
    v_exp_f32 v47, v47
    v_cvt_pk_bf16_f32 v74, v44, v45
    v_exp_f32 v48, v48
    v_exp_f32 v49, v49
    v_cvt_pk_bf16_f32 v75, v46, v47
    v_exp_f32 v50, v50
    v_exp_f32 v51, v51
    v_cvt_pk_bf16_f32 v76, v48, v49
    v_mfma_f32_32x32x16_bf16 v[88:103], v[124:127], v[72:75], v[88:103]
    s_waitcnt lgkmcnt(1)
    buffer_load_dwordx4 v5, s[4:7], s44 offen offset:2048 lds
    buffer_load_dwordx4 v5, s[4:7], s44 offen offset:3072 lds
    v_exp_f32 v52, v52
    v_exp_f32 v53, v53
    v_cvt_pk_bf16_f32 v77, v50, v51
    v_exp_f32 v54, v54
    v_exp_f32 v55, v55
    v_cvt_pk_bf16_f32 v78, v52, v53
    v_exp_f32 v56, v56
    v_cvt_pk_bf16_f32 v79, v54, v55
    v_mfma_f32_32x32x16_bf16 v[40:55], v[120:123], v[16:19], v[24:39]
    s_waitcnt lgkmcnt(0)
    v_exp_f32 v57, v57
    v_exp_f32 v58, v58
    v_exp_f32 v59, v59
    v_cvt_pk_bf16_f32 v80, v56, v57
    v_mfma_f32_32x32x16_bf16 v[88:103], v[128:131], v[76:79], v[88:103]
    v_exp_f32 v60, v60
    v_exp_f32 v61, v61
    v_cvt_pk_bf16_f32 v81, v58, v59
    v_exp_f32 v62, v62
    v_exp_f32 v63, v63
    v_cvt_pk_bf16_f32 v82, v60, v61
    v_exp_f32 v64, v64
    v_exp_f32 v65, v65
    v_cvt_pk_bf16_f32 v83, v62, v63
    v_exp_f32 v66, v66
    v_exp_f32 v67, v67
    v_cvt_pk_bf16_f32 v84, v64, v65
    v_mfma_f32_32x32x16_bf16 v[104:119], v[124:127], v[80:83], v[104:119]
    ds_read_b128 v[124:127], v8 offset:8256
    v_exp_f32 v68, v68
    v_exp_f32 v69, v69
    v_cvt_pk_bf16_f32 v85, v66, v67
    v_exp_f32 v70, v70
    v_exp_f32 v71, v71
    v_cvt_pk_bf16_f32 v86, v68, v69
    v_exp_f32 v40, v40
    v_cvt_pk_bf16_f32 v87, v70, v71
    v_mfma_f32_32x32x16_bf16 v[56:71], v[120:123], v[20:23], v[24:39]
    ds_read_b128 v[120:123], v7 offset:10320
    v_exp_f32 v41, v41
    v_exp_f32 v42, v42
    v_exp_f32 v43, v43
    v_cvt_pk_bf16_f32 v72, v40, v41
    v_mfma_f32_32x32x16_bf16 v[104:119], v[128:131], v[84:87], v[104:119]
    s_waitcnt lgkmcnt(1)
    ds_read_b128 v[128:131], v9 offset:8256
    v_exp_f32 v44, v44
    v_exp_f32 v45, v45
    v_cvt_pk_bf16_f32 v73, v42, v43
    v_exp_f32 v46, v46
    v_exp_f32 v47, v47
    v_cvt_pk_bf16_f32 v74, v44, v45
    v_exp_f32 v48, v48
    v_exp_f32 v49, v49
    v_cvt_pk_bf16_f32 v75, v46, v47
    v_exp_f32 v50, v50
    v_exp_f32 v51, v51
    v_cvt_pk_bf16_f32 v76, v48, v49
    v_mfma_f32_32x32x16_bf16 v[88:103], v[124:127], v[72:75], v[88:103]
    s_waitcnt lgkmcnt(1)
    buffer_load_dwordx4 v[224:227], v4, s[4:7], s50 offen offset:0
    buffer_load_dwordx4 v[228:231], v4, s[4:7], s50 offen offset:1024
    v_exp_f32 v52, v52
    v_exp_f32 v53, v53
    v_cvt_pk_bf16_f32 v77, v50, v51
    v_exp_f32 v54, v54
    v_exp_f32 v55, v55
    v_cvt_pk_bf16_f32 v78, v52, v53
    v_exp_f32 v56, v56
    v_cvt_pk_bf16_f32 v79, v54, v55
    v_mfma_f32_32x32x16_bf16 v[40:55], v[120:123], v[16:19], v[24:39]
    s_waitcnt lgkmcnt(0)
    v_exp_f32 v57, v57
    v_exp_f32 v58, v58
    v_exp_f32 v59, v59
    v_cvt_pk_bf16_f32 v80, v56, v57
    v_mfma_f32_32x32x16_bf16 v[88:103], v[128:131], v[76:79], v[88:103]
    s_add_u32 s23, s23, 16384
    buffer_load_dwordx4 v[232:235], v4, s[4:7], s50 offen offset:2048
    buffer_load_dwordx4 v[236:239], v4, s[4:7], s50 offen offset:3072
    v_exp_f32 v60, v60
    v_exp_f32 v61, v61
    v_cvt_pk_bf16_f32 v81, v58, v59
    v_exp_f32 v62, v62
    v_exp_f32 v63, v63
    v_cvt_pk_bf16_f32 v82, v60, v61
    v_exp_f32 v64, v64
    v_exp_f32 v65, v65
    v_cvt_pk_bf16_f32 v83, v62, v63
    v_exp_f32 v66, v66
    v_exp_f32 v67, v67
    v_cvt_pk_bf16_f32 v84, v64, v65
    v_mfma_f32_32x32x16_bf16 v[104:119], v[124:127], v[80:83], v[104:119]
    s_add_u32 m0, s24, 2064
    ds_read_b128 v[124:127], v8 offset:10320
    v_exp_f32 v68, v68
    v_exp_f32 v69, v69
    v_cvt_pk_bf16_f32 v85, v66, v67
    v_exp_f32 v70, v70
    v_exp_f32 v71, v71
    v_cvt_pk_bf16_f32 v86, v68, v69
    v_exp_f32 v40, v40
    v_cvt_pk_bf16_f32 v87, v70, v71
    v_mfma_f32_32x32x16_bf16 v[56:71], v[120:123], v[20:23], v[24:39]
    s_waitcnt vmcnt(23)
    s_barrier
    ds_read_b128 v[120:123], v7 offset:12384
    v_exp_f32 v41, v41
    v_exp_f32 v42, v42
    v_exp_f32 v43, v43
    v_cvt_pk_bf16_f32 v72, v40, v41
    v_mfma_f32_32x32x16_bf16 v[104:119], v[128:131], v[84:87], v[104:119]
    s_waitcnt lgkmcnt(1)
    ds_read_b128 v[128:131], v9 offset:10320
    v_exp_f32 v44, v44
    v_exp_f32 v45, v45
    v_cvt_pk_bf16_f32 v73, v42, v43
    v_exp_f32 v46, v46
    v_exp_f32 v47, v47
    v_cvt_pk_bf16_f32 v74, v44, v45
    v_exp_f32 v48, v48
    v_exp_f32 v49, v49
    v_cvt_pk_bf16_f32 v75, v46, v47
    v_exp_f32 v50, v50
    v_exp_f32 v51, v51
    v_cvt_pk_bf16_f32 v76, v48, v49
    v_mfma_f32_32x32x16_bf16 v[88:103], v[124:127], v[72:75], v[88:103]
    s_waitcnt lgkmcnt(1)
    buffer_load_dwordx4 v3, s[4:7], s23 offen offset:0 lds
    buffer_load_dwordx4 v3, s[4:7], s23 offen offset:1024 lds
    v_exp_f32 v52, v52
    v_exp_f32 v53, v53
    v_cvt_pk_bf16_f32 v77, v50, v51
    v_exp_f32 v54, v54
    v_exp_f32 v55, v55
    v_cvt_pk_bf16_f32 v78, v52, v53
    v_exp_f32 v56, v56
    v_cvt_pk_bf16_f32 v79, v54, v55
    v_mfma_f32_32x32x16_bf16 v[40:55], v[120:123], v[16:19], v[24:39]
    s_waitcnt lgkmcnt(0)
    buffer_load_dwordx4 v[240:243], v5, s[4:7], s50 offen offset:0
    buffer_load_dwordx4 v[244:247], v5, s[4:7], s50 offen offset:1024
    v_exp_f32 v57, v57
    v_exp_f32 v58, v58
    v_exp_f32 v59, v59
    v_cvt_pk_bf16_f32 v80, v56, v57
    v_mfma_f32_32x32x16_bf16 v[88:103], v[128:131], v[76:79], v[88:103]
    s_add_u32 m0, s29, 0x13000
    v_exp_f32 v60, v60
    v_exp_f32 v61, v61
    v_cvt_pk_bf16_f32 v81, v58, v59
    v_exp_f32 v62, v62
    v_exp_f32 v63, v63
    v_cvt_pk_bf16_f32 v82, v60, v61
    v_exp_f32 v64, v64
    v_exp_f32 v65, v65
    v_cvt_pk_bf16_f32 v83, v62, v63
    v_exp_f32 v66, v66
    v_exp_f32 v67, v67
    v_cvt_pk_bf16_f32 v84, v64, v65
    v_mfma_f32_32x32x16_bf16 v[104:119], v[124:127], v[80:83], v[104:119]
    ds_read_b128 v[124:127], v8 offset:12384
    v_exp_f32 v68, v68
    v_exp_f32 v69, v69
    v_cvt_pk_bf16_f32 v85, v66, v67
    v_exp_f32 v70, v70
    v_exp_f32 v71, v71
    v_cvt_pk_bf16_f32 v86, v68, v69
    v_exp_f32 v40, v40
    v_cvt_pk_bf16_f32 v87, v70, v71
    v_mfma_f32_32x32x16_bf16 v[56:71], v[120:123], v[20:23], v[24:39]
    ds_read_b128 v[120:123], v7 offset:14448
    v_exp_f32 v41, v41
    v_exp_f32 v42, v42
    v_exp_f32 v43, v43
    v_cvt_pk_bf16_f32 v72, v40, v41
    v_mfma_f32_32x32x16_bf16 v[104:119], v[128:131], v[84:87], v[104:119]
    s_waitcnt lgkmcnt(1)
    ds_read_b128 v[128:131], v9 offset:12384
    v_exp_f32 v44, v44
    v_exp_f32 v45, v45
    v_cvt_pk_bf16_f32 v73, v42, v43
    v_exp_f32 v46, v46
    v_exp_f32 v47, v47
    v_cvt_pk_bf16_f32 v74, v44, v45
    v_exp_f32 v48, v48
    v_exp_f32 v49, v49
    v_cvt_pk_bf16_f32 v75, v46, v47
    v_exp_f32 v50, v50
    v_exp_f32 v51, v51
    v_cvt_pk_bf16_f32 v76, v48, v49
    v_mfma_f32_32x32x16_bf16 v[88:103], v[124:127], v[72:75], v[88:103]
    s_waitcnt lgkmcnt(1)
    buffer_load_dwordx4 v6, s[4:7], s44 offen offset:0 lds
    buffer_load_dwordx4 v6, s[4:7], s44 offen offset:1024 lds
    v_exp_f32 v52, v52
    v_exp_f32 v53, v53
    v_cvt_pk_bf16_f32 v77, v50, v51
    v_exp_f32 v54, v54
    v_exp_f32 v55, v55
    v_cvt_pk_bf16_f32 v78, v52, v53
    v_exp_f32 v56, v56
    v_cvt_pk_bf16_f32 v79, v54, v55
    v_mfma_f32_32x32x16_bf16 v[40:55], v[120:123], v[16:19], v[24:39]
    s_waitcnt lgkmcnt(0)
    v_exp_f32 v57, v57
    v_exp_f32 v58, v58
    v_exp_f32 v59, v59
    v_cvt_pk_bf16_f32 v80, v56, v57
    v_mfma_f32_32x32x16_bf16 v[88:103], v[128:131], v[76:79], v[88:103]
    v_exp_f32 v60, v60
    v_exp_f32 v61, v61
    v_cvt_pk_bf16_f32 v81, v58, v59
    v_exp_f32 v62, v62
    v_exp_f32 v63, v63
    v_cvt_pk_bf16_f32 v82, v60, v61
    v_exp_f32 v64, v64
    v_exp_f32 v65, v65
    v_cvt_pk_bf16_f32 v83, v62, v63
    v_exp_f32 v66, v66
    v_exp_f32 v67, v67
    v_cvt_pk_bf16_f32 v84, v64, v65
    v_mfma_f32_32x32x16_bf16 v[104:119], v[124:127], v[80:83], v[104:119]
    ds_read_b128 v[124:127], v8 offset:14448
    v_exp_f32 v68, v68
    v_exp_f32 v69, v69
    v_cvt_pk_bf16_f32 v85, v66, v67
    v_exp_f32 v70, v70
    v_exp_f32 v71, v71
    v_cvt_pk_bf16_f32 v86, v68, v69
    v_exp_f32 v40, v40
    v_cvt_pk_bf16_f32 v87, v70, v71
    v_mfma_f32_32x32x16_bf16 v[56:71], v[120:123], v[20:23], v[24:39]
    ds_read_b128 v[120:123], v7 offset:16512
    v_exp_f32 v41, v41
    v_exp_f32 v42, v42
    v_exp_f32 v43, v43
    v_cvt_pk_bf16_f32 v72, v40, v41
    v_mfma_f32_32x32x16_bf16 v[104:119], v[128:131], v[84:87], v[104:119]
    s_waitcnt lgkmcnt(1)
    ds_read_b128 v[128:131], v9 offset:14448
    v_exp_f32 v44, v44
    v_exp_f32 v45, v45
    v_cvt_pk_bf16_f32 v73, v42, v43
    v_exp_f32 v46, v46
    v_exp_f32 v47, v47
    v_cvt_pk_bf16_f32 v74, v44, v45
    v_exp_f32 v48, v48
    v_exp_f32 v49, v49
    v_cvt_pk_bf16_f32 v75, v46, v47
    v_exp_f32 v50, v50
    v_exp_f32 v51, v51
    v_cvt_pk_bf16_f32 v76, v48, v49
    v_mfma_f32_32x32x16_bf16 v[88:103], v[124:127], v[72:75], v[88:103]
    s_waitcnt lgkmcnt(1)
    buffer_load_dwordx4 v6, s[4:7], s44 offen offset:2048 lds
    buffer_load_dwordx4 v6, s[4:7], s44 offen offset:3072 lds
    v_exp_f32 v52, v52
    v_exp_f32 v53, v53
    v_cvt_pk_bf16_f32 v77, v50, v51
    v_exp_f32 v54, v54
    v_exp_f32 v55, v55
    v_cvt_pk_bf16_f32 v78, v52, v53
    v_exp_f32 v56, v56
    v_cvt_pk_bf16_f32 v79, v54, v55
    v_mfma_f32_32x32x16_bf16 v[40:55], v[120:123], v[16:19], v[24:39]
    s_waitcnt lgkmcnt(0)
    v_exp_f32 v57, v57
    v_exp_f32 v58, v58
    v_exp_f32 v59, v59
    v_cvt_pk_bf16_f32 v80, v56, v57
    v_mfma_f32_32x32x16_bf16 v[88:103], v[128:131], v[76:79], v[88:103]
    v_exp_f32 v60, v60
    v_exp_f32 v61, v61
    v_cvt_pk_bf16_f32 v81, v58, v59
    v_exp_f32 v62, v62
    v_exp_f32 v63, v63
    v_cvt_pk_bf16_f32 v82, v60, v61
    v_exp_f32 v64, v64
    v_exp_f32 v65, v65
    v_cvt_pk_bf16_f32 v83, v62, v63
    v_exp_f32 v66, v66
    v_exp_f32 v67, v67
    v_cvt_pk_bf16_f32 v84, v64, v65
    v_mfma_f32_32x32x16_bf16 v[104:119], v[124:127], v[80:83], v[104:119]
    ds_read_b128 v[124:127], v8 offset:16512
    v_exp_f32 v68, v68
    v_exp_f32 v69, v69
    v_cvt_pk_bf16_f32 v85, v66, v67
    v_exp_f32 v70, v70
    v_exp_f32 v71, v71
    v_cvt_pk_bf16_f32 v86, v68, v69
    v_exp_f32 v40, v40
    v_cvt_pk_bf16_f32 v87, v70, v71
    v_mfma_f32_32x32x16_bf16 v[56:71], v[120:123], v[20:23], v[24:39]
    ds_read_b128 v[120:123], v7 offset:18576
    v_exp_f32 v41, v41
    v_exp_f32 v42, v42
    v_exp_f32 v43, v43
    v_cvt_pk_bf16_f32 v72, v40, v41
    v_mfma_f32_32x32x16_bf16 v[104:119], v[128:131], v[84:87], v[104:119]
    s_waitcnt lgkmcnt(1)
    ds_read_b128 v[128:131], v9 offset:16512
    v_exp_f32 v44, v44
    v_exp_f32 v45, v45
    v_cvt_pk_bf16_f32 v73, v42, v43
    v_exp_f32 v46, v46
    v_exp_f32 v47, v47
    v_cvt_pk_bf16_f32 v74, v44, v45
    v_exp_f32 v48, v48
    v_exp_f32 v49, v49
    v_cvt_pk_bf16_f32 v75, v46, v47
    v_exp_f32 v50, v50
    v_exp_f32 v51, v51
    v_cvt_pk_bf16_f32 v76, v48, v49
    v_mfma_f32_32x32x16_bf16 v[88:103], v[124:127], v[72:75], v[88:103]
    s_waitcnt lgkmcnt(1)
    buffer_load_dwordx4 v[248:251], v5, s[4:7], s50 offen offset:2048
    buffer_load_dwordx4 v[252:255], v5, s[4:7], s50 offen offset:3072
    v_exp_f32 v52, v52
    v_exp_f32 v53, v53
    v_cvt_pk_bf16_f32 v77, v50, v51
    v_exp_f32 v54, v54
    v_exp_f32 v55, v55
    v_cvt_pk_bf16_f32 v78, v52, v53
    v_exp_f32 v56, v56
    v_cvt_pk_bf16_f32 v79, v54, v55
    v_mfma_f32_32x32x16_bf16 v[40:55], v[120:123], v[16:19], v[24:39]
    s_waitcnt lgkmcnt(0)
    s_waitcnt vmcnt(30)
    v_cmp_ne_u32 s[0:1], s34, v133
    v_exp_f32 v57, v57
    v_exp_f32 v58, v58
    v_exp_f32 v59, v59
    v_cvt_pk_bf16_f32 v80, v56, v57
    v_mfma_f32_32x32x16_bf16 v[88:103], v[128:131], v[76:79], v[88:103]
    buffer_load_dwordx4 a[176:179], v6, s[4:7], s50 offen offset:0
    buffer_load_dwordx4 a[180:183], v6, s[4:7], s50 offen offset:1024
    v_exp_f32 v60, v60
    v_exp_f32 v61, v61
    v_cvt_pk_bf16_f32 v81, v58, v59
    v_exp_f32 v62, v62
    v_exp_f32 v63, v63
    v_cvt_pk_bf16_f32 v82, v60, v61
    v_exp_f32 v64, v64
    v_exp_f32 v65, v65
    v_cvt_pk_bf16_f32 v83, v62, v63
    v_exp_f32 v66, v66
    v_exp_f32 v67, v67
    v_cvt_pk_bf16_f32 v84, v64, v65
    v_mfma_f32_32x32x16_bf16 v[104:119], v[124:127], v[80:83], v[104:119]
    s_add_u32 m0, s24, 10320
    ds_read_b128 v[124:127], v8 offset:18576
    v_exp_f32 v68, v68
    v_exp_f32 v69, v69
    v_cvt_pk_bf16_f32 v85, v66, v67
    v_exp_f32 v70, v70
    v_exp_f32 v71, v71
    v_cvt_pk_bf16_f32 v86, v68, v69
    v_exp_f32 v40, v40
    v_cvt_pk_bf16_f32 v87, v70, v71
    v_mfma_f32_32x32x16_bf16 v[56:71], v[120:123], v[20:23], v[24:39]
    s_waitcnt vmcnt(22)
    s_barrier
    ds_read_b128 v[120:123], v7 offset:20640
    v_exp_f32 v41, v41
    v_exp_f32 v42, v42
    v_exp_f32 v43, v43
    v_cvt_pk_bf16_f32 v72, v40, v41
    v_mfma_f32_32x32x16_bf16 v[104:119], v[128:131], v[84:87], v[104:119]
    s_waitcnt lgkmcnt(1)
    ds_read_b128 v[128:131], v9 offset:18576
    v_exp_f32 v44, v44
    v_exp_f32 v45, v45
    v_cvt_pk_bf16_f32 v73, v42, v43
    v_exp_f32 v46, v46
    v_exp_f32 v47, v47
    v_cvt_pk_bf16_f32 v74, v44, v45
    v_exp_f32 v48, v48
    v_exp_f32 v49, v49
    v_cvt_pk_bf16_f32 v75, v46, v47
    v_exp_f32 v50, v50
    v_exp_f32 v51, v51
    v_cvt_pk_bf16_f32 v76, v48, v49
    v_mfma_f32_32x32x16_bf16 v[88:103], v[124:127], v[72:75], v[88:103]
    s_waitcnt lgkmcnt(1)
    buffer_load_dwordx4 v5, s[4:7], s23 offen offset:0 lds
    buffer_load_dwordx4 v5, s[4:7], s23 offen offset:1024 lds
    v_exp_f32 v52, v52
    v_exp_f32 v53, v53
    v_cvt_pk_bf16_f32 v77, v50, v51
    v_exp_f32 v54, v54
    v_exp_f32 v55, v55
    v_cvt_pk_bf16_f32 v78, v52, v53
    v_exp_f32 v56, v56
    v_cvt_pk_bf16_f32 v79, v54, v55
    v_mfma_f32_32x32x16_bf16 v[40:55], v[120:123], v[16:19], v[24:39]
    s_waitcnt lgkmcnt(0)
    buffer_load_dwordx4 a[184:187], v6, s[4:7], s50 offen offset:2048
    buffer_load_dwordx4 a[188:191], v6, s[4:7], s50 offen offset:3072
    v_exp_f32 v57, v57
    v_exp_f32 v58, v58
    v_exp_f32 v59, v59
    v_cvt_pk_bf16_f32 v80, v56, v57
    v_mfma_f32_32x32x16_bf16 v[88:103], v[128:131], v[76:79], v[88:103]
    v_exp_f32 v60, v60
    v_exp_f32 v61, v61
    v_cvt_pk_bf16_f32 v81, v58, v59
    v_exp_f32 v62, v62
    v_exp_f32 v63, v63
    v_cvt_pk_bf16_f32 v82, v60, v61
    v_exp_f32 v64, v64
    v_exp_f32 v65, v65
    v_cvt_pk_bf16_f32 v83, v62, v63
    v_exp_f32 v66, v66
    v_exp_f32 v67, v67
    v_cvt_pk_bf16_f32 v84, v64, v65
    v_mfma_f32_32x32x16_bf16 v[104:119], v[124:127], v[80:83], v[104:119]
    s_cmp_lg_u64 s[0:1], 0
    ds_read_b128 v[124:127], v8 offset:20640
    v_exp_f32 v68, v68
    v_exp_f32 v69, v69
    v_cvt_pk_bf16_f32 v85, v66, v67
    v_exp_f32 v70, v70
    v_exp_f32 v71, v71
    v_cvt_pk_bf16_f32 v86, v68, v69
    v_exp_f32 v40, v40
    v_cvt_pk_bf16_f32 v87, v70, v71
    v_mfma_f32_32x32x16_bf16 v[56:71], v[120:123], v[20:23], v[24:39]
    ds_read_b128 v[120:123], v7 offset:22704
    v_exp_f32 v41, v41
    v_exp_f32 v42, v42
    v_exp_f32 v43, v43
    v_cvt_pk_bf16_f32 v72, v40, v41
    v_mfma_f32_32x32x16_bf16 v[104:119], v[128:131], v[84:87], v[104:119]
    s_waitcnt lgkmcnt(1)
    ds_read_b128 v[128:131], v9 offset:20640
    v_exp_f32 v44, v44
    v_exp_f32 v45, v45
    v_cvt_pk_bf16_f32 v73, v42, v43
    v_exp_f32 v46, v46
    v_exp_f32 v47, v47
    v_cvt_pk_bf16_f32 v74, v44, v45
    v_exp_f32 v48, v48
    v_exp_f32 v49, v49
    v_cvt_pk_bf16_f32 v75, v46, v47
    v_exp_f32 v50, v50
    v_exp_f32 v51, v51
    v_cvt_pk_bf16_f32 v76, v48, v49
    v_mfma_f32_32x32x16_bf16 v[88:103], v[124:127], v[72:75], v[88:103]
    s_waitcnt lgkmcnt(1)
    buffer_load_dwordx4 a[192:195], v3, s[4:7], s51 offen offset:0
    buffer_load_dwordx4 a[196:199], v3, s[4:7], s51 offen offset:1024
    v_exp_f32 v52, v52
    v_exp_f32 v53, v53
    v_cvt_pk_bf16_f32 v77, v50, v51
    v_exp_f32 v54, v54
    v_exp_f32 v55, v55
    v_cvt_pk_bf16_f32 v78, v52, v53
    v_exp_f32 v56, v56
    v_cvt_pk_bf16_f32 v79, v54, v55
    v_mfma_f32_32x32x16_bf16 v[40:55], v[120:123], v[16:19], v[24:39]
    s_waitcnt lgkmcnt(0)
    v_exp_f32 v57, v57
    v_exp_f32 v58, v58
    v_exp_f32 v59, v59
    v_cvt_pk_bf16_f32 v80, v56, v57
    v_mfma_f32_32x32x16_bf16 v[88:103], v[128:131], v[76:79], v[88:103]
    s_cbranch_scc1 Z_main_kernel_2
    buffer_store_dwordx4 a[168:171], v3, s[4:7], s36 offen offset:0
    buffer_store_dwordx4 a[168:171], v3, s[4:7], s36 offen offset:1024
C_main_kernel_3:
    v_exp_f32 v60, v60
    v_exp_f32 v61, v61
    v_cvt_pk_bf16_f32 v81, v58, v59
    v_exp_f32 v62, v62
    v_exp_f32 v63, v63
    v_cvt_pk_bf16_f32 v82, v60, v61
    v_exp_f32 v64, v64
    v_exp_f32 v65, v65
    v_cvt_pk_bf16_f32 v83, v62, v63
    v_exp_f32 v66, v66
    v_exp_f32 v67, v67
    v_cvt_pk_bf16_f32 v84, v64, v65
    v_mfma_f32_32x32x16_bf16 v[104:119], v[124:127], v[80:83], v[104:119]
    s_cmp_lg_u64 s[0:1], 0
    ds_read_b128 v[124:127], v8 offset:22704
    v_exp_f32 v68, v68
    v_exp_f32 v69, v69
    v_cvt_pk_bf16_f32 v85, v66, v67
    v_exp_f32 v70, v70
    v_exp_f32 v71, v71
    v_cvt_pk_bf16_f32 v86, v68, v69
    v_exp_f32 v40, v40
    v_cvt_pk_bf16_f32 v87, v70, v71
    v_mfma_f32_32x32x16_bf16 v[56:71], v[120:123], v[20:23], v[24:39]
    ds_read_b128 v[120:123], v7 offset:24768
    v_exp_f32 v41, v41
    v_exp_f32 v42, v42
    v_exp_f32 v43, v43
    v_cvt_pk_bf16_f32 v72, v40, v41
    v_mfma_f32_32x32x16_bf16 v[104:119], v[128:131], v[84:87], v[104:119]
    s_waitcnt lgkmcnt(1)
    ds_read_b128 v[128:131], v9 offset:22704
    v_exp_f32 v44, v44
    v_exp_f32 v45, v45
    v_cvt_pk_bf16_f32 v73, v42, v43
    v_exp_f32 v46, v46
    v_exp_f32 v47, v47
    v_cvt_pk_bf16_f32 v74, v44, v45
    v_exp_f32 v48, v48
    v_exp_f32 v49, v49
    v_cvt_pk_bf16_f32 v75, v46, v47
    v_exp_f32 v50, v50
    v_exp_f32 v51, v51
    v_cvt_pk_bf16_f32 v76, v48, v49
    v_mfma_f32_32x32x16_bf16 v[88:103], v[124:127], v[72:75], v[88:103]
    s_waitcnt lgkmcnt(1)
    buffer_load_dwordx4 a[200:203], v3, s[4:7], s51 offen offset:2048
    buffer_load_dwordx4 a[204:207], v3, s[4:7], s51 offen offset:3072
    v_exp_f32 v52, v52
    v_exp_f32 v53, v53
    v_cvt_pk_bf16_f32 v77, v50, v51
    v_exp_f32 v54, v54
    v_exp_f32 v55, v55
    v_cvt_pk_bf16_f32 v78, v52, v53
    v_exp_f32 v56, v56
    v_cvt_pk_bf16_f32 v79, v54, v55
    v_mfma_f32_32x32x16_bf16 v[40:55], v[120:123], v[16:19], v[24:39]
    s_waitcnt lgkmcnt(0)
    v_exp_f32 v57, v57
    v_exp_f32 v58, v58
    v_exp_f32 v59, v59
    v_cvt_pk_bf16_f32 v80, v56, v57
    v_mfma_f32_32x32x16_bf16 v[88:103], v[128:131], v[76:79], v[88:103]
    s_cbranch_scc1 Z_main_kernel_4
    buffer_store_dwordx4 a[168:171], v3, s[4:7], s36 offen offset:2048
    buffer_store_dwordx4 a[168:171], v3, s[4:7], s36 offen offset:3072
C_main_kernel_5:
    v_exp_f32 v60, v60
    v_exp_f32 v61, v61
    v_cvt_pk_bf16_f32 v81, v58, v59
    v_exp_f32 v62, v62
    v_exp_f32 v63, v63
    v_cvt_pk_bf16_f32 v82, v60, v61
    v_exp_f32 v64, v64
    v_exp_f32 v65, v65
    v_cvt_pk_bf16_f32 v83, v62, v63
    v_exp_f32 v66, v66
    v_exp_f32 v67, v67
    v_cvt_pk_bf16_f32 v84, v64, v65
    v_mfma_f32_32x32x16_bf16 v[104:119], v[124:127], v[80:83], v[104:119]
    ds_read_b128 v[124:127], v8 offset:24768
    v_exp_f32 v68, v68
    v_exp_f32 v69, v69
    v_cvt_pk_bf16_f32 v85, v66, v67
    v_exp_f32 v70, v70
    v_exp_f32 v71, v71
    v_cvt_pk_bf16_f32 v86, v68, v69
    v_exp_f32 v40, v40
    v_cvt_pk_bf16_f32 v87, v70, v71
    v_mfma_f32_32x32x16_bf16 v[56:71], v[120:123], v[20:23], v[24:39]
    ds_read_b128 v[120:123], v7 offset:0
    v_exp_f32 v41, v41
    v_exp_f32 v42, v42
    v_exp_f32 v43, v43
    v_cvt_pk_bf16_f32 v72, v40, v41
    v_mfma_f32_32x32x16_bf16 v[104:119], v[128:131], v[84:87], v[104:119]
    s_waitcnt lgkmcnt(1)
    ds_read_b128 v[128:131], v9 offset:24768
    v_exp_f32 v44, v44
    v_exp_f32 v45, v45
    v_cvt_pk_bf16_f32 v73, v42, v43
    v_exp_f32 v46, v46
    v_exp_f32 v47, v47
    v_cvt_pk_bf16_f32 v74, v44, v45
    v_exp_f32 v48, v48
    v_exp_f32 v49, v49
    v_cvt_pk_bf16_f32 v75, v46, v47
L_hop_main_kernel_4:
    s_cbranch_execz L_hop_main_kernel_8
    v_exp_f32 v50, v50
    v_exp_f32 v51, v51
    v_cvt_pk_bf16_f32 v76, v48, v49
    v_mfma_f32_32x32x16_bf16 v[88:103], v[124:127], v[72:75], v[88:103]
    s_waitcnt lgkmcnt(1)
    buffer_load_dwordx4 a[208:211], v4, s[4:7], s51 offen offset:0
    buffer_load_dwordx4 a[212:215], v4, s[4:7], s51 offen offset:1024
    v_exp_f32 v52, v52
    v_exp_f32 v53, v53
    v_cvt_pk_bf16_f32 v77, v50, v51
    v_exp_f32 v54, v54
    v_exp_f32 v55, v55
    v_cvt_pk_bf16_f32 v78, v52, v53
    v_exp_f32 v56, v56
    v_cvt_pk_bf16_f32 v79, v54, v55
    v_mfma_f32_32x32x16_bf16 v[40:55], v[120:123], v[16:19], v[24:39]
    s_waitcnt lgkmcnt(0)
    v_exp_f32 v57, v57
    v_exp_f32 v58, v58
    v_exp_f32 v59, v59
    v_cvt_pk_bf16_f32 v80, v56, v57
    v_mfma_f32_32x32x16_bf16 v[88:103], v[128:131], v[76:79], v[88:103]
    s_add_u32 s23, s23, 16384
    v_exp_f32 v60, v60
    v_exp_f32 v61, v61
    v_cvt_pk_bf16_f32 v81, v58, v59
    v_exp_f32 v62, v62
    v_exp_f32 v63, v63
    v_cvt_pk_bf16_f32 v82, v60, v61
    v_exp_f32 v64, v64
    v_exp_f32 v65, v65
    v_cvt_pk_bf16_f32 v83, v62, v63
    v_exp_f32 v66, v66
    v_exp_f32 v67, v67
    v_cvt_pk_bf16_f32 v84, v64, v65
    v_mfma_f32_32x32x16_bf16 v[104:119], v[124:127], v[80:83], v[104:119]
    s_add_u32 m0, s24, 18576
    ds_read_b128 v[124:127], v8 offset:0
    v_exp_f32 v68, v68
    v_exp_f32 v69, v69
    v_cvt_pk_bf16_f32 v85, v66, v67
    v_exp_f32 v70, v70
    v_exp_f32 v71, v71
    v_cvt_pk_bf16_f32 v86, v68, v69
    v_exp_f32 v40, v40
    v_cvt_pk_bf16_f32 v87, v70, v71
    v_mfma_f32_32x32x16_bf16 v[56:71], v[120:123], v[20:23], v[24:39]
    s_waitcnt vmcnt(24)
    s_barrier
    ds_read_b128 v[120:123], v7 offset:2064
    v_exp_f32 v41, v41
    v_exp_f32 v42, v42
    v_exp_f32 v43, v43
    v_cvt_pk_bf16_f32 v72, v40, v41
    v_mfma_f32_32x32x16_bf16 v[104:119], v[128:131], v[84:87], v[104:119]
    s_waitcnt lgkmcnt(1)
    ds_read_b128 v[128:131], v9 offset:0
    v_exp_f32 v44, v44
    v_exp_f32 v45, v45
    v_cvt_pk_bf16_f32 v73, v42, v43
    v_exp_f32 v46, v46
    v_exp_f32 v47, v47
    v_cvt_pk_bf16_f32 v74, v44, v45
    v_exp_f32 v48, v48
    v_exp_f32 v49, v49
    v_cvt_pk_bf16_f32 v75, v46, v47
    v_exp_f32 v50, v50
    v_exp_f32 v51, v51
    v_cvt_pk_bf16_f32 v76, v48, v49
    v_mfma_f32_32x32x16_bf16 v[88:103], v[124:127], v[72:75], v[88:103]
    s_waitcnt lgkmcnt(1)
    buffer_load_dwordx4 v3, s[4:7], s23 offen offset:0 lds
    buffer_load_dwordx4 v3, s[4:7], s23 offen offset:1024 lds
    v_exp_f32 v52, v52
    v_exp_f32 v53, v53
    v_cvt_pk_bf16_f32 v77, v50, v51
    v_exp_f32 v54, v54
    v_exp_f32 v55, v55
    v_cvt_pk_bf16_f32 v78, v52, v53
    v_exp_f32 v56, v56
    v_cvt_pk_bf16_f32 v79, v54, v55
    v_mfma_f32_32x32x16_bf16 v[40:55], v[120:123], v[16:19], v[24:39]
    s_waitcnt lgkmcnt(0)
    buffer_load_dwordx4 a[216:219], v4, s[4:7], s51 offen offset:2048
    buffer_load_dwordx4 a[220:223], v4, s[4:7], s51 offen offset:3072
    v_exp_f32 v57, v57
    v_exp_f32 v58, v58
    v_exp_f32 v59, v59
    v_cvt_pk_bf16_f32 v80, v56, v57
    v_mfma_f32_32x32x16_bf16 v[88:103], v[128:131], v[76:79], v[88:103]
    v_exp_f32 v60, v60
    v_exp_f32 v61, v61
    v_cvt_pk_bf16_f32 v81, v58, v59
    v_exp_f32 v62, v62
    v_exp_f32 v63, v63
    v_cvt_pk_bf16_f32 v82, v60, v61
    v_exp_f32 v64, v64
    v_exp_f32 v65, v65
    v_cvt_pk_bf16_f32 v83, v62, v63
    v_exp_f32 v66, v66
    v_exp_f32 v67, v67
    v_cvt_pk_bf16_f32 v84, v64, v65
    v_mfma_f32_32x32x16_bf16 v[104:119], v[124:127], v[80:83], v[104:119]
    s_cmp_lg_u64 s[0:1], 0
    ds_read_b128 v[124:127], v8 offset:2064
    v_exp_f32 v68, v68
    v_exp_f32 v69, v69
    v_cvt_pk_bf16_f32 v85, v66, v67
    v_exp_f32 v70, v70
    v_exp_f32 v71, v71
    v_cvt_pk_bf16_f32 v86, v68, v69
    v_exp_f32 v40, v40
    v_cvt_pk_bf16_f32 v87, v70, v71
    v_mfma_f32_32x32x16_bf16 v[56:71], v[120:123], v[20:23], v[24:39]
    ds_read_b128 v[120:123], v7 offset:4128
    v_exp_f32 v41, v41
    v_exp_f32 v42, v42
    v_exp_f32 v43, v43
    v_cvt_pk_bf16_f32 v72, v40, v41
    v_mfma_f32_32x32x16_bf16 v[104:119], v[128:131], v[84:87], v[104:119]
    s_waitcnt lgkmcnt(1)
    ds_read_b128 v[128:131], v9 offset:2064
    v_exp_f32 v44, v44
    v_exp_f32 v45, v45
    v_cvt_pk_bf16_f32 v73, v42, v43
    v_exp_f32 v46, v46
    v_exp_f32 v47, v47
    v_cvt_pk_bf16_f32 v74, v44, v45
    v_exp_f32 v48, v48
    v_exp_f32 v49, v49
    v_cvt_pk_bf16_f32 v75, v46, v47
    v_exp_f32 v50, v50
    v_exp_f32 v51, v51
    v_cvt_pk_bf16_f32 v76, v48, v49
    v_mfma_f32_32x32x16_bf16 v[88:103], v[124:127], v[72:75], v[88:103]
    s_waitcnt lgkmcnt(1)
    buffer_load_dwordx4 a[224:227], v5, s[4:7], s51 offen offset:0
    buffer_load_dwordx4 a[228:231], v5, s[4:7], s51 offen offset:1024
    v_exp_f32 v52, v52
    v_exp_f32 v53, v53
    v_cvt_pk_bf16_f32 v77, v50, v51
    v_exp_f32 v54, v54
    v_exp_f32 v55, v55
    v_cvt_pk_bf16_f32 v78, v52, v53
    v_exp_f32 v56, v56
    v_cvt_pk_bf16_f32 v79, v54, v55
    v_mfma_f32_32x32x16_bf16 v[40:55], v[120:123], v[16:19], v[24:39]
    s_waitcnt lgkmcnt(0)
    v_exp_f32 v57, v57
    v_exp_f32 v58, v58
    v_exp_f32 v59, v59
    v_cvt_pk_bf16_f32 v80, v56, v57
    v_mfma_f32_32x32x16_bf16 v[88:103], v[128:131], v[76:79], v[88:103]
    s_cbranch_scc1 Z_main_kernel_6
    buffer_store_dwordx4 a[168:171], v4, s[4:7], s36 offen offset:0
    buffer_store_dwordx4 a[168:171], v4, s[4:7], s36 offen offset:1024
C_main_kernel_7:
    v_exp_f32 v60, v60
    v_exp_f32 v61, v61
    v_cvt_pk_bf16_f32 v81, v58, v59
    v_exp_f32 v62, v62
    v_exp_f32 v63, v63
    v_cvt_pk_bf16_f32 v82, v60, v61
    v_exp_f32 v64, v64
    v_exp_f32 v65, v65
    v_cvt_pk_bf16_f32 v83, v62, v63
    v_exp_f32 v66, v66
    v_exp_f32 v67, v67
    v_cvt_pk_bf16_f32 v84, v64, v65
    v_mfma_f32_32x32x16_bf16 v[104:119], v[124:127], v[80:83], v[104:119]
    s_cmp_lg_u64 s[0:1], 0
    ds_read_b128 v[124:127], v8 offset:4128
    v_exp_f32 v68, v68
    v_exp_f32 v69, v69
    v_cvt_pk_bf16_f32 v85, v66, v67
    v_exp_f32 v70, v70
    v_exp_f32 v71, v71
    v_cvt_pk_bf16_f32 v86, v68, v69
    v_exp_f32 v40, v40
    v_cvt_pk_bf16_f32 v87, v70, v71
    v_mfma_f32_32x32x16_bf16 v[56:71], v[120:123], v[20:23], v[24:39]
    ds_read_b128 v[120:123], v7 offset:6192
    v_exp_f32 v41, v41
    v_exp_f32 v42, v42
    v_exp_f32 v43, v43
    v_cvt_pk_bf16_f32 v72, v40, v41
    v_mfma_f32_32x32x16_bf16 v[104:119], v[128:131], v[84:87], v[104:119]
    s_waitcnt lgkmcnt(1)
    ds_read_b128 v[128:131], v9 offset:4128
    v_exp_f32 v44, v44
    v_exp_f32 v45, v45
    v_cvt_pk_bf16_f32 v73, v42, v43
    v_exp_f32 v46, v46
    v_exp_f32 v47, v47
    v_cvt_pk_bf16_f32 v74, v44, v45
    v_exp_f32 v48, v48
    v_exp_f32 v49, v49
    v_cvt_pk_bf16_f32 v75, v46, v47
    v_exp_f32 v50, v50
    v_exp_f32 v51, v51
    v_cvt_pk_bf16_f32 v76, v48, v49
    v_mfma_f32_32x32x16_bf16 v[88:103], v[124:127], v[72:75], v[88:103]
    s_waitcnt lgkmcnt(1)
    buffer_load_dwordx4 a[232:235], v5, s[4:7], s51 offen offset:2048
    buffer_load_dwordx4 a[236:239], v5, s[4:7], s51 offen offset:3072
    v_exp_f32 v52, v52
    v_exp_f32 v53, v53
    v_cvt_pk_bf16_f32 v77, v50, v51
    v_exp_f32 v54, v54
    v_exp_f32 v55, v55
    v_cvt_pk_bf16_f32 v78, v52, v53
    v_exp_f32 v56, v56
    v_cvt_pk_bf16_f32 v79, v54, v55
    v_mfma_f32_32x32x16_bf16 v[40:55], v[120:123], v[16:19], v[24:39]
    s_waitcnt lgkmcnt(0)
    v_exp_f32 v57, v57
    v_exp_f32 v58, v58
    v_exp_f32 v59, v59
    v_cvt_pk_bf16_f32 v80, v56, v57
    v_mfma_f32_32x32x16_bf16 v[88:103], v[128:131], v[76:79], v[88:103]
    s_cbranch_scc1 Z_main_kernel_8
    buffer_store_dwordx4 a[168:171], v4, s[4:7], s36 offen offset:2048
    buffer_store_dwordx4 a[168:171], v4, s[4:7], s36 offen offset:3072
C_main_kernel_9:
    v_exp_f32 v60, v60
    v_exp_f32 v61, v61
    v_cvt_pk_bf16_f32 v81, v58, v59
    v_exp_f32 v62, v62
    v_exp_f32 v63, v63
    v_cvt_pk_bf16_f32 v82, v60, v61
    v_exp_f32 v64, v64
    v_exp_f32 v65, v65
    v_cvt_pk_bf16_f32 v83, v62, v63
    v_exp_f32 v66, v66
    v_exp_f32 v67, v67
    v_cvt_pk_bf16_f32 v84, v64, v65
    v_mfma_f32_32x32x16_bf16 v[104:119], v[124:127], v[80:83], v[104:119]
    ds_read_b128 v[124:127], v8 offset:6192
    v_exp_f32 v68, v68
    v_exp_f32 v69, v69
    v_cvt_pk_bf16_f32 v85, v66, v67
    v_exp_f32 v70, v70
    v_exp_f32 v71, v71
    v_cvt_pk_bf16_f32 v86, v68, v69
    v_exp_f32 v40, v40
    v_cvt_pk_bf16_f32 v87, v70, v71
    v_mfma_f32_32x32x16_bf16 v[56:71], v[120:123], v[20:23], v[24:39]
    ds_read_b128 v[120:123], v7 offset:8256
    v_exp_f32 v41, v41
    v_exp_f32 v42, v42
    v_exp_f32 v43, v43
    v_cvt_pk_bf16_f32 v72, v40, v41
    v_mfma_f32_32x32x16_bf16 v[104:119], v[128:131], v[84:87], v[104:119]
    s_waitcnt lgkmcnt(1)
    ds_read_b128 v[128:131], v9 offset:6192
    v_exp_f32 v44, v44
    v_exp_f32 v45, v45
    v_cvt_pk_bf16_f32 v73, v42, v43
    v_exp_f32 v46, v46
    v_exp_f32 v47, v47
    v_cvt_pk_bf16_f32 v74, v44, v45
    v_exp_f32 v48, v48
    v_exp_f32 v49, v49
    v_cvt_pk_bf16_f32 v75, v46, v47
    v_exp_f32 v50, v50
    v_exp_f32 v51, v51
    v_cvt_pk_bf16_f32 v76, v48, v49
    v_mfma_f32_32x32x16_bf16 v[88:103], v[124:127], v[72:75], v[88:103]
    s_waitcnt lgkmcnt(1)
    buffer_load_dwordx4 a[240:243], v6, s[4:7], s51 offen offset:0
    buffer_load_dwordx4 a[244:247], v6, s[4:7], s51 offen offset:1024
    v_exp_f32 v52, v52
    v_exp_f32 v53, v53
    v_cvt_pk_bf16_f32 v77, v50, v51
    v_exp_f32 v54, v54
    v_exp_f32 v55, v55
    v_cvt_pk_bf16_f32 v78, v52, v53
    v_exp_f32 v56, v56
    v_cvt_pk_bf16_f32 v79, v54, v55
    v_mfma_f32_32x32x16_bf16 v[40:55], v[120:123], v[16:19], v[24:39]
    s_waitcnt lgkmcnt(0)
    v_exp_f32 v57, v57
    v_exp_f32 v58, v58
    v_exp_f32 v59, v59
    v_cvt_pk_bf16_f32 v80, v56, v57
    v_mfma_f32_32x32x16_bf16 v[88:103], v[128:131], v[76:79], v[88:103]
    v_exp_f32 v60, v60
    v_exp_f32 v61, v61
    v_cvt_pk_bf16_f32 v81, v58, v59
    v_exp_f32 v62, v62
    v_exp_f32 v63, v63
    v_cvt_pk_bf16_f32 v82, v60, v61
    v_exp_f32 v64, v64
    v_exp_f32 v65, v65
    v_cvt_pk_bf16_f32 v83, v62, v63
    v_exp_f32 v66, v66
    v_exp_f32 v67, v67
    v_cvt_pk_bf16_f32 v84, v64, v65
    v_mfma_f32_32x32x16_bf16 v[104:119], v[124:127], v[80:83], v[104:119]
    s_add_u32 m0, s24, 0
    ds_read_b128 v[124:127], v8 offset:8256
    v_exp_f32 v68, v68
    v_exp_f32 v69, v69
    v_cvt_pk_bf16_f32 v85, v66, v67
    v_exp_f32 v70, v70
    v_exp_f32 v71, v71
    v_cvt_pk_bf16_f32 v86, v68, v69
    v_exp_f32 v40, v40
    v_cvt_pk_bf16_f32 v87, v70, v71
    v_mfma_f32_32x32x16_bf16 v[56:71], v[120:123], v[20:23], v[24:39]
    s_waitcnt vmcnt(26)
    s_barrier
    ds_read_b128 v[120:123], v7 offset:10320
    v_exp_f32 v41, v41
    v_exp_f32 v42, v42
    v_exp_f32 v43, v43
    v_cvt_pk_bf16_f32 v72, v40, v41
    v_mfma_f32_32x32x16_bf16 v[104:119], v[128:131], v[84:87], v[104:119]
    s_waitcnt lgkmcnt(1)
    ds_read_b128 v[128:131], v9 offset:8256
    v_exp_f32 v44, v44
    v_exp_f32 v45, v45
    v_cvt_pk_bf16_f32 v73, v42, v43
    v_exp_f32 v46, v46
    v_exp_f32 v47, v47
    v_cvt_pk_bf16_f32 v74, v44, v45
    v_exp_f32 v48, v48
    v_exp_f32 v49, v49
    v_cvt_pk_bf16_f32 v75, v46, v47
    v_exp_f32 v50, v50
    v_exp_f32 v51, v51
    v_cvt_pk_bf16_f32 v76, v48, v49
    v_mfma_f32_32x32x16_bf16 v[88:103], v[124:127], v[72:75], v[88:103]
    s_waitcnt lgkmcnt(1)
    buffer_load_dwordx4 v5, s[4:7], s23 offen offset:0 lds
    buffer_load_dwordx4 v5, s[4:7], s23 offen offset:1024 lds
    v_exp_f32 v52, v52
    v_exp_f32 v53, v53
    v_cvt_pk_bf16_f32 v77, v50, v51
    v_exp_f32 v54, v54
    v_exp_f32 v55, v55
    v_cvt_pk_bf16_f32 v78, v52, v53
    v_exp_f32 v56, v56
    v_cvt_pk_bf16_f32 v79, v54, v55
    v_mfma_f32_32x32x16_bf16 v[40:55], v[120:123], v[16:19], v[24:39]
    s_waitcnt lgkmcnt(0)
    buffer_load_dwordx4 a[248:251], v6, s[4:7], s51 offen offset:2048
    buffer_load_dwordx4 a[252:255], v6, s[4:7], s51 offen offset:3072
    v_exp_f32 v57, v57
    v_exp_f32 v58, v58
    v_exp_f32 v59, v59
    v_cvt_pk_bf16_f32 v80, v56, v57
    v_mfma_f32_32x32x16_bf16 v[88:103], v[128:131], v[76:79], v[88:103]
    v_exp_f32 v60, v60
    v_exp_f32 v61, v61
    v_cvt_pk_bf16_f32 v81, v58, v59
    v_exp_f32 v62, v62
    v_exp_f32 v63, v63
    v_cvt_pk_bf16_f32 v82, v60, v61
    v_exp_f32 v64, v64
    v_exp_f32 v65, v65
    v_cvt_pk_bf16_f32 v83, v62, v63
    v_exp_f32 v66, v66
    v_exp_f32 v67, v67
    v_cvt_pk_bf16_f32 v84, v64, v65
    v_mfma_f32_32x32x16_bf16 v[104:119], v[124:127], v[80:83], v[104:119]
    s_cmp_lg_u64 s[0:1], 0
    ds_read_b128 v[124:127], v8 offset:10320
    v_exp_f32 v68, v68
    v_exp_f32 v69, v69
    v_cvt_pk_bf16_f32 v85, v66, v67
    v_exp_f32 v70, v70
    v_exp_f32 v71, v71
    v_cvt_pk_bf16_f32 v86, v68, v69
    v_exp_f32 v40, v40
    v_cvt_pk_bf16_f32 v87, v70, v71
    v_mfma_f32_32x32x16_bf16 v[56:71], v[120:123], v[20:23], v[24:39]
    ds_read_b128 v[120:123], v7 offset:12384
    v_exp_f32 v41, v41
    v_exp_f32 v42, v42
    v_exp_f32 v43, v43
    v_cvt_pk_bf16_f32 v72, v40, v41
    v_mfma_f32_32x32x16_bf16 v[104:119], v[128:131], v[84:87], v[104:119]
    s_waitcnt lgkmcnt(1)
    ds_read_b128 v[128:131], v9 offset:10320
    v_exp_f32 v44, v44
    v_exp_f32 v45, v45
    v_cvt_pk_bf16_f32 v73, v42, v43
    v_exp_f32 v46, v46
    v_exp_f32 v47, v47
    v_cvt_pk_bf16_f32 v74, v44, v45
    v_exp_f32 v48, v48
    v_exp_f32 v49, v49
    v_cvt_pk_bf16_f32 v75, v46, v47
    v_exp_f32 v50, v50
    v_exp_f32 v51, v51
    v_cvt_pk_bf16_f32 v76, v48, v49
    v_mfma_f32_32x32x16_bf16 v[88:103], v[124:127], v[72:75], v[88:103]
    s_waitcnt lgkmcnt(1)
    buffer_load_dwordx4 a[64:67], v3, s[4:7], s52 offen offset:0
    buffer_load_dwordx4 a[68:71], v3, s[4:7], s52 offen offset:1024
    v_exp_f32 v52, v52
    v_exp_f32 v53, v53
    v_cvt_pk_bf16_f32 v77, v50, v51
    v_exp_f32 v54, v54
    v_exp_f32 v55, v55
    v_cvt_pk_bf16_f32 v78, v52, v53
    v_exp_f32 v56, v56
    v_cvt_pk_bf16_f32 v79, v54, v55
    v_mfma_f32_32x32x16_bf16 v[40:55], v[120:123], v[16:19], v[24:39]
    s_waitcnt lgkmcnt(0)
    v_exp_f32 v57, v57
    v_exp_f32 v58, v58
    v_exp_f32 v59, v59
    v_cvt_pk_bf16_f32 v80, v56, v57
    v_mfma_f32_32x32x16_bf16 v[88:103], v[128:131], v[76:79], v[88:103]
    s_cbranch_scc1 Z_main_kernel_10
    buffer_store_dwordx4 a[168:171], v5, s[4:7], s36 offen offset:0
    buffer_store_dwordx4 a[168:171], v5, s[4:7], s36 offen offset:1024
C_main_kernel_11:
    v_exp_f32 v60, v60
    v_exp_f32 v61, v61
    v_cvt_pk_bf16_f32 v81, v58, v59
    v_exp_f32 v62, v62
    v_exp_f32 v63, v63
    v_cvt_pk_bf16_f32 v82, v60, v61
    v_exp_f32 v64, v64
    v_exp_f32 v65, v65
    v_cvt_pk_bf16_f32 v83, v62, v63
    v_exp_f32 v66, v66
    v_exp_f32 v67, v67
    v_cvt_pk_bf16_f32 v84, v64, v65
    v_mfma_f32_32x32x16_bf16 v[104:119], v[124:127], v[80:83], v[104:119]
    s_cmp_lg_u64 s[0:1], 0
    ds_read_b128 v[124:127], v8 offset:12384
    v_exp_f32 v68, v68
    v_exp_f32 v69, v69
    v_cvt_pk_bf16_f32 v85, v66, v67
    v_exp_f32 v70, v70
    v_exp_f32 v71, v71
    v_cvt_pk_bf16_f32 v86, v68, v69
    v_exp_f32 v40, v40
    v_cvt_pk_bf16_f32 v87, v70, v71
    v_mfma_f32_32x32x16_bf16 v[56:71], v[120:123], v[20:23], v[24:39]
    ds_read_b128 v[120:123], v7 offset:14448
    v_exp_f32 v41, v41
    v_exp_f32 v42, v42
    v_exp_f32 v43, v43
    v_cvt_pk_bf16_f32 v72, v40, v41
    v_mfma_f32_32x32x16_bf16 v[104:119], v[128:131], v[84:87], v[104:119]
    s_waitcnt lgkmcnt(1)
    ds_read_b128 v[128:131], v9 offset:12384
    v_exp_f32 v44, v44
    v_exp_f32 v45, v45
    v_cvt_pk_bf16_f32 v73, v42, v43
    v_exp_f32 v46, v46
    v_exp_f32 v47, v47
    v_cvt_pk_bf16_f32 v74, v44, v45
    v_exp_f32 v48, v48
    v_exp_f32 v49, v49
    v_cvt_pk_bf16_f32 v75, v46, v47
    v_exp_f32 v50, v50
    v_exp_f32 v51, v51
    v_cvt_pk_bf16_f32 v76, v48, v49
    v_mfma_f32_32x32x16_bf16 v[88:103], v[124:127], v[72:75], v[88:103]
    s_waitcnt lgkmcnt(1)
    buffer_load_dwordx4 a[72:75], v3, s[4:7], s52 offen offset:2048
    buffer_load_dwordx4 a[76:79], v3, s[4:7], s52 offen offset:3072
    v_exp_f32 v52, v52
    v_exp_f32 v53, v53
    v_cvt_pk_bf16_f32 v77, v50, v51
    v_exp_f32 v54, v54
    v_exp_f32 v55, v55
    v_cvt_pk_bf16_f32 v78, v52, v53
    v_exp_f32 v56, v56
    v_cvt_pk_bf16_f32 v79, v54, v55
    v_mfma_f32_32x32x16_bf16 v[40:55], v[120:123], v[16:19], v[24:39]
    s_waitcnt lgkmcnt(0)
    v_exp_f32 v57, v57
    v_exp_f32 v58, v58
    v_exp_f32 v59, v59
    v_cvt_pk_bf16_f32 v80, v56, v57
    v_mfma_f32_32x32x16_bf16 v[88:103], v[128:131], v[76:79], v[88:103]
    s_cbranch_scc1 Z_main_kernel_12
    buffer_store_dwordx4 a[168:171], v5, s[4:7], s36 offen offset:2048
    buffer_store_dwordx4 a[168:171], v5, s[4:7], s36 offen offset:3072
C_main_kernel_13:
    v_exp_f32 v60, v60
    v_exp_f32 v61, v61
    v_cvt_pk_bf16_f32 v81, v58, v59
    v_exp_f32 v62, v62
    v_exp_f32 v63, v63
    v_cvt_pk_bf16_f32 v82, v60, v61
    v_exp_f32 v64, v64
    v_exp_f32 v65, v65
    v_cvt_pk_bf16_f32 v83, v62, v63
    v_exp_f32 v66, v66
    v_exp_f32 v67, v67
    v_cvt_pk_bf16_f32 v84, v64, v65
    v_mfma_f32_32x32x16_bf16 v[104:119], v[124:127], v[80:83], v[104:119]
    ds_read_b128 v[124:127], v8 offset:14448
    v_exp_f32 v68, v68
    v_exp_f32 v69, v69
    v_cvt_pk_bf16_f32 v85, v66, v67
    v_exp_f32 v70, v70
    v_exp_f32 v71, v71
    v_cvt_pk_bf16_f32 v86, v68, v69
    v_exp_f32 v40, v40
    v_cvt_pk_bf16_f32 v87, v70, v71
    v_mfma_f32_32x32x16_bf16 v[56:71], v[120:123], v[20:23], v[24:39]
    ds_read_b128 v[120:123], v7 offset:16512
    v_exp_f32 v41, v41
    v_exp_f32 v42, v42
    v_exp_f32 v43, v43
    v_cvt_pk_bf16_f32 v72, v40, v41
    v_mfma_f32_32x32x16_bf16 v[104:119], v[128:131], v[84:87], v[104:119]
    s_waitcnt lgkmcnt(1)
    ds_read_b128 v[128:131], v9 offset:14448
    v_exp_f32 v44, v44
    v_exp_f32 v45, v45
    v_cvt_pk_bf16_f32 v73, v42, v43
    v_exp_f32 v46, v46
    v_exp_f32 v47, v47
    v_cvt_pk_bf16_f32 v74, v44, v45
    v_exp_f32 v48, v48
    v_exp_f32 v49, v49
    v_cvt_pk_bf16_f32 v75, v46, v47
    v_exp_f32 v50, v50
    v_exp_f32 v51, v51
    v_cvt_pk_bf16_f32 v76, v48, v49
    v_mfma_f32_32x32x16_bf16 v[88:103], v[124:127], v[72:75], v[88:103]
    s_waitcnt lgkmcnt(1)
    buffer_load_dwordx4 a[80:83], v4, s[4:7], s52 offen offset:0
    buffer_load_dwordx4 a[84:87], v4, s[4:7], s52 offen offset:1024
    v_exp_f32 v52, v52
    v_exp_f32 v53, v53
    v_cvt_pk_bf16_f32 v77, v50, v51
    v_exp_f32 v54, v54
    v_exp_f32 v55, v55
    v_cvt_pk_bf16_f32 v78, v52, v53
    v_exp_f32 v56, v56
    v_cvt_pk_bf16_f32 v79, v54, v55
    v_mfma_f32_32x32x16_bf16 v[40:55], v[120:123], v[16:19], v[24:39]
    s_waitcnt lgkmcnt(0)
    v_exp_f32 v57, v57
    v_exp_f32 v58, v58
    v_exp_f32 v59, v59
    v_cvt_pk_bf16_f32 v80, v56, v57
    v_mfma_f32_32x32x16_bf16 v[88:103], v[128:131], v[76:79], v[88:103]
    s_add_u32 s23, s23, 16384
    buffer_load_dwordx4 a[88:91], v4, s[4:7], s52 offen offset:2048
    buffer_load_dwordx4 a[92:95], v4, s[4:7], s52 offen offset:3072
    v_exp_f32 v60, v60
    v_exp_f32 v61, v61
    v_cvt_pk_bf16_f32 v81, v58, v59
    v_exp_f32 v62, v62
    v_exp_f32 v63, v63
    v_cvt_pk_bf16_f32 v82, v60, v61
    v_exp_f32 v64, v64
    v_exp_f32 v65, v65
    v_cvt_pk_bf16_f32 v83, v62, v63
    v_exp_f32 v66, v66
    v_exp_f32 v67, v67
    v_cvt_pk_bf16_f32 v84, v64, v65
    v_mfma_f32_32x32x16_bf16 v[104:119], v[124:127], v[80:83], v[104:119]
    s_add_u32 m0, s24, 8256
    ds_read_b128 v[124:127], v8 offset:16512
    v_exp_f32 v68, v68
    v_exp_f32 v69, v69
    v_cvt_pk_bf16_f32 v85, v66, v67
    v_exp_f32 v70, v70
    v_exp_f32 v71, v71
    v_cvt_pk_bf16_f32 v86, v68, v69
    v_exp_f32 v40, v40
    v_cvt_pk_bf16_f32 v87, v70, v71
    v_mfma_f32_32x32x16_bf16 v[56:71], v[120:123], v[20:23], v[24:39]
    s_waitcnt vmcnt(28)
    s_barrier
    ds_read_b128 v[120:123], v7 offset:18576
    v_exp_f32 v41, v41
    v_exp_f32 v42, v42
    v_exp_f32 v43, v43
    v_cvt_pk_bf16_f32 v72, v40, v41
    v_mfma_f32_32x32x16_bf16 v[104:119], v[128:131], v[84:87], v[104:119]
    s_waitcnt lgkmcnt(1)
    ds_read_b128 v[128:131], v9 offset:16512
    v_exp_f32 v44, v44
    v_exp_f32 v45, v45
    v_cvt_pk_bf16_f32 v73, v42, v43
    v_exp_f32 v46, v46
    v_exp_f32 v47, v47
    v_cvt_pk_bf16_f32 v74, v44, v45
    v_exp_f32 v48, v48
    v_exp_f32 v49, v49
    v_cvt_pk_bf16_f32 v75, v46, v47
    v_exp_f32 v50, v50
    v_exp_f32 v51, v51
    v_cvt_pk_bf16_f32 v76, v48, v49
    v_mfma_f32_32x32x16_bf16 v[88:103], v[124:127], v[72:75], v[88:103]
    s_waitcnt lgkmcnt(1)
    buffer_load_dwordx4 v3, s[4:7], s23 offen offset:0 lds
    buffer_load_dwordx4 v3, s[4:7], s23 offen offset:1024 lds
    v_exp_f32 v52, v52
    v_exp_f32 v53, v53
    v_cvt_pk_bf16_f32 v77, v50, v51
    v_exp_f32 v54, v54
    v_exp_f32 v55, v55
    v_cvt_pk_bf16_f32 v78, v52, v53
    v_exp_f32 v56, v56
    v_cvt_pk_bf16_f32 v79, v54, v55
    v_mfma_f32_32x32x16_bf16 v[40:55], v[120:123], v[16:19], v[24:39]
    s_waitcnt lgkmcnt(0)
    buffer_load_dwordx4 a[96:99], v5, s[4:7], s52 offen offset:0
    buffer_load_dwordx4 a[100:103], v5, s[4:7], s52 offen offset:1024
    v_exp_f32 v57, v57
    v_exp_f32 v58, v58
    v_exp_f32 v59, v59
    v_cvt_pk_bf16_f32 v80, v56, v57
    v_mfma_f32_32x32x16_bf16 v[88:103], v[128:131], v[76:79], v[88:103]
    v_exp_f32 v60, v60
    v_exp_f32 v61, v61
    v_cvt_pk_bf16_f32 v81, v58, v59
    v_exp_f32 v62, v62
    v_exp_f32 v63, v63
    v_cvt_pk_bf16_f32 v82, v60, v61
    v_exp_f32 v64, v64
    v_exp_f32 v65, v65
    v_cvt_pk_bf16_f32 v83, v62, v63
    v_exp_f32 v66, v66
    v_exp_f32 v67, v67
    v_cvt_pk_bf16_f32 v84, v64, v65
    v_mfma_f32_32x32x16_bf16 v[104:119], v[124:127], v[80:83], v[104:119]
    ds_read_b128 v[124:127], v8 offset:18576
    v_exp_f32 v68, v68
    v_exp_f32 v69, v69
    v_cvt_pk_bf16_f32 v85, v66, v67
    v_exp_f32 v70, v70
    v_exp_f32 v71, v71
    v_cvt_pk_bf16_f32 v86, v68, v69
    v_exp_f32 v40, v40
    v_cvt_pk_bf16_f32 v87, v70, v71
    v_mfma_f32_32x32x16_bf16 v[56:71], v[120:123], v[20:23], v[24:39]
    ds_read_b128 v[120:123], v7 offset:20640
    v_exp_f32 v41, v41
    v_exp_f32 v42, v42
    v_exp_f32 v43, v43
    v_cvt_pk_bf16_f32 v72, v40, v41
    v_mfma_f32_32x32x16_bf16 v[104:119], v[128:131], v[84:87], v[104:119]
    s_waitcnt lgkmcnt(1)
    ds_read_b128 v[128:131], v9 offset:18576
    v_exp_f32 v44, v44
    v_exp_f32 v45, v45
    v_cvt_pk_bf16_f32 v73, v42, v43
    v_exp_f32 v46, v46
    v_exp_f32 v47, v47
    v_cvt_pk_bf16_f32 v74, v44, v45
    v_exp_f32 v48, v48
    v_exp_f32 v49, v49
    v_cvt_pk_bf16_f32 v75, v46, v47
    v_exp_f32 v50, v50
    v_exp_f32 v51, v51
    v_cvt_pk_bf16_f32 v76, v48, v49
    v_mfma_f32_32x32x16_bf16 v[88:103], v[124:127], v[72:75], v[88:103]
    s_waitcnt lgkmcnt(1)
    buffer_load_dwordx4 a[104:107], v5, s[4:7], s52 offen offset:2048
    buffer_load_dwordx4 a[108:111], v5, s[4:7], s52 offen offset:3072
    v_exp_f32 v52, v52
    v_exp_f32 v53, v53
    v_cvt_pk_bf16_f32 v77, v50, v51
    v_exp_f32 v54, v54
    v_exp_f32 v55, v55
    v_cvt_pk_bf16_f32 v78, v52, v53
    v_exp_f32 v56, v56
    v_cvt_pk_bf16_f32 v79, v54, v55
    v_mfma_f32_32x32x16_bf16 v[40:55], v[120:123], v[16:19], v[24:39]
    s_waitcnt lgkmcnt(0)
    v_exp_f32 v57, v57
    v_exp_f32 v58, v58
    v_exp_f32 v59, v59
    v_cvt_pk_bf16_f32 v80, v56, v57
    v_mfma_f32_32x32x16_bf16 v[88:103], v[128:131], v[76:79], v[88:103]
    v_exp_f32 v60, v60
    v_exp_f32 v61, v61
    v_cvt_pk_bf16_f32 v81, v58, v59
    v_exp_f32 v62, v62
    v_exp_f32 v63, v63
    v_cvt_pk_bf16_f32 v82, v60, v61
    v_exp_f32 v64, v64
    v_exp_f32 v65, v65
    v_cvt_pk_bf16_f32 v83, v62, v63
    v_exp_f32 v66, v66
    v_exp_f32 v67, v67
    v_cvt_pk_bf16_f32 v84, v64, v65
    v_mfma_f32_32x32x16_bf16 v[104:119], v[124:127], v[80:83], v[104:119]
    ds_read_b128 v[124:127], v8 offset:20640
    v_exp_f32 v68, v68
    v_exp_f32 v69, v69
    v_cvt_pk_bf16_f32 v85, v66, v67
    v_exp_f32 v70, v70
    v_exp_f32 v71, v71
    v_cvt_pk_bf16_f32 v86, v68, v69
    v_exp_f32 v40, v40
    v_cvt_pk_bf16_f32 v87, v70, v71
    v_mfma_f32_32x32x16_bf16 v[56:71], v[120:123], v[20:23], v[24:39]
    ds_read_b128 v[120:123], v7 offset:22704
    v_exp_f32 v41, v41
    v_exp_f32 v42, v42
    v_exp_f32 v43, v43
    v_cvt_pk_bf16_f32 v72, v40, v41
    v_mfma_f32_32x32x16_bf16 v[104:119], v[128:131], v[84:87], v[104:119]
    s_waitcnt lgkmcnt(1)
    ds_read_b128 v[128:131], v9 offset:20640
    v_exp_f32 v44, v44
L_hop_main_kernel_5:
    s_cbranch_execz L_hop_main_kernel_9
    v_exp_f32 v45, v45
    v_cvt_pk_bf16_f32 v73, v42, v43
    v_exp_f32 v46, v46
    v_exp_f32 v47, v47
    v_cvt_pk_bf16_f32 v74, v44, v45
    v_exp_f32 v48, v48
    v_exp_f32 v49, v49
    v_cvt_pk_bf16_f32 v75, v46, v47
    v_exp_f32 v50, v50
    v_exp_f32 v51, v51
    v_cvt_pk_bf16_f32 v76, v48, v49
    v_mfma_f32_32x32x16_bf16 v[88:103], v[124:127], v[72:75], v[88:103]
    s_waitcnt lgkmcnt(1)
    buffer_load_dwordx4 a[112:115], v6, s[4:7], s52 offen offset:0
    buffer_load_dwordx4 a[116:119], v6, s[4:7], s52 offen offset:1024
    v_exp_f32 v52, v52
    v_exp_f32 v53, v53
    v_cvt_pk_bf16_f32 v77, v50, v51
    v_exp_f32 v54, v54
    v_exp_f32 v55, v55
    v_cvt_pk_bf16_f32 v78, v52, v53
    v_exp_f32 v56, v56
    v_cvt_pk_bf16_f32 v79, v54, v55
    v_mfma_f32_32x32x16_bf16 v[40:55], v[120:123], v[16:19], v[24:39]
    s_waitcnt lgkmcnt(0)
    v_exp_f32 v57, v57
    v_exp_f32 v58, v58
    v_exp_f32 v59, v59
    v_cvt_pk_bf16_f32 v80, v56, v57
    v_mfma_f32_32x32x16_bf16 v[88:103], v[128:131], v[76:79], v[88:103]
    v_exp_f32 v60, v60
    v_exp_f32 v61, v61
    v_cvt_pk_bf16_f32 v81, v58, v59
    v_exp_f32 v62, v62
    v_exp_f32 v63, v63
    v_cvt_pk_bf16_f32 v82, v60, v61
    v_exp_f32 v64, v64
    v_exp_f32 v65, v65
    v_cvt_pk_bf16_f32 v83, v62, v63
    v_exp_f32 v66, v66
    v_exp_f32 v67, v67
    v_cvt_pk_bf16_f32 v84, v64, v65
    v_mfma_f32_32x32x16_bf16 v[104:119], v[124:127], v[80:83], v[104:119]
    ds_read_b128 v[124:127], v8 offset:22704
    v_exp_f32 v68, v68
    v_exp_f32 v69, v69
    v_cvt_pk_bf16_f32 v85, v66, v67
    v_exp_f32 v70, v70
    v_exp_f32 v71, v71
    v_cvt_pk_bf16_f32 v86, v68, v69
    v_exp_f32 v40, v40
    v_cvt_pk_bf16_f32 v87, v70, v71
    v_mfma_f32_32x32x16_bf16 v[56:71], v[120:123], v[20:23], v[24:39]
    ds_read_b128 v[120:123], v7 offset:24768
    v_exp_f32 v41, v41
    v_exp_f32 v42, v42
    v_exp_f32 v43, v43
    v_cvt_pk_bf16_f32 v72, v40, v41
    v_mfma_f32_32x32x16_bf16 v[104:119], v[128:131], v[84:87], v[104:119]
    s_waitcnt lgkmcnt(1)
    ds_read_b128 v[128:131], v9 offset:22704
    v_exp_f32 v44, v44
    v_exp_f32 v45, v45
    v_cvt_pk_bf16_f32 v73, v42, v43
    v_exp_f32 v46, v46
    v_exp_f32 v47, v47
    v_cvt_pk_bf16_f32 v74, v44, v45
    v_exp_f32 v48, v48
    v_exp_f32 v49, v49
    v_cvt_pk_bf16_f32 v75, v46, v47
    v_exp_f32 v50, v50
    v_exp_f32 v51, v51
    v_cvt_pk_bf16_f32 v76, v48, v49
    v_mfma_f32_32x32x16_bf16 v[88:103], v[124:127], v[72:75], v[88:103]
    s_waitcnt lgkmcnt(1)
    buffer_load_dwordx4 a[120:123], v6, s[4:7], s52 offen offset:2048
    buffer_load_dwordx4 a[124:127], v6, s[4:7], s52 offen offset:3072
    v_exp_f32 v52, v52
    v_exp_f32 v53, v53
    v_cvt_pk_bf16_f32 v77, v50, v51
    v_exp_f32 v54, v54
    v_exp_f32 v55, v55
    v_cvt_pk_bf16_f32 v78, v52, v53
    v_exp_f32 v56, v56
    v_cvt_pk_bf16_f32 v79, v54, v55
    v_mfma_f32_32x32x16_bf16 v[40:55], v[120:123], v[16:19], v[24:39]
    s_waitcnt lgkmcnt(0)
    v_exp_f32 v57, v57
    v_exp_f32 v58, v58
    v_exp_f32 v59, v59
    v_cvt_pk_bf16_f32 v80, v56, v57
    v_mfma_f32_32x32x16_bf16 v[88:103], v[128:131], v[76:79], v[88:103]
    buffer_load_dwordx4 a[128:131], v3, s[4:7], s53 offen offset:0
    buffer_load_dwordx4 a[132:135], v3, s[4:7], s53 offen offset:1024
    v_exp_f32 v60, v60
    v_exp_f32 v61, v61
    v_cvt_pk_bf16_f32 v81, v58, v59
    v_exp_f32 v62, v62
    v_exp_f32 v63, v63
    v_cvt_pk_bf16_f32 v82, v60, v61
    v_exp_f32 v64, v64
    v_exp_f32 v65, v65
    v_cvt_pk_bf16_f32 v83, v62, v63
    v_exp_f32 v66, v66
    v_exp_f32 v67, v67
    v_cvt_pk_bf16_f32 v84, v64, v65
    v_mfma_f32_32x32x16_bf16 v[104:119], v[124:127], v[80:83], v[104:119]
    s_add_u32 m0, s24, 16512
    ds_read_b128 v[124:127], v8 offset:24768
    v_exp_f32 v68, v68
    v_exp_f32 v69, v69
    v_cvt_pk_bf16_f32 v85, v66, v67
    v_exp_f32 v70, v70
    v_exp_f32 v71, v71
    v_cvt_pk_bf16_f32 v86, v68, v69
    v_exp_f32 v40, v40
    v_cvt_pk_bf16_f32 v87, v70, v71
    v_mfma_f32_32x32x16_bf16 v[56:71], v[120:123], v[20:23], v[24:39]
    s_waitcnt vmcnt(26)
    s_barrier
    ds_read_b128 v[120:123], v7 offset:0
    v_exp_f32 v41, v41
    v_exp_f32 v42, v42
    v_exp_f32 v43, v43
    v_cvt_pk_bf16_f32 v72, v40, v41
    v_mfma_f32_32x32x16_bf16 v[104:119], v[128:131], v[84:87], v[104:119]
    s_waitcnt lgkmcnt(1)
    ds_read_b128 v[128:131], v9 offset:24768
    v_exp_f32 v44, v44
    v_exp_f32 v45, v45
    v_cvt_pk_bf16_f32 v73, v42, v43
    v_exp_f32 v46, v46
    v_exp_f32 v47, v47
    v_cvt_pk_bf16_f32 v74, v44, v45
    v_exp_f32 v48, v48
    v_exp_f32 v49, v49
    v_cvt_pk_bf16_f32 v75, v46, v47
    v_exp_f32 v50, v50
    v_exp_f32 v51, v51
    v_cvt_pk_bf16_f32 v76, v48, v49
    v_mfma_f32_32x32x16_bf16 v[88:103], v[124:127], v[72:75], v[88:103]
    s_waitcnt lgkmcnt(1)
    buffer_load_dwordx4 v5, s[4:7], s23 offen offset:0 lds
    buffer_load_dwordx4 v5, s[4:7], s23 offen offset:1024 lds
    v_exp_f32 v52, v52
    v_exp_f32 v53, v53
    v_cvt_pk_bf16_f32 v77, v50, v51
    v_exp_f32 v54, v54
    v_exp_f32 v55, v55
    v_cvt_pk_bf16_f32 v78, v52, v53
    v_exp_f32 v56, v56
    v_cvt_pk_bf16_f32 v79, v54, v55
    v_mfma_f32_32x32x16_bf16 v[40:55], v[120:123], v[16:19], v[24:39]
    s_waitcnt lgkmcnt(0)
    buffer_load_dwordx4 a[136:139], v3, s[4:7], s53 offen offset:2048
    buffer_load_dwordx4 a[140:143], v3, s[4:7], s53 offen offset:3072
    v_exp_f32 v57, v57
    v_exp_f32 v58, v58
    v_exp_f32 v59, v59
    v_cvt_pk_bf16_f32 v80, v56, v57
    v_mfma_f32_32x32x16_bf16 v[88:103], v[128:131], v[76:79], v[88:103]
    buffer_load_dword v0, v134, s[4:7], s68 offen sc1
    v_exp_f32 v60, v60
    v_exp_f32 v61, v61
    v_cvt_pk_bf16_f32 v81, v58, v59
    v_exp_f32 v62, v62
    v_exp_f32 v63, v63
    v_cvt_pk_bf16_f32 v82, v60, v61
    v_exp_f32 v64, v64
    v_exp_f32 v65, v65
    v_cvt_pk_bf16_f32 v83, v62, v63
    v_exp_f32 v66, v66
    v_exp_f32 v67, v67
    v_cvt_pk_bf16_f32 v84, v64, v65
    v_mfma_f32_32x32x16_bf16 v[104:119], v[124:127], v[80:83], v[104:119]
    ds_read_b128 v[124:127], v8 offset:0
    v_exp_f32 v68, v68
    v_exp_f32 v69, v69
    v_cvt_pk_bf16_f32 v85, v66, v67
    v_exp_f32 v70, v70
    v_exp_f32 v71, v71
    v_cvt_pk_bf16_f32 v86, v68, v69
    v_exp_f32 v40, v40
    v_cvt_pk_bf16_f32 v87, v70, v71
    v_mfma_f32_32x32x16_bf16 v[56:71], v[120:123], v[20:23], v[24:39]
    ds_read_b128 v[120:123], v7 offset:2064
    v_exp_f32 v41, v41
    v_exp_f32 v42, v42
    v_exp_f32 v43, v43
    v_cvt_pk_bf16_f32 v72, v40, v41
    v_mfma_f32_32x32x16_bf16 v[104:119], v[128:131], v[84:87], v[104:119]
    s_waitcnt lgkmcnt(1)
    ds_read_b128 v[128:131], v9 offset:0
    v_exp_f32 v44, v44
    v_exp_f32 v45, v45
    v_cvt_pk_bf16_f32 v73, v42, v43
    v_exp_f32 v46, v46
    v_exp_f32 v47, v47
    v_cvt_pk_bf16_f32 v74, v44, v45
    v_exp_f32 v48, v48
    v_exp_f32 v49, v49
    v_cvt_pk_bf16_f32 v75, v46, v47
    v_exp_f32 v50, v50
    v_exp_f32 v51, v51
    v_cvt_pk_bf16_f32 v76, v48, v49
    v_mfma_f32_32x32x16_bf16 v[88:103], v[124:127], v[72:75], v[88:103]
    s_waitcnt lgkmcnt(1)
    buffer_load_dwordx4 a[144:147], v4, s[4:7], s53 offen offset:0
    buffer_load_dwordx4 a[148:151], v4, s[4:7], s53 offen offset:1024
    v_exp_f32 v52, v52
    v_exp_f32 v53, v53
    v_cvt_pk_bf16_f32 v77, v50, v51
    v_exp_f32 v54, v54
    v_exp_f32 v55, v55
    v_cvt_pk_bf16_f32 v78, v52, v53
    v_exp_f32 v56, v56
    v_cvt_pk_bf16_f32 v79, v54, v55
    v_mfma_f32_32x32x16_bf16 v[40:55], v[120:123], v[16:19], v[24:39]
    s_waitcnt lgkmcnt(0)
    v_exp_f32 v57, v57
    v_exp_f32 v58, v58
    v_exp_f32 v59, v59
    v_cvt_pk_bf16_f32 v80, v56, v57
    v_mfma_f32_32x32x16_bf16 v[88:103], v[128:131], v[76:79], v[88:103]
    v_exp_f32 v60, v60
    v_exp_f32 v61, v61
    v_cvt_pk_bf16_f32 v81, v58, v59
    v_exp_f32 v62, v62
    v_exp_f32 v63, v63
    v_cvt_pk_bf16_f32 v82, v60, v61
    v_exp_f32 v64, v64
    v_exp_f32 v65, v65
    v_cvt_pk_bf16_f32 v83, v62, v63
    v_exp_f32 v66, v66
    v_exp_f32 v67, v67
    v_cvt_pk_bf16_f32 v84, v64, v65
    v_mfma_f32_32x32x16_bf16 v[104:119], v[124:127], v[80:83], v[104:119]
    ds_read_b128 v[124:127], v8 offset:2064
    v_exp_f32 v68, v68
    v_exp_f32 v69, v69
    v_cvt_pk_bf16_f32 v85, v66, v67
    v_exp_f32 v70, v70
    v_exp_f32 v71, v71
    v_cvt_pk_bf16_f32 v86, v68, v69
    v_exp_f32 v40, v40
    v_cvt_pk_bf16_f32 v87, v70, v71
    v_mfma_f32_32x32x16_bf16 v[56:71], v[120:123], v[20:23], v[24:39]
    ds_read_b128 v[120:123], v7 offset:4128
    v_exp_f32 v41, v41
    v_exp_f32 v42, v42
    v_exp_f32 v43, v43
    v_cvt_pk_bf16_f32 v72, v40, v41
    v_mfma_f32_32x32x16_bf16 v[104:119], v[128:131], v[84:87], v[104:119]
    s_waitcnt lgkmcnt(1)
    ds_read_b128 v[128:131], v9 offset:2064
    v_exp_f32 v44, v44
    v_exp_f32 v45, v45
    v_cvt_pk_bf16_f32 v73, v42, v43
    v_exp_f32 v46, v46
    v_exp_f32 v47, v47
    v_cvt_pk_bf16_f32 v74, v44, v45
    v_exp_f32 v48, v48
    v_exp_f32 v49, v49
    v_cvt_pk_bf16_f32 v75, v46, v47
    v_exp_f32 v50, v50
    v_exp_f32 v51, v51
    v_cvt_pk_bf16_f32 v76, v48, v49
    v_mfma_f32_32x32x16_bf16 v[88:103], v[124:127], v[72:75], v[88:103]
    s_waitcnt lgkmcnt(1)
    buffer_load_dwordx4 a[152:155], v4, s[4:7], s53 offen offset:2048
    buffer_load_dwordx4 a[156:159], v4, s[4:7], s53 offen offset:3072
    v_exp_f32 v52, v52
    v_exp_f32 v53, v53
    v_cvt_pk_bf16_f32 v77, v50, v51
    v_exp_f32 v54, v54
    v_exp_f32 v55, v55
    v_cvt_pk_bf16_f32 v78, v52, v53
    v_exp_f32 v56, v56
    v_cvt_pk_bf16_f32 v79, v54, v55
    v_mfma_f32_32x32x16_bf16 v[40:55], v[120:123], v[16:19], v[24:39]
    s_waitcnt lgkmcnt(0)
    v_exp_f32 v57, v57
    v_exp_f32 v58, v58
    v_exp_f32 v59, v59
    v_cvt_pk_bf16_f32 v80, v56, v57
    v_mfma_f32_32x32x16_bf16 v[88:103], v[128:131], v[76:79], v[88:103]
    v_exp_f32 v60, v60
    v_exp_f32 v61, v61
    v_cvt_pk_bf16_f32 v81, v58, v59
    v_exp_f32 v62, v62
    v_exp_f32 v63, v63
    v_cvt_pk_bf16_f32 v82, v60, v61
    v_exp_f32 v64, v64
    v_exp_f32 v65, v65
    v_cvt_pk_bf16_f32 v83, v62, v63
    v_exp_f32 v66, v66
    v_exp_f32 v67, v67
    v_cvt_pk_bf16_f32 v84, v64, v65
    v_mfma_f32_32x32x16_bf16 v[104:119], v[124:127], v[80:83], v[104:119]
    ds_read_b128 v[124:127], v8 offset:4128
    v_exp_f32 v68, v68
    v_exp_f32 v69, v69
    v_cvt_pk_bf16_f32 v85, v66, v67
    v_exp_f32 v70, v70
    v_exp_f32 v71, v71
    v_cvt_pk_bf16_f32 v86, v68, v69
    v_exp_f32 v40, v40
    v_cvt_pk_bf16_f32 v87, v70, v71
    v_mfma_f32_32x32x16_bf16 v[56:71], v[120:123], v[20:23], v[24:39]
    ds_read_b128 v[120:123], v7 offset:6192
    v_exp_f32 v41, v41
    v_exp_f32 v42, v42
    v_exp_f32 v43, v43
    v_cvt_pk_bf16_f32 v72, v40, v41
    v_mfma_f32_32x32x16_bf16 v[104:119], v[128:131], v[84:87], v[104:119]
    s_waitcnt lgkmcnt(1)
    ds_read_b128 v[128:131], v9 offset:4128
    v_exp_f32 v44, v44
    v_exp_f32 v45, v45
    v_cvt_pk_bf16_f32 v73, v42, v43
    v_exp_f32 v46, v46
    v_exp_f32 v47, v47
    v_cvt_pk_bf16_f32 v74, v44, v45
    v_exp_f32 v48, v48
    v_exp_f32 v49, v49
    v_cvt_pk_bf16_f32 v75, v46, v47
    v_exp_f32 v50, v50
    v_exp_f32 v51, v51
    v_cvt_pk_bf16_f32 v76, v48, v49
    v_mfma_f32_32x32x16_bf16 v[88:103], v[124:127], v[72:75], v[88:103]
    s_waitcnt lgkmcnt(1)
    v_exp_f32 v52, v52
    v_exp_f32 v53, v53
    v_cvt_pk_bf16_f32 v77, v50, v51
    v_exp_f32 v54, v54
    v_exp_f32 v55, v55
    v_cvt_pk_bf16_f32 v78, v52, v53
    v_exp_f32 v56, v56
    v_cvt_pk_bf16_f32 v79, v54, v55
    v_mfma_f32_32x32x16_bf16 v[40:55], v[120:123], v[16:19], v[24:39]
    s_waitcnt lgkmcnt(0)
    v_exp_f32 v57, v57
    v_exp_f32 v58, v58
    v_exp_f32 v59, v59
    v_cvt_pk_bf16_f32 v80, v56, v57
    v_mfma_f32_32x32x16_bf16 v[88:103], v[128:131], v[76:79], v[88:103]
    buffer_load_dword v0, v138, s[4:7], 0 offen offset:0 sc1
    v_exp_f32 v60, v60
    v_exp_f32 v61, v61
    v_cvt_pk_bf16_f32 v81, v58, v59
    v_exp_f32 v62, v62
    v_exp_f32 v63, v63
    v_cvt_pk_bf16_f32 v82, v60, v61
    v_exp_f32 v64, v64
    v_exp_f32 v65, v65
    v_cvt_pk_bf16_f32 v83, v62, v63
    v_exp_f32 v66, v66
    v_exp_f32 v67, v67
    v_cvt_pk_bf16_f32 v84, v64, v65
    v_mfma_f32_32x32x16_bf16 v[104:119], v[124:127], v[80:83], v[104:119]
    ds_read_b128 v[124:127], v8 offset:6192
    v_exp_f32 v68, v68
    v_exp_f32 v69, v69
    v_cvt_pk_bf16_f32 v85, v66, v67
    v_exp_f32 v70, v70
    v_exp_f32 v71, v71
    v_cvt_pk_bf16_f32 v86, v68, v69
    v_exp_f32 v40, v40
    v_cvt_pk_bf16_f32 v87, v70, v71
    v_mfma_f32_32x32x16_bf16 v[56:71], v[120:123], v[20:23], v[24:39]
    s_waitcnt vmcnt(20)
    s_barrier
    ds_read_b128 v[120:123], v7 offset:8256
    v_exp_f32 v41, v41
    v_exp_f32 v42, v42
    v_exp_f32 v43, v43
    v_cvt_pk_bf16_f32 v72, v40, v41
    v_mfma_f32_32x32x16_bf16 v[104:119], v[128:131], v[84:87], v[104:119]
    s_waitcnt lgkmcnt(1)
    ds_read_b128 v[128:131], v9 offset:6192
    v_exp_f32 v44, v44
    v_exp_f32 v45, v45
    v_cvt_pk_bf16_f32 v73, v42, v43
    v_exp_f32 v46, v46
    v_exp_f32 v47, v47
    v_cvt_pk_bf16_f32 v74, v44, v45
    v_exp_f32 v48, v48
    v_exp_f32 v49, v49
    v_cvt_pk_bf16_f32 v75, v46, v47
    v_exp_f32 v50, v50
    v_exp_f32 v51, v51
    v_cvt_pk_bf16_f32 v76, v48, v49
    v_mfma_f32_32x32x16_bf16 v[88:103], v[124:127], v[72:75], v[88:103]
    s_waitcnt lgkmcnt(1)
    v_exp_f32 v52, v52
    v_exp_f32 v53, v53
    v_cvt_pk_bf16_f32 v77, v50, v51
    v_exp_f32 v54, v54
    v_exp_f32 v55, v55
    v_cvt_pk_bf16_f32 v78, v52, v53
    v_exp_f32 v56, v56
    v_cvt_pk_bf16_f32 v79, v54, v55
    v_mfma_f32_32x32x16_bf16 v[40:55], v[120:123], v[16:19], v[24:39]
    s_waitcnt lgkmcnt(0)
    v_exp_f32 v57, v57
    v_exp_f32 v58, v58
    v_exp_f32 v59, v59
    v_cvt_pk_bf16_f32 v80, v56, v57
    v_mfma_f32_32x32x16_bf16 v[88:103], v[128:131], v[76:79], v[88:103]
    global_load_dword v0, v[136:137], off
    v_exp_f32 v60, v60
    v_exp_f32 v61, v61
    v_cvt_pk_bf16_f32 v81, v58, v59
    v_exp_f32 v62, v62
    v_exp_f32 v63, v63
    v_cvt_pk_bf16_f32 v82, v60, v61
    v_exp_f32 v64, v64
    v_exp_f32 v65, v65
    v_cvt_pk_bf16_f32 v83, v62, v63
    v_exp_f32 v66, v66
    v_exp_f32 v67, v67
    v_cvt_pk_bf16_f32 v84, v64, v65
    v_mfma_f32_32x32x16_bf16 v[104:119], v[124:127], v[80:83], v[104:119]
    ds_read_b128 v[124:127], v8 offset:8256
    v_exp_f32 v68, v68
    v_exp_f32 v69, v69
    v_cvt_pk_bf16_f32 v85, v66, v67
    v_exp_f32 v70, v70
    v_exp_f32 v71, v71
    v_cvt_pk_bf16_f32 v86, v68, v69
    v_exp_f32 v40, v40
    v_cvt_pk_bf16_f32 v87, v70, v71
    v_mfma_f32_32x32x16_bf16 v[56:71], v[120:123], v[20:23], v[24:39]
    ds_read_b128 v[120:123], v7 offset:10320
    v_exp_f32 v41, v41
    v_exp_f32 v42, v42
    v_exp_f32 v43, v43
    v_cvt_pk_bf16_f32 v72, v40, v41
    v_mfma_f32_32x32x16_bf16 v[104:119], v[128:131], v[84:87], v[104:119]
    s_waitcnt lgkmcnt(1)
    ds_read_b128 v[128:131], v9 offset:8256
    v_exp_f32 v44, v44
    v_exp_f32 v45, v45
    v_cvt_pk_bf16_f32 v73, v42, v43
    v_exp_f32 v46, v46
    v_exp_f32 v47, v47
    v_cvt_pk_bf16_f32 v74, v44, v45
    v_exp_f32 v48, v48
    v_exp_f32 v49, v49
    v_cvt_pk_bf16_f32 v75, v46, v47
    v_exp_f32 v50, v50
    v_exp_f32 v51, v51
    v_cvt_pk_bf16_f32 v76, v48, v49
    v_mfma_f32_32x32x16_bf16 v[88:103], v[124:127], v[72:75], v[88:103]
    s_waitcnt lgkmcnt(1)
    v_exp_f32 v52, v52
    v_exp_f32 v53, v53
    v_cvt_pk_bf16_f32 v77, v50, v51
    v_exp_f32 v54, v54
    v_exp_f32 v55, v55
    v_cvt_pk_bf16_f32 v78, v52, v53
    v_exp_f32 v56, v56
    v_cvt_pk_bf16_f32 v79, v54, v55
    v_mfma_f32_32x32x16_bf16 v[40:55], v[120:123], v[16:19], v[24:39]
    s_waitcnt lgkmcnt(0)
    v_exp_f32 v57, v57
    v_exp_f32 v58, v58
    v_exp_f32 v59, v59
    v_cvt_pk_bf16_f32 v80, v56, v57
    v_mfma_f32_32x32x16_bf16 v[88:103], v[128:131], v[76:79], v[88:103]
    buffer_load_dword v0, v139, s[4:7], 0 offen offset:0 sc1
    v_exp_f32 v60, v60
    v_exp_f32 v61, v61
    v_cvt_pk_bf16_f32 v81, v58, v59
    v_exp_f32 v62, v62
    v_exp_f32 v63, v63
    v_cvt_pk_bf16_f32 v82, v60, v61
    v_exp_f32 v64, v64
    v_exp_f32 v65, v65
    v_cvt_pk_bf16_f32 v83, v62, v63
    v_exp_f32 v66, v66
    v_exp_f32 v67, v67
    v_cvt_pk_bf16_f32 v84, v64, v65
    v_mfma_f32_32x32x16_bf16 v[104:119], v[124:127], v[80:83], v[104:119]
    ds_read_b128 v[124:127], v8 offset:10320
    v_exp_f32 v68, v68
    v_exp_f32 v69, v69
    v_cvt_pk_bf16_f32 v85, v66, v67
    v_exp_f32 v70, v70
    v_exp_f32 v71, v71
    v_cvt_pk_bf16_f32 v86, v68, v69
    v_exp_f32 v40, v40
    v_cvt_pk_bf16_f32 v87, v70, v71
    v_mfma_f32_32x32x16_bf16 v[56:71], v[120:123], v[20:23], v[24:39]
    ds_read_b128 v[120:123], v7 offset:12384
    v_exp_f32 v41, v41
    v_exp_f32 v42, v42
    v_exp_f32 v43, v43
    v_cvt_pk_bf16_f32 v72, v40, v41
    v_mfma_f32_32x32x16_bf16 v[104:119], v[128:131], v[84:87], v[104:119]
    s_waitcnt lgkmcnt(1)
    ds_read_b128 v[128:131], v9 offset:10320
    v_exp_f32 v44, v44
    v_exp_f32 v45, v45
    v_cvt_pk_bf16_f32 v73, v42, v43
    v_exp_f32 v46, v46
    v_exp_f32 v47, v47
    v_cvt_pk_bf16_f32 v74, v44, v45
    v_exp_f32 v48, v48
    v_exp_f32 v49, v49
    v_cvt_pk_bf16_f32 v75, v46, v47
    v_exp_f32 v50, v50
    v_exp_f32 v51, v51
    v_cvt_pk_bf16_f32 v76, v48, v49
    v_mfma_f32_32x32x16_bf16 v[88:103], v[124:127], v[72:75], v[88:103]
    s_waitcnt lgkmcnt(1)
    v_exp_f32 v52, v52
    v_exp_f32 v53, v53
    v_cvt_pk_bf16_f32 v77, v50, v51
    v_exp_f32 v54, v54
    v_exp_f32 v55, v55
    v_cvt_pk_bf16_f32 v78, v52, v53
    v_exp_f32 v56, v56
    v_cvt_pk_bf16_f32 v79, v54, v55
    v_mfma_f32_32x32x16_bf16 v[40:55], v[120:123], v[16:19], v[24:39]
    s_waitcnt lgkmcnt(0)
    v_exp_f32 v57, v57
    v_exp_f32 v58, v58
    v_exp_f32 v59, v59
    v_cvt_pk_bf16_f32 v80, v56, v57
    v_mfma_f32_32x32x16_bf16 v[88:103], v[128:131], v[76:79], v[88:103]
    v_exp_f32 v60, v60
    v_exp_f32 v61, v61
    v_cvt_pk_bf16_f32 v81, v58, v59
    v_exp_f32 v62, v62
    v_exp_f32 v63, v63
    v_cvt_pk_bf16_f32 v82, v60, v61
    v_exp_f32 v64, v64
    v_exp_f32 v65, v65
    v_cvt_pk_bf16_f32 v83, v62, v63
    v_exp_f32 v66, v66
    v_exp_f32 v67, v67
    v_cvt_pk_bf16_f32 v84, v64, v65
    v_mfma_f32_32x32x16_bf16 v[104:119], v[124:127], v[80:83], v[104:119]
    ds_read_b128 v[124:127], v8 offset:12384
    v_exp_f32 v68, v68
    v_exp_f32 v69, v69
    v_cvt_pk_bf16_f32 v85, v66, v67
    v_exp_f32 v70, v70
    v_exp_f32 v71, v71
    v_cvt_pk_bf16_f32 v86, v68, v69
    v_exp_f32 v40, v40
    v_cvt_pk_bf16_f32 v87, v70, v71
    v_mfma_f32_32x32x16_bf16 v[56:71], v[120:123], v[20:23], v[24:39]
    ds_read_b128 v[120:123], v7 offset:14448
    v_exp_f32 v41, v41
    v_exp_f32 v42, v42
    v_exp_f32 v43, v43
    v_cvt_pk_bf16_f32 v72, v40, v41
    v_mfma_f32_32x32x16_bf16 v[104:119], v[128:131], v[84:87], v[104:119]
    s_waitcnt lgkmcnt(1)
    ds_read_b128 v[128:131], v9 offset:12384
    v_exp_f32 v44, v44
    v_exp_f32 v45, v45
    v_cvt_pk_bf16_f32 v73, v42, v43
    v_exp_f32 v46, v46
    v_exp_f32 v47, v47
    v_cvt_pk_bf16_f32 v74, v44, v45
    v_exp_f32 v48, v48
    v_exp_f32 v49, v49
    v_cvt_pk_bf16_f32 v75, v46, v47
    v_exp_f32 v50, v50
    v_exp_f32 v51, v51
    v_cvt_pk_bf16_f32 v76, v48, v49
    v_mfma_f32_32x32x16_bf16 v[88:103], v[124:127], v[72:75], v[88:103]
    s_waitcnt lgkmcnt(1)
    v_exp_f32 v52, v52
    v_exp_f32 v53, v53
    v_cvt_pk_bf16_f32 v77, v50, v51
    v_exp_f32 v54, v54
    v_exp_f32 v55, v55
    v_cvt_pk_bf16_f32 v78, v52, v53
    v_exp_f32 v56, v56
    v_cvt_pk_bf16_f32 v79, v54, v55
    v_mfma_f32_32x32x16_bf16 v[40:55], v[120:123], v[16:19], v[24:39]
    s_waitcnt lgkmcnt(0)
    v_exp_f32 v57, v57
    v_exp_f32 v58, v58
    v_exp_f32 v59, v59
    v_cvt_pk_bf16_f32 v80, v56, v57
    v_mfma_f32_32x32x16_bf16 v[88:103], v[128:131], v[76:79], v[88:103]
    buffer_load_dword v0, v140, s[4:7], 0 offen sc1
    v_exp_f32 v60, v60
    v_exp_f32 v61, v61
    v_cvt_pk_bf16_f32 v81, v58, v59
    v_exp_f32 v62, v62
    v_exp_f32 v63, v63
    v_cvt_pk_bf16_f32 v82, v60, v61
    v_exp_f32 v64, v64
    v_exp_f32 v65, v65
    v_cvt_pk_bf16_f32 v83, v62, v63
    v_exp_f32 v66, v66
    v_exp_f32 v67, v67
    v_cvt_pk_bf16_f32 v84, v64, v65
    v_mfma_f32_32x32x16_bf16 v[104:119], v[124:127], v[80:83], v[104:119]
    ds_read_b128 v[124:127], v8 offset:14448
    v_exp_f32 v68, v68
    v_exp_f32 v69, v69
    v_cvt_pk_bf16_f32 v85, v66, v67
    v_exp_f32 v70, v70
    v_exp_f32 v71, v71
    v_cvt_pk_bf16_f32 v86, v68, v69
    v_exp_f32 v40, v40
    v_cvt_pk_bf16_f32 v87, v70, v71
    v_mfma_f32_32x32x16_bf16 v[56:71], v[120:123], v[20:23], v[24:39]
    s_waitcnt vmcnt(11)
    s_barrier
    ds_read_b128 v[120:123], v7 offset:16512
    v_exp_f32 v41, v41
    v_exp_f32 v42, v42
    v_exp_f32 v43, v43
    v_cvt_pk_bf16_f32 v72, v40, v41
    v_mfma_f32_32x32x16_bf16 v[104:119], v[128:131], v[84:87], v[104:119]
    s_waitcnt lgkmcnt(1)
    ds_read_b128 v[128:131], v9 offset:14448
    v_exp_f32 v44, v44
    v_exp_f32 v45, v45
    v_cvt_pk_bf16_f32 v73, v42, v43
    v_exp_f32 v46, v46
    v_exp_f32 v47, v47
    v_cvt_pk_bf16_f32 v74, v44, v45
    v_exp_f32 v48, v48
    v_exp_f32 v49, v49
    v_cvt_pk_bf16_f32 v75, v46, v47
    v_exp_f32 v50, v50
    v_exp_f32 v51, v51
    v_cvt_pk_bf16_f32 v76, v48, v49
    v_mfma_f32_32x32x16_bf16 v[88:103], v[124:127], v[72:75], v[88:103]
    s_waitcnt lgkmcnt(1)
    v_exp_f32 v52, v52
    v_exp_f32 v53, v53
    v_cvt_pk_bf16_f32 v77, v50, v51
    v_exp_f32 v54, v54
    v_exp_f32 v55, v55
    v_cvt_pk_bf16_f32 v78, v52, v53
    v_exp_f32 v56, v56
    v_cvt_pk_bf16_f32 v79, v54, v55
    v_mfma_f32_32x32x16_bf16 v[40:55], v[120:123], v[16:19], v[24:39]
    s_waitcnt lgkmcnt(0)
    v_exp_f32 v57, v57
    v_exp_f32 v58, v58
    v_exp_f32 v59, v59
    v_cvt_pk_bf16_f32 v80, v56, v57
    v_mfma_f32_32x32x16_bf16 v[88:103], v[128:131], v[76:79], v[88:103]
    v_exp_f32 v60, v60
    v_exp_f32 v61, v61
    v_cvt_pk_bf16_f32 v81, v58, v59
    v_exp_f32 v62, v62
    v_exp_f32 v63, v63
    v_cvt_pk_bf16_f32 v82, v60, v61
    v_exp_f32 v64, v64
    v_exp_f32 v65, v65
    v_cvt_pk_bf16_f32 v83, v62, v63
    v_exp_f32 v66, v66
    v_exp_f32 v67, v67
    v_cvt_pk_bf16_f32 v84, v64, v65
    v_mfma_f32_32x32x16_bf16 v[104:119], v[124:127], v[80:83], v[104:119]
    ds_read_b128 v[124:127], v8 offset:16512
    v_exp_f32 v68, v68
    v_exp_f32 v69, v69
    v_cvt_pk_bf16_f32 v85, v66, v67
    v_exp_f32 v70, v70
    v_exp_f32 v71, v71
    v_cvt_pk_bf16_f32 v86, v68, v69
    v_exp_f32 v40, v40
    v_cvt_pk_bf16_f32 v87, v70, v71
    v_mfma_f32_32x32x16_bf16 v[56:71], v[120:123], v[20:23], v[24:39]
    ds_read_b128 v[120:123], v7 offset:18576
    v_exp_f32 v41, v41
    v_exp_f32 v42, v42
    v_exp_f32 v43, v43
    v_cvt_pk_bf16_f32 v72, v40, v41
    v_mfma_f32_32x32x16_bf16 v[104:119], v[128:131], v[84:87], v[104:119]
    s_waitcnt lgkmcnt(1)
    ds_read_b128 v[128:131], v9 offset:16512
    v_exp_f32 v44, v44
    v_exp_f32 v45, v45
    v_cvt_pk_bf16_f32 v73, v42, v43
    v_exp_f32 v46, v46
    v_exp_f32 v47, v47
    v_cvt_pk_bf16_f32 v74, v44, v45
    v_exp_f32 v48, v48
    v_exp_f32 v49, v49
    v_cvt_pk_bf16_f32 v75, v46, v47
    v_exp_f32 v50, v50
    v_exp_f32 v51, v51
    v_cvt_pk_bf16_f32 v76, v48, v49
    v_mfma_f32_32x32x16_bf16 v[88:103], v[124:127], v[72:75], v[88:103]
    s_waitcnt lgkmcnt(1)
    v_exp_f32 v52, v52
    v_exp_f32 v53, v53
    v_cvt_pk_bf16_f32 v77, v50, v51
    v_exp_f32 v54, v54
    v_exp_f32 v55, v55
    v_cvt_pk_bf16_f32 v78, v52, v53
    v_exp_f32 v56, v56
    v_cvt_pk_bf16_f32 v79, v54, v55
    v_mfma_f32_32x32x16_bf16 v[40:55], v[120:123], v[16:19], v[24:39]
    s_waitcnt lgkmcnt(0)
    v_exp_f32 v57, v57
    v_exp_f32 v58, v58
    v_exp_f32 v59, v59
    v_cvt_pk_bf16_f32 v80, v56, v57
    v_mfma_f32_32x32x16_bf16 v[88:103], v[128:131], v[76:79], v[88:103]
    v_exp_f32 v60, v60
    v_exp_f32 v61, v61
    v_cvt_pk_bf16_f32 v81, v58, v59
L_hop_main_kernel_6:
    s_cbranch_execz L_hop_main_kernel_10
    v_exp_f32 v62, v62
    v_exp_f32 v63, v63
    v_cvt_pk_bf16_f32 v82, v60, v61
    v_exp_f32 v64, v64
    v_exp_f32 v65, v65
    v_cvt_pk_bf16_f32 v83, v62, v63
    v_exp_f32 v66, v66
    v_exp_f32 v67, v67
    v_cvt_pk_bf16_f32 v84, v64, v65
    v_mfma_f32_32x32x16_bf16 v[104:119], v[124:127], v[80:83], v[104:119]
    ds_read_b128 v[124:127], v8 offset:18576
    v_exp_f32 v68, v68
    v_exp_f32 v69, v69
    v_cvt_pk_bf16_f32 v85, v66, v67
    v_exp_f32 v70, v70
    v_exp_f32 v71, v71
    v_cvt_pk_bf16_f32 v86, v68, v69
    v_exp_f32 v40, v40
    v_cvt_pk_bf16_f32 v87, v70, v71
    v_mfma_f32_32x32x16_bf16 v[56:71], v[120:123], v[20:23], v[24:39]
    ds_read_b128 v[120:123], v7 offset:20640
    v_exp_f32 v41, v41
    v_exp_f32 v42, v42
    v_exp_f32 v43, v43
    v_cvt_pk_bf16_f32 v72, v40, v41
    v_mfma_f32_32x32x16_bf16 v[104:119], v[128:131], v[84:87], v[104:119]
    s_waitcnt lgkmcnt(1)
    ds_read_b128 v[128:131], v9 offset:18576
    v_exp_f32 v44, v44
    v_exp_f32 v45, v45
    v_cvt_pk_bf16_f32 v73, v42, v43
    v_exp_f32 v46, v46
    v_exp_f32 v47, v47
    v_cvt_pk_bf16_f32 v74, v44, v45
    v_exp_f32 v48, v48
    v_exp_f32 v49, v49
    v_cvt_pk_bf16_f32 v75, v46, v47
    v_exp_f32 v50, v50
    v_exp_f32 v51, v51
    v_cvt_pk_bf16_f32 v76, v48, v49
    v_mfma_f32_32x32x16_bf16 v[88:103], v[124:127], v[72:75], v[88:103]
    s_waitcnt lgkmcnt(1)
    v_exp_f32 v52, v52
    v_exp_f32 v53, v53
    v_cvt_pk_bf16_f32 v77, v50, v51
    v_exp_f32 v54, v54
    v_exp_f32 v55, v55
    v_cvt_pk_bf16_f32 v78, v52, v53
    v_exp_f32 v56, v56
    v_cvt_pk_bf16_f32 v79, v54, v55
    v_mfma_f32_32x32x16_bf16 v[40:55], v[120:123], v[16:19], v[24:39]
    s_waitcnt lgkmcnt(0)
    v_exp_f32 v57, v57
    v_exp_f32 v58, v58
    v_exp_f32 v59, v59
    v_cvt_pk_bf16_f32 v80, v56, v57
    v_mfma_f32_32x32x16_bf16 v[88:103], v[128:131], v[76:79], v[88:103]
    v_exp_f32 v60, v60
    v_exp_f32 v61, v61
    v_cvt_pk_bf16_f32 v81, v58, v59
    v_exp_f32 v62, v62
    v_exp_f32 v63, v63
    v_cvt_pk_bf16_f32 v82, v60, v61
    v_exp_f32 v64, v64
    v_exp_f32 v65, v65
    v_cvt_pk_bf16_f32 v83, v62, v63
    v_exp_f32 v66, v66
    v_exp_f32 v67, v67
    v_cvt_pk_bf16_f32 v84, v64, v65
    v_mfma_f32_32x32x16_bf16 v[104:119], v[124:127], v[80:83], v[104:119]
    ds_read_b128 v[124:127], v8 offset:20640
    v_exp_f32 v68, v68
    v_exp_f32 v69, v69
    v_cvt_pk_bf16_f32 v85, v66, v67
    v_exp_f32 v70, v70
    v_exp_f32 v71, v71
    v_cvt_pk_bf16_f32 v86, v68, v69
    v_exp_f32 v40, v40
    v_cvt_pk_bf16_f32 v87, v70, v71
    v_mfma_f32_32x32x16_bf16 v[56:71], v[120:123], v[20:23], v[24:39]
    ds_read_b128 v[120:123], v7 offset:22704
    v_exp_f32 v41, v41
    v_exp_f32 v42, v42
    v_exp_f32 v43, v43
    v_cvt_pk_bf16_f32 v72, v40, v41
    v_mfma_f32_32x32x16_bf16 v[104:119], v[128:131], v[84:87], v[104:119]
    s_waitcnt lgkmcnt(1)
    ds_read_b128 v[128:131], v9 offset:20640
    v_exp_f32 v44, v44
    v_exp_f32 v45, v45
    v_cvt_pk_bf16_f32 v73, v42, v43
    v_exp_f32 v46, v46
    v_exp_f32 v47, v47
    v_cvt_pk_bf16_f32 v74, v44, v45
    v_exp_f32 v48, v48
    v_exp_f32 v49, v49
    v_cvt_pk_bf16_f32 v75, v46, v47
    v_exp_f32 v50, v50
    v_exp_f32 v51, v51
    v_cvt_pk_bf16_f32 v76, v48, v49
    v_mfma_f32_32x32x16_bf16 v[88:103], v[124:127], v[72:75], v[88:103]
    s_waitcnt lgkmcnt(1)
    v_exp_f32 v52, v52
    v_exp_f32 v53, v53
    v_cvt_pk_bf16_f32 v77, v50, v51
    v_exp_f32 v54, v54
    v_exp_f32 v55, v55
    v_cvt_pk_bf16_f32 v78, v52, v53
    v_exp_f32 v56, v56
    v_cvt_pk_bf16_f32 v79, v54, v55
    v_mfma_f32_32x32x16_bf16 v[40:55], v[120:123], v[16:19], v[24:39]
    s_waitcnt lgkmcnt(0)
    v_exp_f32 v57, v57
    v_exp_f32 v58, v58
    v_exp_f32 v59, v59
    v_cvt_pk_bf16_f32 v80, v56, v57
    v_mfma_f32_32x32x16_bf16 v[88:103], v[128:131], v[76:79], v[88:103]
    v_exp_f32 v60, v60
    v_exp_f32 v61, v61
    v_cvt_pk_bf16_f32 v81, v58, v59
    v_exp_f32 v62, v62
    v_exp_f32 v63, v63
    v_cvt_pk_bf16_f32 v82, v60, v61
    v_exp_f32 v64, v64
    v_exp_f32 v65, v65
    v_cvt_pk_bf16_f32 v83, v62, v63
    v_exp_f32 v66, v66
    v_exp_f32 v67, v67
    v_cvt_pk_bf16_f32 v84, v64, v65
    v_mfma_f32_32x32x16_bf16 v[104:119], v[124:127], v[80:83], v[104:119]
    ds_read_b128 v[124:127], v8 offset:22704
    v_exp_f32 v68, v68
    v_exp_f32 v69, v69
    v_cvt_pk_bf16_f32 v85, v66, v67
    v_exp_f32 v70, v70
    v_exp_f32 v71, v71
    v_cvt_pk_bf16_f32 v86, v68, v69
    v_exp_f32 v40, v40
    v_cvt_pk_bf16_f32 v87, v70, v71
    v_mfma_f32_32x32x16_bf16 v[56:71], v[120:123], v[20:23], v[24:39]
    v_exp_f32 v41, v41
    v_exp_f32 v42, v42
    v_exp_f32 v43, v43
    v_cvt_pk_bf16_f32 v72, v40, v41
    v_mfma_f32_32x32x16_bf16 v[104:119], v[128:131], v[84:87], v[104:119]
    s_waitcnt lgkmcnt(0)
    ds_read_b128 v[128:131], v9 offset:22704
    v_exp_f32 v44, v44
    v_exp_f32 v45, v45
    v_cvt_pk_bf16_f32 v73, v42, v43
    v_exp_f32 v46, v46
    v_exp_f32 v47, v47
    v_cvt_pk_bf16_f32 v74, v44, v45
    v_exp_f32 v48, v48
    v_exp_f32 v49, v49
    v_cvt_pk_bf16_f32 v75, v46, v47
    v_exp_f32 v50, v50
    v_exp_f32 v51, v51
    v_cvt_pk_bf16_f32 v76, v48, v49
    v_mfma_f32_32x32x16_bf16 v[88:103], v[124:127], v[72:75], v[88:103]
    v_exp_f32 v52, v52
    v_exp_f32 v53, v53
    v_cvt_pk_bf16_f32 v77, v50, v51
    v_exp_f32 v54, v54
    v_exp_f32 v55, v55
    v_cvt_pk_bf16_f32 v78, v52, v53
    v_exp_f32 v56, v56
    v_cvt_pk_bf16_f32 v79, v54, v55
    s_waitcnt lgkmcnt(0)
    v_exp_f32 v57, v57
    v_exp_f32 v58, v58
    v_exp_f32 v59, v59
    v_cvt_pk_bf16_f32 v80, v56, v57
    v_mfma_f32_32x32x16_bf16 v[88:103], v[128:131], v[76:79], v[88:103]
    v_exp_f32 v60, v60
    v_exp_f32 v61, v61
    v_cvt_pk_bf16_f32 v81, v58, v59
    v_exp_f32 v62, v62
    v_exp_f32 v63, v63
    v_cvt_pk_bf16_f32 v82, v60, v61
    v_exp_f32 v64, v64
    v_exp_f32 v65, v65
    v_cvt_pk_bf16_f32 v83, v62, v63
    v_exp_f32 v66, v66
    v_exp_f32 v67, v67
    v_cvt_pk_bf16_f32 v84, v64, v65
    v_mfma_f32_32x32x16_bf16 v[104:119], v[124:127], v[80:83], v[104:119]
    v_exp_f32 v68, v68
    v_exp_f32 v69, v69
    v_cvt_pk_bf16_f32 v85, v66, v67
    v_exp_f32 v70, v70
    v_exp_f32 v71, v71
    v_cvt_pk_bf16_f32 v86, v68, v69
    v_cvt_pk_bf16_f32 v87, v70, v71
    v_rcp_f32 v44, v96
    s_nop 0
    v_mfma_f32_32x32x16_bf16 v[104:119], v[128:131], v[84:87], v[104:119]
    v_pk_mul_f32 v[40:41], v[96:97], 0 op_sel_hi:[1,0]
    v_pk_fma_f32 v[40:41], v[88:89], 0, v[40:41] op_sel_hi:[1,0,1]
    v_pk_fma_f32 v[40:41], v[90:91], 0, v[40:41] op_sel_hi:[1,0,1]
    v_pk_fma_f32 v[40:41], v[92:93], 0, v[40:41] op_sel_hi:[1,0,1]
    v_pk_fma_f32 v[40:41], v[94:95], 0, v[40:41] op_sel_hi:[1,0,1]
    v_pk_mul_f32 v[88:89], v[88:89], v[44:45] op_sel_hi:[1,0]
    v_pk_mul_f32 v[90:91], v[90:91], v[44:45] op_sel_hi:[1,0]
    v_pk_mul_f32 v[92:93], v[92:93], v[44:45] op_sel_hi:[1,0]
    v_pk_mul_f32 v[94:95], v[94:95], v[44:45] op_sel_hi:[1,0]
    v_cvt_pk_bf16_f32 v72, v88, v89
    v_cvt_pk_bf16_f32 v73, v90, v91
    v_cvt_pk_bf16_f32 v74, v92, v93
    v_cvt_pk_bf16_f32 v75, v94, v95
    v_min_u32 v72, s32, v72
    s_mov_b32 s19, 0x30800000
    s_mov_b32 s22, 0x4e800000
    v_rcp_f32 v46, v112
    v_pk_fma_f32 v[40:41], v[104:105], 0, v[40:41] op_sel_hi:[1,0,1]
    v_pk_fma_f32 v[40:41], v[106:107], 0, v[40:41] op_sel_hi:[1,0,1]
    v_pk_fma_f32 v[40:41], v[108:109], 0, v[40:41] op_sel_hi:[1,0,1]
    v_pk_fma_f32 v[40:41], v[110:111], 0, v[40:41] op_sel_hi:[1,0,1]
    v_pk_fma_f32 v[40:41], v[112:113], 0, v[40:41] op_sel_hi:[1,0,1]
    v_min_f32 v42, v96, v112
    v_max_f32 v43, v96, v112
    v_cmp_u_f32 vcc, v40, v41
    v_cmp_gt_f32 s[20:21], s19, v42
    s_or_b64 vcc, vcc, s[20:21]
    v_cmp_lt_f32 s[20:21], s22, v43
    s_or_b64 vcc, vcc, s[20:21]
    s_cbranch_vccnz L_attn_slow
L_attn_fin:
    s_cmp_lg_u64 s[0:1], 0
    s_cbranch_scc1 L_tail_sc
    buffer_store_dwordx4 v[72:75], v2, s[4:7], s55 offen
    ds_read_b128 v[120:123], v10 offset:0
    ds_read_b128 v[124:127], v10 offset:4096
    ds_read_b128 v[128:131], v10 offset:8192
    ds_read_b128 v[132:135], v10 offset:12288
    ds_read_b128 v[136:139], v10 offset:16384
    ds_read_b128 v[140:143], v10 offset:20480
    v_pk_mul_f32 v[104:105], v[104:105], v[46:47] op_sel_hi:[1,0]
    v_pk_mul_f32 v[106:107], v[106:107], v[46:47] op_sel_hi:[1,0]
    v_pk_mul_f32 v[108:109], v[108:109], v[46:47] op_sel_hi:[1,0]
    v_pk_mul_f32 v[110:111], v[110:111], v[46:47] op_sel_hi:[1,0]
    v_cvt_pk_bf16_f32 v80, v104, v105
    v_cvt_pk_bf16_f32 v81, v106, v107
    v_cvt_pk_bf16_f32 v82, v108, v109
    v_cvt_pk_bf16_f32 v83, v110, v111
    v_min_u32 v80, s32, v80
    buffer_store_dwordx4 v[80:83], v2, s[4:7], s56 offen
    buffer_load_dwordx4 v[16:19], v3, s[4:7], s57 offen offset:0 sc1
    buffer_load_dwordx4 v[20:23], v3, s[4:7], s57 offen offset:1024 sc1
    ds_read_b128 v[96:99], v10 offset:24576
    ds_read_b128 v[100:103], v10 offset:28672
    ds_read_b128 v[116:119], v10 offset:32768
    ds_read_b128 v[104:107], v10 offset:36864
    ds_read_b128 v[108:111], v10 offset:40960
    ds_read_b128 v[112:115], v10 offset:45056
    v_add_u32 v8, 0x10000, v3
    s_waitcnt lgkmcnt(10)
    v_mfma_f32_16x16x32_bf16 a[168:171], v[120:123], a[172:175], 0
    ds_read_b128 v[120:123], v10 offset:49152
    buffer_load_dwordx4 v[24:27], v3, s[4:7], s57 offen offset:2048 sc1
    v_accvgpr_read_b32 v81, a160
    v_mfma_f32_16x16x32_bf16 a[168:171], v[124:127], a[172:175], a[168:171]
    s_waitcnt lgkmcnt(9)
    ds_read_b128 v[124:127], v10 offset:53248
    v_accvgpr_read_b32 v83, a161
    v_mfma_f32_16x16x32_bf16 a[168:171], v[128:131], a[172:175], a[168:171]
    ds_read_b128 v[128:131], v10 offset:57344
    buffer_load_dwordx4 v[28:31], v3, s[4:7], s57 offen offset:3072 sc1
    v_accvgpr_read_b32 v85, a162
    v_accvgpr_read_b32 v87, a163
    v_mfma_f32_16x16x32_bf16 a[168:171], v[132:135], a[172:175], a[168:171]
    s_waitcnt lgkmcnt(9)
    ds_read_b128 v[132:135], v10 offset:61440
    v_accvgpr_read_b32 v89, a164
    v_mfma_f32_16x16x32_bf16 a[168:171], v[136:139], a[172:175], a[168:171]
    ds_read_b128 v[136:139], v3 offset:0
    buffer_load_dwordx4 v[32:35], v4, s[4:7], s57 offen offset:0 sc1
    v_accvgpr_read_b32 v91, a165
    v_mfma_f32_16x16x32_bf16 a[168:171], v[140:143], a[172:175], a[168:171]
    s_waitcnt lgkmcnt(9)
    ds_read_b128 v[140:143], v3 offset:1024
    v_accvgpr_read_b32 v93, a166
    v_mfma_f32_16x16x32_bf16 a[168:171], v[96:99], a[172:175], a[168:171]
    ds_read_b128 v[96:99], v3 offset:2048
    buffer_load_dwordx4 v[36:39], v4, s[4:7], s57 offen offset:1024 sc1
    v_accvgpr_read_b32 v95, a167
    v_mfma_f32_16x16x32_bf16 a[168:171], v[100:103], a[172:175], a[168:171]
    s_waitcnt lgkmcnt(9)
    ds_read_b128 v[100:103], v3 offset:3072
    v_lshlrev_b32 v80, 16, v81
    v_and_b32 v81, 0xffff0000, v81
    v_mfma_f32_16x16x32_bf16 a[168:171], v[116:119], a[172:175], a[168:171]
    ds_read_b128 v[116:119], v3 offset:4096
    v_lshlrev_b32 v82, 16, v83
    v_and_b32 v83, 0xffff0000, v83
    v_mfma_f32_16x16x32_bf16 a[168:171], v[104:107], a[172:175], a[168:171]
    s_waitcnt lgkmcnt(9)
    ds_read_b128 v[104:107], v3 offset:5120
    v_lshlrev_b32 v84, 16, v85
    v_mfma_f32_16x16x32_bf16 a[168:171], v[108:111], a[172:175], a[168:171]
    ds_read_b128 v[108:111], v3 offset:6144
    v_and_b32 v85, 0xffff0000, v85
    v_lshlrev_b32 v86, 16, v87
    v_mfma_f32_16x16x32_bf16 a[168:171], v[112:115], a[172:175], a[168:171]
    s_waitcnt lgkmcnt(9)
    ds_read_b128 v[112:115], v3 offset:7168
    v_and_b32 v87, 0xffff0000, v87
    v_mfma_f32_16x16x32_bf16 a[168:171], v[120:123], a[172:175], a[168:171]
    ds_read_b128 v[120:123], v3 offset:8192
    v_lshlrev_b32 v88, 16, v89
    v_and_b32 v89, 0xffff0000, v89
    v_mfma_f32_16x16x32_bf16 a[168:171], v[124:127], a[172:175], a[168:171]
    s_waitcnt lgkmcnt(9)
    ds_read_b128 v[124:127], v3 offset:9216
    v_lshlrev_b32 v90, 16, v91
    v_and_b32 v91, 0xffff0000, v91
    v_mfma_f32_16x16x32_bf16 a[168:171], v[128:131], a[172:175], a[168:171]
    ds_read_b128 v[128:131], v3 offset:10240
    v_lshlrev_b32 v92, 16, v93
    v_and_b32 v93, 0xffff0000, v93
    v_mfma_f32_16x16x32_bf16 a[168:171], v[132:135], a[172:175], a[168:171]
    ds_read_b128 v[132:135], v3 offset:11264
    v_lshlrev_b32 v94, 16, v95
    v_and_b32 v95, 0xffff0000, v95
    s_barrier
    s_nop 3
    ds_write_b128 v11, a[168:171]
    s_waitcnt vmcnt(4)
    v_max_u32 v0, v16, v20
    v_cmp_eq_u32 vcc, -1, v0
    s_cbranch_vccz C_main_kernel_32
R_main_kernel_31:
    buffer_load_dwordx4 v[16:19], v3, s[4:7], s57 offen offset:0 sc1
    buffer_load_dwordx4 v[20:23], v3, s[4:7], s57 offen offset:1024 sc1
    buffer_load_dwordx4 v[24:27], v3, s[4:7], s57 offen offset:2048 sc1
    buffer_load_dwordx4 v[28:31], v3, s[4:7], s57 offen offset:3072 sc1
    buffer_load_dwordx4 v[32:35], v4, s[4:7], s57 offen offset:0 sc1
    buffer_load_dwordx4 v[36:39], v4, s[4:7], s57 offen offset:1024 sc1
    s_add_u32 s33, s33, 1
    s_cmp_gt_u32 s33, 20000
    s_waitcnt vmcnt(4)
    v_max_u32 v0, v16, v20
    v_cmp_eq_u32 vcc, -1, v0
    s_cbranch_scc1 C_main_kernel_32
    s_cbranch_vccnz R_main_kernel_31
C_main_kernel_32:
    s_waitcnt lgkmcnt(11)
    v_mfma_f32_16x16x32_bf16 v[80:83], v[136:139], v[16:19], v[80:83]
    ds_read_b128 v[136:139], v3 offset:12288
    buffer_load_dwordx4 v[40:43], v4, s[4:7], s57 offen offset:2048 sc1
    v_mfma_f32_16x16x32_bf16 v[84:87], v[140:143], v[16:19], v[84:87]
    s_waitcnt lgkmcnt(8)
    ds_read_b128 v[140:143], v3 offset:13312
    v_mfma_f32_16x16x32_bf16 v[88:91], v[96:99], v[16:19], v[88:91]
    ds_read_b128 v[96:99], v3 offset:14336
    buffer_load_dwordx4 v[44:47], v4, s[4:7], s57 offen offset:3072 sc1
    v_mfma_f32_16x16x32_bf16 v[92:95], v[100:103], v[16:19], v[92:95]
    ds_read_b128 v[100:103], v3 offset:15360
    ds_write_b128 v15, a[0:3] offset:0
    v_mfma_f32_16x16x32_bf16 v[80:83], v[116:119], v[20:23], v[80:83]
    s_waitcnt vmcnt(4)
    ds_read_b128 v[116:119], v3 offset:16384
    v_max_u32 v0, v24, v28
    v_mfma_f32_16x16x32_bf16 v[84:87], v[104:107], v[20:23], v[84:87]
    s_waitcnt lgkmcnt(9)
    ds_read_b128 v[104:107], v3 offset:17408
    v_cmp_eq_u32 vcc, -1, v0
    v_mfma_f32_16x16x32_bf16 v[88:91], v[108:111], v[20:23], v[88:91]
    ds_read_b128 v[108:111], v3 offset:18432
    v_mfma_f32_16x16x32_bf16 v[92:95], v[112:115], v[20:23], v[92:95]
    s_cbranch_vccnz R_main_kernel_33
C_main_kernel_34:
    ds_read_b128 v[112:115], v3 offset:19456
    v_mfma_f32_16x16x32_bf16 v[80:83], v[120:123], v[24:27], v[80:83]
    ds_read_b128 v[120:123], v3 offset:20480
    buffer_load_dwordx4 v[48:51], v5, s[4:7], s57 offen offset:0 sc1
    v_mfma_f32_16x16x32_bf16 v[84:87], v[124:127], v[24:27], v[84:87]
    s_waitcnt lgkmcnt(8)
    ds_read_b128 v[124:127], v3 offset:21504
    v_mfma_f32_16x16x32_bf16 v[88:91], v[128:131], v[24:27], v[88:91]
    ds_read_b128 v[128:131], v3 offset:22528
    buffer_load_dwordx4 v[52:55], v5, s[4:7], s57 offen offset:1024 sc1
    v_mfma_f32_16x16x32_bf16 v[92:95], v[132:135], v[24:27], v[92:95]
    ds_read_b128 v[132:135], v3 offset:23552
    ds_write_b128 v15, a[4:7] offset:1024
    v_mfma_f32_16x16x32_bf16 v[80:83], v[136:139], v[28:31], v[80:83]
    s_waitcnt vmcnt(4)
    ds_read_b128 v[136:139], v3 offset:24576
    v_max_u32 v0, v32, v36
    v_mfma_f32_16x16x32_bf16 v[84:87], v[140:143], v[28:31], v[84:87]
    s_waitcnt lgkmcnt(8)
    ds_read_b128 v[140:143], v3 offset:25600
    v_cmp_eq_u32 vcc, -1, v0
    v_mfma_f32_16x16x32_bf16 v[88:91], v[96:99], v[28:31], v[88:91]
    ds_read_b128 v[96:99], v3 offset:26624
    v_mfma_f32_16x16x32_bf16 v[92:95], v[100:103], v[28:31], v[92:95]
    s_cbranch_vccnz R_main_kernel_35
C_main_kernel_36:
    ds_read_b128 v[100:103], v3 offset:27648
    v_mfma_f32_16x16x32_bf16 v[80:83], v[116:119], v[32:35], v[80:83]
    ds_read_b128 v[116:119], v3 offset:28672
    buffer_load_dwordx4 v[56:59], v5, s[4:7], s57 offen offset:2048 sc1
    v_mfma_f32_16x16x32_bf16 v[84:87], v[104:107], v[32:35], v[84:87]
    s_waitcnt lgkmcnt(8)
    ds_read_b128 v[104:107], v3 offset:29696
    v_mfma_f32_16x16x32_bf16 v[88:91], v[108:111], v[32:35], v[88:91]
    ds_read_b128 v[108:111], v3 offset:30720
    buffer_load_dwordx4 v[60:63], v5, s[4:7], s57 offen offset:3072 sc1
    v_mfma_f32_16x16x32_bf16 v[92:95], v[112:115], v[32:35], v[92:95]
    ds_read_b128 v[112:115], v3 offset:31744
    ds_write_b128 v15, a[8:11] offset:2048
    v_mfma_f32_16x16x32_bf16 v[80:83], v[120:123], v[36:39], v[80:83]
    s_waitcnt vmcnt(4)
    ds_read_b128 v[120:123], v3 offset:32768
    v_max_u32 v0, v40, v44
    v_mfma_f32_16x16x32_bf16 v[84:87], v[124:127], v[36:39], v[84:87]
    s_waitcnt lgkmcnt(8)
    ds_read_b128 v[124:127], v3 offset:33792
    v_cmp_eq_u32 vcc, -1, v0
    v_mfma_f32_16x16x32_bf16 v[88:91], v[128:131], v[36:39], v[88:91]
    ds_read_b128 v[128:131], v3 offset:34816
    v_mfma_f32_16x16x32_bf16 v[92:95], v[132:135], v[36:39], v[92:95]
    s_cbranch_vccnz R_main_kernel_37
C_main_kernel_38:
    ds_read_b128 v[132:135], v3 offset:35840
    v_mfma_f32_16x16x32_bf16 v[80:83], v[136:139], v[40:43], v[80:83]
    ds_read_b128 v[136:139], v3 offset:36864
    buffer_load_dwordx4 v[64:67], v6, s[4:7], s57 offen offset:0 sc1
    v_mfma_f32_16x16x32_bf16 v[84:87], v[140:143], v[40:43], v[84:87]
    s_waitcnt lgkmcnt(8)
    ds_read_b128 v[140:143], v3 offset:37888
    v_mfma_f32_16x16x32_bf16 v[88:91], v[96:99], v[40:43], v[88:91]
    ds_read_b128 v[96:99], v3 offset:38912
    buffer_load_dwordx4 v[68:71], v6, s[4:7], s57 offen offset:1024 sc1
    v_mfma_f32_16x16x32_bf16 v[92:95], v[100:103], v[40:43], v[92:95]
    ds_read_b128 v[100:103], v3 offset:39936
    ds_write_b128 v15, a[12:15] offset:3072
    v_mfma_f32_16x16x32_bf16 v[80:83], v[116:119], v[44:47], v[80:83]
    s_waitcnt vmcnt(4)
    ds_read_b128 v[116:119], v3 offset:40960
    v_max_u32 v0, v48, v52
    v_mfma_f32_16x16x32_bf16 v[84:87], v[104:107], v[44:47], v[84:87]
    s_waitcnt lgkmcnt(8)
    ds_read_b128 v[104:107], v3 offset:41984
    v_cmp_eq_u32 vcc, -1, v0
    v_mfma_f32_16x16x32_bf16 v[88:91], v[108:111], v[44:47], v[88:91]
    ds_read_b128 v[108:111], v3 offset:43008
    v_mfma_f32_16x16x32_bf16 v[92:95], v[112:115], v[44:47], v[92:95]
    s_cbranch_vccnz R_main_kernel_39
C_main_kernel_40:
    ds_read_b128 v[112:115], v3 offset:44032
    v_lshrrev_b32 v9, 5, v1
    v_mfma_f32_16x16x32_bf16 v[80:83], v[120:123], v[48:51], v[80:83]
    ds_read_b128 v[120:123], v3 offset:45056
    buffer_load_dwordx4 v[72:75], v6, s[4:7], s57 offen offset:2048 sc1
    v_mfma_f32_16x16x32_bf16 v[84:87], v[124:127], v[48:51], v[84:87]
    s_waitcnt lgkmcnt(8)
    ds_read_b128 v[124:127], v3 offset:46080
    v_lshlrev_b32 v9, 31, v9
    v_mfma_f32_16x16x32_bf16 v[88:91], v[128:131], v[48:51], v[88:91]
    ds_read_b128 v[128:131], v3 offset:47104
    buffer_load_dwordx4 v[76:79], v6, s[4:7], s57 offen offset:3072 sc1
    v_mfma_f32_16x16x32_bf16 v[92:95], v[132:135], v[48:51], v[92:95]
    ds_read_b128 v[132:135], v3 offset:48128
    ds_write_b128 v15, a[16:19] offset:4096
    v_mfma_f32_16x16x32_bf16 v[80:83], v[136:139], v[52:55], v[80:83]
    s_waitcnt vmcnt(4)
    ds_read_b128 v[136:139], v3 offset:49152
    v_max_u32 v0, v56, v60
    v_mfma_f32_16x16x32_bf16 v[84:87], v[140:143], v[52:55], v[84:87]
    s_waitcnt lgkmcnt(8)
    ds_read_b128 v[140:143], v3 offset:50176
    v_cmp_eq_u32 vcc, -1, v0
    v_mfma_f32_16x16x32_bf16 v[88:91], v[96:99], v[52:55], v[88:91]
    ds_read_b128 v[96:99], v3 offset:51200
    v_lshl_add_u32 v9, v12, 4, v9
    v_mfma_f32_16x16x32_bf16 v[92:95], v[100:103], v[52:55], v[92:95]
    s_cbranch_vccnz R_main_kernel_41
C_main_kernel_42:
    ds_read_b128 v[100:103], v3 offset:52224
    v_lshl_add_u32 v9, v13, 2, v9
    v_mfma_f32_16x16x32_bf16 v[80:83], v[116:119], v[56:59], v[80:83]
    ds_read_b128 v[116:119], v3 offset:53248
    v_add_u32 v9, s67, v9
    v_mfma_f32_16x16x32_bf16 v[84:87], v[104:107], v[56:59], v[84:87]
    s_waitcnt lgkmcnt(8)
    ds_read_b128 v[104:107], v3 offset:54272
    v_mov_b32 v14, 0x4000
    v_mfma_f32_16x16x32_bf16 v[88:91], v[108:111], v[56:59], v[88:91]
    ds_read_b128 v[108:111], v3 offset:55296
    v_add_u32 v2, -1, v12
    v_mfma_f32_16x16x32_bf16 v[92:95], v[112:115], v[56:59], v[92:95]
    ds_read_b128 v[112:115], v3 offset:56320
    ds_write_b128 v15, a[20:23] offset:5120
    v_mfma_f32_16x16x32_bf16 v[80:83], v[120:123], v[60:63], v[80:83]
    s_waitcnt vmcnt(2)
    ds_read_b128 v[120:123], v3 offset:57344
    v_max_u32 v0, v64, v68
    v_mfma_f32_16x16x32_bf16 v[84:87], v[124:127], v[60:63], v[84:87]
    s_waitcnt lgkmcnt(8)
    ds_read_b128 v[124:127], v3 offset:58368
    v_cmp_eq_u32 vcc, -1, v0
    v_mfma_f32_16x16x32_bf16 v[88:91], v[128:131], v[60:63], v[88:91]
    ds_read_b128 v[128:131], v3 offset:59392
    v_bfe_i32 v2, v2, 4, 1
    v_mfma_f32_16x16x32_bf16 v[92:95], v[132:135], v[60:63], v[92:95]
    s_cbranch_vccnz R_main_kernel_43
C_main_kernel_44:
    ds_read_b128 v[132:135], v3 offset:60416
    v_bfi_b32 v2, v2, s64, v14
    v_mfma_f32_16x16x32_bf16 v[80:83], v[136:139], v[64:67], v[80:83]
    ds_read_b128 v[136:139], v3 offset:61440
    v_add_u32 v2, v3, v2
    v_mfma_f32_16x16x32_bf16 v[84:87], v[140:143], v[64:67], v[84:87]
    s_waitcnt lgkmcnt(8)
    ds_read_b128 v[140:143], v3 offset:62464
    v_add_u32 v10, 1, v12
    v_mfma_f32_16x16x32_bf16 v[88:91], v[96:99], v[64:67], v[88:91]
    ds_read_b128 v[96:99], v3 offset:63488
    v_bfe_i32 v10, v10, 4, 1
    v_mfma_f32_16x16x32_bf16 v[92:95], v[100:103], v[64:67], v[92:95]
    ds_read_b128 v[100:103], v3 offset:64512
    v_bfi_b32 v10, v10, s65, v14
    v_mfma_f32_16x16x32_bf16 v[80:83], v[116:119], v[68:71], v[80:83]
    s_waitcnt vmcnt(0)
    ds_read_b128 a[0:3], v8 offset:0
    v_max_u32 v0, v72, v76
    v_mfma_f32_16x16x32_bf16 v[84:87], v[104:107], v[68:71], v[84:87]
    s_waitcnt lgkmcnt(7)
    ds_read_b128 a[4:7], v8 offset:1024
    v_cmp_eq_u32 vcc, -1, v0
    v_mfma_f32_16x16x32_bf16 v[88:91], v[108:111], v[68:71], v[88:91]
    ds_read_b128 a[8:11], v8 offset:2048
    v_add_u32 v10, v4, v10
    v_mfma_f32_16x16x32_bf16 v[92:95], v[112:115], v[68:71], v[92:95]
    s_cbranch_vccnz R_main_kernel_45
C_main_kernel_46:
    ds_read_b128 a[12:15], v8 offset:3072
    v_add_u32 v11, -2, v12
    v_mfma_f32_16x16x32_bf16 v[80:83], v[120:123], v[72:75], v[80:83]
    ds_read_b128 a[16:19], v8 offset:4096
    v_bfe_i32 v11, v11, 4, 1
    v_mfma_f32_16x16x32_bf16 v[84:87], v[124:127], v[72:75], v[84:87]
    s_waitcnt lgkmcnt(7)
    ds_read_b128 a[20:23], v8 offset:5120
    v_bfi_b32 v11, v11, s64, v14
    v_mfma_f32_16x16x32_bf16 v[88:91], v[128:131], v[72:75], v[88:91]
    ds_read_b128 v[116:119], v8 offset:6144
    v_add_u32 v11, v5, v11
    v_mfma_f32_16x16x32_bf16 v[92:95], v[132:135], v[72:75], v[92:95]
    ds_read_b128 v[120:123], v8 offset:7168
    v_add_u32 v15, 2, v12
    v_mfma_f32_16x16x32_bf16 v[80:83], v[136:139], v[76:79], v[80:83]
    ds_read_b128 v[124:127], v8 offset:8192
    v_bfe_i32 v15, v15, 4, 1
    v_mfma_f32_16x16x32_bf16 v[84:87], v[140:143], v[76:79], v[84:87]
    s_waitcnt lgkmcnt(9)
    ds_read_b128 v[128:131], v8 offset:9216
    v_bfi_b32 v15, v15, s65, v14
    v_mfma_f32_16x16x32_bf16 v[88:91], v[96:99], v[76:79], v[88:91]
    v_add_u32 v15, v6, v15
    v_mfma_f32_16x16x32_bf16 v[92:95], v[100:103], v[76:79], v[92:95]
    v_cvt_pk_bf16_f32 v48, v80, v81
    v_cvt_pk_bf16_f32 v49, v82, v83
    v_cvt_pk_bf16_f32 v50, v84, v85
    v_cvt_pk_bf16_f32 v51, v86, v87
    v_min_u32 v48, s32, v48
    buffer_store_dwordx4 v[48:51], v3, s[4:7], s59 offen offset:0
    v_cvt_pk_bf16_f32 v52, v88, v89
    v_cvt_pk_bf16_f32 v53, v90, v91
    v_cvt_pk_bf16_f32 v54, v92, v93
    v_cvt_pk_bf16_f32 v55, v94, v95
    v_min_u32 v52, s32, v52
    buffer_store_dwordx4 v[52:55], v3, s[4:7], s59 offen offset:1024
    v_dot2_f32_bf16 v132, v48, s31, 0
    v_dot2_f32_bf16 v133, v48, v48, 0
    v_dot2_f32_bf16 v132, v49, s31, v132
    v_dot2_f32_bf16 v133, v49, v49, v133
    v_dot2_f32_bf16 v132, v50, s31, v132
    v_dot2_f32_bf16 v133, v50, v50, v133
    v_dot2_f32_bf16 v132, v51, s31, v132
    v_dot2_f32_bf16 v133, v51, v51, v133
    v_dot2_f32_bf16 v132, v52, s31, v132
    v_dot2_f32_bf16 v133, v52, v52, v133
    v_dot2_f32_bf16 v132, v53, s31, v132
    v_dot2_f32_bf16 v133, v53, v53, v133
    v_dot2_f32_bf16 v132, v54, s31, v132
    v_dot2_f32_bf16 v133, v54, v54, v133
    v_dot2_f32_bf16 v132, v55, s31, v132
    v_dot2_f32_bf16 v133, v55, v55, v133
    s_nop 2
    v_permlane16_swap_b32 v132, v133
    v_add_f32 v132, v132, v133
    v_mov_b32 v133, v132
    s_nop 1
    v_permlane32_swap_b32 v132, v133
    v_add_f32 v132, v132, v133
    v_min_u32 v132, s32, v132
    buffer_store_dword v132, v9, s[4:7], s41 offen
    v_add_u32 v132, s45, v3
    v_lshlrev_b32 v133, 4, v13
    v_add_u32 v133, 0x26900, v133
    v_mfma_f32_16x16x32_bf16 a[160:163], v[144:147], a[172:175], 0
    buffer_load_dwordx4 v[16:19], v3, s[4:7], s58 offen offset:0 sc1
    v_mfma_f32_16x16x32_bf16 a[160:163], v[148:151], a[172:175], a[160:163]
    v_mfma_f32_16x16x32_bf16 a[160:163], v[152:155], a[172:175], a[160:163]
    buffer_load_dwordx4 v[20:23], v3, s[4:7], s58 offen offset:1024 sc1
    v_mfma_f32_16x16x32_bf16 a[160:163], v[156:159], a[172:175], a[160:163]
    s_waitcnt lgkmcnt(0)
    s_barrier
    v_mfma_f32_16x16x32_bf16 a[160:163], v[160:163], a[172:175], a[160:163]
    buffer_load_dwordx4 v[24:27], v3, s[4:7], s58 offen offset:2048 sc1
    v_mfma_f32_16x16x32_bf16 a[160:163], v[164:167], a[172:175], a[160:163]
    v_mfma_f32_16x16x32_bf16 a[160:163], v[168:171], a[172:175], a[160:163]
    buffer_load_dwordx4 v[28:31], v3, s[4:7], s58 offen offset:3072 sc1
    v_mfma_f32_16x16x32_bf16 a[160:163], v[172:175], a[172:175], a[160:163]
    v_mfma_f32_16x16x32_bf16 a[160:163], v[176:179], a[172:175], a[160:163]
    v_mfma_f32_16x16x32_bf16 a[160:163], v[180:183], a[172:175], a[160:163]
    buffer_load_dwordx4 v[32:35], v4, s[4:7], s58 offen offset:0 sc1
    v_mfma_f32_16x16x32_bf16 a[160:163], v[184:187], a[172:175], a[160:163]
    v_mfma_f32_16x16x32_bf16 a[160:163], v[188:191], a[172:175], a[160:163]
    buffer_load_dwordx4 v[36:39], v4, s[4:7], s58 offen offset:1024 sc1
    v_mfma_f32_16x16x32_bf16 a[160:163], v[192:195], a[172:175], a[160:163]
    v_mfma_f32_16x16x32_bf16 a[160:163], v[196:199], a[172:175], a[160:163]
    buffer_load_dwordx4 v[96:99], v3, s[4:7], s41 offen sc1
    v_mfma_f32_16x16x32_bf16 a[160:163], v[200:203], a[172:175], a[160:163]
    v_mfma_f32_16x16x32_bf16 a[160:163], v[204:207], a[172:175], a[160:163]
    s_waitcnt vmcnt(5)
    v_max_u32 v0, v16, v20
    v_cmp_eq_u32 vcc, -1, v0
    s_cbranch_vccz C_main_kernel_66
R_main_kernel_65:
    buffer_load_dwordx4 v[16:19], v3, s[4:7], s58 offen offset:0 sc1
    buffer_load_dwordx4 v[20:23], v3, s[4:7], s58 offen offset:1024 sc1
    buffer_load_dwordx4 v[24:27], v3, s[4:7], s58 offen offset:2048 sc1
    buffer_load_dwordx4 v[28:31], v3, s[4:7], s58 offen offset:3072 sc1
    buffer_load_dwordx4 v[32:35], v4, s[4:7], s58 offen offset:0 sc1
L_hop_main_kernel_7:
    s_cbranch_execz L_hop_main_kernel_11
    buffer_load_dwordx4 v[36:39], v4, s[4:7], s58 offen offset:1024 sc1
    buffer_load_dwordx4 v[96:99], v3, s[4:7], s41 offen sc1
    s_add_u32 s33, s33, 1
    s_cmp_gt_u32 s33, 20000
    s_waitcnt vmcnt(5)
    v_max_u32 v0, v16, v20
    v_cmp_eq_u32 vcc, -1, v0
    s_cbranch_scc1 C_main_kernel_66
    s_cbranch_vccnz R_main_kernel_65
C_main_kernel_66:
    s_waitcnt lgkmcnt(8)
    v_mfma_f32_16x16x32_bf16 v[100:103], a[0:3], v[16:19], 0
    ds_read_b128 a[0:3], v8 offset:10240
    buffer_load_dwordx4 v[40:43], v4, s[4:7], s58 offen offset:2048 sc1
    v_mfma_f32_16x16x32_bf16 v[104:107], a[4:7], v[16:19], 0
    s_waitcnt lgkmcnt(5)
    ds_read_b128 a[4:7], v8 offset:11264
    v_mov_b32 v142, 0x3727c5ac
    v_mfma_f32_16x16x32_bf16 v[108:111], a[8:11], v[16:19], 0
    ds_read_b128 a[8:11], v8 offset:12288
    buffer_load_dwordx4 v[44:47], v4, s[4:7], s58 offen offset:3072 sc1
    v_mfma_f32_16x16x32_bf16 v[112:115], a[12:15], v[16:19], 0
    ds_read_b128 a[12:15], v8 offset:13312
    v_add_u32 v143, s69, v12
    v_mfma_f32_16x16x32_bf16 v[100:103], a[16:19], v[20:23], v[100:103]
    s_waitcnt vmcnt(5)
    ds_read_b128 a[16:19], v8 offset:14336
    v_max_u32 v0, v24, v28
    v_mfma_f32_16x16x32_bf16 v[104:107], a[20:23], v[20:23], v[104:107]
    s_waitcnt lgkmcnt(5)
    ds_read_b128 a[20:23], v8 offset:15360
    v_cmp_eq_u32 vcc, -1, v0
    v_mfma_f32_16x16x32_bf16 v[108:111], v[116:119], v[20:23], v[108:111]
    ds_read_b128 v[116:119], v8 offset:16384
    v_mfma_f32_16x16x32_bf16 v[112:115], v[120:123], v[20:23], v[112:115]
    s_cbranch_vccnz R_main_kernel_67
C_main_kernel_68:
    ds_read_b128 v[120:123], v8 offset:17408
    v_bfe_i32 v143, v143, 4, 1
    v_mfma_f32_16x16x32_bf16 v[100:103], v[124:127], v[24:27], v[100:103]
    ds_read_b128 v[124:127], v8 offset:18432
    buffer_load_dwordx4 v[48:51], v5, s[4:7], s58 offen offset:0 sc1
    v_mfma_f32_16x16x32_bf16 v[104:107], v[128:131], v[24:27], v[104:107]
    s_waitcnt lgkmcnt(5)
    ds_read_b128 v[128:131], v8 offset:19456
    v_mfma_f32_16x16x32_bf16 v[108:111], a[0:3], v[24:27], v[108:111]
    ds_read_b128 a[0:3], v8 offset:20480
    buffer_load_dwordx4 v[52:55], v5, s[4:7], s58 offen offset:1024 sc1
    v_mfma_f32_16x16x32_bf16 v[112:115], a[4:7], v[24:27], v[112:115]
    ds_read_b128 a[4:7], v8 offset:21504
    v_bfi_b32 v14, v143, s70, v14
    v_mfma_f32_16x16x32_bf16 v[100:103], a[8:11], v[28:31], v[100:103]
    s_waitcnt vmcnt(5)
    ds_read_b128 a[8:11], v8 offset:22528
    v_max_u32 v0, v32, v36
    v_mfma_f32_16x16x32_bf16 v[104:107], a[12:15], v[28:31], v[104:107]
    s_waitcnt lgkmcnt(5)
    ds_read_b128 a[12:15], v8 offset:23552
    v_cmp_eq_u32 vcc, -1, v0
    v_mfma_f32_16x16x32_bf16 v[108:111], a[16:19], v[28:31], v[108:111]
    ds_read_b128 a[16:19], v8 offset:24576
    v_mfma_f32_16x16x32_bf16 v[112:115], a[20:23], v[28:31], v[112:115]
    s_cbranch_vccnz R_main_kernel_69
C_main_kernel_70:
    ds_read_b128 a[20:23], v8 offset:25600
    v_xor_b32 v143, -1, v143
    v_mfma_f32_16x16x32_bf16 v[100:103], v[116:119], v[32:35], v[100:103]
    ds_read_b128 v[116:119], v8 offset:26624
    buffer_load_dwordx4 v[56:59], v5, s[4:7], s58 offen offset:2048 sc1
    v_mfma_f32_16x16x32_bf16 v[104:107], v[120:123], v[32:35], v[104:107]
    s_waitcnt lgkmcnt(5)
    ds_read_b128 v[120:123], v8 offset:27648
    v_mfma_f32_16x16x32_bf16 v[108:111], v[124:127], v[32:35], v[108:111]
    ds_read_b128 v[124:127], v8 offset:28672
    buffer_load_dwordx4 v[60:63], v5, s[4:7], s58 offen offset:3072 sc1
    v_mfma_f32_16x16x32_bf16 v[112:115], v[128:131], v[32:35], v[112:115]
    ds_read_b128 v[128:131], v8 offset:29696
    v_and_b32 v143, 0x80000000, v143
    v_mfma_f32_16x16x32_bf16 v[100:103], a[0:3], v[36:39], v[100:103]
    s_waitcnt vmcnt(4)
    ds_read_b128 a[0:3], v8 offset:30720
    v_max_u32 v0, v40, v44
    v_mfma_f32_16x16x32_bf16 v[104:107], a[4:7], v[36:39], v[104:107]
    s_waitcnt lgkmcnt(5)
    ds_read_b128 a[4:7], v8 offset:31744
    v_cmp_eq_u32 vcc, -1, v0
    v_mfma_f32_16x16x32_bf16 v[108:111], a[8:11], v[36:39], v[108:111]
    ds_read_b128 a[8:11], v8 offset:32768
    v_mfma_f32_16x16x32_bf16 v[112:115], a[12:15], v[36:39], v[112:115]
    s_cbranch_vccnz R_main_kernel_71
C_main_kernel_72:
    ds_read_b128 a[12:15], v8 offset:33792
    v_add_u32 v143, v143, v3
    v_mfma_f32_16x16x32_bf16 v[100:103], a[16:19], v[40:43], v[100:103]
    ds_read_b128 a[16:19], v8 offset:34816
    buffer_load_dwordx4 v[64:67], v6, s[4:7], s58 offen offset:0 sc1
    v_mfma_f32_16x16x32_bf16 v[104:107], a[20:23], v[40:43], v[104:107]
    s_waitcnt lgkmcnt(5)
    ds_read_b128 a[20:23], v8 offset:35840
    v_mfma_f32_16x16x32_bf16 v[108:111], v[116:119], v[40:43], v[108:111]
    ds_read_b128 v[116:119], v8 offset:36864
    buffer_load_dwordx4 v[68:71], v6, s[4:7], s58 offen offset:1024 sc1
    v_max_u32 v0, v96, v97
    v_mfma_f32_16x16x32_bf16 v[112:115], v[120:123], v[40:43], v[112:115]
    ds_read_b128 v[120:123], v8 offset:37888
    v_max3_u32 v0, v0, v98, v99
    v_mfma_f32_16x16x32_bf16 v[100:103], v[124:127], v[44:47], v[100:103]
    s_waitcnt vmcnt(4)
    ds_read_b128 v[124:127], v8 offset:38912
    v_max3_u32 v0, v0, v48, v52
    v_mfma_f32_16x16x32_bf16 v[104:107], v[128:131], v[44:47], v[104:107]
    s_waitcnt lgkmcnt(5)
    ds_read_b128 v[128:131], v8 offset:39936
    v_cmp_eq_u32 vcc, -1, v0
    v_mfma_f32_16x16x32_bf16 v[108:111], a[0:3], v[44:47], v[108:111]
    ds_read_b128 a[0:3], v8 offset:40960
    v_add_u32 v14, v14, v3
    v_mfma_f32_16x16x32_bf16 v[112:115], a[4:7], v[44:47], v[112:115]
    s_cbranch_vccnz R_main_kernel_73
C_main_kernel_74:
    ds_read_b128 a[4:7], v8 offset:41984
    v_add_f32 v96, v96, v98
    v_add_f32 v97, v97, v99
    v_mfma_f32_16x16x32_bf16 v[100:103], a[8:11], v[48:51], v[100:103]
    ds_read_b128 a[8:11], v8 offset:43008
    buffer_load_dwordx4 v[72:75], v6, s[4:7], s58 offen offset:2048 sc1
    v_mfma_f32_16x16x32_bf16 v[104:107], a[12:15], v[48:51], v[104:107]
    s_waitcnt lgkmcnt(5)
    ds_read_b128 a[12:15], v8 offset:44032
    v_mov_b32 v98, v96
    v_mfma_f32_16x16x32_bf16 v[108:111], a[16:19], v[48:51], v[108:111]
    ds_read_b128 a[16:19], v8 offset:45056
    buffer_load_dwordx4 v[76:79], v6, s[4:7], s58 offen offset:3072 sc1
    v_mfma_f32_16x16x32_bf16 v[112:115], a[20:23], v[48:51], v[112:115]
    ds_read_b128 a[20:23], v8 offset:46080
    v_mov_b32 v99, v97
    v_permlane16_swap_b32 v96, v98
    v_mfma_f32_16x16x32_bf16 v[100:103], v[116:119], v[52:55], v[100:103]
    s_waitcnt vmcnt(4)
    ds_read_b128 v[116:119], v8 offset:47104
    v_max_u32 v0, v56, v60
    v_mfma_f32_16x16x32_bf16 v[104:107], v[120:123], v[52:55], v[104:107]
    s_waitcnt lgkmcnt(5)
    ds_read_b128 v[120:123], v8 offset:48128
    v_cmp_eq_u32 vcc, -1, v0
    v_mfma_f32_16x16x32_bf16 v[108:111], v[124:127], v[52:55], v[108:111]
    ds_read_b128 v[124:127], v8 offset:49152
    v_permlane16_swap_b32 v97, v99
    v_mfma_f32_16x16x32_bf16 v[112:115], v[128:131], v[52:55], v[112:115]
    s_cbranch_vccnz R_main_kernel_75
C_main_kernel_76:
    ds_read_b128 v[128:131], v8 offset:50176
    v_add_f32 v96, v96, v98
    v_add_f32 v97, v97, v99
    v_mfma_f32_16x16x32_bf16 v[100:103], a[0:3], v[56:59], v[100:103]
    ds_read_b128 a[0:3], v8 offset:51200
    v_mov_b32 v98, v96
    v_mfma_f32_16x16x32_bf16 v[104:107], a[4:7], v[56:59], v[104:107]
    s_waitcnt lgkmcnt(5)
    ds_read_b128 a[4:7], v8 offset:52224
    v_mov_b32 v99, v97
    v_mfma_f32_16x16x32_bf16 v[108:111], a[8:11], v[56:59], v[108:111]
    ds_read_b128 a[8:11], v8 offset:53248
    v_permlane32_swap_b32 v96, v98
    v_permlane32_swap_b32 v97, v99
    v_mfma_f32_16x16x32_bf16 v[112:115], a[12:15], v[56:59], v[112:115]
    ds_read_b128 a[12:15], v8 offset:54272
    v_add_f32 v96, v96, v98
    v_mfma_f32_16x16x32_bf16 v[100:103], a[16:19], v[60:63], v[100:103]
    s_waitcnt vmcnt(2)
    ds_read_b128 a[16:19], v8 offset:55296
    v_max_u32 v0, v64, v68
    v_mfma_f32_16x16x32_bf16 v[104:107], a[20:23], v[60:63], v[104:107]
    s_waitcnt lgkmcnt(5)
    ds_read_b128 a[20:23], v8 offset:56320
    v_cmp_eq_u32 vcc, -1, v0
    v_mfma_f32_16x16x32_bf16 v[108:111], v[116:119], v[60:63], v[108:111]
    ds_read_b128 v[116:119], v8 offset:57344
    v_add_f32 v97, v97, v99
    v_mul_f32 v134, 0xbb000000, v96
    v_mfma_f32_16x16x32_bf16 v[112:115], v[120:123], v[60:63], v[112:115]
    s_cbranch_vccnz R_main_kernel_77
C_main_kernel_78:
    ds_read_b128 v[120:123], v8 offset:58368
    v_mul_f32 v97, 0x3b000000, v97
    v_mfma_f32_16x16x32_bf16 v[100:103], v[124:127], v[64:67], v[100:103]
    ds_read_b128 v[124:127], v8 offset:59392
    v_fma_f32 v97, -v134, v134, v97
    v_max_f32 v97, 0, v97
    v_mfma_f32_16x16x32_bf16 v[104:107], v[128:131], v[64:67], v[104:107]
    s_waitcnt lgkmcnt(5)
    ds_read_b128 v[128:131], v8 offset:60416
    v_add_f32 v140, 0x3727c5ac, v97
    v_mfma_f32_16x16x32_bf16 v[108:111], a[0:3], v[64:67], v[108:111]
    ds_read_b128 a[0:3], v8 offset:61440
    v_rsq_f32 v138, v140
    v_mfma_f32_16x16x32_bf16 v[112:115], a[4:7], v[64:67], v[112:115]
    ds_read_b128 a[4:7], v8 offset:62464
    v_mul_f32 v140, v138, v138
    v_fma_f32 v140, v140, v97, v142
    v_mfma_f32_16x16x32_bf16 v[100:103], a[8:11], v[68:71], v[100:103]
    s_waitcnt vmcnt(0)
    ds_read_b128 a[8:11], v8 offset:63488
    v_max_u32 v0, v72, v76
    v_mfma_f32_16x16x32_bf16 v[104:107], a[12:15], v[68:71], v[104:107]
    s_waitcnt lgkmcnt(5)
    ds_read_b128 a[12:15], v8 offset:64512
    v_cmp_eq_u32 vcc, -1, v0
    v_mfma_f32_16x16x32_bf16 v[108:111], a[16:19], v[68:71], v[108:111]
    ds_read_b128 a[16:19], v7 offset:0
    v_rsq_f32 v140, v140
    v_mfma_f32_16x16x32_bf16 v[112:115], a[20:23], v[68:71], v[112:115]
    s_cbranch_vccnz R_main_kernel_79
C_main_kernel_80:
    ds_read_b128 a[20:23], v7 offset:1024
    v_mul_f32 v139, v134, v138
    v_mul_f32 v141, v138, v140
    v_mfma_f32_16x16x32_bf16 v[100:103], v[116:119], v[72:75], v[100:103]
    ds_read_b128 v[116:119], v7 offset:2048
    ds_read_b128 v[16:19], v133 offset:0
    v_mfma_f32_16x16x32_bf16 v[104:107], v[120:123], v[72:75], v[104:107]
    s_waitcnt lgkmcnt(6)
    ds_read_b128 v[120:123], v7 offset:3072
    ds_read_b128 v[20:23], v133 offset:64
    v_mfma_f32_16x16x32_bf16 v[108:111], v[124:127], v[72:75], v[108:111]
    ds_read_b128 v[124:127], v7 offset:4096
    ds_read_b128 v[24:27], v133 offset:128
    v_mfma_f32_16x16x32_bf16 v[112:115], v[128:131], v[72:75], v[112:115]
    ds_read_b128 v[128:131], v7 offset:5120
    ds_read_b128 v[28:31], v133 offset:192
    v_mfma_f32_16x16x32_bf16 v[100:103], a[0:3], v[76:79], v[100:103]
    ds_read_b128 a[0:3], v7 offset:6144
    v_rcp_f32 v135, v141
    v_mfma_f32_16x16x32_bf16 v[104:107], a[4:7], v[76:79], v[104:107]
    s_waitcnt lgkmcnt(11)
    ds_read_b128 a[4:7], v7 offset:7168
    v_mul_f32 v136, v141, v141
    v_mul_f32 v137, 0xc0135761, v141
    v_mfma_f32_16x16x32_bf16 v[108:111], a[8:11], v[76:79], v[108:111]
    ds_read_b128 a[8:11], v7 offset:8192
    v_mul_f32 v136, v136, v141
    v_mfma_f32_16x16x32_bf16 v[112:115], a[12:15], v[76:79], v[112:115]
    ds_read_b128 a[12:15], v7 offset:9216
    v_mul_f32 v136, 0xbdd2d3e8, v136
    s_waitcnt lgkmcnt(4)
    s_cmp_lg_u32 s66, 0
    v_pk_fma_f32 v[100:101], v[16:17], v[134:135], v[100:101] op_sel_hi:[1,0,1]
    v_pk_fma_f32 v[102:103], v[18:19], v[134:135], v[102:103] op_sel_hi:[1,0,1]
    v_pk_fma_f32 v[104:105], v[20:21], v[134:135], v[104:105] op_sel_hi:[1,0,1]
    v_pk_fma_f32 v[106:107], v[22:23], v[134:135], v[106:107] op_sel_hi:[1,0,1]
    v_pk_mul_f32 v[32:33], v[100:101], v[100:101]
    v_pk_mul_f32 v[34:35], v[102:103], v[102:103]
    v_pk_mul_f32 v[36:37], v[104:105], v[104:105]
    v_pk_mul_f32 v[38:39], v[106:107], v[106:107]
    v_pk_fma_f32 v[32:33], v[32:33], v[136:137], v[136:137] op_sel:[0,0,1] op_sel_hi:[1,0,1]
    v_pk_fma_f32 v[34:35], v[34:35], v[136:137], v[136:137] op_sel:[0,0,1] op_sel_hi:[1,0,1]
    v_pk_fma_f32 v[36:37], v[36:37], v[136:137], v[136:137] op_sel:[0,0,1] op_sel_hi:[1,0,1]
    v_pk_fma_f32 v[38:39], v[38:39], v[136:137], v[136:137] op_sel:[0,0,1] op_sel_hi:[1,0,1]
    v_pk_mul_f32 v[32:33], v[32:33], v[100:101]
    v_pk_mul_f32 v[34:35], v[34:35], v[102:103]
    v_pk_mul_f32 v[36:37], v[36:37], v[104:105]
    v_pk_mul_f32 v[38:39], v[38:39], v[106:107]
    v_exp_f32 v32, v32
    v_exp_f32 v33, v33
    v_exp_f32 v34, v34
    v_exp_f32 v35, v35
    v_exp_f32 v36, v36
    v_exp_f32 v37, v37
    v_exp_f32 v38, v38
    v_exp_f32 v39, v39
    v_pk_fma_f32 v[32:33], v[32:33], v[134:135], v[134:135] op_sel:[0,1,1] op_sel_hi:[1,1,1]
    v_pk_fma_f32 v[34:35], v[34:35], v[134:135], v[134:135] op_sel:[0,1,1] op_sel_hi:[1,1,1]
    v_pk_fma_f32 v[36:37], v[36:37], v[134:135], v[134:135] op_sel:[0,1,1] op_sel_hi:[1,1,1]
    v_pk_fma_f32 v[38:39], v[38:39], v[134:135], v[134:135] op_sel:[0,1,1] op_sel_hi:[1,1,1]
    v_rcp_f32 v32, v32
    v_rcp_f32 v33, v33
    v_rcp_f32 v34, v34
    v_rcp_f32 v35, v35
    v_rcp_f32 v36, v36
    v_rcp_f32 v37, v37
    v_rcp_f32 v38, v38
    v_rcp_f32 v39, v39
    v_pk_mul_f32 v[100:101], v[100:101], v[32:33]
    v_pk_mul_f32 v[102:103], v[102:103], v[34:35]
    v_pk_mul_f32 v[104:105], v[104:105], v[36:37]
    v_pk_mul_f32 v[106:107], v[106:107], v[38:39]
    v_cvt_pk_bf16_f32 v48, v100, v101
    v_cvt_pk_bf16_f32 v49, v102, v103
    v_cvt_pk_bf16_f32 v50, v104, v105
    v_cvt_pk_bf16_f32 v51, v106, v107
    v_min_u32 v48, s32, v48
    s_cbranch_scc1 M_main_kernel_81
C_main_kernel_82:
    buffer_store_dwordx4 v[48:51], v14, s[4:7], s61 offen offset:0
    v_pk_fma_f32 v[108:109], v[24:25], v[134:135], v[108:109] op_sel_hi:[1,0,1]
    v_pk_fma_f32 v[110:111], v[26:27], v[134:135], v[110:111] op_sel_hi:[1,0,1]
    v_pk_fma_f32 v[112:113], v[28:29], v[134:135], v[112:113] op_sel_hi:[1,0,1]
    v_pk_fma_f32 v[114:115], v[30:31], v[134:135], v[114:115] op_sel_hi:[1,0,1]
    v_pk_mul_f32 v[40:41], v[108:109], v[108:109]
    v_pk_mul_f32 v[42:43], v[110:111], v[110:111]
    v_pk_mul_f32 v[44:45], v[112:113], v[112:113]
    v_pk_mul_f32 v[46:47], v[114:115], v[114:115]
    v_pk_fma_f32 v[40:41], v[40:41], v[136:137], v[136:137] op_sel:[0,0,1] op_sel_hi:[1,0,1]
    v_pk_fma_f32 v[42:43], v[42:43], v[136:137], v[136:137] op_sel:[0,0,1] op_sel_hi:[1,0,1]
    v_pk_fma_f32 v[44:45], v[44:45], v[136:137], v[136:137] op_sel:[0,0,1] op_sel_hi:[1,0,1]
    v_pk_fma_f32 v[46:47], v[46:47], v[136:137], v[136:137] op_sel:[0,0,1] op_sel_hi:[1,0,1]
    v_pk_mul_f32 v[40:41], v[40:41], v[108:109]
    v_pk_mul_f32 v[42:43], v[42:43], v[110:111]
    v_pk_mul_f32 v[44:45], v[44:45], v[112:113]
    v_pk_mul_f32 v[46:47], v[46:47], v[114:115]
    v_exp_f32 v40, v40
    v_exp_f32 v41, v41
    v_exp_f32 v42, v42
    v_exp_f32 v43, v43
    v_exp_f32 v44, v44
    v_exp_f32 v45, v45
    v_exp_f32 v46, v46
    v_exp_f32 v47, v47
    v_pk_fma_f32 v[40:41], v[40:41], v[134:135], v[134:135] op_sel:[0,1,1] op_sel_hi:[1,1,1]
    v_pk_fma_f32 v[42:43], v[42:43], v[134:135], v[134:135] op_sel:[0,1,1] op_sel_hi:[1,1,1]
    v_pk_fma_f32 v[44:45], v[44:45], v[134:135], v[134:135] op_sel:[0,1,1] op_sel_hi:[1,1,1]
    v_pk_fma_f32 v[46:47], v[46:47], v[134:135], v[134:135] op_sel:[0,1,1] op_sel_hi:[1,1,1]
    v_rcp_f32 v40, v40
    v_rcp_f32 v41, v41
    v_rcp_f32 v42, v42
    v_rcp_f32 v43, v43
    v_rcp_f32 v44, v44
    v_rcp_f32 v45, v45
    v_rcp_f32 v46, v46
    v_rcp_f32 v47, v47
    v_pk_mul_f32 v[108:109], v[108:109], v[40:41]
    v_pk_mul_f32 v[110:111], v[110:111], v[42:43]
    v_pk_mul_f32 v[112:113], v[112:113], v[44:45]
    v_pk_mul_f32 v[114:115], v[114:115], v[46:47]
    v_cvt_pk_bf16_f32 v52, v108, v109
    v_cvt_pk_bf16_f32 v53, v110, v111
    v_cvt_pk_bf16_f32 v54, v112, v113
    v_cvt_pk_bf16_f32 v55, v114, v115
    v_min_u32 v52, s32, v52
    s_cbranch_scc1 M_main_kernel_83
C_main_kernel_84:
    buffer_store_dwordx4 v[52:55], v14, s[4:7], s61 offen offset:1024
    v_pk_fma_f32 v[100:101], v[80:81], v[138:139], v[138:139] op_sel:[0,0,1] op_sel_hi:[1,0,1]
    v_pk_fma_f32 v[102:103], v[82:83], v[138:139], v[138:139] op_sel:[0,0,1] op_sel_hi:[1,0,1]
    v_pk_fma_f32 v[104:105], v[84:85], v[138:139], v[138:139] op_sel:[0,0,1] op_sel_hi:[1,0,1]
    v_pk_fma_f32 v[106:107], v[86:87], v[138:139], v[138:139] op_sel:[0,0,1] op_sel_hi:[1,0,1]
    v_pk_fma_f32 v[108:109], v[88:89], v[138:139], v[138:139] op_sel:[0,0,1] op_sel_hi:[1,0,1]
    v_pk_fma_f32 v[110:111], v[90:91], v[138:139], v[138:139] op_sel:[0,0,1] op_sel_hi:[1,0,1]
    v_pk_fma_f32 v[112:113], v[92:93], v[138:139], v[138:139] op_sel:[0,0,1] op_sel_hi:[1,0,1]
    v_pk_fma_f32 v[114:115], v[94:95], v[138:139], v[138:139] op_sel:[0,0,1] op_sel_hi:[1,0,1]
    v_mfma_f32_16x16x32_bf16 a[164:167], v[208:211], a[172:175], 0
    ds_write_b128 v132, a[24:27] offset:0
    v_mfma_f32_16x16x32_bf16 a[164:167], v[212:215], a[172:175], a[164:167]
    ds_write_b128 v132, a[28:31] offset:1024
    v_mfma_f32_16x16x32_bf16 a[164:167], v[216:219], a[172:175], a[164:167]
    ds_write_b128 v132, a[32:35] offset:2048
    v_mfma_f32_16x16x32_bf16 a[164:167], v[220:223], a[172:175], a[164:167]
    ds_write_b128 v132, a[36:39] offset:3072
    v_mfma_f32_16x16x32_bf16 a[164:167], v[224:227], a[172:175], a[164:167]
    buffer_load_dwordx4 v[16:19], v2, s[4:7], s60 offen offset:0 sc1
    ds_write_b128 v132, a[40:43] offset:4096
    v_mfma_f32_16x16x32_bf16 a[164:167], v[228:231], a[172:175], a[164:167]
    ds_write_b128 v132, a[44:47] offset:5120
    v_mfma_f32_16x16x32_bf16 a[164:167], v[232:235], a[172:175], a[164:167]
    buffer_load_dwordx4 v[20:23], v2, s[4:7], s60 offen offset:1024 sc1
    ds_write_b128 v132, a[48:51] offset:6144
    v_mfma_f32_16x16x32_bf16 a[164:167], v[236:239], a[172:175], a[164:167]
    ds_write_b128 v132, a[52:55] offset:7168
    v_mfma_f32_16x16x32_bf16 a[164:167], v[240:243], a[172:175], a[164:167]
    buffer_load_dwordx4 v[24:27], v2, s[4:7], s60 offen offset:2048 sc1
    ds_write_b128 v132, a[56:59] offset:8192
    v_mfma_f32_16x16x32_bf16 a[164:167], v[244:247], a[172:175], a[164:167]
    ds_write_b128 v132, a[60:63] offset:9216
    v_mfma_f32_16x16x32_bf16 a[164:167], v[248:251], a[172:175], a[164:167]
    buffer_load_dwordx4 v[28:31], v2, s[4:7], s60 offen offset:3072 sc1
    v_mfma_f32_16x16x32_bf16 a[164:167], v[252:255], a[172:175], a[164:167]
    v_mfma_f32_16x16x32_bf16 a[164:167], a[176:179], a[172:175], a[164:167]
    buffer_load_dwordx4 v[32:35], v10, s[4:7], s60 offen offset:0 sc1
    v_mfma_f32_16x16x32_bf16 a[164:167], a[180:183], a[172:175], a[164:167]
    v_mfma_f32_16x16x32_bf16 a[164:167], a[184:187], a[172:175], a[164:167]
    buffer_load_dwordx4 v[36:39], v10, s[4:7], s60 offen offset:1024 sc1
    v_mfma_f32_16x16x32_bf16 a[164:167], a[188:191], a[172:175], a[164:167]
    s_waitcnt lgkmcnt(0)
    s_barrier
    s_waitcnt vmcnt(4)
    v_max_u32 v0, v16, v20
    v_cmp_eq_u32 vcc, -1, v0
    s_cbranch_vccz C_main_kernel_103
R_main_kernel_102:
    buffer_load_dwordx4 v[16:19], v2, s[4:7], s60 offen offset:0 sc1
    buffer_load_dwordx4 v[20:23], v2, s[4:7], s60 offen offset:1024 sc1
    buffer_load_dwordx4 v[24:27], v2, s[4:7], s60 offen offset:2048 sc1
    buffer_load_dwordx4 v[28:31], v2, s[4:7], s60 offen offset:3072 sc1
    buffer_load_dwordx4 v[32:35], v10, s[4:7], s60 offen offset:0 sc1
    buffer_load_dwordx4 v[36:39], v10, s[4:7], s60 offen offset:1024 sc1
    s_add_u32 s33, s33, 1
    s_cmp_gt_u32 s33, 20000
    s_waitcnt vmcnt(4)
    v_max_u32 v0, v16, v20
    v_cmp_eq_u32 vcc, -1, v0
    s_cbranch_scc1 C_main_kernel_103
    s_cbranch_vccnz R_main_kernel_102
C_main_kernel_103:
    s_waitcnt lgkmcnt(15)
    v_mfma_f32_16x16x32_bf16 v[100:103], a[16:19], v[16:19], v[100:103]
    ds_read_b128 a[16:19], v7 offset:10240
    buffer_load_dwordx4 v[40:43], v10, s[4:7], s60 offen offset:2048 sc1
    v_mfma_f32_16x16x32_bf16 v[104:107], a[20:23], v[16:19], v[104:107]
    s_waitcnt lgkmcnt(15)
    ds_read_b128 a[20:23], v7 offset:11264
    v_mfma_f32_16x16x32_bf16 v[108:111], v[116:119], v[16:19], v[108:111]
    ds_read_b128 v[116:119], v7 offset:12288
    buffer_load_dwordx4 v[44:47], v10, s[4:7], s60 offen offset:3072 sc1
    v_mfma_f32_16x16x32_bf16 v[112:115], v[120:123], v[16:19], v[112:115]
    ds_read_b128 v[120:123], v7 offset:13312
    v_mfma_f32_16x16x32_bf16 v[100:103], v[124:127], v[20:23], v[100:103]
    s_waitcnt vmcnt(4)
    ds_read_b128 v[124:127], v7 offset:14336
    v_max_u32 v0, v24, v28
    v_mfma_f32_16x16x32_bf16 v[104:107], v[128:131], v[20:23], v[104:107]
    s_waitcnt lgkmcnt(15)
    ds_read_b128 v[128:131], v7 offset:15360
    v_cmp_eq_u32 vcc, -1, v0
    v_mfma_f32_16x16x32_bf16 v[108:111], a[0:3], v[20:23], v[108:111]
    ds_read_b128 a[0:3], v7 offset:16384
    v_mfma_f32_16x16x32_bf16 v[112:115], a[4:7], v[20:23], v[112:115]
    s_cbranch_vccnz R_main_kernel_104
C_main_kernel_105:
    ds_read_b128 a[4:7], v7 offset:17408
    v_mfma_f32_16x16x32_bf16 v[100:103], a[8:11], v[24:27], v[100:103]
    ds_read_b128 a[8:11], v7 offset:18432
    buffer_load_dwordx4 v[48:51], v11, s[4:7], s60 offen offset:0 sc1
    v_mfma_f32_16x16x32_bf16 v[104:107], a[12:15], v[24:27], v[104:107]
    s_waitcnt lgkmcnt(5)
    ds_read_b128 a[12:15], v7 offset:19456
    v_mfma_f32_16x16x32_bf16 v[108:111], a[16:19], v[24:27], v[108:111]
    ds_read_b128 a[16:19], v7 offset:20480
    buffer_load_dwordx4 v[52:55], v11, s[4:7], s60 offen offset:1024 sc1
    v_mfma_f32_16x16x32_bf16 v[112:115], a[20:23], v[24:27], v[112:115]
    ds_read_b128 a[20:23], v7 offset:21504
    v_mfma_f32_16x16x32_bf16 v[100:103], v[116:119], v[28:31], v[100:103]
    s_waitcnt vmcnt(4)
    ds_read_b128 v[116:119], v7 offset:22528
    v_max_u32 v0, v32, v36
    v_mfma_f32_16x16x32_bf16 v[104:107], v[120:123], v[28:31], v[104:107]
    s_waitcnt lgkmcnt(5)
    ds_read_b128 v[120:123], v7 offset:23552
    v_cmp_eq_u32 vcc, -1, v0
    v_mfma_f32_16x16x32_bf16 v[108:111], v[124:127], v[28:31], v[108:111]
    ds_read_b128 v[124:127], v3 offset:24576
    v_mfma_f32_16x16x32_bf16 v[112:115], v[128:131], v[28:31], v[112:115]
    s_cbranch_vccnz R_main_kernel_106
C_main_kernel_107:
    ds_read_b128 v[128:131], v3 offset:25600
    v_mfma_f32_16x16x32_bf16 v[100:103], a[0:3], v[32:35], v[100:103]
    ds_read_b128 a[0:3], v3 offset:26624
    buffer_load_dwordx4 v[56:59], v11, s[4:7], s60 offen offset:2048 sc1
    v_mfma_f32_16x16x32_bf16 v[104:107], a[4:7], v[32:35], v[104:107]
    s_waitcnt lgkmcnt(5)
    ds_read_b128 a[4:7], v3 offset:27648
    v_mfma_f32_16x16x32_bf16 v[108:111], a[8:11], v[32:35], v[108:111]
    ds_read_b128 a[8:11], v3 offset:28672
    buffer_load_dwordx4 v[60:63], v11, s[4:7], s60 offen offset:3072 sc1
    v_mfma_f32_16x16x32_bf16 v[112:115], a[12:15], v[32:35], v[112:115]
    ds_read_b128 a[12:15], v3 offset:29696
    v_mfma_f32_16x16x32_bf16 v[100:103], a[16:19], v[36:39], v[100:103]
    s_waitcnt vmcnt(4)
    ds_read_b128 a[16:19], v3 offset:30720
    v_max_u32 v0, v40, v44
    v_mfma_f32_16x16x32_bf16 v[104:107], a[20:23], v[36:39], v[104:107]
    s_waitcnt lgkmcnt(5)
    ds_read_b128 a[20:23], v3 offset:31744
    v_cmp_eq_u32 vcc, -1, v0
    v_mfma_f32_16x16x32_bf16 v[108:111], v[116:119], v[36:39], v[108:111]
    ds_read_b128 v[116:119], v3 offset:32768
    v_mfma_f32_16x16x32_bf16 v[112:115], v[120:123], v[36:39], v[112:115]
    s_cbranch_vccnz R_main_kernel_108
C_main_kernel_109:
    ds_read_b128 v[120:123], v3 offset:33792
    v_mfma_f32_16x16x32_bf16 v[100:103], v[124:127], v[40:43], v[100:103]
    ds_read_b128 v[124:127], v3 offset:34816
    buffer_load_dwordx4 v[64:67], v15, s[4:7], s60 offen offset:0 sc1
    v_mfma_f32_16x16x32_bf16 v[104:107], v[128:131], v[40:43], v[104:107]
    s_waitcnt lgkmcnt(5)
    ds_read_b128 v[128:131], v3 offset:35840
    v_mfma_f32_16x16x32_bf16 v[108:111], a[0:3], v[40:43], v[108:111]
    ds_read_b128 a[0:3], v3 offset:36864
    buffer_load_dwordx4 v[68:71], v15, s[4:7], s60 offen offset:1024 sc1
    v_mfma_f32_16x16x32_bf16 v[112:115], a[4:7], v[40:43], v[112:115]
    ds_read_b128 a[4:7], v3 offset:37888
    v_mfma_f32_16x16x32_bf16 v[100:103], a[8:11], v[44:47], v[100:103]
    s_waitcnt vmcnt(4)
    ds_read_b128 a[8:11], v3 offset:38912
    v_max_u32 v0, v48, v52
    v_mfma_f32_16x16x32_bf16 v[104:107], a[12:15], v[44:47], v[104:107]
    s_waitcnt lgkmcnt(5)
    ds_read_b128 a[12:15], v3 offset:39936
    v_cmp_eq_u32 vcc, -1, v0
    v_mfma_f32_16x16x32_bf16 v[108:111], a[16:19], v[44:47], v[108:111]
    ds_read_b128 a[16:19], v3 offset:40960
    v_mfma_f32_16x16x32_bf16 v[112:115], a[20:23], v[44:47], v[112:115]
    s_cbranch_vccnz R_main_kernel_110
C_main_kernel_111:
    ds_read_b128 a[20:23], v3 offset:41984
    v_lshl_add_u32 v14, v13, 2, v12
    v_mfma_f32_16x16x32_bf16 v[100:103], v[116:119], v[48:51], v[100:103]
    ds_read_b128 v[116:119], v3 offset:43008
    buffer_load_dwordx4 v[72:75], v15, s[4:7], s60 offen offset:2048 sc1
    v_mfma_f32_16x16x32_bf16 v[104:107], v[120:123], v[48:51], v[104:107]
    s_waitcnt lgkmcnt(5)
    ds_read_b128 v[120:123], v3 offset:44032
    v_mfma_f32_16x16x32_bf16 v[108:111], v[124:127], v[48:51], v[108:111]
    ds_read_b128 v[124:127], v3 offset:45056
    buffer_load_dwordx4 v[76:79], v15, s[4:7], s60 offen offset:3072 sc1
    v_mfma_f32_16x16x32_bf16 v[112:115], v[128:131], v[48:51], v[112:115]
    ds_read_b128 v[128:131], v3 offset:46080
    v_mfma_f32_16x16x32_bf16 v[100:103], a[0:3], v[52:55], v[100:103]
    s_waitcnt vmcnt(4)
    ds_read_b128 a[0:3], v3 offset:47104
    v_max_u32 v0, v56, v60
    v_mfma_f32_16x16x32_bf16 v[104:107], a[4:7], v[52:55], v[104:107]
    s_waitcnt lgkmcnt(5)
    ds_read_b128 a[4:7], v3 offset:48128
    v_cmp_eq_u32 vcc, -1, v0
    v_mfma_f32_16x16x32_bf16 v[108:111], a[8:11], v[52:55], v[108:111]
    ds_read_b128 a[8:11], v3 offset:49152
    v_and_b32 v14, 15, v14
    v_mfma_f32_16x16x32_bf16 v[112:115], a[12:15], v[52:55], v[112:115]
    s_cbranch_vccnz R_main_kernel_112
C_main_kernel_113:
    ds_read_b128 a[12:15], v3 offset:50176
    v_mfma_f32_16x16x32_bf16 v[100:103], a[16:19], v[56:59], v[100:103]
    ds_read_b128 a[16:19], v3 offset:51200
    v_mfma_f32_16x16x32_bf16 v[104:107], a[20:23], v[56:59], v[104:107]
    s_waitcnt lgkmcnt(5)
    ds_read_b128 a[20:23], v3 offset:52224
    v_mfma_f32_16x16x32_bf16 v[108:111], v[116:119], v[56:59], v[108:111]
    ds_read_b128 v[116:119], v3 offset:53248
    v_lshlrev_b32 v14, 4, v14
    v_mfma_f32_16x16x32_bf16 v[112:115], v[120:123], v[56:59], v[112:115]
    ds_read_b128 v[120:123], v3 offset:54272
    v_mfma_f32_16x16x32_bf16 v[100:103], v[124:127], v[60:63], v[100:103]
    s_waitcnt vmcnt(2)
    ds_read_b128 v[124:127], v3 offset:55296
    v_max_u32 v0, v64, v68
    v_mfma_f32_16x16x32_bf16 v[104:107], v[128:131], v[60:63], v[104:107]
    s_waitcnt lgkmcnt(5)
    ds_read_b128 v[128:131], v3 offset:56320
    v_cmp_eq_u32 vcc, -1, v0
    v_mfma_f32_16x16x32_bf16 v[108:111], a[0:3], v[60:63], v[108:111]
    ds_read_b128 a[0:3], v3 offset:57344
    v_mfma_f32_16x16x32_bf16 v[112:115], a[4:7], v[60:63], v[112:115]
    s_cbranch_vccnz R_main_kernel_114
C_main_kernel_115:
    ds_read_b128 a[4:7], v3 offset:58368
    v_lshl_add_u32 v14, v13, 8, v14
    v_mfma_f32_16x16x32_bf16 v[100:103], a[8:11], v[64:67], v[100:103]
    ds_read_b128 a[8:11], v3 offset:59392
    v_mfma_f32_16x16x32_bf16 v[104:107], a[12:15], v[64:67], v[104:107]
    s_waitcnt lgkmcnt(5)
    ds_read_b128 a[12:15], v3 offset:60416
    v_mfma_f32_16x16x32_bf16 v[108:111], a[16:19], v[64:67], v[108:111]
    ds_read_b128 a[16:19], v3 offset:61440
    v_mfma_f32_16x16x32_bf16 v[112:115], a[20:23], v[64:67], v[112:115]
    ds_read_b128 a[20:23], v3 offset:62464
    s_lshl_b32 s19, s18, 12
    v_mfma_f32_16x16x32_bf16 v[100:103], v[116:119], v[68:71], v[100:103]
    s_waitcnt vmcnt(0)
    ds_read_b128 v[116:119], v3 offset:63488
    v_max_u32 v0, v72, v76
    v_mfma_f32_16x16x32_bf16 v[104:107], v[120:123], v[68:71], v[104:107]
    s_waitcnt lgkmcnt(5)
    ds_read_b128 v[120:123], v3 offset:64512
    v_cmp_eq_u32 vcc, -1, v0
    v_mfma_f32_16x16x32_bf16 v[108:111], v[124:127], v[68:71], v[108:111]
    v_mfma_f32_16x16x32_bf16 v[112:115], v[128:131], v[68:71], v[112:115]
    s_cbranch_vccnz R_main_kernel_116
C_main_kernel_117:
    v_mfma_f32_16x16x32_bf16 v[100:103], a[0:3], v[72:75], v[100:103]
    v_add_u32 v14, s19, v14
    v_mfma_f32_16x16x32_bf16 v[104:107], a[4:7], v[72:75], v[104:107]
    s_waitcnt lgkmcnt(2)
    v_mfma_f32_16x16x32_bf16 v[108:111], a[8:11], v[72:75], v[108:111]
    v_mfma_f32_16x16x32_bf16 v[112:115], a[12:15], v[72:75], v[112:115]
    v_mfma_f32_16x16x32_bf16 v[100:103], a[16:19], v[76:79], v[100:103]
    v_add_u32 v7, s29, v8
    v_mfma_f32_16x16x32_bf16 v[104:107], a[20:23], v[76:79], v[104:107]
    s_waitcnt lgkmcnt(0)
    v_mfma_f32_16x16x32_bf16 v[108:111], v[116:119], v[76:79], v[108:111]
    v_mfma_f32_16x16x32_bf16 v[112:115], v[120:123], v[76:79], v[112:115]
    s_nop 2
    v_cvt_pk_bf16_f32 v48, v100, v101
    v_cvt_pk_bf16_f32 v49, v102, v103
    v_cvt_pk_bf16_f32 v50, v104, v105
    v_cvt_pk_bf16_f32 v51, v106, v107
    v_min_u32 v48, s32, v48
    buffer_store_dwordx4 v[48:51], v3, s[4:7], s63 offen offset:0
    v_cvt_pk_bf16_f32 v52, v108, v109
    v_cvt_pk_bf16_f32 v53, v110, v111
    v_cvt_pk_bf16_f32 v54, v112, v113
    v_cvt_pk_bf16_f32 v55, v114, v115
    v_min_u32 v52, s32, v52
    buffer_store_dwordx4 v[52:55], v3, s[4:7], s63 offen offset:1024
    v_dot2_f32_bf16 v132, v48, s31, 0
    v_dot2_f32_bf16 v133, v48, v48, 0
    v_dot2_f32_bf16 v132, v49, s31, v132
    v_dot2_f32_bf16 v133, v49, v49, v133
    v_dot2_f32_bf16 v132, v50, s31, v132
    v_dot2_f32_bf16 v133, v50, v50, v133
    v_dot2_f32_bf16 v132, v51, s31, v132
    v_dot2_f32_bf16 v133, v51, v51, v133
    v_dot2_f32_bf16 v132, v52, s31, v132
    v_dot2_f32_bf16 v133, v52, v52, v133
    v_dot2_f32_bf16 v132, v53, s31, v132
    v_dot2_f32_bf16 v133, v53, v53, v133
    v_dot2_f32_bf16 v132, v54, s31, v132
    v_dot2_f32_bf16 v133, v54, v54, v133
    v_dot2_f32_bf16 v132, v55, s31, v132
    v_dot2_f32_bf16 v133, v55, v55, v133
    s_nop 2
    v_permlane16_swap_b32 v132, v133
    v_add_f32 v132, v132, v133
L_hop_main_kernel_8:
    s_cbranch_execz L_hopb_main_kernel
    v_mov_b32 v133, v132
    s_nop 1
    v_permlane32_swap_b32 v132, v133
    v_add_f32 v132, v132, v133
    v_min_u32 v132, s32, v132
    buffer_store_dword v132, v9, s[4:7], s42 offen
    v_pk_add_f32 v[80:81], v[80:81], v[100:101]
    v_pk_add_f32 v[82:83], v[82:83], v[102:103]
    v_pk_add_f32 v[84:85], v[84:85], v[104:105]
    v_pk_add_f32 v[86:87], v[86:87], v[106:107]
    v_pk_add_f32 v[88:89], v[88:89], v[108:109]
    v_pk_add_f32 v[90:91], v[90:91], v[110:111]
    v_pk_add_f32 v[92:93], v[92:93], v[112:113]
    v_pk_add_f32 v[94:95], v[94:95], v[114:115]
    ds_write_b128 v14, v[80:83] offset:0
    ds_write_b128 v14, v[84:87] offset:1024
    ds_write_b128 v14, v[88:91] offset:2048
    ds_write_b128 v14, v[92:95] offset:3072
    v_mfma_f32_16x16x32_bf16 a[168:171], a[192:195], a[172:175], 0
    buffer_load_dwordx4 v[16:19], v3, s[4:7], s62 offen offset:0 sc1
    v_accvgpr_read_b32 v108, a160
    v_accvgpr_read_b32 v109, a161
    v_mfma_f32_16x16x32_bf16 a[168:171], a[196:199], a[172:175], a[168:171]
    v_accvgpr_read_b32 v110, a162
    v_accvgpr_read_b32 v111, a163
    v_mfma_f32_16x16x32_bf16 a[168:171], a[200:203], a[172:175], a[168:171]
    buffer_load_dwordx4 v[20:23], v3, s[4:7], s62 offen offset:1024 sc1
    v_accvgpr_read_b32 v112, a164
    v_accvgpr_read_b32 v113, a165
    v_mfma_f32_16x16x32_bf16 a[168:171], a[204:207], a[172:175], a[168:171]
    v_accvgpr_read_b32 v114, a166
    v_accvgpr_read_b32 v115, a167
    v_mfma_f32_16x16x32_bf16 a[168:171], a[208:211], a[172:175], a[168:171]
    buffer_load_dwordx4 v[24:27], v3, s[4:7], s62 offen offset:2048 sc1
    s_lshl_b32 s19, s18, 8
    v_lshlrev_b32 v15, 4, v12
    v_mfma_f32_16x16x32_bf16 a[168:171], a[212:215], a[172:175], a[168:171]
    v_add_u32 v15, 0x26a00, v15
    v_mfma_f32_16x16x32_bf16 a[168:171], a[216:219], a[172:175], a[168:171]
    buffer_load_dwordx4 v[28:31], v3, s[4:7], s62 offen offset:3072 sc1
    v_add_u32 v2, s19, v15
    v_add_u32 v10, s3, v3
    v_mfma_f32_16x16x32_bf16 a[168:171], a[220:223], a[172:175], a[168:171]
    s_cmp_eq_u32 s18, 3
    s_cselect_b32 s19, 0x80000000, 0
    v_add_u32 v11, s19, v5
    v_mfma_f32_16x16x32_bf16 a[168:171], a[224:227], a[172:175], a[168:171]
    s_lshr_b32 s19, s19, 21
    v_subrev_u32 v12, s19, v5
    v_mfma_f32_16x16x32_bf16 a[168:171], a[228:231], a[172:175], a[168:171]
    buffer_load_dwordx4 v[32:35], v4, s[4:7], s62 offen offset:0 sc1
    s_lshl_b32 s19, s71, 14
    v_add_u32 v80, s19, v8
    v_mfma_f32_16x16x32_bf16 a[168:171], a[232:235], a[172:175], a[168:171]
    s_lshl_b32 s19, s71, 8
    v_mfma_f32_16x16x32_bf16 a[168:171], a[236:239], a[172:175], a[168:171]
    buffer_load_dwordx4 v[36:39], v4, s[4:7], s62 offen offset:1024 sc1
    v_add_u32 v83, s19, v15
    s_lshl_b32 s19, s72, 14
    v_mfma_f32_16x16x32_bf16 a[168:171], a[240:243], a[172:175], a[168:171]
    v_add_u32 v81, s19, v8
    s_lshl_b32 s19, s72, 8
    v_mfma_f32_16x16x32_bf16 a[168:171], a[244:247], a[172:175], a[168:171]
    buffer_load_dwordx4 v[136:139], v3, s[4:7], s42 offen sc1
    v_add_u32 v142, s19, v15
    s_lshl_b32 s19, s73, 14
    v_mfma_f32_16x16x32_bf16 a[168:171], a[248:251], a[172:175], a[168:171]
    v_add_u32 v82, s19, v8
    s_lshl_b32 s19, s73, 8
    v_mfma_f32_16x16x32_bf16 a[168:171], a[252:255], a[172:175], a[168:171]
    v_add_u32 v143, s19, v15
    s_waitcnt vmcnt(5)
    v_max_u32 v0, v16, v20
    v_cmp_eq_u32 vcc, -1, v0
    s_cbranch_vccz C_main_kernel_137
R_main_kernel_136:
    buffer_load_dwordx4 v[16:19], v3, s[4:7], s62 offen offset:0 sc1
    buffer_load_dwordx4 v[20:23], v3, s[4:7], s62 offen offset:1024 sc1
    buffer_load_dwordx4 v[24:27], v3, s[4:7], s62 offen offset:2048 sc1
    buffer_load_dwordx4 v[28:31], v3, s[4:7], s62 offen offset:3072 sc1
    buffer_load_dwordx4 v[32:35], v4, s[4:7], s62 offen offset:0 sc1
    buffer_load_dwordx4 v[36:39], v4, s[4:7], s62 offen offset:1024 sc1
    buffer_load_dwordx4 v[136:139], v3, s[4:7], s42 offen sc1
    s_add_u32 s33, s33, 1
    s_cmp_gt_u32 s33, 20000
    s_waitcnt vmcnt(5)
    v_max_u32 v0, v16, v20
    v_cmp_eq_u32 vcc, -1, v0
    s_cbranch_scc1 C_main_kernel_137
    s_cbranch_vccnz R_main_kernel_136
C_main_kernel_137:
    v_mfma_f32_16x16x32_bf16 v[84:87], v[144:147], v[16:19], 0
    ds_write_b128 v7, v[16:19] offset:0
    v_mfma_f32_16x16x32_bf16 v[88:91], v[208:211], v[16:19], 0
    ds_write_b128 v7, v[20:23] offset:1024
    v_mfma_f32_16x16x32_bf16 v[92:95], a[192:195], v[16:19], 0
    s_waitcnt vmcnt(3)
    v_max_u32 v0, v24, v28
    v_accvgpr_read_b32 v116, a168
    v_mfma_f32_16x16x32_bf16 v[84:87], v[148:151], v[20:23], v[84:87]
    v_cmp_eq_u32 vcc, -1, v0
    buffer_load_dwordx4 v[40:43], v4, s[4:7], s62 offen offset:2048 sc1
    v_mfma_f32_16x16x32_bf16 v[88:91], v[212:215], v[20:23], v[88:91]
    buffer_load_dwordx4 v[44:47], v4, s[4:7], s62 offen offset:3072 sc1
    v_mfma_f32_16x16x32_bf16 v[92:95], a[196:199], v[20:23], v[92:95]
    s_cbranch_vccnz R_main_kernel_138
C_main_kernel_139:
    v_mfma_f32_16x16x32_bf16 v[84:87], v[152:155], v[24:27], v[84:87]
    ds_write_b128 v7, v[24:27] offset:2048
    v_mfma_f32_16x16x32_bf16 v[88:91], v[216:219], v[24:27], v[88:91]
    ds_write_b128 v7, v[28:31] offset:3072
    v_accvgpr_read_b32 v117, a169
    v_mfma_f32_16x16x32_bf16 v[92:95], a[200:203], v[24:27], v[92:95]
    s_waitcnt vmcnt(3)
    v_max_u32 v0, v32, v36
    v_mfma_f32_16x16x32_bf16 v[84:87], v[156:159], v[28:31], v[84:87]
    v_cmp_eq_u32 vcc, -1, v0
    buffer_load_dwordx4 v[48:51], v5, s[4:7], s62 offen offset:0 sc1
    v_mfma_f32_16x16x32_bf16 v[88:91], v[220:223], v[28:31], v[88:91]
    buffer_load_dwordx4 v[52:55], v5, s[4:7], s62 offen offset:1024 sc1
    v_mfma_f32_16x16x32_bf16 v[92:95], a[204:207], v[28:31], v[92:95]
    s_cbranch_vccnz R_main_kernel_140
C_main_kernel_141:
    v_mfma_f32_16x16x32_bf16 v[84:87], v[160:163], v[32:35], v[84:87]
    ds_write_b128 v7, v[32:35] offset:4096
    v_mfma_f32_16x16x32_bf16 v[88:91], v[224:227], v[32:35], v[88:91]
    ds_write_b128 v7, v[36:39] offset:5120
    v_accvgpr_read_b32 v118, a170
    v_mfma_f32_16x16x32_bf16 v[92:95], a[208:211], v[32:35], v[92:95]
    s_waitcnt vmcnt(2)
    v_max_u32 v0, v40, v44
    v_mfma_f32_16x16x32_bf16 v[84:87], v[164:167], v[36:39], v[84:87]
    v_cmp_eq_u32 vcc, -1, v0
    buffer_load_dwordx4 v[56:59], v5, s[4:7], s62 offen offset:2048 sc1
    v_mfma_f32_16x16x32_bf16 v[88:91], v[228:231], v[36:39], v[88:91]
    buffer_load_dwordx4 v[60:63], v5, s[4:7], s62 offen offset:3072 sc1
    v_mfma_f32_16x16x32_bf16 v[92:95], a[212:215], v[36:39], v[92:95]
    s_cbranch_vccnz R_main_kernel_142
C_main_kernel_143:
    v_mfma_f32_16x16x32_bf16 v[84:87], v[168:171], v[40:43], v[84:87]
    ds_write_b128 v7, v[40:43] offset:6144
    v_max_u32 v0, v136, v137
    v_accvgpr_read_b32 v119, a171
    v_mfma_f32_16x16x32_bf16 v[88:91], v[232:235], v[40:43], v[88:91]
    ds_write_b128 v7, v[44:47] offset:7168
    v_max3_u32 v0, v0, v138, v139
    v_mfma_f32_16x16x32_bf16 v[92:95], a[216:219], v[40:43], v[92:95]
    s_waitcnt vmcnt(2)
    v_max3_u32 v0, v0, v48, v52
    v_mfma_f32_16x16x32_bf16 v[84:87], v[172:175], v[44:47], v[84:87]
    v_cmp_eq_u32 vcc, -1, v0
    buffer_load_dwordx4 v[64:67], v6, s[4:7], s62 offen offset:0 sc1
    v_mfma_f32_16x16x32_bf16 v[88:91], v[236:239], v[44:47], v[88:91]
    buffer_load_dwordx4 v[68:71], v6, s[4:7], s62 offen offset:1024 sc1
    v_mfma_f32_16x16x32_bf16 v[92:95], a[220:223], v[44:47], v[92:95]
    s_cbranch_vccnz R_main_kernel_144
C_main_kernel_145:
    v_mfma_f32_16x16x32_bf16 v[84:87], v[176:179], v[48:51], v[84:87]
    ds_write_b128 v7, v[48:51] offset:8192
    v_mfma_f32_16x16x32_bf16 v[88:91], v[240:243], v[48:51], v[88:91]
    ds_write_b128 v7, v[52:55] offset:9216
    v_mfma_f32_16x16x32_bf16 v[92:95], a[224:227], v[48:51], v[92:95]
    s_waitcnt vmcnt(2)
    v_max_u32 v0, v56, v60
    v_mfma_f32_16x16x32_bf16 v[84:87], v[180:183], v[52:55], v[84:87]
    v_cmp_eq_u32 vcc, -1, v0
    buffer_load_dwordx4 v[72:75], v6, s[4:7], s62 offen offset:2048 sc1
    v_add_f32 v136, v136, v138
    v_mfma_f32_16x16x32_bf16 v[88:91], v[244:247], v[52:55], v[88:91]
    buffer_load_dwordx4 v[76:79], v6, s[4:7], s62 offen offset:3072 sc1
    v_add_f32 v137, v137, v139
    v_mov_b32 v138, v136
    v_mfma_f32_16x16x32_bf16 v[92:95], a[228:231], v[52:55], v[92:95]
    s_cbranch_vccnz R_main_kernel_146
C_main_kernel_147:
    v_mov_b32 v139, v137
    v_mfma_f32_16x16x32_bf16 v[84:87], v[184:187], v[56:59], v[84:87]
    ds_write_b128 v7, v[56:59] offset:10240
    v_mfma_f32_16x16x32_bf16 v[88:91], v[248:251], v[56:59], v[88:91]
    ds_write_b128 v7, v[60:63] offset:11264
    v_mfma_f32_16x16x32_bf16 v[92:95], a[232:235], v[56:59], v[92:95]
    s_waitcnt vmcnt(2)
    v_max_u32 v0, v64, v68
    v_mfma_f32_16x16x32_bf16 v[84:87], v[188:191], v[60:63], v[84:87]
    v_cmp_eq_u32 vcc, -1, v0
    v_permlane16_swap_b32 v136, v138
    v_permlane16_swap_b32 v137, v139
    v_mfma_f32_16x16x32_bf16 v[88:91], v[252:255], v[60:63], v[88:91]
    v_add_f32 v136, v136, v138
    v_add_f32 v137, v137, v139
    v_mov_b32 v138, v136
    v_mfma_f32_16x16x32_bf16 v[92:95], a[236:239], v[60:63], v[92:95]
    s_cbranch_vccnz R_main_kernel_148
C_main_kernel_149:
    v_mov_b32 v139, v137
    v_mfma_f32_16x16x32_bf16 v[84:87], v[192:195], v[64:67], v[84:87]
    ds_write_b128 v7, v[64:67] offset:12288
    v_mfma_f32_16x16x32_bf16 v[88:91], a[176:179], v[64:67], v[88:91]
    ds_write_b128 v7, v[68:71] offset:13312
    v_mfma_f32_16x16x32_bf16 v[92:95], a[240:243], v[64:67], v[92:95]
    s_waitcnt vmcnt(0)
    v_max_u32 v0, v72, v76
    v_mfma_f32_16x16x32_bf16 v[84:87], v[196:199], v[68:71], v[84:87]
    v_cmp_eq_u32 vcc, -1, v0
    v_permlane32_swap_b32 v136, v138
    v_permlane32_swap_b32 v137, v139
    v_mfma_f32_16x16x32_bf16 v[88:91], a[180:183], v[68:71], v[88:91]
    v_add_f32 v136, v136, v138
    v_add_f32 v137, v137, v139
    v_mfma_f32_16x16x32_bf16 v[92:95], a[244:247], v[68:71], v[92:95]
    s_cbranch_vccnz R_main_kernel_150
C_main_kernel_151:
    v_mul_f32 v132, 0xbb000000, v136
    v_mfma_f32_16x16x32_bf16 v[84:87], v[200:203], v[72:75], v[84:87]
    ds_write_b128 v7, v[72:75] offset:14336
    v_mfma_f32_16x16x32_bf16 v[88:91], a[184:187], v[72:75], v[88:91]
    ds_write_b128 v7, v[76:79] offset:15360
    v_mfma_f32_16x16x32_bf16 v[92:95], a[248:251], v[72:75], v[92:95]
    v_mul_f32 v137, 0x3b000000, v137
    v_fma_f32 v137, -v132, v132, v137
    v_max_f32 v137, 0, v137
    v_mfma_f32_16x16x32_bf16 v[84:87], v[204:207], v[76:79], v[84:87]
    v_add_f32 v140, 0x3727c5ac, v137
    v_rsq_f32 v141, v140
    v_mfma_f32_16x16x32_bf16 v[88:91], a[188:191], v[76:79], v[88:91]
    v_rcp_f32 v133, v141
    v_mul_f32 v134, v141, v141
    v_mul_f32 v135, 0xc0135761, v141
    v_mfma_f32_16x16x32_bf16 v[92:95], a[252:255], v[76:79], v[92:95]
    v_mul_f32 v134, v134, v141
    v_mul_f32 v134, 0xbdd2d3e8, v134
    ds_write_b128 v2, v[132:135]
    s_waitcnt lgkmcnt(0)
    s_barrier
    ds_read_b128 v[16:19], v80 offset:0
    ds_read_b128 v[20:23], v80 offset:1024
    ds_read_b128 v[24:27], v80 offset:2048
    ds_read_b128 v[28:31], v80 offset:3072
    v_fma_f32 v84, v132, v108, v84
    v_fma_f32 v85, v132, v109, v85
    v_fma_f32 v86, v132, v110, v86
    v_fma_f32 v87, v132, v111, v87
    v_fma_f32 v88, v132, v112, v88
    v_fma_f32 v89, v132, v113, v89
    v_fma_f32 v90, v132, v114, v90
    v_fma_f32 v91, v132, v115, v91
    v_mul_f32 v120, v84, v84
    v_mul_f32 v121, v85, v85
    v_mul_f32 v122, v86, v86
    v_mul_f32 v123, v87, v87
    v_mul_f32 v124, v88, v88
    v_mul_f32 v125, v89, v89
    v_mul_f32 v126, v90, v90
    v_mul_f32 v127, v91, v91
    v_fma_f32 v120, v120, v134, v135
    v_fma_f32 v121, v121, v134, v135
    v_fma_f32 v122, v122, v134, v135
    v_fma_f32 v123, v123, v134, v135
    s_waitcnt lgkmcnt(3)
    v_mfma_f32_16x16x32_bf16 v[96:99], v[144:147], v[16:19], 0
    buffer_load_dwordx4 a[160:163], v5, s[4:7], s53 offen offset:0
    v_fma_f32 v124, v124, v134, v135
    v_fma_f32 v125, v125, v134, v135
    v_mfma_f32_16x16x32_bf16 v[100:103], v[208:211], v[16:19], 0
    v_fma_f32 v126, v126, v134, v135
    v_fma_f32 v127, v127, v134, v135
    v_mul_f32 v120, v120, v84
    v_mfma_f32_16x16x32_bf16 v[104:107], a[192:195], v[16:19], 0
    s_waitcnt lgkmcnt(2)
    ds_read_b128 v[16:19], v80 offset:4096
    v_mul_f32 v121, v121, v85
    v_mul_f32 v122, v122, v86
    v_mfma_f32_16x16x32_bf16 v[96:99], v[148:151], v[20:23], v[96:99]
    buffer_load_dwordx4 a[164:167], v5, s[4:7], s53 offen offset:1024
    v_mul_f32 v123, v123, v87
    v_mfma_f32_16x16x32_bf16 v[100:103], v[212:215], v[20:23], v[100:103]
    v_mul_f32 v124, v124, v88
    v_mul_f32 v125, v125, v89
    v_mul_f32 v126, v126, v90
    v_mul_f32 v127, v127, v91
    v_mfma_f32_16x16x32_bf16 v[104:107], a[196:199], v[20:23], v[104:107]
    s_waitcnt lgkmcnt(2)
    ds_read_b128 v[20:23], v80 offset:5120
    v_exp_f32 v120, v120
    v_mfma_f32_16x16x32_bf16 v[96:99], v[152:155], v[24:27], v[96:99]
    v_exp_f32 v121, v121
    v_mfma_f32_16x16x32_bf16 v[100:103], v[216:219], v[24:27], v[100:103]
    v_exp_f32 v122, v122
    v_exp_f32 v123, v123
    v_mfma_f32_16x16x32_bf16 v[104:107], a[200:203], v[24:27], v[104:107]
    s_waitcnt lgkmcnt(2)
    ds_read_b128 v[24:27], v80 offset:6144
    v_exp_f32 v124, v124
    v_mfma_f32_16x16x32_bf16 v[96:99], v[156:159], v[28:31], v[96:99]
    buffer_load_dwordx4 a[168:171], v5, s[4:7], s53 offen offset:2048
    v_mfma_f32_16x16x32_bf16 v[100:103], v[220:223], v[28:31], v[100:103]
    v_exp_f32 v125, v125
    v_exp_f32 v126, v126
    v_mfma_f32_16x16x32_bf16 v[104:107], a[204:207], v[28:31], v[104:107]
    s_waitcnt lgkmcnt(2)
    ds_read_b128 v[28:31], v80 offset:7168
    v_exp_f32 v127, v127
    v_mfma_f32_16x16x32_bf16 v[96:99], v[160:163], v[16:19], v[96:99]
    buffer_load_dwordx4 a[172:175], v5, s[4:7], s53 offen offset:3072
    v_fma_f32 v120, v120, v133, v133
    v_mfma_f32_16x16x32_bf16 v[100:103], v[224:227], v[16:19], v[100:103]
    v_fma_f32 v121, v121, v133, v133
    v_fma_f32 v122, v122, v133, v133
    v_fma_f32 v123, v123, v133, v133
    v_fma_f32 v124, v124, v133, v133
    v_mfma_f32_16x16x32_bf16 v[104:107], a[208:211], v[16:19], v[104:107]
    s_waitcnt lgkmcnt(2)
    ds_read_b128 v[16:19], v80 offset:8192
    v_fma_f32 v125, v125, v133, v133
    v_mfma_f32_16x16x32_bf16 v[96:99], v[164:167], v[20:23], v[96:99]
    v_fma_f32 v126, v126, v133, v133
    v_fma_f32 v127, v127, v133, v133
    v_rcp_f32 v120, v120
    v_mfma_f32_16x16x32_bf16 v[100:103], v[228:231], v[20:23], v[100:103]
    v_rcp_f32 v121, v121
    v_mfma_f32_16x16x32_bf16 v[104:107], a[212:215], v[20:23], v[104:107]
    s_waitcnt lgkmcnt(2)
    ds_read_b128 v[20:23], v80 offset:9216
    v_rcp_f32 v122, v122
    v_mfma_f32_16x16x32_bf16 v[96:99], v[168:171], v[24:27], v[96:99]
    buffer_load_dwordx4 a[0:3], v6, s[4:7], s53 offen offset:0
    v_rcp_f32 v123, v123
    v_mfma_f32_16x16x32_bf16 v[100:103], v[232:235], v[24:27], v[100:103]
    v_rcp_f32 v124, v124
    v_rcp_f32 v125, v125
    v_mfma_f32_16x16x32_bf16 v[104:107], a[216:219], v[24:27], v[104:107]
    s_waitcnt lgkmcnt(2)
    ds_read_b128 v[24:27], v80 offset:10240
    v_mfma_f32_16x16x32_bf16 v[96:99], v[172:175], v[28:31], v[96:99]
    v_rcp_f32 v126, v126
    v_rcp_f32 v127, v127
    v_mfma_f32_16x16x32_bf16 v[100:103], v[236:239], v[28:31], v[100:103]
    v_mul_f32 v84, v84, v120
    v_mul_f32 v85, v85, v121
    v_mul_f32 v86, v86, v122
    v_mfma_f32_16x16x32_bf16 v[104:107], a[220:223], v[28:31], v[104:107]
    s_waitcnt lgkmcnt(2)
    ds_read_b128 v[28:31], v80 offset:11264
    v_mul_f32 v87, v87, v123
    v_mul_f32 v88, v88, v124
    v_mfma_f32_16x16x32_bf16 v[96:99], v[176:179], v[16:19], v[96:99]
    buffer_load_dwordx4 a[4:7], v6, s[4:7], s53 offen offset:1024
    v_mul_f32 v89, v89, v125
    v_mfma_f32_16x16x32_bf16 v[100:103], v[240:243], v[16:19], v[100:103]
    v_mul_f32 v90, v90, v126
    v_mul_f32 v91, v91, v127
    v_cvt_pk_bf16_f32 v136, v84, v85
    v_cvt_pk_bf16_f32 v137, v86, v87
    v_mfma_f32_16x16x32_bf16 v[104:107], a[224:227], v[16:19], v[104:107]
    s_waitcnt lgkmcnt(2)
    ds_read_b128 v[16:19], v80 offset:12288
    v_cvt_pk_bf16_f32 v138, v88, v89
    v_mfma_f32_16x16x32_bf16 v[96:99], v[180:183], v[20:23], v[96:99]
    buffer_load_dwordx4 a[8:11], v6, s[4:7], s53 offen offset:2048
    v_cvt_pk_bf16_f32 v139, v90, v91
    v_min_u32 v136, s32, v136
    v_mfma_f32_16x16x32_bf16 v[100:103], v[244:247], v[20:23], v[100:103]
    v_min_u32 v138, s32, v138
    buffer_store_dwordx4 v[136:139], v3, s[4:7], s74 offen
    v_fma_f32 v92, v132, v116, v92
    v_mfma_f32_16x16x32_bf16 v[104:107], a[228:231], v[20:23], v[104:107]
    s_waitcnt lgkmcnt(2)
    ds_read_b128 v[20:23], v80 offset:13312
    v_fma_f32 v93, v132, v117, v93
    v_mfma_f32_16x16x32_bf16 v[96:99], v[184:187], v[24:27], v[96:99]
    ds_read_b128 v[32:35], v83
    v_fma_f32 v94, v132, v118, v94
    v_fma_f32 v95, v132, v119, v95
    v_mfma_f32_16x16x32_bf16 v[100:103], v[248:251], v[24:27], v[100:103]
    v_mul_f32 v128, v92, v92
    v_mul_f32 v129, v93, v93
    v_mul_f32 v130, v94, v94
    v_mul_f32 v131, v95, v95
    v_mfma_f32_16x16x32_bf16 v[104:107], a[232:235], v[24:27], v[104:107]
    s_waitcnt lgkmcnt(3)
    ds_read_b128 v[24:27], v80 offset:14336
    v_fma_f32 v128, v128, v134, v135
    v_mfma_f32_16x16x32_bf16 v[96:99], v[188:191], v[28:31], v[96:99]
    buffer_load_dwordx4 a[12:15], v6, s[4:7], s53 offen offset:3072
    v_fma_f32 v129, v129, v134, v135
    v_fma_f32 v130, v130, v134, v135
    v_mfma_f32_16x16x32_bf16 v[100:103], v[252:255], v[28:31], v[100:103]
    v_fma_f32 v131, v131, v134, v135
    v_mul_f32 v128, v128, v92
    v_mul_f32 v129, v129, v93
    v_mfma_f32_16x16x32_bf16 v[104:107], a[236:239], v[28:31], v[104:107]
    s_waitcnt lgkmcnt(3)
    ds_read_b128 v[28:31], v80 offset:15360
    v_mul_f32 v130, v130, v94
    v_mul_f32 v131, v131, v95
    v_mfma_f32_16x16x32_bf16 v[96:99], v[192:195], v[16:19], v[96:99]
    buffer_load_dwordx4 a[16:19], v3, s[4:7], s54 offen offset:0
    v_exp_f32 v128, v128
    v_mfma_f32_16x16x32_bf16 v[100:103], a[176:179], v[16:19], v[100:103]
    v_exp_f32 v129, v129
    v_mfma_f32_16x16x32_bf16 v[104:107], a[240:243], v[16:19], v[104:107]
    s_waitcnt lgkmcnt(3)
    ds_read_b128 v[16:19], v81 offset:0
    v_exp_f32 v130, v130
    v_mfma_f32_16x16x32_bf16 v[96:99], v[196:199], v[20:23], v[96:99]
    v_exp_f32 v131, v131
    v_fma_f32 v128, v128, v133, v133
    v_mfma_f32_16x16x32_bf16 v[100:103], a[180:183], v[20:23], v[100:103]
    v_fma_f32 v129, v129, v133, v133
    v_fma_f32 v130, v130, v133, v133
    v_fma_f32 v131, v131, v133, v133
    v_mfma_f32_16x16x32_bf16 v[104:107], a[244:247], v[20:23], v[104:107]
    s_waitcnt lgkmcnt(2)
    ds_read_b128 v[20:23], v81 offset:1024
    v_rcp_f32 v128, v128
    v_mfma_f32_16x16x32_bf16 v[96:99], v[200:203], v[24:27], v[96:99]
    buffer_load_dwordx4 a[20:23], v3, s[4:7], s54 offen offset:1024
    v_rcp_f32 v129, v129
    v_mfma_f32_16x16x32_bf16 v[100:103], a[184:187], v[24:27], v[100:103]
    v_rcp_f32 v130, v130
    v_rcp_f32 v131, v131
    v_mfma_f32_16x16x32_bf16 v[104:107], a[248:251], v[24:27], v[104:107]
    s_waitcnt lgkmcnt(2)
    ds_read_b128 v[24:27], v81 offset:2048
    v_mul_f32 v92, v92, v128
    v_mfma_f32_16x16x32_bf16 v[96:99], v[204:207], v[28:31], v[96:99]
    v_mul_f32 v93, v93, v129
    v_mul_f32 v94, v94, v130
    v_mul_f32 v95, v95, v131
    v_mfma_f32_16x16x32_bf16 v[100:103], a[188:191], v[28:31], v[100:103]
    v_cvt_pk_bf16_f32 v140, v92, v93
    v_cvt_pk_bf16_f32 v141, v94, v95
    v_min_u32 v140, s32, v140
    v_mfma_f32_16x16x32_bf16 v[104:107], a[252:255], v[28:31], v[104:107]
    s_waitcnt lgkmcnt(2)
    ds_read_b128 v[28:31], v81 offset:3072
    buffer_store_dwordx2 v[140:141], v10, s[4:7], s74 offen
    v_mfma_f32_16x16x32_bf16 v[84:87], v[144:147], v[16:19], 0
    buffer_load_dwordx4 a[24:27], v3, s[4:7], s54 offen offset:2048
    v_mfma_f32_16x16x32_bf16 v[88:91], v[208:211], v[16:19], 0
    v_mfma_f32_16x16x32_bf16 v[92:95], a[192:195], v[16:19], 0
    s_waitcnt lgkmcnt(2)
    ds_read_b128 v[16:19], v81 offset:4096
    v_fma_f32 v96, v32, v108, v96
    v_fma_f32 v97, v32, v109, v97
    v_mfma_f32_16x16x32_bf16 v[84:87], v[148:151], v[20:23], v[84:87]
    buffer_load_dwordx4 a[28:31], v3, s[4:7], s54 offen offset:3072
    v_fma_f32 v98, v32, v110, v98
    v_fma_f32 v99, v32, v111, v99
    v_mfma_f32_16x16x32_bf16 v[88:91], v[212:215], v[20:23], v[88:91]
    v_fma_f32 v100, v32, v112, v100
    v_fma_f32 v101, v32, v113, v101
    v_fma_f32 v102, v32, v114, v102
    v_fma_f32 v103, v32, v115, v103
    v_mfma_f32_16x16x32_bf16 v[92:95], a[196:199], v[20:23], v[92:95]
    s_waitcnt lgkmcnt(2)
    ds_read_b128 v[20:23], v81 offset:5120
    v_mul_f32 v120, v96, v96
    v_mul_f32 v121, v97, v97
    v_mfma_f32_16x16x32_bf16 v[84:87], v[152:155], v[24:27], v[84:87]
    v_mul_f32 v122, v98, v98
    v_mul_f32 v123, v99, v99
    v_mul_f32 v124, v100, v100
    v_mul_f32 v125, v101, v101
    v_mfma_f32_16x16x32_bf16 v[88:91], v[216:219], v[24:27], v[88:91]
    v_mul_f32 v126, v102, v102
    v_mul_f32 v127, v103, v103
    v_fma_f32 v120, v120, v34, v35
    v_fma_f32 v121, v121, v34, v35
    v_mfma_f32_16x16x32_bf16 v[92:95], a[200:203], v[24:27], v[92:95]
    s_waitcnt lgkmcnt(2)
    ds_read_b128 v[24:27], v81 offset:6144
    v_fma_f32 v122, v122, v34, v35
    v_fma_f32 v123, v123, v34, v35
    v_mfma_f32_16x16x32_bf16 v[84:87], v[156:159], v[28:31], v[84:87]
    buffer_load_dwordx4 a[32:35], v4, s[4:7], s54 offen offset:0
    v_fma_f32 v124, v124, v34, v35
    v_fma_f32 v125, v125, v34, v35
    v_mfma_f32_16x16x32_bf16 v[88:91], v[220:223], v[28:31], v[88:91]
    v_fma_f32 v126, v126, v34, v35
    v_fma_f32 v127, v127, v34, v35
    v_mul_f32 v120, v120, v96
    v_mul_f32 v121, v121, v97
    v_mfma_f32_16x16x32_bf16 v[92:95], a[204:207], v[28:31], v[92:95]
    s_waitcnt lgkmcnt(2)
    ds_read_b128 v[28:31], v81 offset:7168
    v_mul_f32 v122, v122, v98
    v_mul_f32 v123, v123, v99
    v_mfma_f32_16x16x32_bf16 v[84:87], v[160:163], v[16:19], v[84:87]
    buffer_load_dwordx4 a[36:39], v4, s[4:7], s54 offen offset:1024
    v_mul_f32 v124, v124, v100
    v_mul_f32 v125, v125, v101
    v_mfma_f32_16x16x32_bf16 v[88:91], v[224:227], v[16:19], v[88:91]
    v_mul_f32 v126, v126, v102
    v_mul_f32 v127, v127, v103
    v_exp_f32 v120, v120
    v_mfma_f32_16x16x32_bf16 v[92:95], a[208:211], v[16:19], v[92:95]
    s_waitcnt lgkmcnt(2)
    ds_read_b128 v[16:19], v81 offset:8192
    v_exp_f32 v121, v121
    v_mfma_f32_16x16x32_bf16 v[84:87], v[164:167], v[20:23], v[84:87]
    v_exp_f32 v122, v122
    v_exp_f32 v123, v123
    v_mfma_f32_16x16x32_bf16 v[88:91], v[228:231], v[20:23], v[88:91]
    v_exp_f32 v124, v124
    v_exp_f32 v125, v125
    v_mfma_f32_16x16x32_bf16 v[92:95], a[212:215], v[20:23], v[92:95]
    s_waitcnt lgkmcnt(2)
    ds_read_b128 v[20:23], v81 offset:9216
    v_exp_f32 v126, v126
    v_mfma_f32_16x16x32_bf16 v[84:87], v[168:171], v[24:27], v[84:87]
    buffer_load_dwordx4 a[40:43], v4, s[4:7], s54 offen offset:2048
    v_exp_f32 v127, v127
    v_mfma_f32_16x16x32_bf16 v[88:91], v[232:235], v[24:27], v[88:91]
    v_fma_f32 v120, v120, v33, v33
    v_fma_f32 v121, v121, v33, v33
    v_fma_f32 v122, v122, v33, v33
    v_fma_f32 v123, v123, v33, v33
    v_mfma_f32_16x16x32_bf16 v[92:95], a[216:219], v[24:27], v[92:95]
    s_waitcnt lgkmcnt(2)
    ds_read_b128 v[24:27], v81 offset:10240
    v_fma_f32 v124, v124, v33, v33
    v_fma_f32 v125, v125, v33, v33
    v_mfma_f32_16x16x32_bf16 v[84:87], v[172:175], v[28:31], v[84:87]
    v_fma_f32 v126, v126, v33, v33
    v_fma_f32 v127, v127, v33, v33
    v_rcp_f32 v120, v120
    v_mfma_f32_16x16x32_bf16 v[88:91], v[236:239], v[28:31], v[88:91]
    v_rcp_f32 v121, v121
    v_rcp_f32 v122, v122
    v_mfma_f32_16x16x32_bf16 v[92:95], a[220:223], v[28:31], v[92:95]
    s_waitcnt lgkmcnt(2)
    ds_read_b128 v[28:31], v81 offset:11264
    v_rcp_f32 v123, v123
    v_mfma_f32_16x16x32_bf16 v[84:87], v[176:179], v[16:19], v[84:87]
    buffer_load_dwordx4 a[44:47], v4, s[4:7], s54 offen offset:3072
    v_rcp_f32 v124, v124
    v_mfma_f32_16x16x32_bf16 v[88:91], v[240:243], v[16:19], v[88:91]
    v_rcp_f32 v125, v125
    v_rcp_f32 v126, v126
    v_mfma_f32_16x16x32_bf16 v[92:95], a[224:227], v[16:19], v[92:95]
    s_waitcnt lgkmcnt(2)
    ds_read_b128 v[16:19], v81 offset:12288
    v_rcp_f32 v127, v127
    v_mfma_f32_16x16x32_bf16 v[84:87], v[180:183], v[20:23], v[84:87]
    buffer_load_dwordx4 a[48:51], v11, s[4:7], s54 offen offset:0
    v_mul_f32 v96, v96, v120
    v_mul_f32 v97, v97, v121
    v_mfma_f32_16x16x32_bf16 v[88:91], v[244:247], v[20:23], v[88:91]
    v_mul_f32 v98, v98, v122
    v_mul_f32 v99, v99, v123
    v_mul_f32 v100, v100, v124
    v_mul_f32 v101, v101, v125
    v_mfma_f32_16x16x32_bf16 v[92:95], a[228:231], v[20:23], v[92:95]
    s_waitcnt lgkmcnt(2)
    ds_read_b128 v[20:23], v81 offset:13312
    v_mul_f32 v102, v102, v126
    v_mul_f32 v103, v103, v127
    v_mfma_f32_16x16x32_bf16 v[84:87], v[184:187], v[24:27], v[84:87]
    ds_read_b128 v[36:39], v142
    v_cvt_pk_bf16_f32 v136, v96, v97
    v_cvt_pk_bf16_f32 v137, v98, v99
    v_cvt_pk_bf16_f32 v138, v100, v101
    v_mfma_f32_16x16x32_bf16 v[88:91], v[248:251], v[24:27], v[88:91]
    v_cvt_pk_bf16_f32 v139, v102, v103
    v_min_u32 v136, s32, v136
    v_min_u32 v138, s32, v138
    v_mfma_f32_16x16x32_bf16 v[92:95], a[232:235], v[24:27], v[92:95]
    s_waitcnt lgkmcnt(3)
    ds_read_b128 v[24:27], v81 offset:14336
    buffer_store_dwordx4 v[136:139], v3, s[4:7], s75 offen
    v_fma_f32 v104, v32, v116, v104
    v_mfma_f32_16x16x32_bf16 v[84:87], v[188:191], v[28:31], v[84:87]
    buffer_load_dwordx4 a[52:55], v11, s[4:7], s54 offen offset:1024
    v_fma_f32 v105, v32, v117, v105
    v_fma_f32 v106, v32, v118, v106
    v_mfma_f32_16x16x32_bf16 v[88:91], v[252:255], v[28:31], v[88:91]
    v_fma_f32 v107, v32, v119, v107
    v_mul_f32 v128, v104, v104
    v_mul_f32 v129, v105, v105
    v_mul_f32 v130, v106, v106
    v_mfma_f32_16x16x32_bf16 v[92:95], a[236:239], v[28:31], v[92:95]
    s_waitcnt lgkmcnt(3)
    ds_read_b128 v[28:31], v81 offset:15360
    v_mul_f32 v131, v107, v107
    v_fma_f32 v128, v128, v34, v35
    v_mfma_f32_16x16x32_bf16 v[84:87], v[192:195], v[16:19], v[84:87]
    buffer_load_dwordx4 a[56:59], v11, s[4:7], s54 offen offset:2048
    v_fma_f32 v129, v129, v34, v35
    v_fma_f32 v130, v130, v34, v35
    v_mfma_f32_16x16x32_bf16 v[88:91], a[176:179], v[16:19], v[88:91]
    v_fma_f32 v131, v131, v34, v35
    v_mul_f32 v128, v128, v104
    v_mul_f32 v129, v129, v105
    v_mul_f32 v130, v130, v106
    v_mfma_f32_16x16x32_bf16 v[92:95], a[240:243], v[16:19], v[92:95]
    s_waitcnt lgkmcnt(3)
    ds_read_b128 v[16:19], v82 offset:0
    v_mul_f32 v131, v131, v107
    v_exp_f32 v128, v128
    v_mfma_f32_16x16x32_bf16 v[84:87], v[196:199], v[20:23], v[84:87]
    v_exp_f32 v129, v129
    v_mfma_f32_16x16x32_bf16 v[88:91], a[180:183], v[20:23], v[88:91]
    v_exp_f32 v130, v130
    v_exp_f32 v131, v131
    v_fma_f32 v128, v128, v33, v33
    v_mfma_f32_16x16x32_bf16 v[92:95], a[244:247], v[20:23], v[92:95]
    s_waitcnt lgkmcnt(2)
    ds_read_b128 v[20:23], v82 offset:1024
    v_fma_f32 v129, v129, v33, v33
    v_fma_f32 v130, v130, v33, v33
    v_mfma_f32_16x16x32_bf16 v[84:87], v[200:203], v[24:27], v[84:87]
    buffer_load_dwordx4 a[60:63], v11, s[4:7], s54 offen offset:3072
    v_fma_f32 v131, v131, v33, v33
    v_rcp_f32 v128, v128
    v_mfma_f32_16x16x32_bf16 v[88:91], a[184:187], v[24:27], v[88:91]
    v_rcp_f32 v129, v129
    v_mfma_f32_16x16x32_bf16 v[92:95], a[248:251], v[24:27], v[92:95]
    s_waitcnt lgkmcnt(2)
    ds_read_b128 v[24:27], v82 offset:2048
    v_rcp_f32 v130, v130
    v_mfma_f32_16x16x32_bf16 v[84:87], v[204:207], v[28:31], v[84:87]
    v_rcp_f32 v131, v131
    v_mul_f32 v104, v104, v128
    v_mul_f32 v105, v105, v129
    v_mul_f32 v106, v106, v130
    v_mfma_f32_16x16x32_bf16 v[88:91], a[188:191], v[28:31], v[88:91]
    v_mul_f32 v107, v107, v131
    v_cvt_pk_bf16_f32 v140, v104, v105
    v_cvt_pk_bf16_f32 v141, v106, v107
    v_min_u32 v140, s32, v140
    v_mfma_f32_16x16x32_bf16 v[92:95], a[252:255], v[28:31], v[92:95]
    s_waitcnt lgkmcnt(2)
    ds_read_b128 v[28:31], v82 offset:3072
    buffer_store_dwordx2 v[140:141], v10, s[4:7], s75 offen
    v_mfma_f32_16x16x32_bf16 v[96:99], v[144:147], v[16:19], 0
    v_mfma_f32_16x16x32_bf16 v[100:103], v[208:211], v[16:19], 0
    v_mfma_f32_16x16x32_bf16 v[104:107], a[192:195], v[16:19], 0
    s_waitcnt lgkmcnt(2)
    ds_read_b128 v[16:19], v82 offset:4096
    v_fma_f32 v84, v36, v108, v84
    v_fma_f32 v85, v36, v109, v85
    v_mfma_f32_16x16x32_bf16 v[96:99], v[148:151], v[20:23], v[96:99]
L_hop_main_kernel_9:
    s_cbranch_execz L_hopb_main_kernel
    v_fma_f32 v86, v36, v110, v86
    v_fma_f32 v87, v36, v111, v87
    v_fma_f32 v88, v36, v112, v88
    v_mfma_f32_16x16x32_bf16 v[100:103], v[212:215], v[20:23], v[100:103]
    v_fma_f32 v89, v36, v113, v89
    v_fma_f32 v90, v36, v114, v90
    v_fma_f32 v91, v36, v115, v91
    v_mul_f32 v120, v84, v84
    v_mfma_f32_16x16x32_bf16 v[104:107], a[196:199], v[20:23], v[104:107]
    s_waitcnt lgkmcnt(2)
    ds_read_b128 v[20:23], v82 offset:5120
    v_mul_f32 v121, v85, v85
    v_mul_f32 v122, v86, v86
    v_mfma_f32_16x16x32_bf16 v[96:99], v[152:155], v[24:27], v[96:99]
    v_mul_f32 v123, v87, v87
    v_mul_f32 v124, v88, v88
    v_mul_f32 v125, v89, v89
    v_mfma_f32_16x16x32_bf16 v[100:103], v[216:219], v[24:27], v[100:103]
    v_mul_f32 v126, v90, v90
    v_mul_f32 v127, v91, v91
    v_fma_f32 v120, v120, v38, v39
    v_fma_f32 v121, v121, v38, v39
    v_mfma_f32_16x16x32_bf16 v[104:107], a[200:203], v[24:27], v[104:107]
    s_waitcnt lgkmcnt(2)
    ds_read_b128 v[24:27], v82 offset:6144
    v_fma_f32 v122, v122, v38, v39
    v_fma_f32 v123, v123, v38, v39
    v_mfma_f32_16x16x32_bf16 v[96:99], v[156:159], v[28:31], v[96:99]
    v_fma_f32 v124, v124, v38, v39
    v_fma_f32 v125, v125, v38, v39
    v_fma_f32 v126, v126, v38, v39
    v_fma_f32 v127, v127, v38, v39
    v_mfma_f32_16x16x32_bf16 v[100:103], v[220:223], v[28:31], v[100:103]
    v_mul_f32 v120, v120, v84
    v_mul_f32 v121, v121, v85
    v_mul_f32 v122, v122, v86
    v_mfma_f32_16x16x32_bf16 v[104:107], a[204:207], v[28:31], v[104:107]
    s_waitcnt lgkmcnt(2)
    ds_read_b128 v[28:31], v82 offset:7168
    v_mul_f32 v123, v123, v87
    v_mul_f32 v124, v124, v88
    v_mfma_f32_16x16x32_bf16 v[96:99], v[160:163], v[16:19], v[96:99]
    v_mul_f32 v125, v125, v89
    v_mul_f32 v126, v126, v90
    v_mul_f32 v127, v127, v91
    v_mfma_f32_16x16x32_bf16 v[100:103], v[224:227], v[16:19], v[100:103]
    v_exp_f32 v120, v120
    v_exp_f32 v121, v121
    v_mfma_f32_16x16x32_bf16 v[104:107], a[208:211], v[16:19], v[104:107]
    s_waitcnt lgkmcnt(2)
    ds_read_b128 v[16:19], v82 offset:8192
    v_exp_f32 v122, v122
    v_mfma_f32_16x16x32_bf16 v[96:99], v[164:167], v[20:23], v[96:99]
    v_exp_f32 v123, v123
    v_exp_f32 v124, v124
    v_mfma_f32_16x16x32_bf16 v[100:103], v[228:231], v[20:23], v[100:103]
    v_exp_f32 v125, v125
    v_exp_f32 v126, v126
    v_mfma_f32_16x16x32_bf16 v[104:107], a[212:215], v[20:23], v[104:107]
    s_waitcnt lgkmcnt(2)
    ds_read_b128 v[20:23], v82 offset:9216
    v_exp_f32 v127, v127
    v_mfma_f32_16x16x32_bf16 v[96:99], v[168:171], v[24:27], v[96:99]
    buffer_load_dwordx4 v[40:43], v3, s[4:7], s37 offen offset:0 sc1
    v_fma_f32 v120, v120, v37, v37
    v_fma_f32 v121, v121, v37, v37
    v_mfma_f32_16x16x32_bf16 v[100:103], v[232:235], v[24:27], v[100:103]
    v_fma_f32 v122, v122, v37, v37
    v_fma_f32 v123, v123, v37, v37
    v_fma_f32 v124, v124, v37, v37
    v_fma_f32 v125, v125, v37, v37
    v_mfma_f32_16x16x32_bf16 v[104:107], a[216:219], v[24:27], v[104:107]
    s_waitcnt lgkmcnt(2)
    ds_read_b128 v[24:27], v82 offset:10240
    v_fma_f32 v126, v126, v37, v37
    v_mfma_f32_16x16x32_bf16 v[96:99], v[172:175], v[28:31], v[96:99]
    buffer_load_dwordx4 v[44:47], v3, s[4:7], s37 offen offset:1024 sc1
    v_fma_f32 v127, v127, v37, v37
    v_rcp_f32 v120, v120
    v_mfma_f32_16x16x32_bf16 v[100:103], v[236:239], v[28:31], v[100:103]
    v_rcp_f32 v121, v121
    v_rcp_f32 v122, v122
    v_mfma_f32_16x16x32_bf16 v[104:107], a[220:223], v[28:31], v[104:107]
    s_waitcnt lgkmcnt(2)
    ds_read_b128 v[28:31], v82 offset:11264
    v_rcp_f32 v123, v123
    v_mfma_f32_16x16x32_bf16 v[96:99], v[176:179], v[16:19], v[96:99]
    buffer_load_dwordx4 v[48:51], v3, s[4:7], s37 offen offset:2048 sc1
    v_rcp_f32 v124, v124
    v_mfma_f32_16x16x32_bf16 v[100:103], v[240:243], v[16:19], v[100:103]
    v_rcp_f32 v125, v125
    v_rcp_f32 v126, v126
    v_mfma_f32_16x16x32_bf16 v[104:107], a[224:227], v[16:19], v[104:107]
    s_waitcnt lgkmcnt(2)
    ds_read_b128 v[16:19], v82 offset:12288
    v_rcp_f32 v127, v127
    v_mfma_f32_16x16x32_bf16 v[96:99], v[180:183], v[20:23], v[96:99]
    buffer_load_dwordx4 v[52:55], v3, s[4:7], s37 offen offset:3072 sc1
    v_mul_f32 v84, v84, v120
    v_mul_f32 v85, v85, v121
    v_mfma_f32_16x16x32_bf16 v[100:103], v[244:247], v[20:23], v[100:103]
    v_mul_f32 v86, v86, v122
    v_mul_f32 v87, v87, v123
    v_mul_f32 v88, v88, v124
    v_mul_f32 v89, v89, v125
    v_mfma_f32_16x16x32_bf16 v[104:107], a[228:231], v[20:23], v[104:107]
    s_waitcnt lgkmcnt(2)
    ds_read_b128 v[20:23], v82 offset:13312
    v_mul_f32 v90, v90, v126
    v_mfma_f32_16x16x32_bf16 v[96:99], v[184:187], v[24:27], v[96:99]
    ds_read_b128 v[32:35], v143
    buffer_load_dwordx4 v[56:59], v4, s[4:7], s37 offen offset:0 sc1
    v_mul_f32 v91, v91, v127
    v_cvt_pk_bf16_f32 v136, v84, v85
    v_mfma_f32_16x16x32_bf16 v[100:103], v[248:251], v[24:27], v[100:103]
    v_cvt_pk_bf16_f32 v137, v86, v87
    v_cvt_pk_bf16_f32 v138, v88, v89
    v_cvt_pk_bf16_f32 v139, v90, v91
    v_min_u32 v136, s32, v136
    v_mfma_f32_16x16x32_bf16 v[104:107], a[232:235], v[24:27], v[104:107]
    s_waitcnt lgkmcnt(3)
    ds_read_b128 v[24:27], v82 offset:14336
    v_min_u32 v138, s32, v138
    v_mfma_f32_16x16x32_bf16 v[96:99], v[188:191], v[28:31], v[96:99]
    buffer_load_dwordx4 v[60:63], v4, s[4:7], s37 offen offset:1024 sc1
    buffer_store_dwordx4 v[136:139], v3, s[4:7], s76 offen
    v_fma_f32 v92, v36, v116, v92
    v_fma_f32 v93, v36, v117, v93
    v_mfma_f32_16x16x32_bf16 v[100:103], v[252:255], v[28:31], v[100:103]
    v_fma_f32 v94, v36, v118, v94
    v_fma_f32 v95, v36, v119, v95
    v_mul_f32 v128, v92, v92
    v_mfma_f32_16x16x32_bf16 v[104:107], a[236:239], v[28:31], v[104:107]
    s_waitcnt lgkmcnt(3)
    ds_read_b128 v[28:31], v82 offset:15360
    v_mul_f32 v129, v93, v93
    v_mul_f32 v130, v94, v94
    v_mfma_f32_16x16x32_bf16 v[96:99], v[192:195], v[16:19], v[96:99]
    buffer_load_dwordx4 v[64:67], v4, s[4:7], s37 offen offset:2048 sc1
    v_mul_f32 v131, v95, v95
    v_fma_f32 v128, v128, v38, v39
    v_fma_f32 v129, v129, v38, v39
    v_mfma_f32_16x16x32_bf16 v[100:103], a[176:179], v[16:19], v[100:103]
    v_fma_f32 v130, v130, v38, v39
    v_fma_f32 v131, v131, v38, v39
    v_mul_f32 v128, v128, v92
    v_mul_f32 v129, v129, v93
    v_mfma_f32_16x16x32_bf16 v[104:107], a[240:243], v[16:19], v[104:107]
    s_waitcnt lgkmcnt(3)
    v_mul_f32 v130, v130, v94
    v_mul_f32 v131, v131, v95
    v_mfma_f32_16x16x32_bf16 v[96:99], v[196:199], v[20:23], v[96:99]
    buffer_load_dwordx4 v[68:71], v4, s[4:7], s37 offen offset:3072 sc1
    v_exp_f32 v128, v128
    v_mfma_f32_16x16x32_bf16 v[100:103], a[180:183], v[20:23], v[100:103]
    v_exp_f32 v129, v129
    v_exp_f32 v130, v130
    v_mfma_f32_16x16x32_bf16 v[104:107], a[244:247], v[20:23], v[104:107]
    s_waitcnt lgkmcnt(1)
    v_exp_f32 v131, v131
    v_fma_f32 v128, v128, v37, v37
    v_mfma_f32_16x16x32_bf16 v[96:99], v[200:203], v[24:27], v[96:99]
    buffer_load_dwordx4 v[72:75], v5, s[4:7], s37 offen offset:0 sc1
    v_fma_f32 v129, v129, v37, v37
    v_fma_f32 v130, v130, v37, v37
    v_fma_f32 v131, v131, v37, v37
    v_mfma_f32_16x16x32_bf16 v[100:103], a[184:187], v[24:27], v[100:103]
    v_rcp_f32 v128, v128
    v_rcp_f32 v129, v129
    v_mfma_f32_16x16x32_bf16 v[104:107], a[248:251], v[24:27], v[104:107]
    s_waitcnt lgkmcnt(0)
    v_rcp_f32 v130, v130
    v_mfma_f32_16x16x32_bf16 v[96:99], v[204:207], v[28:31], v[96:99]
    buffer_load_dwordx4 v[76:79], v5, s[4:7], s37 offen offset:1024 sc1
    v_rcp_f32 v131, v131
    v_mul_f32 v92, v92, v128
    v_mfma_f32_16x16x32_bf16 v[100:103], a[188:191], v[28:31], v[100:103]
    v_mul_f32 v93, v93, v129
    v_mul_f32 v94, v94, v130
    v_mul_f32 v95, v95, v131
    v_cvt_pk_bf16_f32 v140, v92, v93
    v_mfma_f32_16x16x32_bf16 v[104:107], a[252:255], v[28:31], v[104:107]
    v_cvt_pk_bf16_f32 v141, v94, v95
    v_min_u32 v140, s32, v140
    buffer_store_dwordx2 v[140:141], v10, s[4:7], s76 offen
    buffer_load_dwordx4 v[80:83], v12, s[4:7], s37 offen offset:2048 sc1
    v_add_u32 v2, 0x20000, v14
    s_waitcnt vmcnt(11)
    v_max_u32 v0, v40, v42
    v_max3_u32 v0, v0, v44, v46
    v_cmp_eq_u32 vcc, -1, v0
    s_cbranch_vccnz R_main_kernel_152
C_main_kernel_153:
    s_waitcnt lgkmcnt(2)
    v_mfma_f32_16x16x32_bf16 v[232:235], a[64:67], v[40:43], 0
    v_mfma_f32_16x16x32_bf16 v[236:239], a[68:71], v[40:43], 0
    v_mfma_f32_16x16x32_bf16 v[240:243], a[72:75], v[40:43], 0
    v_fma_f32 v96, v32, v108, v96
    v_fma_f32 v97, v32, v109, v97
    v_fma_f32 v98, v32, v110, v98
    v_fma_f32 v99, v32, v111, v99
    v_mfma_f32_16x16x32_bf16 v[244:247], a[76:79], v[40:43], 0
    s_waitcnt vmcnt(9)
    v_max_u32 v0, v48, v50
    v_fma_f32 v100, v32, v112, v100
    v_fma_f32 v101, v32, v113, v101
    v_fma_f32 v102, v32, v114, v102
    v_mfma_f32_16x16x32_bf16 v[232:235], a[80:83], v[44:47], v[232:235]
    v_max3_u32 v0, v0, v52, v54
    v_fma_f32 v103, v32, v115, v103
    v_mul_f32 v120, v96, v96
    v_mul_f32 v121, v97, v97
    v_mfma_f32_16x16x32_bf16 v[236:239], a[84:87], v[44:47], v[236:239]
    v_cmp_eq_u32 vcc, -1, v0
    v_mul_f32 v122, v98, v98
    v_mul_f32 v123, v99, v99
    v_mul_f32 v124, v100, v100
    v_mfma_f32_16x16x32_bf16 v[240:243], a[88:91], v[44:47], v[240:243]
    v_mul_f32 v125, v101, v101
    v_mul_f32 v126, v102, v102
    v_mul_f32 v127, v103, v103
    v_fma_f32 v120, v120, v34, v35
    v_fma_f32 v121, v121, v34, v35
    v_mfma_f32_16x16x32_bf16 v[244:247], a[92:95], v[44:47], v[244:247]
    s_cbranch_vccnz R_main_kernel_154
C_main_kernel_155:
    v_fma_f32 v122, v122, v34, v35
    v_fma_f32 v123, v123, v34, v35
    v_fma_f32 v124, v124, v34, v35
    v_mfma_f32_16x16x32_bf16 v[232:235], a[96:99], v[48:51], v[232:235]
    v_fma_f32 v125, v125, v34, v35
    v_fma_f32 v126, v126, v34, v35
    v_fma_f32 v127, v127, v34, v35
    v_mul_f32 v120, v120, v96
    v_mfma_f32_16x16x32_bf16 v[236:239], a[100:103], v[48:51], v[236:239]
    v_mul_f32 v121, v121, v97
    v_mul_f32 v122, v122, v98
    v_mul_f32 v123, v123, v99
    v_mul_f32 v124, v124, v100
    v_mul_f32 v125, v125, v101
    v_mfma_f32_16x16x32_bf16 v[240:243], a[104:107], v[48:51], v[240:243]
    v_mul_f32 v126, v126, v102
    v_mul_f32 v127, v127, v103
    v_exp_f32 v120, v120
    v_mfma_f32_16x16x32_bf16 v[244:247], a[108:111], v[48:51], v[244:247]
    s_waitcnt vmcnt(7)
    v_max_u32 v0, v56, v58
    v_exp_f32 v121, v121
    v_mfma_f32_16x16x32_bf16 v[232:235], a[112:115], v[52:55], v[232:235]
    v_max3_u32 v0, v0, v60, v62
    v_exp_f32 v122, v122
    v_exp_f32 v123, v123
    v_mfma_f32_16x16x32_bf16 v[236:239], a[116:119], v[52:55], v[236:239]
    v_cmp_eq_u32 vcc, -1, v0
    v_exp_f32 v124, v124
    v_exp_f32 v125, v125
    v_mfma_f32_16x16x32_bf16 v[240:243], a[120:123], v[52:55], v[240:243]
    v_exp_f32 v126, v126
    v_exp_f32 v127, v127
    v_mfma_f32_16x16x32_bf16 v[244:247], a[124:127], v[52:55], v[244:247]
    s_cbranch_vccnz R_main_kernel_156
C_main_kernel_157:
    v_fma_f32 v120, v120, v33, v33
    v_fma_f32 v121, v121, v33, v33
    v_fma_f32 v122, v122, v33, v33
    v_mfma_f32_16x16x32_bf16 v[232:235], a[128:131], v[56:59], v[232:235]
    v_fma_f32 v123, v123, v33, v33
    v_fma_f32 v124, v124, v33, v33
    v_fma_f32 v125, v125, v33, v33
    v_fma_f32 v126, v126, v33, v33
    v_mfma_f32_16x16x32_bf16 v[236:239], a[132:135], v[56:59], v[236:239]
    v_fma_f32 v127, v127, v33, v33
    v_rcp_f32 v120, v120
    v_rcp_f32 v121, v121
    v_mfma_f32_16x16x32_bf16 v[240:243], a[136:139], v[56:59], v[240:243]
    buffer_load_dwordx4 v[144:147], v3, s[4:7], s30 offen offset:0 sc1
    v_rcp_f32 v122, v122
    v_mfma_f32_16x16x32_bf16 v[244:247], a[140:143], v[56:59], v[244:247]
    s_waitcnt vmcnt(5)
    v_max_u32 v0, v64, v66
    v_rcp_f32 v123, v123
    v_rcp_f32 v124, v124
    v_mfma_f32_16x16x32_bf16 v[232:235], a[144:147], v[60:63], v[232:235]
    v_max3_u32 v0, v0, v68, v70
    v_rcp_f32 v125, v125
    v_mfma_f32_16x16x32_bf16 v[236:239], a[148:151], v[60:63], v[236:239]
    v_cmp_eq_u32 vcc, -1, v0
    v_rcp_f32 v126, v126
    v_rcp_f32 v127, v127
    v_mfma_f32_16x16x32_bf16 v[240:243], a[152:155], v[60:63], v[240:243]
    s_waitcnt vmcnt(15)
    buffer_load_dwordx4 v[148:151], v3, s[4:7], s30 offen offset:1024 sc1
    v_mul_f32 v96, v96, v120
    v_mul_f32 v97, v97, v121
    v_mfma_f32_16x16x32_bf16 v[244:247], a[156:159], v[60:63], v[244:247]
    s_cbranch_vccnz R_main_kernel_158
C_main_kernel_159:
    v_mul_f32 v98, v98, v122
    v_mul_f32 v99, v99, v123
    v_mul_f32 v100, v100, v124
    v_mul_f32 v101, v101, v125
    v_mfma_f32_16x16x32_bf16 v[232:235], a[160:163], v[64:67], v[232:235]
    v_mul_f32 v102, v102, v126
    v_mul_f32 v103, v103, v127
    v_cvt_pk_bf16_f32 v136, v96, v97
    v_cvt_pk_bf16_f32 v137, v98, v99
    v_mfma_f32_16x16x32_bf16 v[236:239], a[164:167], v[64:67], v[236:239]
    v_cvt_pk_bf16_f32 v138, v100, v101
    v_cvt_pk_bf16_f32 v139, v102, v103
    v_min_u32 v136, s32, v136
    v_min_u32 v138, s32, v138
    v_mfma_f32_16x16x32_bf16 v[240:243], a[168:171], v[64:67], v[240:243]
    buffer_load_dwordx4 v[152:155], v3, s[4:7], s30 offen offset:2048 sc1
    buffer_store_dwordx4 v[136:139], v3, s[4:7], s77 offen
    v_fma_f32 v104, v32, v116, v104
    v_fma_f32 v105, v32, v117, v105
    v_mfma_f32_16x16x32_bf16 v[244:247], a[172:175], v[64:67], v[244:247]
    s_waitcnt vmcnt(6)
    v_max_u32 v0, v72, v74
    v_fma_f32 v106, v32, v118, v106
    v_fma_f32 v107, v32, v119, v107
    v_mfma_f32_16x16x32_bf16 v[232:235], a[0:3], v[68:71], v[232:235]
    v_max3_u32 v0, v0, v76, v78
    v_mul_f32 v128, v104, v104
    v_mul_f32 v129, v105, v105
    v_mul_f32 v130, v106, v106
    v_mul_f32 v131, v107, v107
    v_mfma_f32_16x16x32_bf16 v[236:239], a[4:7], v[68:71], v[236:239]
    v_cmp_eq_u32 vcc, -1, v0
    v_fma_f32 v128, v128, v34, v35
    v_fma_f32 v129, v129, v34, v35
    v_fma_f32 v130, v130, v34, v35
    v_mfma_f32_16x16x32_bf16 v[240:243], a[8:11], v[68:71], v[240:243]
    buffer_load_dwordx4 v[156:159], v3, s[4:7], s30 offen offset:3072 sc1
    v_fma_f32 v131, v131, v34, v35
    v_mul_f32 v128, v128, v104
    v_mul_f32 v129, v129, v105
    v_mfma_f32_16x16x32_bf16 v[244:247], a[12:15], v[68:71], v[244:247]
    s_cbranch_vccnz R_main_kernel_160
C_main_kernel_161:
    v_mul_f32 v130, v130, v106
    v_mul_f32 v131, v131, v107
    v_exp_f32 v128, v128
    v_mfma_f32_16x16x32_bf16 v[232:235], a[16:19], v[72:75], v[232:235]
    v_exp_f32 v129, v129
    v_exp_f32 v130, v130
    v_mfma_f32_16x16x32_bf16 v[236:239], a[20:23], v[72:75], v[236:239]
    v_exp_f32 v131, v131
    v_fma_f32 v128, v128, v33, v33
    v_fma_f32 v129, v129, v33, v33
    v_mfma_f32_16x16x32_bf16 v[240:243], a[24:27], v[72:75], v[240:243]
    buffer_load_dwordx4 v[160:163], v4, s[4:7], s30 offen offset:0 sc1
    v_fma_f32 v130, v130, v33, v33
    v_fma_f32 v131, v131, v33, v33
    v_rcp_f32 v128, v128
    v_mfma_f32_16x16x32_bf16 v[244:247], a[28:31], v[72:75], v[244:247]
    v_rcp_f32 v129, v129
    v_rcp_f32 v130, v130
    v_mfma_f32_16x16x32_bf16 v[232:235], a[32:35], v[76:79], v[232:235]
    s_waitcnt vmcnt(6)
    v_max_u32 v0, v80, v82
    v_rcp_f32 v131, v131
    v_mfma_f32_16x16x32_bf16 v[236:239], a[36:39], v[76:79], v[236:239]
    v_cmp_eq_u32 vcc, -1, v0
    v_mul_f32 v104, v104, v128
    v_mul_f32 v105, v105, v129
    v_mul_f32 v106, v106, v130
    v_mul_f32 v107, v107, v131
    v_mfma_f32_16x16x32_bf16 v[240:243], a[40:43], v[76:79], v[240:243]
    buffer_load_dwordx4 v[164:167], v4, s[4:7], s30 offen offset:1024 sc1
    v_cvt_pk_bf16_f32 v140, v104, v105
    v_cvt_pk_bf16_f32 v141, v106, v107
    v_min_u32 v140, s32, v140
    v_mfma_f32_16x16x32_bf16 v[244:247], a[44:47], v[76:79], v[244:247]
    s_cbranch_vccnz R_main_kernel_162
C_main_kernel_163:
    s_waitcnt vmcnt(5)
    v_max_u32 v0, v144, v146
    buffer_store_dwordx2 v[140:141], v10, s[4:7], s77 offen
    v_mfma_f32_16x16x32_bf16 v[232:235], a[48:51], v[80:83], v[232:235]
    v_max3_u32 v0, v0, v148, v150
    v_mfma_f32_16x16x32_bf16 v[236:239], a[52:55], v[80:83], v[236:239]
    v_cmp_eq_u32 vcc, -1, v0
    v_mfma_f32_16x16x32_bf16 v[240:243], a[56:59], v[80:83], v[240:243]
    buffer_load_dwordx4 v[168:171], v4, s[4:7], s30 offen offset:2048 sc1
    v_mfma_f32_16x16x32_bf16 v[244:247], a[60:63], v[80:83], v[244:247]
    s_cbranch_vccnz R_main_kernel_164
C_main_kernel_165:
    v_mfma_f32_16x16x32_bf16 v[16:19], a[64:67], v[144:147], 0
    v_mfma_f32_16x16x32_bf16 v[20:23], a[68:71], v[144:147], 0
    ds_write_b128 v2, v[232:235] offset:0
    v_mfma_f32_16x16x32_bf16 v[24:27], a[72:75], v[144:147], 0
    buffer_load_dwordx4 v[172:175], v4, s[4:7], s30 offen offset:3072 sc1
    v_mfma_f32_16x16x32_bf16 v[28:31], a[76:79], v[144:147], 0
    s_waitcnt vmcnt(5)
    v_max_u32 v0, v152, v154
    v_mfma_f32_16x16x32_bf16 v[16:19], a[80:83], v[148:151], v[16:19]
    v_max3_u32 v0, v0, v156, v158
    v_mfma_f32_16x16x32_bf16 v[20:23], a[84:87], v[148:151], v[20:23]
    v_cmp_eq_u32 vcc, -1, v0
    v_mfma_f32_16x16x32_bf16 v[24:27], a[88:91], v[148:151], v[24:27]
    buffer_load_dwordx4 v[176:179], v5, s[4:7], s30 offen offset:0 sc1
    v_mfma_f32_16x16x32_bf16 v[28:31], a[92:95], v[148:151], v[28:31]
    s_cbranch_vccnz R_main_kernel_166
C_main_kernel_167:
    v_mfma_f32_16x16x32_bf16 v[16:19], a[96:99], v[152:155], v[16:19]
    v_mfma_f32_16x16x32_bf16 v[20:23], a[100:103], v[152:155], v[20:23]
    ds_write_b128 v2, v[236:239] offset:1024
    v_mfma_f32_16x16x32_bf16 v[24:27], a[104:107], v[152:155], v[24:27]
    buffer_load_dwordx4 v[180:183], v5, s[4:7], s30 offen offset:1024 sc1
    v_mfma_f32_16x16x32_bf16 v[28:31], a[108:111], v[152:155], v[28:31]
    s_waitcnt vmcnt(5)
    v_max_u32 v0, v160, v162
    v_mfma_f32_16x16x32_bf16 v[16:19], a[112:115], v[156:159], v[16:19]
    v_max3_u32 v0, v0, v164, v166
    v_mfma_f32_16x16x32_bf16 v[20:23], a[116:119], v[156:159], v[20:23]
    v_cmp_eq_u32 vcc, -1, v0
    v_mfma_f32_16x16x32_bf16 v[24:27], a[120:123], v[156:159], v[24:27]
    buffer_load_dwordx4 v[184:187], v12, s[4:7], s30 offen offset:2048 sc1
    v_lshrrev_b32 v7, 2, v1
    v_and_b32 v8, 3, v1
    v_mfma_f32_16x16x32_bf16 v[28:31], a[124:127], v[156:159], v[28:31]
    s_cbranch_vccnz R_main_kernel_168
C_main_kernel_169:
    v_lshl_add_u32 v9, v8, 2, v7
    v_mfma_f32_16x16x32_bf16 v[16:19], a[128:131], v[160:163], v[16:19]
    v_and_b32 v9, 15, v9
    v_mfma_f32_16x16x32_bf16 v[20:23], a[132:135], v[160:163], v[20:23]
    ds_write_b128 v2, v[240:243] offset:2048
    v_lshlrev_b32 v9, 4, v9
    v_mfma_f32_16x16x32_bf16 v[24:27], a[136:139], v[160:163], v[24:27]
    buffer_load_dwordx4 v[188:191], v3, s[4:7], s78 offen offset:0 sc1
    v_lshl_add_u32 v9, v8, 8, v9
    v_mfma_f32_16x16x32_bf16 v[28:31], a[140:143], v[160:163], v[28:31]
    s_waitcnt vmcnt(4)
    v_max_u32 v0, v168, v170
    v_mfma_f32_16x16x32_bf16 v[16:19], a[144:147], v[164:167], v[16:19]
    v_max3_u32 v0, v0, v172, v174
    v_mfma_f32_16x16x32_bf16 v[20:23], a[148:151], v[164:167], v[20:23]
    v_cmp_eq_u32 vcc, -1, v0
    v_mfma_f32_16x16x32_bf16 v[24:27], a[152:155], v[164:167], v[24:27]
    buffer_load_dwordx4 v[192:195], v3, s[4:7], s78 offen offset:1024 sc1
    v_lshlrev_b32 v7, 10, v7
    v_mfma_f32_16x16x32_bf16 v[28:31], a[156:159], v[164:167], v[28:31]
    s_cbranch_vccnz R_main_kernel_170
C_main_kernel_171:
    v_lshl_add_u32 v7, v8, 4, v7
    v_mfma_f32_16x16x32_bf16 v[16:19], a[160:163], v[168:171], v[16:19]
    s_and_b32 s19, s18, 1
    v_mfma_f32_16x16x32_bf16 v[20:23], a[164:167], v[168:171], v[20:23]
    ds_write_b128 v2, v[244:247] offset:3072
    s_lshl_b32 s19, s19, 11
    v_mfma_f32_16x16x32_bf16 v[24:27], a[168:171], v[168:171], v[24:27]
    buffer_load_dwordx4 v[196:199], v3, s[4:7], s78 offen offset:2048 sc1
    v_add_u32 v9, s19, v9
    v_mfma_f32_16x16x32_bf16 v[28:31], a[172:175], v[168:171], v[28:31]
    s_waitcnt vmcnt(4)
    v_max_u32 v0, v176, v178
    v_mfma_f32_16x16x32_bf16 v[16:19], a[0:3], v[172:175], v[16:19]
    v_max3_u32 v0, v0, v180, v182
    v_mfma_f32_16x16x32_bf16 v[20:23], a[4:7], v[172:175], v[20:23]
    v_cmp_eq_u32 vcc, -1, v0
    v_mfma_f32_16x16x32_bf16 v[24:27], a[8:11], v[172:175], v[24:27]
    buffer_load_dwordx4 v[200:203], v3, s[4:7], s78 offen offset:3072 sc1
    s_mov_b32 s22, 16384
    v_mfma_f32_16x16x32_bf16 v[28:31], a[12:15], v[172:175], v[28:31]
    s_cbranch_vccnz R_main_kernel_172
C_main_kernel_173:
    s_cmp_lt_u32 s18, 2
    s_cselect_b32 s19, 0x20000, s22
    v_mfma_f32_16x16x32_bf16 v[16:19], a[16:19], v[176:179], v[16:19]
    v_add_u32 v8, s19, v9
    v_mfma_f32_16x16x32_bf16 v[20:23], a[20:23], v[176:179], v[20:23]
    s_lshr_b32 s22, s18, 1
    v_mfma_f32_16x16x32_bf16 v[24:27], a[24:27], v[176:179], v[24:27]
    buffer_load_dwordx4 v[204:207], v4, s[4:7], s78 offen offset:0 sc1
    s_lshl_b32 s19, s22, 14
    v_mfma_f32_16x16x32_bf16 v[28:31], a[28:31], v[176:179], v[28:31]
    s_add_u32 s19, s19, 0x8000
    v_mfma_f32_16x16x32_bf16 v[16:19], a[32:35], v[180:183], v[16:19]
    s_waitcnt vmcnt(5)
    v_max_u32 v0, v184, v186
    v_mfma_f32_16x16x32_bf16 v[20:23], a[36:39], v[180:183], v[20:23]
    v_cmp_eq_u32 vcc, -1, v0
    v_mfma_f32_16x16x32_bf16 v[24:27], a[40:43], v[180:183], v[24:27]
    buffer_load_dwordx4 v[208:211], v4, s[4:7], s78 offen offset:1024 sc1
    v_add_u32 v124, s19, v9
    v_mfma_f32_16x16x32_bf16 v[28:31], a[44:47], v[180:183], v[28:31]
    s_cbranch_vccnz R_main_kernel_174
C_main_kernel_175:
    s_waitcnt vmcnt(4)
    v_max_u32 v0, v188, v190
    v_mfma_f32_16x16x32_bf16 v[16:19], a[48:51], v[184:187], v[16:19]
    v_max3_u32 v0, v0, v192, v194
    v_mfma_f32_16x16x32_bf16 v[20:23], a[52:55], v[184:187], v[20:23]
    v_cmp_eq_u32 vcc, -1, v0
    v_mfma_f32_16x16x32_bf16 v[24:27], a[56:59], v[184:187], v[24:27]
    buffer_load_dwordx4 v[212:215], v4, s[4:7], s78 offen offset:2048 sc1
    s_lshl_b32 s19, s22, 12
    v_mfma_f32_16x16x32_bf16 v[28:31], a[60:63], v[184:187], v[28:31]
    s_cbranch_vccnz R_main_kernel_176
C_main_kernel_177:
    v_add_u32 v9, s19, v9
    v_mfma_f32_16x16x32_bf16 v[232:235], a[64:67], v[188:191], 0
    v_mfma_f32_16x16x32_bf16 v[236:239], a[68:71], v[188:191], 0
    ds_write_b128 v14, v[16:19] offset:16384
    v_mfma_f32_16x16x32_bf16 v[240:243], a[72:75], v[188:191], 0
    buffer_load_dwordx4 v[216:219], v4, s[4:7], s78 offen offset:3072 sc1
    v_mfma_f32_16x16x32_bf16 v[244:247], a[76:79], v[188:191], 0
    s_waitcnt vmcnt(4)
    v_max_u32 v0, v196, v198
    v_mfma_f32_16x16x32_bf16 v[232:235], a[80:83], v[192:195], v[232:235]
    v_max3_u32 v0, v0, v200, v202
    v_mfma_f32_16x16x32_bf16 v[236:239], a[84:87], v[192:195], v[236:239]
    v_cmp_eq_u32 vcc, -1, v0
    v_mfma_f32_16x16x32_bf16 v[240:243], a[88:91], v[192:195], v[240:243]
    buffer_load_dwordx4 v[220:223], v5, s[4:7], s78 offen offset:0 sc1
    v_mfma_f32_16x16x32_bf16 v[244:247], a[92:95], v[192:195], v[244:247]
    s_cbranch_vccnz R_main_kernel_178
C_main_kernel_179:
    v_mfma_f32_16x16x32_bf16 v[232:235], a[96:99], v[196:199], v[232:235]
    v_mfma_f32_16x16x32_bf16 v[236:239], a[100:103], v[196:199], v[236:239]
    ds_write_b128 v14, v[20:23] offset:17408
    v_mfma_f32_16x16x32_bf16 v[240:243], a[104:107], v[196:199], v[240:243]
    buffer_load_dwordx4 v[224:227], v5, s[4:7], s78 offen offset:1024 sc1
    v_mfma_f32_16x16x32_bf16 v[244:247], a[108:111], v[196:199], v[244:247]
    s_waitcnt vmcnt(4)
    v_max_u32 v0, v204, v206
    v_mfma_f32_16x16x32_bf16 v[232:235], a[112:115], v[200:203], v[232:235]
    v_max3_u32 v0, v0, v208, v210
    v_mfma_f32_16x16x32_bf16 v[236:239], a[116:119], v[200:203], v[236:239]
    v_cmp_eq_u32 vcc, -1, v0
    v_mfma_f32_16x16x32_bf16 v[240:243], a[120:123], v[200:203], v[240:243]
    buffer_load_dwordx4 v[228:231], v12, s[4:7], s78 offen offset:2048 sc1
    v_mfma_f32_16x16x32_bf16 v[244:247], a[124:127], v[200:203], v[244:247]
    s_cbranch_vccnz R_main_kernel_180
C_main_kernel_181:
    v_mfma_f32_16x16x32_bf16 v[232:235], a[128:131], v[204:207], v[232:235]
    v_mfma_f32_16x16x32_bf16 v[236:239], a[132:135], v[204:207], v[236:239]
    ds_write_b128 v14, v[24:27] offset:18432
    v_mfma_f32_16x16x32_bf16 v[240:243], a[136:139], v[204:207], v[240:243]
    buffer_load_dwordx4 v[40:43], v3, s[4:7], s79 offen offset:0 sc1
    v_mfma_f32_16x16x32_bf16 v[244:247], a[140:143], v[204:207], v[244:247]
    s_waitcnt vmcnt(4)
    v_max_u32 v0, v212, v214
    v_mfma_f32_16x16x32_bf16 v[232:235], a[144:147], v[208:211], v[232:235]
    v_max3_u32 v0, v0, v216, v218
    v_mfma_f32_16x16x32_bf16 v[236:239], a[148:151], v[208:211], v[236:239]
    v_cmp_eq_u32 vcc, -1, v0
    v_mfma_f32_16x16x32_bf16 v[240:243], a[152:155], v[208:211], v[240:243]
    buffer_load_dwordx4 v[44:47], v3, s[4:7], s79 offen offset:1024 sc1
    v_mfma_f32_16x16x32_bf16 v[244:247], a[156:159], v[208:211], v[244:247]
    s_cbranch_vccnz R_main_kernel_182
C_main_kernel_183:
    v_mfma_f32_16x16x32_bf16 v[232:235], a[160:163], v[212:215], v[232:235]
    v_mfma_f32_16x16x32_bf16 v[236:239], a[164:167], v[212:215], v[236:239]
    ds_write_b128 v14, v[28:31] offset:19456
    v_mfma_f32_16x16x32_bf16 v[240:243], a[168:171], v[212:215], v[240:243]
    buffer_load_dwordx4 v[48:51], v3, s[4:7], s79 offen offset:2048 sc1
    v_mfma_f32_16x16x32_bf16 v[244:247], a[172:175], v[212:215], v[244:247]
    s_waitcnt vmcnt(4)
    v_max_u32 v0, v220, v222
    v_mfma_f32_16x16x32_bf16 v[232:235], a[0:3], v[216:219], v[232:235]
    v_max3_u32 v0, v0, v224, v226
    v_mfma_f32_16x16x32_bf16 v[236:239], a[4:7], v[216:219], v[236:239]
    v_cmp_eq_u32 vcc, -1, v0
    v_mfma_f32_16x16x32_bf16 v[240:243], a[8:11], v[216:219], v[240:243]
    buffer_load_dwordx4 v[52:55], v3, s[4:7], s79 offen offset:3072 sc1
    v_mfma_f32_16x16x32_bf16 v[244:247], a[12:15], v[216:219], v[244:247]
    s_cbranch_vccnz R_main_kernel_184
C_main_kernel_185:
    v_mfma_f32_16x16x32_bf16 v[232:235], a[16:19], v[220:223], v[232:235]
    s_waitcnt lgkmcnt(0)
    s_barrier
    v_mfma_f32_16x16x32_bf16 v[236:239], a[20:23], v[220:223], v[236:239]
    v_mfma_f32_16x16x32_bf16 v[240:243], a[24:27], v[220:223], v[240:243]
    buffer_load_dwordx4 v[56:59], v4, s[4:7], s79 offen offset:0 sc1
    v_mfma_f32_16x16x32_bf16 v[244:247], a[28:31], v[220:223], v[244:247]
    v_mfma_f32_16x16x32_bf16 v[232:235], a[32:35], v[224:227], v[232:235]
    s_waitcnt vmcnt(5)
    v_max_u32 v0, v228, v230
    v_mfma_f32_16x16x32_bf16 v[236:239], a[36:39], v[224:227], v[236:239]
    v_cmp_eq_u32 vcc, -1, v0
    v_mfma_f32_16x16x32_bf16 v[240:243], a[40:43], v[224:227], v[240:243]
    buffer_load_dwordx4 v[60:63], v4, s[4:7], s79 offen offset:1024 sc1
    v_mfma_f32_16x16x32_bf16 v[244:247], a[44:47], v[224:227], v[244:247]
    s_cbranch_vccnz R_main_kernel_186
C_main_kernel_187:
    s_waitcnt vmcnt(4)
    v_max_u32 v0, v40, v42
    v_mfma_f32_16x16x32_bf16 v[232:235], a[48:51], v[228:231], v[232:235]
    v_max3_u32 v0, v0, v44, v46
    v_mfma_f32_16x16x32_bf16 v[236:239], a[52:55], v[228:231], v[236:239]
    v_cmp_eq_u32 vcc, -1, v0
    v_mfma_f32_16x16x32_bf16 v[240:243], a[56:59], v[228:231], v[240:243]
    buffer_load_dwordx4 v[64:67], v4, s[4:7], s79 offen offset:2048 sc1
    v_mfma_f32_16x16x32_bf16 v[244:247], a[60:63], v[228:231], v[244:247]
    s_cbranch_vccnz R_main_kernel_188
C_main_kernel_189:
    v_mfma_f32_16x16x32_bf16 v[16:19], a[64:67], v[40:43], 0
    ds_read_b128 v[84:87], v8 offset:0
    ds_read_b128 v[88:91], v8 offset:1024
    v_mfma_f32_16x16x32_bf16 v[20:23], a[68:71], v[40:43], 0
    ds_write_b128 v14, v[232:235] offset:32768
    ds_read_b128 v[92:95], v8 offset:4096
    ds_read_b128 v[96:99], v8 offset:5120
    v_mfma_f32_16x16x32_bf16 v[24:27], a[72:75], v[40:43], 0
    buffer_load_dwordx4 v[68:71], v4, s[4:7], s79 offen offset:3072 sc1
    ds_read_b128 v[100:103], v8 offset:8192
    v_mfma_f32_16x16x32_bf16 v[28:31], a[76:79], v[40:43], 0
    s_waitcnt vmcnt(4)
    v_max_u32 v0, v48, v50
    v_mfma_f32_16x16x32_bf16 v[16:19], a[80:83], v[44:47], v[16:19]
    v_max3_u32 v0, v0, v52, v54
    v_mfma_f32_16x16x32_bf16 v[20:23], a[84:87], v[44:47], v[20:23]
    v_cmp_eq_u32 vcc, -1, v0
    v_mfma_f32_16x16x32_bf16 v[24:27], a[88:91], v[44:47], v[24:27]
    buffer_load_dwordx4 v[72:75], v5, s[4:7], s79 offen offset:0 sc1
    ds_read_b128 v[104:107], v8 offset:9216
    ds_read_b128 v[108:111], v8 offset:12288
    v_mfma_f32_16x16x32_bf16 v[28:31], a[92:95], v[44:47], v[28:31]
    s_cbranch_vccnz R_main_kernel_190
C_main_kernel_191:
    ds_read_b128 v[112:115], v8 offset:13312
    ds_read_b128 v[116:119], v9 offset:0
    v_mfma_f32_16x16x32_bf16 v[16:19], a[96:99], v[48:51], v[16:19]
    ds_read_b128 v[120:123], v9 offset:1024
    v_mfma_f32_16x16x32_bf16 v[20:23], a[100:103], v[48:51], v[20:23]
    ds_write_b128 v14, v[236:239] offset:33792
    s_waitcnt lgkmcnt(7)
    v_add_f32 v84, v84, v92
    v_mfma_f32_16x16x32_bf16 v[24:27], a[104:107], v[48:51], v[24:27]
    buffer_load_dwordx4 v[76:79], v5, s[4:7], s79 offen offset:1024 sc1
    v_add_f32 v85, v85, v93
    v_add_f32 v86, v86, v94
    v_mfma_f32_16x16x32_bf16 v[28:31], a[108:111], v[48:51], v[28:31]
    s_waitcnt vmcnt(4)
    v_max_u32 v0, v56, v58
    v_mfma_f32_16x16x32_bf16 v[16:19], a[112:115], v[52:55], v[16:19]
    v_max3_u32 v0, v0, v60, v62
    v_mfma_f32_16x16x32_bf16 v[20:23], a[116:119], v[52:55], v[20:23]
    v_cmp_eq_u32 vcc, -1, v0
    v_mfma_f32_16x16x32_bf16 v[24:27], a[120:123], v[52:55], v[24:27]
    buffer_load_dwordx4 v[80:83], v12, s[4:7], s79 offen offset:2048 sc1
    v_add_f32 v87, v87, v95
    v_mfma_f32_16x16x32_bf16 v[28:31], a[124:127], v[52:55], v[28:31]
    s_cbranch_vccnz R_main_kernel_192
C_main_kernel_193:
    v_add_f32 v88, v88, v96
    v_add_f32 v89, v89, v97
    v_mfma_f32_16x16x32_bf16 v[16:19], a[128:131], v[56:59], v[16:19]
    v_add_f32 v90, v90, v98
    v_add_f32 v91, v91, v99
    v_mfma_f32_16x16x32_bf16 v[20:23], a[132:135], v[56:59], v[20:23]
    ds_write_b128 v14, v[240:243] offset:34816
    s_waitcnt lgkmcnt(4)
    v_mfma_f32_16x16x32_bf16 v[24:27], a[136:139], v[56:59], v[24:27]
    v_add_f32 v100, v100, v108
    v_add_f32 v101, v101, v109
    v_mfma_f32_16x16x32_bf16 v[28:31], a[140:143], v[56:59], v[28:31]
L_hop_main_kernel_10:
    s_cbranch_execz L_hopb_main_kernel
    s_waitcnt vmcnt(3)
    v_max_u32 v0, v64, v66
    v_mfma_f32_16x16x32_bf16 v[16:19], a[144:147], v[60:63], v[16:19]
    v_max3_u32 v0, v0, v68, v70
    v_mfma_f32_16x16x32_bf16 v[20:23], a[148:151], v[60:63], v[20:23]
    v_cmp_eq_u32 vcc, -1, v0
    v_mfma_f32_16x16x32_bf16 v[24:27], a[152:155], v[60:63], v[24:27]
    v_add_f32 v102, v102, v110
    v_add_f32 v103, v103, v111
    v_mfma_f32_16x16x32_bf16 v[28:31], a[156:159], v[60:63], v[28:31]
    s_cbranch_vccnz R_main_kernel_194
C_main_kernel_195:
    v_add_f32 v104, v104, v112
    v_mfma_f32_16x16x32_bf16 v[16:19], a[160:163], v[64:67], v[16:19]
    v_add_f32 v105, v105, v113
    v_add_f32 v106, v106, v114
    v_mfma_f32_16x16x32_bf16 v[20:23], a[164:167], v[64:67], v[20:23]
    ds_write_b128 v14, v[244:247] offset:35840
    v_add_f32 v107, v107, v115
    s_waitcnt lgkmcnt(3)
    v_mfma_f32_16x16x32_bf16 v[24:27], a[168:171], v[64:67], v[24:27]
    v_add_f32 v84, v84, v116
    v_mfma_f32_16x16x32_bf16 v[28:31], a[172:175], v[64:67], v[28:31]
    s_waitcnt vmcnt(1)
    v_max_u32 v0, v72, v74
    v_mfma_f32_16x16x32_bf16 v[16:19], a[0:3], v[68:71], v[16:19]
    v_max3_u32 v0, v0, v76, v78
    v_mfma_f32_16x16x32_bf16 v[20:23], a[4:7], v[68:71], v[20:23]
    v_cmp_eq_u32 vcc, -1, v0
    v_mfma_f32_16x16x32_bf16 v[24:27], a[8:11], v[68:71], v[24:27]
    v_add_f32 v85, v85, v117
    v_add_f32 v86, v86, v118
    v_mfma_f32_16x16x32_bf16 v[28:31], a[12:15], v[68:71], v[28:31]
    s_cbranch_vccnz R_main_kernel_196
C_main_kernel_197:
    v_add_f32 v87, v87, v119
    v_add_f32 v88, v88, v120
    v_mfma_f32_16x16x32_bf16 v[16:19], a[16:19], v[72:75], v[16:19]
    v_add_f32 v89, v89, v121
    v_mfma_f32_16x16x32_bf16 v[20:23], a[20:23], v[72:75], v[20:23]
    v_add_f32 v90, v90, v122
    v_add_f32 v91, v91, v123
    v_mfma_f32_16x16x32_bf16 v[24:27], a[24:27], v[72:75], v[24:27]
    v_add_f32 v84, v84, v100
    v_add_f32 v85, v85, v101
    v_mfma_f32_16x16x32_bf16 v[28:31], a[28:31], v[72:75], v[28:31]
    v_add_f32 v86, v86, v102
    v_mfma_f32_16x16x32_bf16 v[16:19], a[32:35], v[76:79], v[16:19]
    s_waitcnt vmcnt(0)
    v_max_u32 v0, v80, v82
    v_mfma_f32_16x16x32_bf16 v[20:23], a[36:39], v[76:79], v[20:23]
    v_cmp_eq_u32 vcc, -1, v0
    v_mfma_f32_16x16x32_bf16 v[24:27], a[40:43], v[76:79], v[24:27]
    v_add_f32 v87, v87, v103
    v_add_f32 v88, v88, v104
    v_mfma_f32_16x16x32_bf16 v[28:31], a[44:47], v[76:79], v[28:31]
    s_cbranch_vccnz R_main_kernel_198
C_main_kernel_199:
    v_add_f32 v89, v89, v105
    v_add_f32 v90, v90, v106
    v_mfma_f32_16x16x32_bf16 v[16:19], a[48:51], v[80:83], v[16:19]
    v_add_f32 v91, v91, v107
    v_mfma_f32_16x16x32_bf16 v[20:23], a[52:55], v[80:83], v[20:23]
    v_cvt_pk_bf16_f32 v92, v84, v85
    v_cvt_pk_bf16_f32 v93, v86, v87
    v_mfma_f32_16x16x32_bf16 v[24:27], a[56:59], v[80:83], v[24:27]
    v_cvt_pk_bf16_f32 v94, v88, v89
    v_cvt_pk_bf16_f32 v95, v90, v91
    v_mfma_f32_16x16x32_bf16 v[28:31], a[60:63], v[80:83], v[28:31]
    buffer_store_dwordx4 v[92:95], v7, s[12:15], s28 offen
    ds_write_b128 v14, v[16:19] offset:49152
    ds_write_b128 v14, v[20:23] offset:50176
    s_nop 1
    ds_write_b128 v14, v[24:27] offset:51200
    s_nop 1
    ds_write_b128 v14, v[28:31] offset:52224
    s_waitcnt lgkmcnt(0)
    s_barrier
    ds_read_b128 v[84:87], v124 offset:0
    ds_read_b128 v[88:91], v124 offset:1024
    ds_read_b128 v[92:95], v124 offset:4096
    ds_read_b128 v[96:99], v124 offset:5120
    ds_read_b128 v[100:103], v124 offset:8192
    ds_read_b128 v[104:107], v124 offset:9216
    ds_read_b128 v[108:111], v124 offset:12288
    ds_read_b128 v[112:115], v124 offset:13312
    ds_read_b128 v[116:119], v9 offset:8192
    ds_read_b128 v[120:123], v9 offset:9216
    s_waitcnt lgkmcnt(6)
    v_pk_add_f32 v[84:85], v[84:85], v[92:93]
    v_pk_add_f32 v[86:87], v[86:87], v[94:95]
    v_pk_add_f32 v[88:89], v[88:89], v[96:97]
    v_pk_add_f32 v[90:91], v[90:91], v[98:99]
    s_waitcnt lgkmcnt(2)
    v_pk_add_f32 v[100:101], v[100:101], v[108:109]
    v_pk_add_f32 v[102:103], v[102:103], v[110:111]
    v_pk_add_f32 v[104:105], v[104:105], v[112:113]
    v_pk_add_f32 v[106:107], v[106:107], v[114:115]
    s_waitcnt lgkmcnt(0)
    v_pk_add_f32 v[84:85], v[84:85], v[116:117]
    v_pk_add_f32 v[86:87], v[86:87], v[118:119]
    v_pk_add_f32 v[88:89], v[88:89], v[120:121]
    v_pk_add_f32 v[90:91], v[90:91], v[122:123]
    v_pk_add_f32 v[84:85], v[84:85], v[100:101]
    v_pk_add_f32 v[86:87], v[86:87], v[102:103]
    v_pk_add_f32 v[88:89], v[88:89], v[104:105]
    v_pk_add_f32 v[90:91], v[90:91], v[106:107]
    v_cvt_pk_bf16_f32 v92, v84, v85
    v_cvt_pk_bf16_f32 v93, v86, v87
    v_cvt_pk_bf16_f32 v94, v88, v89
    v_cvt_pk_bf16_f32 v95, v90, v91
    buffer_store_dwordx4 v[92:95], v7, s[12:15], s27 offen
L_k2_done:
    s_endpgm
R_main_kernel_33:
    buffer_load_dwordx4 v[24:27], v3, s[4:7], s57 offen offset:2048 sc1
    buffer_load_dwordx4 v[28:31], v3, s[4:7], s57 offen offset:3072 sc1
    buffer_load_dwordx4 v[32:35], v4, s[4:7], s57 offen offset:0 sc1
    buffer_load_dwordx4 v[36:39], v4, s[4:7], s57 offen offset:1024 sc1
    buffer_load_dwordx4 v[40:43], v4, s[4:7], s57 offen offset:2048 sc1
    buffer_load_dwordx4 v[44:47], v4, s[4:7], s57 offen offset:3072 sc1
    s_add_u32 s33, s33, 1
    s_cmp_gt_u32 s33, 20000
    s_waitcnt vmcnt(4)
    v_max_u32 v0, v24, v28
    v_cmp_eq_u32 vcc, -1, v0
    s_cbranch_scc1 C_main_kernel_34
    s_cbranch_vccnz R_main_kernel_33
    s_branch C_main_kernel_34
R_main_kernel_35:
    buffer_load_dwordx4 v[32:35], v4, s[4:7], s57 offen offset:0 sc1
    buffer_load_dwordx4 v[36:39], v4, s[4:7], s57 offen offset:1024 sc1
    buffer_load_dwordx4 v[40:43], v4, s[4:7], s57 offen offset:2048 sc1
    buffer_load_dwordx4 v[44:47], v4, s[4:7], s57 offen offset:3072 sc1
    buffer_load_dwordx4 v[48:51], v5, s[4:7], s57 offen offset:0 sc1
    buffer_load_dwordx4 v[52:55], v5, s[4:7], s57 offen offset:1024 sc1
    s_add_u32 s33, s33, 1
    s_cmp_gt_u32 s33, 20000
    s_waitcnt vmcnt(4)
    v_max_u32 v0, v32, v36
    v_cmp_eq_u32 vcc, -1, v0
    s_cbranch_scc1 C_main_kernel_36
    s_cbranch_vccnz R_main_kernel_35
    s_branch C_main_kernel_36
R_main_kernel_37:
    buffer_load_dwordx4 v[40:43], v4, s[4:7], s57 offen offset:2048 sc1
    buffer_load_dwordx4 v[44:47], v4, s[4:7], s57 offen offset:3072 sc1
    buffer_load_dwordx4 v[48:51], v5, s[4:7], s57 offen offset:0 sc1
    buffer_load_dwordx4 v[52:55], v5, s[4:7], s57 offen offset:1024 sc1
    buffer_load_dwordx4 v[56:59], v5, s[4:7], s57 offen offset:2048 sc1
    buffer_load_dwordx4 v[60:63], v5, s[4:7], s57 offen offset:3072 sc1
    s_add_u32 s33, s33, 1
    s_cmp_gt_u32 s33, 20000
    s_waitcnt vmcnt(4)
    v_max_u32 v0, v40, v44
    v_cmp_eq_u32 vcc, -1, v0
    s_cbranch_scc1 C_main_kernel_38
    s_cbranch_vccnz R_main_kernel_37
    s_branch C_main_kernel_38
R_main_kernel_39:
    buffer_load_dwordx4 v[48:51], v5, s[4:7], s57 offen offset:0 sc1
    buffer_load_dwordx4 v[52:55], v5, s[4:7], s57 offen offset:1024 sc1
    buffer_load_dwordx4 v[56:59], v5, s[4:7], s57 offen offset:2048 sc1
    buffer_load_dwordx4 v[60:63], v5, s[4:7], s57 offen offset:3072 sc1
    buffer_load_dwordx4 v[64:67], v6, s[4:7], s57 offen offset:0 sc1
    buffer_load_dwordx4 v[68:71], v6, s[4:7], s57 offen offset:1024 sc1
    s_add_u32 s33, s33, 1
    s_cmp_gt_u32 s33, 20000
    s_waitcnt vmcnt(4)
    v_max_u32 v0, v48, v52
    v_cmp_eq_u32 vcc, -1, v0
    s_cbranch_scc1 C_main_kernel_40
    s_cbranch_vccnz R_main_kernel_39
    s_branch C_main_kernel_40
R_main_kernel_41:
    buffer_load_dwordx4 v[56:59], v5, s[4:7], s57 offen offset:2048 sc1
    buffer_load_dwordx4 v[60:63], v5, s[4:7], s57 offen offset:3072 sc1
    buffer_load_dwordx4 v[64:67], v6, s[4:7], s57 offen offset:0 sc1
    buffer_load_dwordx4 v[68:71], v6, s[4:7], s57 offen offset:1024 sc1
    buffer_load_dwordx4 v[72:75], v6, s[4:7], s57 offen offset:2048 sc1
    buffer_load_dwordx4 v[76:79], v6, s[4:7], s57 offen offset:3072 sc1
    s_add_u32 s33, s33, 1
    s_cmp_gt_u32 s33, 20000
    s_waitcnt vmcnt(4)
    v_max_u32 v0, v56, v60
    v_cmp_eq_u32 vcc, -1, v0
    s_cbranch_scc1 C_main_kernel_42
    s_cbranch_vccnz R_main_kernel_41
    s_branch C_main_kernel_42
R_main_kernel_43:
    buffer_load_dwordx4 v[64:67], v6, s[4:7], s57 offen offset:0 sc1
    buffer_load_dwordx4 v[68:71], v6, s[4:7], s57 offen offset:1024 sc1
    buffer_load_dwordx4 v[72:75], v6, s[4:7], s57 offen offset:2048 sc1
    buffer_load_dwordx4 v[76:79], v6, s[4:7], s57 offen offset:3072 sc1
    s_add_u32 s33, s33, 1
    s_cmp_gt_u32 s33, 20000
    s_waitcnt vmcnt(2)
    v_max_u32 v0, v64, v68
    v_cmp_eq_u32 vcc, -1, v0
    s_cbranch_scc1 C_main_kernel_44
    s_cbranch_vccnz R_main_kernel_43
    s_branch C_main_kernel_44
R_main_kernel_45:
    buffer_load_dwordx4 v[72:75], v6, s[4:7], s57 offen offset:2048 sc1
    buffer_load_dwordx4 v[76:79], v6, s[4:7], s57 offen offset:3072 sc1
    s_add_u32 s33, s33, 1
    s_cmp_gt_u32 s33, 20000
    s_waitcnt vmcnt(0)
    v_max_u32 v0, v72, v76
    v_cmp_eq_u32 vcc, -1, v0
    s_cbranch_scc1 C_main_kernel_46
    s_cbranch_vccnz R_main_kernel_45
    s_branch C_main_kernel_46
R_main_kernel_67:
    buffer_load_dwordx4 v[24:27], v3, s[4:7], s58 offen offset:2048 sc1
    buffer_load_dwordx4 v[28:31], v3, s[4:7], s58 offen offset:3072 sc1
    buffer_load_dwordx4 v[32:35], v4, s[4:7], s58 offen offset:0 sc1
    buffer_load_dwordx4 v[36:39], v4, s[4:7], s58 offen offset:1024 sc1
    buffer_load_dwordx4 v[96:99], v3, s[4:7], s41 offen sc1
    buffer_load_dwordx4 v[40:43], v4, s[4:7], s58 offen offset:2048 sc1
    buffer_load_dwordx4 v[44:47], v4, s[4:7], s58 offen offset:3072 sc1
    s_add_u32 s33, s33, 1
    s_cmp_gt_u32 s33, 20000
    s_waitcnt vmcnt(5)
    v_max_u32 v0, v24, v28
    v_cmp_eq_u32 vcc, -1, v0
    s_cbranch_scc1 C_main_kernel_68
    s_cbranch_vccnz R_main_kernel_67
    s_branch C_main_kernel_68
R_main_kernel_69:
    buffer_load_dwordx4 v[32:35], v4, s[4:7], s58 offen offset:0 sc1
    buffer_load_dwordx4 v[36:39], v4, s[4:7], s58 offen offset:1024 sc1
    buffer_load_dwordx4 v[96:99], v3, s[4:7], s41 offen sc1
    buffer_load_dwordx4 v[40:43], v4, s[4:7], s58 offen offset:2048 sc1
    buffer_load_dwordx4 v[44:47], v4, s[4:7], s58 offen offset:3072 sc1
    buffer_load_dwordx4 v[48:51], v5, s[4:7], s58 offen offset:0 sc1
    buffer_load_dwordx4 v[52:55], v5, s[4:7], s58 offen offset:1024 sc1
    s_add_u32 s33, s33, 1
    s_cmp_gt_u32 s33, 20000
    s_waitcnt vmcnt(5)
    v_max_u32 v0, v32, v36
    v_cmp_eq_u32 vcc, -1, v0
    s_cbranch_scc1 C_main_kernel_70
    s_cbranch_vccnz R_main_kernel_69
    s_branch C_main_kernel_70
R_main_kernel_71:
    buffer_load_dwordx4 v[40:43], v4, s[4:7], s58 offen offset:2048 sc1
    buffer_load_dwordx4 v[44:47], v4, s[4:7], s58 offen offset:3072 sc1
    buffer_load_dwordx4 v[48:51], v5, s[4:7], s58 offen offset:0 sc1
    buffer_load_dwordx4 v[52:55], v5, s[4:7], s58 offen offset:1024 sc1
    buffer_load_dwordx4 v[56:59], v5, s[4:7], s58 offen offset:2048 sc1
    buffer_load_dwordx4 v[60:63], v5, s[4:7], s58 offen offset:3072 sc1
    s_add_u32 s33, s33, 1
    s_cmp_gt_u32 s33, 20000
    s_waitcnt vmcnt(4)
    v_max_u32 v0, v40, v44
    v_cmp_eq_u32 vcc, -1, v0
    s_cbranch_scc1 C_main_kernel_72
    s_cbranch_vccnz R_main_kernel_71
    s_branch C_main_kernel_72
R_main_kernel_73:
    buffer_load_dwordx4 v[96:99], v3, s[4:7], s41 offen sc1
    buffer_load_dwordx4 v[48:51], v5, s[4:7], s58 offen offset:0 sc1
    buffer_load_dwordx4 v[52:55], v5, s[4:7], s58 offen offset:1024 sc1
    buffer_load_dwordx4 v[56:59], v5, s[4:7], s58 offen offset:2048 sc1
    buffer_load_dwordx4 v[60:63], v5, s[4:7], s58 offen offset:3072 sc1
    buffer_load_dwordx4 v[64:67], v6, s[4:7], s58 offen offset:0 sc1
    buffer_load_dwordx4 v[68:71], v6, s[4:7], s58 offen offset:1024 sc1
    s_add_u32 s33, s33, 1
    s_cmp_gt_u32 s33, 20000
    s_waitcnt vmcnt(4)
    v_max_u32 v0, v96, v97
    v_max3_u32 v0, v0, v98, v99
    v_max3_u32 v0, v0, v48, v52
    v_cmp_eq_u32 vcc, -1, v0
    s_cbranch_scc1 C_main_kernel_74
    s_cbranch_vccnz R_main_kernel_73
    s_branch C_main_kernel_74
R_main_kernel_75:
    buffer_load_dwordx4 v[56:59], v5, s[4:7], s58 offen offset:2048 sc1
    buffer_load_dwordx4 v[60:63], v5, s[4:7], s58 offen offset:3072 sc1
    buffer_load_dwordx4 v[64:67], v6, s[4:7], s58 offen offset:0 sc1
    buffer_load_dwordx4 v[68:71], v6, s[4:7], s58 offen offset:1024 sc1
    buffer_load_dwordx4 v[72:75], v6, s[4:7], s58 offen offset:2048 sc1
    buffer_load_dwordx4 v[76:79], v6, s[4:7], s58 offen offset:3072 sc1
    s_add_u32 s33, s33, 1
    s_cmp_gt_u32 s33, 20000
    s_waitcnt vmcnt(4)
    v_max_u32 v0, v56, v60
    v_cmp_eq_u32 vcc, -1, v0
    s_cbranch_scc1 C_main_kernel_76
    s_cbranch_vccnz R_main_kernel_75
    s_branch C_main_kernel_76
R_main_kernel_77:
    buffer_load_dwordx4 v[64:67], v6, s[4:7], s58 offen offset:0 sc1
    buffer_load_dwordx4 v[68:71], v6, s[4:7], s58 offen offset:1024 sc1
    buffer_load_dwordx4 v[72:75], v6, s[4:7], s58 offen offset:2048 sc1
    buffer_load_dwordx4 v[76:79], v6, s[4:7], s58 offen offset:3072 sc1
    s_add_u32 s33, s33, 1
    s_cmp_gt_u32 s33, 20000
    s_waitcnt vmcnt(2)
    v_max_u32 v0, v64, v68
    v_cmp_eq_u32 vcc, -1, v0
    s_cbranch_scc1 C_main_kernel_78
    s_cbranch_vccnz R_main_kernel_77
    s_branch C_main_kernel_78
R_main_kernel_79:
    buffer_load_dwordx4 v[72:75], v6, s[4:7], s58 offen offset:2048 sc1
    buffer_load_dwordx4 v[76:79], v6, s[4:7], s58 offen offset:3072 sc1
    s_add_u32 s33, s33, 1
    s_cmp_gt_u32 s33, 20000
    s_waitcnt vmcnt(0)
    v_max_u32 v0, v72, v76
    v_cmp_eq_u32 vcc, -1, v0
    s_cbranch_scc1 C_main_kernel_80
    s_cbranch_vccnz R_main_kernel_79
    s_branch C_main_kernel_80
M_main_kernel_81:
    buffer_store_dwordx4 v[48:51], v143, s[4:7], s66 offen offset:0 sc1
    s_branch C_main_kernel_82
M_main_kernel_83:
    buffer_store_dwordx4 v[52:55], v143, s[4:7], s66 offen offset:1024 sc1
    s_branch C_main_kernel_84
R_main_kernel_104:
    buffer_load_dwordx4 v[24:27], v2, s[4:7], s60 offen offset:2048 sc1
    buffer_load_dwordx4 v[28:31], v2, s[4:7], s60 offen offset:3072 sc1
    buffer_load_dwordx4 v[32:35], v10, s[4:7], s60 offen offset:0 sc1
    buffer_load_dwordx4 v[36:39], v10, s[4:7], s60 offen offset:1024 sc1
    buffer_load_dwordx4 v[40:43], v10, s[4:7], s60 offen offset:2048 sc1
    buffer_load_dwordx4 v[44:47], v10, s[4:7], s60 offen offset:3072 sc1
    s_add_u32 s33, s33, 1
    s_cmp_gt_u32 s33, 20000
    s_waitcnt vmcnt(4)
    v_max_u32 v0, v24, v28
    v_cmp_eq_u32 vcc, -1, v0
    s_cbranch_scc1 C_main_kernel_105
    s_cbranch_vccnz R_main_kernel_104
    s_branch C_main_kernel_105
R_main_kernel_106:
    buffer_load_dwordx4 v[32:35], v10, s[4:7], s60 offen offset:0 sc1
    buffer_load_dwordx4 v[36:39], v10, s[4:7], s60 offen offset:1024 sc1
    buffer_load_dwordx4 v[40:43], v10, s[4:7], s60 offen offset:2048 sc1
    buffer_load_dwordx4 v[44:47], v10, s[4:7], s60 offen offset:3072 sc1
    buffer_load_dwordx4 v[48:51], v11, s[4:7], s60 offen offset:0 sc1
    buffer_load_dwordx4 v[52:55], v11, s[4:7], s60 offen offset:1024 sc1
    s_add_u32 s33, s33, 1
    s_cmp_gt_u32 s33, 20000
    s_waitcnt vmcnt(4)
    v_max_u32 v0, v32, v36
    v_cmp_eq_u32 vcc, -1, v0
    s_cbranch_scc1 C_main_kernel_107
    s_cbranch_vccnz R_main_kernel_106
    s_branch C_main_kernel_107
R_main_kernel_108:
    buffer_load_dwordx4 v[40:43], v10, s[4:7], s60 offen offset:2048 sc1
    buffer_load_dwordx4 v[44:47], v10, s[4:7], s60 offen offset:3072 sc1
    buffer_load_dwordx4 v[48:51], v11, s[4:7], s60 offen offset:0 sc1
    buffer_load_dwordx4 v[52:55], v11, s[4:7], s60 offen offset:1024 sc1
    buffer_load_dwordx4 v[56:59], v11, s[4:7], s60 offen offset:2048 sc1
    buffer_load_dwordx4 v[60:63], v11, s[4:7], s60 offen offset:3072 sc1
    s_add_u32 s33, s33, 1
    s_cmp_gt_u32 s33, 20000
    s_waitcnt vmcnt(4)
    v_max_u32 v0, v40, v44
    v_cmp_eq_u32 vcc, -1, v0
    s_cbranch_scc1 C_main_kernel_109
    s_cbranch_vccnz R_main_kernel_108
    s_branch C_main_kernel_109
R_main_kernel_110:
    buffer_load_dwordx4 v[48:51], v11, s[4:7], s60 offen offset:0 sc1
    buffer_load_dwordx4 v[52:55], v11, s[4:7], s60 offen offset:1024 sc1
    buffer_load_dwordx4 v[56:59], v11, s[4:7], s60 offen offset:2048 sc1
    buffer_load_dwordx4 v[60:63], v11, s[4:7], s60 offen offset:3072 sc1
    buffer_load_dwordx4 v[64:67], v15, s[4:7], s60 offen offset:0 sc1
    buffer_load_dwordx4 v[68:71], v15, s[4:7], s60 offen offset:1024 sc1
    s_add_u32 s33, s33, 1
    s_cmp_gt_u32 s33, 20000
    s_waitcnt vmcnt(4)
    v_max_u32 v0, v48, v52
    v_cmp_eq_u32 vcc, -1, v0
    s_cbranch_scc1 C_main_kernel_111
    s_cbranch_vccnz R_main_kernel_110
    s_branch C_main_kernel_111
R_main_kernel_112:
    buffer_load_dwordx4 v[56:59], v11, s[4:7], s60 offen offset:2048 sc1
    buffer_load_dwordx4 v[60:63], v11, s[4:7], s60 offen offset:3072 sc1
    buffer_load_dwordx4 v[64:67], v15, s[4:7], s60 offen offset:0 sc1
    buffer_load_dwordx4 v[68:71], v15, s[4:7], s60 offen offset:1024 sc1
    buffer_load_dwordx4 v[72:75], v15, s[4:7], s60 offen offset:2048 sc1
    buffer_load_dwordx4 v[76:79], v15, s[4:7], s60 offen offset:3072 sc1
    s_add_u32 s33, s33, 1
    s_cmp_gt_u32 s33, 20000
    s_waitcnt vmcnt(4)
    v_max_u32 v0, v56, v60
    v_cmp_eq_u32 vcc, -1, v0
    s_cbranch_scc1 C_main_kernel_113
    s_cbranch_vccnz R_main_kernel_112
    s_branch C_main_kernel_113
R_main_kernel_114:
    buffer_load_dwordx4 v[64:67], v15, s[4:7], s60 offen offset:0 sc1
    buffer_load_dwordx4 v[68:71], v15, s[4:7], s60 offen offset:1024 sc1
    buffer_load_dwordx4 v[72:75], v15, s[4:7], s60 offen offset:2048 sc1
    buffer_load_dwordx4 v[76:79], v15, s[4:7], s60 offen offset:3072 sc1
    s_add_u32 s33, s33, 1
    s_cmp_gt_u32 s33, 20000
    s_waitcnt vmcnt(2)
    v_max_u32 v0, v64, v68
    v_cmp_eq_u32 vcc, -1, v0
    s_cbranch_scc1 C_main_kernel_115
    s_cbranch_vccnz R_main_kernel_114
    s_branch C_main_kernel_115
R_main_kernel_116:
    buffer_load_dwordx4 v[72:75], v15, s[4:7], s60 offen offset:2048 sc1
    buffer_load_dwordx4 v[76:79], v15, s[4:7], s60 offen offset:3072 sc1
    s_add_u32 s33, s33, 1
    s_cmp_gt_u32 s33, 20000
    s_waitcnt vmcnt(0)
    v_max_u32 v0, v72, v76
    v_cmp_eq_u32 vcc, -1, v0
    s_cbranch_scc1 C_main_kernel_117
    s_cbranch_vccnz R_main_kernel_116
    s_branch C_main_kernel_117
R_main_kernel_138:
    buffer_load_dwordx4 v[24:27], v3, s[4:7], s62 offen offset:2048 sc1
    buffer_load_dwordx4 v[28:31], v3, s[4:7], s62 offen offset:3072 sc1
    buffer_load_dwordx4 v[32:35], v4, s[4:7], s62 offen offset:0 sc1
    buffer_load_dwordx4 v[36:39], v4, s[4:7], s62 offen offset:1024 sc1
    buffer_load_dwordx4 v[136:139], v3, s[4:7], s42 offen sc1
    buffer_load_dwordx4 v[40:43], v4, s[4:7], s62 offen offset:2048 sc1
    buffer_load_dwordx4 v[44:47], v4, s[4:7], s62 offen offset:3072 sc1
    s_add_u32 s33, s33, 1
    s_cmp_gt_u32 s33, 20000
    s_waitcnt vmcnt(5)
    v_max_u32 v0, v24, v28
    v_cmp_eq_u32 vcc, -1, v0
    s_cbranch_scc1 C_main_kernel_139
    s_cbranch_vccnz R_main_kernel_138
    s_branch C_main_kernel_139
R_main_kernel_140:
    buffer_load_dwordx4 v[32:35], v4, s[4:7], s62 offen offset:0 sc1
    buffer_load_dwordx4 v[36:39], v4, s[4:7], s62 offen offset:1024 sc1
    buffer_load_dwordx4 v[136:139], v3, s[4:7], s42 offen sc1
    buffer_load_dwordx4 v[40:43], v4, s[4:7], s62 offen offset:2048 sc1
    buffer_load_dwordx4 v[44:47], v4, s[4:7], s62 offen offset:3072 sc1
    buffer_load_dwordx4 v[48:51], v5, s[4:7], s62 offen offset:0 sc1
    buffer_load_dwordx4 v[52:55], v5, s[4:7], s62 offen offset:1024 sc1
    s_add_u32 s33, s33, 1
    s_cmp_gt_u32 s33, 20000
    s_waitcnt vmcnt(5)
    v_max_u32 v0, v32, v36
    v_cmp_eq_u32 vcc, -1, v0
    s_cbranch_scc1 C_main_kernel_141
    s_cbranch_vccnz R_main_kernel_140
    s_branch C_main_kernel_141
R_main_kernel_142:
    buffer_load_dwordx4 v[40:43], v4, s[4:7], s62 offen offset:2048 sc1
    buffer_load_dwordx4 v[44:47], v4, s[4:7], s62 offen offset:3072 sc1
    buffer_load_dwordx4 v[48:51], v5, s[4:7], s62 offen offset:0 sc1
    buffer_load_dwordx4 v[52:55], v5, s[4:7], s62 offen offset:1024 sc1
    buffer_load_dwordx4 v[56:59], v5, s[4:7], s62 offen offset:2048 sc1
    buffer_load_dwordx4 v[60:63], v5, s[4:7], s62 offen offset:3072 sc1
    s_add_u32 s33, s33, 1
    s_cmp_gt_u32 s33, 20000
    s_waitcnt vmcnt(4)
    v_max_u32 v0, v40, v44
    v_cmp_eq_u32 vcc, -1, v0
    s_cbranch_scc1 C_main_kernel_143
    s_cbranch_vccnz R_main_kernel_142
    s_branch C_main_kernel_143
R_main_kernel_144:
    buffer_load_dwordx4 v[136:139], v3, s[4:7], s42 offen sc1
    buffer_load_dwordx4 v[48:51], v5, s[4:7], s62 offen offset:0 sc1
    buffer_load_dwordx4 v[52:55], v5, s[4:7], s62 offen offset:1024 sc1
    buffer_load_dwordx4 v[56:59], v5, s[4:7], s62 offen offset:2048 sc1
    buffer_load_dwordx4 v[60:63], v5, s[4:7], s62 offen offset:3072 sc1
    buffer_load_dwordx4 v[64:67], v6, s[4:7], s62 offen offset:0 sc1
    buffer_load_dwordx4 v[68:71], v6, s[4:7], s62 offen offset:1024 sc1
    s_add_u32 s33, s33, 1
    s_cmp_gt_u32 s33, 20000
    s_waitcnt vmcnt(4)
    v_max_u32 v0, v136, v137
    v_max3_u32 v0, v0, v138, v139
    v_max3_u32 v0, v0, v48, v52
    v_cmp_eq_u32 vcc, -1, v0
    s_cbranch_scc1 C_main_kernel_145
    s_cbranch_vccnz R_main_kernel_144
    s_branch C_main_kernel_145
R_main_kernel_146:
    buffer_load_dwordx4 v[56:59], v5, s[4:7], s62 offen offset:2048 sc1
    buffer_load_dwordx4 v[60:63], v5, s[4:7], s62 offen offset:3072 sc1
    buffer_load_dwordx4 v[64:67], v6, s[4:7], s62 offen offset:0 sc1
    buffer_load_dwordx4 v[68:71], v6, s[4:7], s62 offen offset:1024 sc1
    buffer_load_dwordx4 v[72:75], v6, s[4:7], s62 offen offset:2048 sc1
    buffer_load_dwordx4 v[76:79], v6, s[4:7], s62 offen offset:3072 sc1
    s_add_u32 s33, s33, 1
    s_cmp_gt_u32 s33, 20000
    s_waitcnt vmcnt(4)
    v_max_u32 v0, v56, v60
    v_cmp_eq_u32 vcc, -1, v0
    s_cbranch_scc1 C_main_kernel_147
    s_cbranch_vccnz R_main_kernel_146
    s_branch C_main_kernel_147
R_main_kernel_148:
    buffer_load_dwordx4 v[64:67], v6, s[4:7], s62 offen offset:0 sc1
    buffer_load_dwordx4 v[68:71], v6, s[4:7], s62 offen offset:1024 sc1
    buffer_load_dwordx4 v[72:75], v6, s[4:7], s62 offen offset:2048 sc1
    buffer_load_dwordx4 v[76:79], v6, s[4:7], s62 offen offset:3072 sc1
    s_add_u32 s33, s33, 1
    s_cmp_gt_u32 s33, 20000
    s_waitcnt vmcnt(2)
    v_max_u32 v0, v64, v68
    v_cmp_eq_u32 vcc, -1, v0
    s_cbranch_scc1 C_main_kernel_149
    s_cbranch_vccnz R_main_kernel_148
    s_branch C_main_kernel_149
R_main_kernel_150:
    buffer_load_dwordx4 v[72:75], v6, s[4:7], s62 offen offset:2048 sc1
    buffer_load_dwordx4 v[76:79], v6, s[4:7], s62 offen offset:3072 sc1
    s_add_u32 s33, s33, 1
    s_cmp_gt_u32 s33, 20000
    s_waitcnt vmcnt(0)
    v_max_u32 v0, v72, v76
    v_cmp_eq_u32 vcc, -1, v0
    s_cbranch_scc1 C_main_kernel_151
    s_cbranch_vccnz R_main_kernel_150
    s_branch C_main_kernel_151
R_main_kernel_152:
    buffer_load_dwordx4 v[40:43], v3, s[4:7], s37 offen offset:0 sc1
    buffer_load_dwordx4 v[44:47], v3, s[4:7], s37 offen offset:1024 sc1
    buffer_load_dwordx4 v[48:51], v3, s[4:7], s37 offen offset:2048 sc1
    buffer_load_dwordx4 v[52:55], v3, s[4:7], s37 offen offset:3072 sc1
    buffer_load_dwordx4 v[56:59], v4, s[4:7], s37 offen offset:0 sc1
    buffer_load_dwordx4 v[60:63], v4, s[4:7], s37 offen offset:1024 sc1
    buffer_load_dwordx4 v[64:67], v4, s[4:7], s37 offen offset:2048 sc1
    buffer_load_dwordx4 v[68:71], v4, s[4:7], s37 offen offset:3072 sc1
    buffer_load_dwordx4 v[72:75], v5, s[4:7], s37 offen offset:0 sc1
    buffer_load_dwordx4 v[76:79], v5, s[4:7], s37 offen offset:1024 sc1
    buffer_load_dwordx4 v[80:83], v12, s[4:7], s37 offen offset:2048 sc1
    s_add_u32 s33, s33, 1
    s_cmp_gt_u32 s33, 20000
    s_waitcnt vmcnt(1)
    v_max_u32 v0, v40, v42
    v_max3_u32 v0, v0, v44, v46
    v_cmp_eq_u32 vcc, -1, v0
    s_cbranch_scc1 C_main_kernel_153
    s_cbranch_vccnz R_main_kernel_152
    s_branch C_main_kernel_153
R_main_kernel_154:
    buffer_load_dwordx4 v[48:51], v3, s[4:7], s37 offen offset:2048 sc1
    buffer_load_dwordx4 v[52:55], v3, s[4:7], s37 offen offset:3072 sc1
    buffer_load_dwordx4 v[56:59], v4, s[4:7], s37 offen offset:0 sc1
    buffer_load_dwordx4 v[60:63], v4, s[4:7], s37 offen offset:1024 sc1
    buffer_load_dwordx4 v[64:67], v4, s[4:7], s37 offen offset:2048 sc1
    buffer_load_dwordx4 v[68:71], v4, s[4:7], s37 offen offset:3072 sc1
    buffer_load_dwordx4 v[72:75], v5, s[4:7], s37 offen offset:0 sc1
    buffer_load_dwordx4 v[76:79], v5, s[4:7], s37 offen offset:1024 sc1
    buffer_load_dwordx4 v[80:83], v12, s[4:7], s37 offen offset:2048 sc1
    s_add_u32 s33, s33, 1
    s_cmp_gt_u32 s33, 20000
    s_waitcnt vmcnt(1)
    v_max_u32 v0, v48, v50
    v_max3_u32 v0, v0, v52, v54
    v_cmp_eq_u32 vcc, -1, v0
    s_cbranch_scc1 C_main_kernel_155
    s_cbranch_vccnz R_main_kernel_154
    s_branch C_main_kernel_155
R_main_kernel_156:
    buffer_load_dwordx4 v[56:59], v4, s[4:7], s37 offen offset:0 sc1
    buffer_load_dwordx4 v[60:63], v4, s[4:7], s37 offen offset:1024 sc1
    buffer_load_dwordx4 v[64:67], v4, s[4:7], s37 offen offset:2048 sc1
    buffer_load_dwordx4 v[68:71], v4, s[4:7], s37 offen offset:3072 sc1
    buffer_load_dwordx4 v[72:75], v5, s[4:7], s37 offen offset:0 sc1
    buffer_load_dwordx4 v[76:79], v5, s[4:7], s37 offen offset:1024 sc1
    buffer_load_dwordx4 v[80:83], v12, s[4:7], s37 offen offset:2048 sc1
    s_add_u32 s33, s33, 1
    s_cmp_gt_u32 s33, 20000
    s_waitcnt vmcnt(1)
    v_max_u32 v0, v56, v58
    v_max3_u32 v0, v0, v60, v62
    v_cmp_eq_u32 vcc, -1, v0
    s_cbranch_scc1 C_main_kernel_157
    s_cbranch_vccnz R_main_kernel_156
    s_branch C_main_kernel_157
R_main_kernel_158:
    buffer_load_dwordx4 v[64:67], v4, s[4:7], s37 offen offset:2048 sc1
    buffer_load_dwordx4 v[68:71], v4, s[4:7], s37 offen offset:3072 sc1
    buffer_load_dwordx4 v[72:75], v5, s[4:7], s37 offen offset:0 sc1
    buffer_load_dwordx4 v[76:79], v5, s[4:7], s37 offen offset:1024 sc1
    buffer_load_dwordx4 v[80:83], v12, s[4:7], s37 offen offset:2048 sc1
    buffer_load_dwordx4 v[144:147], v3, s[4:7], s30 offen offset:0 sc1
    buffer_load_dwordx4 v[148:151], v3, s[4:7], s30 offen offset:1024 sc1
    s_add_u32 s33, s33, 1
    s_cmp_gt_u32 s33, 20000
    s_waitcnt vmcnt(3)
    v_max_u32 v0, v64, v66
    v_max3_u32 v0, v0, v68, v70
    v_cmp_eq_u32 vcc, -1, v0
    s_cbranch_scc1 C_main_kernel_159
    s_cbranch_vccnz R_main_kernel_158
    s_branch C_main_kernel_159
R_main_kernel_160:
    buffer_load_dwordx4 v[72:75], v5, s[4:7], s37 offen offset:0 sc1
    buffer_load_dwordx4 v[76:79], v5, s[4:7], s37 offen offset:1024 sc1
    buffer_load_dwordx4 v[80:83], v12, s[4:7], s37 offen offset:2048 sc1
    buffer_load_dwordx4 v[144:147], v3, s[4:7], s30 offen offset:0 sc1
    buffer_load_dwordx4 v[148:151], v3, s[4:7], s30 offen offset:1024 sc1
    buffer_load_dwordx4 v[152:155], v3, s[4:7], s30 offen offset:2048 sc1
    buffer_load_dwordx4 v[156:159], v3, s[4:7], s30 offen offset:3072 sc1
    s_add_u32 s33, s33, 1
    s_cmp_gt_u32 s33, 20000
    s_waitcnt vmcnt(1)
    v_max_u32 v0, v72, v74
    v_max3_u32 v0, v0, v76, v78
    v_cmp_eq_u32 vcc, -1, v0
    s_cbranch_scc1 C_main_kernel_161
    s_cbranch_vccnz R_main_kernel_160
    s_branch C_main_kernel_161
R_main_kernel_162:
    buffer_load_dwordx4 v[80:83], v12, s[4:7], s37 offen offset:2048 sc1
    buffer_load_dwordx4 v[144:147], v3, s[4:7], s30 offen offset:0 sc1
    buffer_load_dwordx4 v[148:151], v3, s[4:7], s30 offen offset:1024 sc1
    buffer_load_dwordx4 v[152:155], v3, s[4:7], s30 offen offset:2048 sc1
    buffer_load_dwordx4 v[156:159], v3, s[4:7], s30 offen offset:3072 sc1
    buffer_load_dwordx4 v[160:163], v4, s[4:7], s30 offen offset:0 sc1
    buffer_load_dwordx4 v[164:167], v4, s[4:7], s30 offen offset:1024 sc1
    s_add_u32 s33, s33, 1
    s_cmp_gt_u32 s33, 20000
    s_waitcnt vmcnt(3)
    v_max_u32 v0, v80, v82
    v_cmp_eq_u32 vcc, -1, v0
    s_cbranch_scc1 C_main_kernel_163
    s_cbranch_vccnz R_main_kernel_162
    s_branch C_main_kernel_163
R_main_kernel_164:
    buffer_load_dwordx4 v[144:147], v3, s[4:7], s30 offen offset:0 sc1
    buffer_load_dwordx4 v[148:151], v3, s[4:7], s30 offen offset:1024 sc1
    buffer_load_dwordx4 v[152:155], v3, s[4:7], s30 offen offset:2048 sc1
    buffer_load_dwordx4 v[156:159], v3, s[4:7], s30 offen offset:3072 sc1
    buffer_load_dwordx4 v[160:163], v4, s[4:7], s30 offen offset:0 sc1
    buffer_load_dwordx4 v[164:167], v4, s[4:7], s30 offen offset:1024 sc1
    buffer_load_dwordx4 v[168:171], v4, s[4:7], s30 offen offset:2048 sc1
    s_add_u32 s33, s33, 1
    s_cmp_gt_u32 s33, 20000
    s_waitcnt vmcnt(1)
    v_max_u32 v0, v144, v146
    v_max3_u32 v0, v0, v148, v150
    v_cmp_eq_u32 vcc, -1, v0
    s_cbranch_scc1 C_main_kernel_165
    s_cbranch_vccnz R_main_kernel_164
    s_branch C_main_kernel_165
R_main_kernel_166:
    buffer_load_dwordx4 v[152:155], v3, s[4:7], s30 offen offset:2048 sc1
    buffer_load_dwordx4 v[156:159], v3, s[4:7], s30 offen offset:3072 sc1
    buffer_load_dwordx4 v[160:163], v4, s[4:7], s30 offen offset:0 sc1
    buffer_load_dwordx4 v[164:167], v4, s[4:7], s30 offen offset:1024 sc1
    buffer_load_dwordx4 v[168:171], v4, s[4:7], s30 offen offset:2048 sc1
    buffer_load_dwordx4 v[172:175], v4, s[4:7], s30 offen offset:3072 sc1
    buffer_load_dwordx4 v[176:179], v5, s[4:7], s30 offen offset:0 sc1
    s_add_u32 s33, s33, 1
    s_cmp_gt_u32 s33, 20000
    s_waitcnt vmcnt(3)
    v_max_u32 v0, v152, v154
    v_max3_u32 v0, v0, v156, v158
    v_cmp_eq_u32 vcc, -1, v0
    s_cbranch_scc1 C_main_kernel_167
    s_cbranch_vccnz R_main_kernel_166
    s_branch C_main_kernel_167
R_main_kernel_168:
    buffer_load_dwordx4 v[160:163], v4, s[4:7], s30 offen offset:0 sc1
    buffer_load_dwordx4 v[164:167], v4, s[4:7], s30 offen offset:1024 sc1
    buffer_load_dwordx4 v[168:171], v4, s[4:7], s30 offen offset:2048 sc1
    buffer_load_dwordx4 v[172:175], v4, s[4:7], s30 offen offset:3072 sc1
    buffer_load_dwordx4 v[176:179], v5, s[4:7], s30 offen offset:0 sc1
    buffer_load_dwordx4 v[180:183], v5, s[4:7], s30 offen offset:1024 sc1
    buffer_load_dwordx4 v[184:187], v12, s[4:7], s30 offen offset:2048 sc1
    s_add_u32 s33, s33, 1
    s_cmp_gt_u32 s33, 20000
    s_waitcnt vmcnt(5)
    v_max_u32 v0, v160, v162
    v_max3_u32 v0, v0, v164, v166
    v_cmp_eq_u32 vcc, -1, v0
    s_cbranch_scc1 C_main_kernel_169
    s_cbranch_vccnz R_main_kernel_168
    s_branch C_main_kernel_169
R_main_kernel_170:
    buffer_load_dwordx4 v[168:171], v4, s[4:7], s30 offen offset:2048 sc1
    buffer_load_dwordx4 v[172:175], v4, s[4:7], s30 offen offset:3072 sc1
    buffer_load_dwordx4 v[176:179], v5, s[4:7], s30 offen offset:0 sc1
    buffer_load_dwordx4 v[180:183], v5, s[4:7], s30 offen offset:1024 sc1
    buffer_load_dwordx4 v[184:187], v12, s[4:7], s30 offen offset:2048 sc1
    buffer_load_dwordx4 v[188:191], v3, s[4:7], s78 offen offset:0 sc1
    buffer_load_dwordx4 v[192:195], v3, s[4:7], s78 offen offset:1024 sc1
    s_add_u32 s33, s33, 1
    s_cmp_gt_u32 s33, 20000
    s_waitcnt vmcnt(5)
    v_max_u32 v0, v168, v170
    v_max3_u32 v0, v0, v172, v174
    v_cmp_eq_u32 vcc, -1, v0
    s_cbranch_scc1 C_main_kernel_171
    s_cbranch_vccnz R_main_kernel_170
    s_branch C_main_kernel_171
R_main_kernel_172:
    buffer_load_dwordx4 v[176:179], v5, s[4:7], s30 offen offset:0 sc1
    buffer_load_dwordx4 v[180:183], v5, s[4:7], s30 offen offset:1024 sc1
    buffer_load_dwordx4 v[184:187], v12, s[4:7], s30 offen offset:2048 sc1
    buffer_load_dwordx4 v[188:191], v3, s[4:7], s78 offen offset:0 sc1
    buffer_load_dwordx4 v[192:195], v3, s[4:7], s78 offen offset:1024 sc1
    buffer_load_dwordx4 v[196:199], v3, s[4:7], s78 offen offset:2048 sc1
    buffer_load_dwordx4 v[200:203], v3, s[4:7], s78 offen offset:3072 sc1
    s_add_u32 s33, s33, 1
    s_cmp_gt_u32 s33, 20000
    s_waitcnt vmcnt(5)
    v_max_u32 v0, v176, v178
L_hop_main_kernel_11:
    s_cbranch_execz L_hopb_main_kernel
    v_max3_u32 v0, v0, v180, v182
    v_cmp_eq_u32 vcc, -1, v0
    s_cbranch_scc1 C_main_kernel_173
    s_cbranch_vccnz R_main_kernel_172
    s_branch C_main_kernel_173
R_main_kernel_174:
    buffer_load_dwordx4 v[184:187], v12, s[4:7], s30 offen offset:2048 sc1
    buffer_load_dwordx4 v[188:191], v3, s[4:7], s78 offen offset:0 sc1
    buffer_load_dwordx4 v[192:195], v3, s[4:7], s78 offen offset:1024 sc1
    buffer_load_dwordx4 v[196:199], v3, s[4:7], s78 offen offset:2048 sc1
    buffer_load_dwordx4 v[200:203], v3, s[4:7], s78 offen offset:3072 sc1
    buffer_load_dwordx4 v[204:207], v4, s[4:7], s78 offen offset:0 sc1
    buffer_load_dwordx4 v[208:211], v4, s[4:7], s78 offen offset:1024 sc1
    s_add_u32 s33, s33, 1
    s_cmp_gt_u32 s33, 20000
    s_waitcnt vmcnt(6)
    v_max_u32 v0, v184, v186
    v_cmp_eq_u32 vcc, -1, v0
    s_cbranch_scc1 C_main_kernel_175
    s_cbranch_vccnz R_main_kernel_174
    s_branch C_main_kernel_175
R_main_kernel_176:
    buffer_load_dwordx4 v[188:191], v3, s[4:7], s78 offen offset:0 sc1
    buffer_load_dwordx4 v[192:195], v3, s[4:7], s78 offen offset:1024 sc1
    buffer_load_dwordx4 v[196:199], v3, s[4:7], s78 offen offset:2048 sc1
    buffer_load_dwordx4 v[200:203], v3, s[4:7], s78 offen offset:3072 sc1
    buffer_load_dwordx4 v[204:207], v4, s[4:7], s78 offen offset:0 sc1
    buffer_load_dwordx4 v[208:211], v4, s[4:7], s78 offen offset:1024 sc1
    buffer_load_dwordx4 v[212:215], v4, s[4:7], s78 offen offset:2048 sc1
    s_add_u32 s33, s33, 1
    s_cmp_gt_u32 s33, 20000
    s_waitcnt vmcnt(5)
    v_max_u32 v0, v188, v190
    v_max3_u32 v0, v0, v192, v194
    v_cmp_eq_u32 vcc, -1, v0
    s_cbranch_scc1 C_main_kernel_177
    s_cbranch_vccnz R_main_kernel_176
    s_branch C_main_kernel_177
R_main_kernel_178:
    buffer_load_dwordx4 v[196:199], v3, s[4:7], s78 offen offset:2048 sc1
    buffer_load_dwordx4 v[200:203], v3, s[4:7], s78 offen offset:3072 sc1
    buffer_load_dwordx4 v[204:207], v4, s[4:7], s78 offen offset:0 sc1
    buffer_load_dwordx4 v[208:211], v4, s[4:7], s78 offen offset:1024 sc1
    buffer_load_dwordx4 v[212:215], v4, s[4:7], s78 offen offset:2048 sc1
    buffer_load_dwordx4 v[216:219], v4, s[4:7], s78 offen offset:3072 sc1
    buffer_load_dwordx4 v[220:223], v5, s[4:7], s78 offen offset:0 sc1
    s_add_u32 s33, s33, 1
    s_cmp_gt_u32 s33, 20000
    s_waitcnt vmcnt(5)
    v_max_u32 v0, v196, v198
    v_max3_u32 v0, v0, v200, v202
    v_cmp_eq_u32 vcc, -1, v0
    s_cbranch_scc1 C_main_kernel_179
    s_cbranch_vccnz R_main_kernel_178
    s_branch C_main_kernel_179
R_main_kernel_180:
    buffer_load_dwordx4 v[204:207], v4, s[4:7], s78 offen offset:0 sc1
    buffer_load_dwordx4 v[208:211], v4, s[4:7], s78 offen offset:1024 sc1
    buffer_load_dwordx4 v[212:215], v4, s[4:7], s78 offen offset:2048 sc1
    buffer_load_dwordx4 v[216:219], v4, s[4:7], s78 offen offset:3072 sc1
    buffer_load_dwordx4 v[220:223], v5, s[4:7], s78 offen offset:0 sc1
    buffer_load_dwordx4 v[224:227], v5, s[4:7], s78 offen offset:1024 sc1
    buffer_load_dwordx4 v[228:231], v12, s[4:7], s78 offen offset:2048 sc1
    s_add_u32 s33, s33, 1
    s_cmp_gt_u32 s33, 20000
    s_waitcnt vmcnt(5)
    v_max_u32 v0, v204, v206
    v_max3_u32 v0, v0, v208, v210
    v_cmp_eq_u32 vcc, -1, v0
    s_cbranch_scc1 C_main_kernel_181
    s_cbranch_vccnz R_main_kernel_180
    s_branch C_main_kernel_181
R_main_kernel_182:
    buffer_load_dwordx4 v[212:215], v4, s[4:7], s78 offen offset:2048 sc1
    buffer_load_dwordx4 v[216:219], v4, s[4:7], s78 offen offset:3072 sc1
    buffer_load_dwordx4 v[220:223], v5, s[4:7], s78 offen offset:0 sc1
    buffer_load_dwordx4 v[224:227], v5, s[4:7], s78 offen offset:1024 sc1
    buffer_load_dwordx4 v[228:231], v12, s[4:7], s78 offen offset:2048 sc1
    buffer_load_dwordx4 v[40:43], v3, s[4:7], s79 offen offset:0 sc1
    buffer_load_dwordx4 v[44:47], v3, s[4:7], s79 offen offset:1024 sc1
    s_add_u32 s33, s33, 1
    s_cmp_gt_u32 s33, 20000
    s_waitcnt vmcnt(5)
    v_max_u32 v0, v212, v214
    v_max3_u32 v0, v0, v216, v218
    v_cmp_eq_u32 vcc, -1, v0
    s_cbranch_scc1 C_main_kernel_183
    s_cbranch_vccnz R_main_kernel_182
    s_branch C_main_kernel_183
R_main_kernel_184:
    buffer_load_dwordx4 v[220:223], v5, s[4:7], s78 offen offset:0 sc1
    buffer_load_dwordx4 v[224:227], v5, s[4:7], s78 offen offset:1024 sc1
    buffer_load_dwordx4 v[228:231], v12, s[4:7], s78 offen offset:2048 sc1
    buffer_load_dwordx4 v[40:43], v3, s[4:7], s79 offen offset:0 sc1
    buffer_load_dwordx4 v[44:47], v3, s[4:7], s79 offen offset:1024 sc1
    buffer_load_dwordx4 v[48:51], v3, s[4:7], s79 offen offset:2048 sc1
    buffer_load_dwordx4 v[52:55], v3, s[4:7], s79 offen offset:3072 sc1
    s_add_u32 s33, s33, 1
    s_cmp_gt_u32 s33, 20000
    s_waitcnt vmcnt(5)
    v_max_u32 v0, v220, v222
    v_max3_u32 v0, v0, v224, v226
    v_cmp_eq_u32 vcc, -1, v0
    s_cbranch_scc1 C_main_kernel_185
    s_cbranch_vccnz R_main_kernel_184
    s_branch C_main_kernel_185
R_main_kernel_186:
    buffer_load_dwordx4 v[228:231], v12, s[4:7], s78 offen offset:2048 sc1
    buffer_load_dwordx4 v[40:43], v3, s[4:7], s79 offen offset:0 sc1
    buffer_load_dwordx4 v[44:47], v3, s[4:7], s79 offen offset:1024 sc1
    buffer_load_dwordx4 v[48:51], v3, s[4:7], s79 offen offset:2048 sc1
    buffer_load_dwordx4 v[52:55], v3, s[4:7], s79 offen offset:3072 sc1
    buffer_load_dwordx4 v[56:59], v4, s[4:7], s79 offen offset:0 sc1
    buffer_load_dwordx4 v[60:63], v4, s[4:7], s79 offen offset:1024 sc1
    s_add_u32 s33, s33, 1
    s_cmp_gt_u32 s33, 20000
    s_waitcnt vmcnt(6)
    v_max_u32 v0, v228, v230
    v_cmp_eq_u32 vcc, -1, v0
    s_cbranch_scc1 C_main_kernel_187
    s_cbranch_vccnz R_main_kernel_186
    s_branch C_main_kernel_187
R_main_kernel_188:
    buffer_load_dwordx4 v[40:43], v3, s[4:7], s79 offen offset:0 sc1
    buffer_load_dwordx4 v[44:47], v3, s[4:7], s79 offen offset:1024 sc1
    buffer_load_dwordx4 v[48:51], v3, s[4:7], s79 offen offset:2048 sc1
    buffer_load_dwordx4 v[52:55], v3, s[4:7], s79 offen offset:3072 sc1
    buffer_load_dwordx4 v[56:59], v4, s[4:7], s79 offen offset:0 sc1
    buffer_load_dwordx4 v[60:63], v4, s[4:7], s79 offen offset:1024 sc1
    buffer_load_dwordx4 v[64:67], v4, s[4:7], s79 offen offset:2048 sc1
    s_add_u32 s33, s33, 1
    s_cmp_gt_u32 s33, 20000
    s_waitcnt vmcnt(5)
    v_max_u32 v0, v40, v42
    v_max3_u32 v0, v0, v44, v46
    v_cmp_eq_u32 vcc, -1, v0
    s_cbranch_scc1 C_main_kernel_189
    s_cbranch_vccnz R_main_kernel_188
    s_branch C_main_kernel_189
R_main_kernel_190:
    buffer_load_dwordx4 v[48:51], v3, s[4:7], s79 offen offset:2048 sc1
    buffer_load_dwordx4 v[52:55], v3, s[4:7], s79 offen offset:3072 sc1
    buffer_load_dwordx4 v[56:59], v4, s[4:7], s79 offen offset:0 sc1
    buffer_load_dwordx4 v[60:63], v4, s[4:7], s79 offen offset:1024 sc1
    buffer_load_dwordx4 v[64:67], v4, s[4:7], s79 offen offset:2048 sc1
    buffer_load_dwordx4 v[68:71], v4, s[4:7], s79 offen offset:3072 sc1
    buffer_load_dwordx4 v[72:75], v5, s[4:7], s79 offen offset:0 sc1
    s_add_u32 s33, s33, 1
    s_cmp_gt_u32 s33, 20000
    s_waitcnt vmcnt(5)
    v_max_u32 v0, v48, v50
    v_max3_u32 v0, v0, v52, v54
    v_cmp_eq_u32 vcc, -1, v0
    s_cbranch_scc1 C_main_kernel_191
    s_cbranch_vccnz R_main_kernel_190
    s_branch C_main_kernel_191
R_main_kernel_192:
    buffer_load_dwordx4 v[56:59], v4, s[4:7], s79 offen offset:0 sc1
    buffer_load_dwordx4 v[60:63], v4, s[4:7], s79 offen offset:1024 sc1
    buffer_load_dwordx4 v[64:67], v4, s[4:7], s79 offen offset:2048 sc1
    buffer_load_dwordx4 v[68:71], v4, s[4:7], s79 offen offset:3072 sc1
    buffer_load_dwordx4 v[72:75], v5, s[4:7], s79 offen offset:0 sc1
    buffer_load_dwordx4 v[76:79], v5, s[4:7], s79 offen offset:1024 sc1
    buffer_load_dwordx4 v[80:83], v12, s[4:7], s79 offen offset:2048 sc1
    s_add_u32 s33, s33, 1
    s_cmp_gt_u32 s33, 20000
    s_waitcnt vmcnt(5)
    v_max_u32 v0, v56, v58
    v_max3_u32 v0, v0, v60, v62
    v_cmp_eq_u32 vcc, -1, v0
    s_cbranch_scc1 C_main_kernel_193
    s_cbranch_vccnz R_main_kernel_192
    s_branch C_main_kernel_193
R_main_kernel_194:
    buffer_load_dwordx4 v[64:67], v4, s[4:7], s79 offen offset:2048 sc1
    buffer_load_dwordx4 v[68:71], v4, s[4:7], s79 offen offset:3072 sc1
    buffer_load_dwordx4 v[72:75], v5, s[4:7], s79 offen offset:0 sc1
    buffer_load_dwordx4 v[76:79], v5, s[4:7], s79 offen offset:1024 sc1
    buffer_load_dwordx4 v[80:83], v12, s[4:7], s79 offen offset:2048 sc1
    s_add_u32 s33, s33, 1
    s_cmp_gt_u32 s33, 20000
    s_waitcnt vmcnt(3)
    v_max_u32 v0, v64, v66
    v_max3_u32 v0, v0, v68, v70
    v_cmp_eq_u32 vcc, -1, v0
    s_cbranch_scc1 C_main_kernel_195
    s_cbranch_vccnz R_main_kernel_194
    s_branch C_main_kernel_195
R_main_kernel_196:
    buffer_load_dwordx4 v[72:75], v5, s[4:7], s79 offen offset:0 sc1
    buffer_load_dwordx4 v[76:79], v5, s[4:7], s79 offen offset:1024 sc1
    buffer_load_dwordx4 v[80:83], v12, s[4:7], s79 offen offset:2048 sc1
    s_add_u32 s33, s33, 1
    s_cmp_gt_u32 s33, 20000
    s_waitcnt vmcnt(1)
    v_max_u32 v0, v72, v74
    v_max3_u32 v0, v0, v76, v78
    v_cmp_eq_u32 vcc, -1, v0
    s_cbranch_scc1 C_main_kernel_197
    s_cbranch_vccnz R_main_kernel_196
    s_branch C_main_kernel_197
R_main_kernel_198:
    buffer_load_dwordx4 v[80:83], v12, s[4:7], s79 offen offset:2048 sc1
    s_add_u32 s33, s33, 1
    s_cmp_gt_u32 s33, 20000
    s_waitcnt vmcnt(0)
    v_max_u32 v0, v80, v82
    v_cmp_eq_u32 vcc, -1, v0
    s_cbranch_scc1 C_main_kernel_199
    s_cbranch_vccnz R_main_kernel_198
    s_branch C_main_kernel_199
L_hopb_main_kernel:
    s_setpc_b64 s[20:21]
L_code_end:
L_tail_sc:
    s_nop 7
    s_waitcnt vmcnt(0)
L_xt_poll:
    v_mbcnt_lo_u32_b32 v133, -1, 0
    v_and_b32 v133, 31, v133
    v_lshlrev_b32 v133, 7, v133
    buffer_load_dword v133, v133, s[4:7], s35 offen sc1
    s_add_u32 s33, s33, 1
    s_cmp_gt_u32 s33, 20000
    s_waitcnt vmcnt(0)
    v_cmp_eq_u32 vcc, -1, v133
    s_cbranch_scc1 L_xt_done
    s_cbranch_vccnz L_xt_poll
L_xt_done:
    buffer_store_dwordx4 v[72:75], v2, s[4:7], s55 offen sc1
    ds_read_b128 v[120:123], v10 offset:0
    ds_read_b128 v[124:127], v10 offset:4096
    ds_read_b128 v[128:131], v10 offset:8192
    ds_read_b128 v[132:135], v10 offset:12288
    ds_read_b128 v[136:139], v10 offset:16384
    ds_read_b128 v[140:143], v10 offset:20480
    v_pk_mul_f32 v[104:105], v[104:105], v[46:47] op_sel_hi:[1,0]
    v_pk_mul_f32 v[106:107], v[106:107], v[46:47] op_sel_hi:[1,0]
    v_pk_mul_f32 v[108:109], v[108:109], v[46:47] op_sel_hi:[1,0]
    v_pk_mul_f32 v[110:111], v[110:111], v[46:47] op_sel_hi:[1,0]
    v_cvt_pk_bf16_f32 v80, v104, v105
    v_cvt_pk_bf16_f32 v81, v106, v107
    v_cvt_pk_bf16_f32 v82, v108, v109
    v_cvt_pk_bf16_f32 v83, v110, v111
    v_min_u32 v80, s32, v80
    buffer_store_dwordx4 v[80:83], v2, s[4:7], s56 offen sc1
    buffer_load_dwordx4 v[16:19], v3, s[4:7], s57 offen offset:0 sc1
    buffer_load_dwordx4 v[20:23], v3, s[4:7], s57 offen offset:1024 sc1
    ds_read_b128 v[96:99], v10 offset:24576
    ds_read_b128 v[100:103], v10 offset:28672
    ds_read_b128 v[116:119], v10 offset:32768
    ds_read_b128 v[104:107], v10 offset:36864
    ds_read_b128 v[108:111], v10 offset:40960
    ds_read_b128 v[112:115], v10 offset:45056
    v_add_u32 v8, 0x10000, v3
    s_waitcnt lgkmcnt(10)
    v_mfma_f32_16x16x32_bf16 a[168:171], v[120:123], a[172:175], 0
    ds_read_b128 v[120:123], v10 offset:49152
    buffer_load_dwordx4 v[24:27], v3, s[4:7], s57 offen offset:2048 sc1
    v_accvgpr_read_b32 v81, a160
    v_mfma_f32_16x16x32_bf16 a[168:171], v[124:127], a[172:175], a[168:171]
    s_waitcnt lgkmcnt(9)
    ds_read_b128 v[124:127], v10 offset:53248
    v_accvgpr_read_b32 v83, a161
    v_mfma_f32_16x16x32_bf16 a[168:171], v[128:131], a[172:175], a[168:171]
    ds_read_b128 v[128:131], v10 offset:57344
    buffer_load_dwordx4 v[28:31], v3, s[4:7], s57 offen offset:3072 sc1
    v_accvgpr_read_b32 v85, a162
    v_accvgpr_read_b32 v87, a163
    v_mfma_f32_16x16x32_bf16 a[168:171], v[132:135], a[172:175], a[168:171]
    s_waitcnt lgkmcnt(9)
    ds_read_b128 v[132:135], v10 offset:61440
    v_accvgpr_read_b32 v89, a164
    v_mfma_f32_16x16x32_bf16 a[168:171], v[136:139], a[172:175], a[168:171]
    ds_read_b128 v[136:139], v3 offset:0
    buffer_load_dwordx4 v[32:35], v4, s[4:7], s57 offen offset:0 sc1
    v_accvgpr_read_b32 v91, a165
    v_mfma_f32_16x16x32_bf16 a[168:171], v[140:143], a[172:175], a[168:171]
    s_waitcnt lgkmcnt(9)
    ds_read_b128 v[140:143], v3 offset:1024
    v_accvgpr_read_b32 v93, a166
    v_mfma_f32_16x16x32_bf16 a[168:171], v[96:99], a[172:175], a[168:171]
    ds_read_b128 v[96:99], v3 offset:2048
    buffer_load_dwordx4 v[36:39], v4, s[4:7], s57 offen offset:1024 sc1
    v_accvgpr_read_b32 v95, a167
    v_mfma_f32_16x16x32_bf16 a[168:171], v[100:103], a[172:175], a[168:171]
    s_waitcnt lgkmcnt(9)
    ds_read_b128 v[100:103], v3 offset:3072
    v_lshlrev_b32 v80, 16, v81
    v_and_b32 v81, 0xffff0000, v81
    v_mfma_f32_16x16x32_bf16 a[168:171], v[116:119], a[172:175], a[168:171]
    ds_read_b128 v[116:119], v3 offset:4096
    v_lshlrev_b32 v82, 16, v83
    v_and_b32 v83, 0xffff0000, v83
    v_mfma_f32_16x16x32_bf16 a[168:171], v[104:107], a[172:175], a[168:171]
    s_waitcnt lgkmcnt(9)
    ds_read_b128 v[104:107], v3 offset:5120
    v_lshlrev_b32 v84, 16, v85
    v_mfma_f32_16x16x32_bf16 a[168:171], v[108:111], a[172:175], a[168:171]
    ds_read_b128 v[108:111], v3 offset:6144
    v_and_b32 v85, 0xffff0000, v85
    v_lshlrev_b32 v86, 16, v87
    v_mfma_f32_16x16x32_bf16 a[168:171], v[112:115], a[172:175], a[168:171]
    s_waitcnt lgkmcnt(9)
    ds_read_b128 v[112:115], v3 offset:7168
    v_and_b32 v87, 0xffff0000, v87
    v_mfma_f32_16x16x32_bf16 a[168:171], v[120:123], a[172:175], a[168:171]
    ds_read_b128 v[120:123], v3 offset:8192
    v_lshlrev_b32 v88, 16, v89
    v_and_b32 v89, 0xffff0000, v89
    v_mfma_f32_16x16x32_bf16 a[168:171], v[124:127], a[172:175], a[168:171]
    s_waitcnt lgkmcnt(9)
    ds_read_b128 v[124:127], v3 offset:9216
    v_lshlrev_b32 v90, 16, v91
    v_and_b32 v91, 0xffff0000, v91
    v_mfma_f32_16x16x32_bf16 a[168:171], v[128:131], a[172:175], a[168:171]
    ds_read_b128 v[128:131], v3 offset:10240
    v_lshlrev_b32 v92, 16, v93
    v_and_b32 v93, 0xffff0000, v93
    v_mfma_f32_16x16x32_bf16 a[168:171], v[132:135], a[172:175], a[168:171]
    ds_read_b128 v[132:135], v3 offset:11264
    v_lshlrev_b32 v94, 16, v95
    v_and_b32 v95, 0xffff0000, v95
    s_barrier
    s_nop 3
    ds_write_b128 v11, a[168:171]
    s_waitcnt vmcnt(4)
    v_max_u32 v0, v16, v20
    v_cmp_eq_u32 vcc, -1, v0
    s_cbranch_vccz C_main_kernel_218
R_main_kernel_217:
    buffer_load_dwordx4 v[16:19], v3, s[4:7], s57 offen offset:0 sc1
    buffer_load_dwordx4 v[20:23], v3, s[4:7], s57 offen offset:1024 sc1
    buffer_load_dwordx4 v[24:27], v3, s[4:7], s57 offen offset:2048 sc1
    buffer_load_dwordx4 v[28:31], v3, s[4:7], s57 offen offset:3072 sc1
    buffer_load_dwordx4 v[32:35], v4, s[4:7], s57 offen offset:0 sc1
    buffer_load_dwordx4 v[36:39], v4, s[4:7], s57 offen offset:1024 sc1
    s_add_u32 s33, s33, 1
    s_cmp_gt_u32 s33, 20000
    s_waitcnt vmcnt(4)
    v_max_u32 v0, v16, v20
    v_cmp_eq_u32 vcc, -1, v0
    s_cbranch_scc1 C_main_kernel_218
    s_cbranch_vccnz R_main_kernel_217
C_main_kernel_218:
    s_waitcnt lgkmcnt(11)
    v_mfma_f32_16x16x32_bf16 v[80:83], v[136:139], v[16:19], v[80:83]
    ds_read_b128 v[136:139], v3 offset:12288
    buffer_load_dwordx4 v[40:43], v4, s[4:7], s57 offen offset:2048 sc1
    v_mfma_f32_16x16x32_bf16 v[84:87], v[140:143], v[16:19], v[84:87]
    s_waitcnt lgkmcnt(8)
    ds_read_b128 v[140:143], v3 offset:13312
    v_mfma_f32_16x16x32_bf16 v[88:91], v[96:99], v[16:19], v[88:91]
    ds_read_b128 v[96:99], v3 offset:14336
    buffer_load_dwordx4 v[44:47], v4, s[4:7], s57 offen offset:3072 sc1
    v_mfma_f32_16x16x32_bf16 v[92:95], v[100:103], v[16:19], v[92:95]
    ds_read_b128 v[100:103], v3 offset:15360
    ds_write_b128 v15, a[0:3] offset:0
    v_mfma_f32_16x16x32_bf16 v[80:83], v[116:119], v[20:23], v[80:83]
    s_waitcnt vmcnt(4)
    ds_read_b128 v[116:119], v3 offset:16384
    v_max_u32 v0, v24, v28
    v_mfma_f32_16x16x32_bf16 v[84:87], v[104:107], v[20:23], v[84:87]
    s_waitcnt lgkmcnt(9)
    ds_read_b128 v[104:107], v3 offset:17408
    v_cmp_eq_u32 vcc, -1, v0
    v_mfma_f32_16x16x32_bf16 v[88:91], v[108:111], v[20:23], v[88:91]
    ds_read_b128 v[108:111], v3 offset:18432
    v_mfma_f32_16x16x32_bf16 v[92:95], v[112:115], v[20:23], v[92:95]
    s_cbranch_vccnz R_main_kernel_219
C_main_kernel_220:
    ds_read_b128 v[112:115], v3 offset:19456
    v_mfma_f32_16x16x32_bf16 v[80:83], v[120:123], v[24:27], v[80:83]
    ds_read_b128 v[120:123], v3 offset:20480
    buffer_load_dwordx4 v[48:51], v5, s[4:7], s57 offen offset:0 sc1
    v_mfma_f32_16x16x32_bf16 v[84:87], v[124:127], v[24:27], v[84:87]
    s_waitcnt lgkmcnt(8)
    ds_read_b128 v[124:127], v3 offset:21504
    v_mfma_f32_16x16x32_bf16 v[88:91], v[128:131], v[24:27], v[88:91]
    ds_read_b128 v[128:131], v3 offset:22528
    buffer_load_dwordx4 v[52:55], v5, s[4:7], s57 offen offset:1024 sc1
    v_mfma_f32_16x16x32_bf16 v[92:95], v[132:135], v[24:27], v[92:95]
    ds_read_b128 v[132:135], v3 offset:23552
    ds_write_b128 v15, a[4:7] offset:1024
    v_mfma_f32_16x16x32_bf16 v[80:83], v[136:139], v[28:31], v[80:83]
    s_waitcnt vmcnt(4)
    ds_read_b128 v[136:139], v3 offset:24576
    v_max_u32 v0, v32, v36
    v_mfma_f32_16x16x32_bf16 v[84:87], v[140:143], v[28:31], v[84:87]
    s_waitcnt lgkmcnt(8)
    ds_read_b128 v[140:143], v3 offset:25600
    v_cmp_eq_u32 vcc, -1, v0
    v_mfma_f32_16x16x32_bf16 v[88:91], v[96:99], v[28:31], v[88:91]
    ds_read_b128 v[96:99], v3 offset:26624
    v_mfma_f32_16x16x32_bf16 v[92:95], v[100:103], v[28:31], v[92:95]
    s_cbranch_vccnz R_main_kernel_221
C_main_kernel_222:
    ds_read_b128 v[100:103], v3 offset:27648
    v_mfma_f32_16x16x32_bf16 v[80:83], v[116:119], v[32:35], v[80:83]
    ds_read_b128 v[116:119], v3 offset:28672
    buffer_load_dwordx4 v[56:59], v5, s[4:7], s57 offen offset:2048 sc1
    v_mfma_f32_16x16x32_bf16 v[84:87], v[104:107], v[32:35], v[84:87]
    s_waitcnt lgkmcnt(8)
    ds_read_b128 v[104:107], v3 offset:29696
    v_mfma_f32_16x16x32_bf16 v[88:91], v[108:111], v[32:35], v[88:91]
    ds_read_b128 v[108:111], v3 offset:30720
    buffer_load_dwordx4 v[60:63], v5, s[4:7], s57 offen offset:3072 sc1
    v_mfma_f32_16x16x32_bf16 v[92:95], v[112:115], v[32:35], v[92:95]
    ds_read_b128 v[112:115], v3 offset:31744
    ds_write_b128 v15, a[8:11] offset:2048
    v_mfma_f32_16x16x32_bf16 v[80:83], v[120:123], v[36:39], v[80:83]
    s_waitcnt vmcnt(4)
    ds_read_b128 v[120:123], v3 offset:32768
    v_max_u32 v0, v40, v44
    v_mfma_f32_16x16x32_bf16 v[84:87], v[124:127], v[36:39], v[84:87]
    s_waitcnt lgkmcnt(8)
    ds_read_b128 v[124:127], v3 offset:33792
    v_cmp_eq_u32 vcc, -1, v0
    v_mfma_f32_16x16x32_bf16 v[88:91], v[128:131], v[36:39], v[88:91]
    ds_read_b128 v[128:131], v3 offset:34816
    v_mfma_f32_16x16x32_bf16 v[92:95], v[132:135], v[36:39], v[92:95]
    s_cbranch_vccnz R_main_kernel_223
C_main_kernel_224:
    ds_read_b128 v[132:135], v3 offset:35840
    v_mfma_f32_16x16x32_bf16 v[80:83], v[136:139], v[40:43], v[80:83]
    ds_read_b128 v[136:139], v3 offset:36864
    buffer_load_dwordx4 v[64:67], v6, s[4:7], s57 offen offset:0 sc1
    v_mfma_f32_16x16x32_bf16 v[84:87], v[140:143], v[40:43], v[84:87]
    s_waitcnt lgkmcnt(8)
    ds_read_b128 v[140:143], v3 offset:37888
    v_mfma_f32_16x16x32_bf16 v[88:91], v[96:99], v[40:43], v[88:91]
    ds_read_b128 v[96:99], v3 offset:38912
    buffer_load_dwordx4 v[68:71], v6, s[4:7], s57 offen offset:1024 sc1
    v_mfma_f32_16x16x32_bf16 v[92:95], v[100:103], v[40:43], v[92:95]
    ds_read_b128 v[100:103], v3 offset:39936
    ds_write_b128 v15, a[12:15] offset:3072
    v_mfma_f32_16x16x32_bf16 v[80:83], v[116:119], v[44:47], v[80:83]
    s_waitcnt vmcnt(4)
    ds_read_b128 v[116:119], v3 offset:40960
    v_max_u32 v0, v48, v52
    v_mfma_f32_16x16x32_bf16 v[84:87], v[104:107], v[44:47], v[84:87]
    s_waitcnt lgkmcnt(8)
    ds_read_b128 v[104:107], v3 offset:41984
    v_cmp_eq_u32 vcc, -1, v0
    v_mfma_f32_16x16x32_bf16 v[88:91], v[108:111], v[44:47], v[88:91]
    ds_read_b128 v[108:111], v3 offset:43008
    v_mfma_f32_16x16x32_bf16 v[92:95], v[112:115], v[44:47], v[92:95]
    s_cbranch_vccnz R_main_kernel_225
C_main_kernel_226:
    ds_read_b128 v[112:115], v3 offset:44032
    v_lshrrev_b32 v9, 5, v1
    v_mfma_f32_16x16x32_bf16 v[80:83], v[120:123], v[48:51], v[80:83]
    ds_read_b128 v[120:123], v3 offset:45056
    buffer_load_dwordx4 v[72:75], v6, s[4:7], s57 offen offset:2048 sc1
    v_mfma_f32_16x16x32_bf16 v[84:87], v[124:127], v[48:51], v[84:87]
    s_waitcnt lgkmcnt(8)
    ds_read_b128 v[124:127], v3 offset:46080
    v_lshlrev_b32 v9, 31, v9
    v_mfma_f32_16x16x32_bf16 v[88:91], v[128:131], v[48:51], v[88:91]
    ds_read_b128 v[128:131], v3 offset:47104
    buffer_load_dwordx4 v[76:79], v6, s[4:7], s57 offen offset:3072 sc1
    v_mfma_f32_16x16x32_bf16 v[92:95], v[132:135], v[48:51], v[92:95]
    ds_read_b128 v[132:135], v3 offset:48128
    ds_write_b128 v15, a[16:19] offset:4096
    v_mfma_f32_16x16x32_bf16 v[80:83], v[136:139], v[52:55], v[80:83]
    s_waitcnt vmcnt(4)
    ds_read_b128 v[136:139], v3 offset:49152
    v_max_u32 v0, v56, v60
    v_mfma_f32_16x16x32_bf16 v[84:87], v[140:143], v[52:55], v[84:87]
    s_waitcnt lgkmcnt(8)
    ds_read_b128 v[140:143], v3 offset:50176
    v_cmp_eq_u32 vcc, -1, v0
    v_mfma_f32_16x16x32_bf16 v[88:91], v[96:99], v[52:55], v[88:91]
    ds_read_b128 v[96:99], v3 offset:51200
    v_lshl_add_u32 v9, v12, 4, v9
    v_mfma_f32_16x16x32_bf16 v[92:95], v[100:103], v[52:55], v[92:95]
    s_cbranch_vccnz R_main_kernel_227
C_main_kernel_228:
    ds_read_b128 v[100:103], v3 offset:52224
    v_lshl_add_u32 v9, v13, 2, v9
    v_mfma_f32_16x16x32_bf16 v[80:83], v[116:119], v[56:59], v[80:83]
    ds_read_b128 v[116:119], v3 offset:53248
    v_add_u32 v9, s67, v9
    v_mfma_f32_16x16x32_bf16 v[84:87], v[104:107], v[56:59], v[84:87]
    s_waitcnt lgkmcnt(8)
    ds_read_b128 v[104:107], v3 offset:54272
    v_mov_b32 v14, 0x4000
    v_mfma_f32_16x16x32_bf16 v[88:91], v[108:111], v[56:59], v[88:91]
    ds_read_b128 v[108:111], v3 offset:55296
    v_add_u32 v2, -1, v12
    v_mfma_f32_16x16x32_bf16 v[92:95], v[112:115], v[56:59], v[92:95]
    ds_read_b128 v[112:115], v3 offset:56320
    ds_write_b128 v15, a[20:23] offset:5120
    v_mfma_f32_16x16x32_bf16 v[80:83], v[120:123], v[60:63], v[80:83]
    s_waitcnt vmcnt(2)
    ds_read_b128 v[120:123], v3 offset:57344
    v_max_u32 v0, v64, v68
    v_mfma_f32_16x16x32_bf16 v[84:87], v[124:127], v[60:63], v[84:87]
    s_waitcnt lgkmcnt(8)
    ds_read_b128 v[124:127], v3 offset:58368
    v_cmp_eq_u32 vcc, -1, v0
    v_mfma_f32_16x16x32_bf16 v[88:91], v[128:131], v[60:63], v[88:91]
    ds_read_b128 v[128:131], v3 offset:59392
    v_bfe_i32 v2, v2, 4, 1
    v_mfma_f32_16x16x32_bf16 v[92:95], v[132:135], v[60:63], v[92:95]
    s_cbranch_vccnz R_main_kernel_229
C_main_kernel_230:
    ds_read_b128 v[132:135], v3 offset:60416
    v_bfi_b32 v2, v2, s64, v14
    v_mfma_f32_16x16x32_bf16 v[80:83], v[136:139], v[64:67], v[80:83]
    ds_read_b128 v[136:139], v3 offset:61440
    v_add_u32 v2, v3, v2
    v_mfma_f32_16x16x32_bf16 v[84:87], v[140:143], v[64:67], v[84:87]
    s_waitcnt lgkmcnt(8)
    ds_read_b128 v[140:143], v3 offset:62464
    v_add_u32 v10, 1, v12
    v_mfma_f32_16x16x32_bf16 v[88:91], v[96:99], v[64:67], v[88:91]
    ds_read_b128 v[96:99], v3 offset:63488
    v_bfe_i32 v10, v10, 4, 1
    v_mfma_f32_16x16x32_bf16 v[92:95], v[100:103], v[64:67], v[92:95]
    ds_read_b128 v[100:103], v3 offset:64512
    v_bfi_b32 v10, v10, s65, v14
    v_mfma_f32_16x16x32_bf16 v[80:83], v[116:119], v[68:71], v[80:83]
    s_waitcnt vmcnt(0)
    ds_read_b128 a[0:3], v8 offset:0
    v_max_u32 v0, v72, v76
    v_mfma_f32_16x16x32_bf16 v[84:87], v[104:107], v[68:71], v[84:87]
    s_waitcnt lgkmcnt(7)
    ds_read_b128 a[4:7], v8 offset:1024
    v_cmp_eq_u32 vcc, -1, v0
    v_mfma_f32_16x16x32_bf16 v[88:91], v[108:111], v[68:71], v[88:91]
    ds_read_b128 a[8:11], v8 offset:2048
    v_add_u32 v10, v4, v10
    v_mfma_f32_16x16x32_bf16 v[92:95], v[112:115], v[68:71], v[92:95]
    s_cbranch_vccnz R_main_kernel_231
C_main_kernel_232:
    ds_read_b128 a[12:15], v8 offset:3072
    v_add_u32 v11, -2, v12
    v_mfma_f32_16x16x32_bf16 v[80:83], v[120:123], v[72:75], v[80:83]
    ds_read_b128 a[16:19], v8 offset:4096
    v_bfe_i32 v11, v11, 4, 1
    v_mfma_f32_16x16x32_bf16 v[84:87], v[124:127], v[72:75], v[84:87]
    s_waitcnt lgkmcnt(7)
    ds_read_b128 a[20:23], v8 offset:5120
    v_bfi_b32 v11, v11, s64, v14
    v_mfma_f32_16x16x32_bf16 v[88:91], v[128:131], v[72:75], v[88:91]
    ds_read_b128 v[116:119], v8 offset:6144
    v_add_u32 v11, v5, v11
    v_mfma_f32_16x16x32_bf16 v[92:95], v[132:135], v[72:75], v[92:95]
    ds_read_b128 v[120:123], v8 offset:7168
    v_add_u32 v15, 2, v12
    v_mfma_f32_16x16x32_bf16 v[80:83], v[136:139], v[76:79], v[80:83]
    ds_read_b128 v[124:127], v8 offset:8192
    v_bfe_i32 v15, v15, 4, 1
    v_mfma_f32_16x16x32_bf16 v[84:87], v[140:143], v[76:79], v[84:87]
    s_waitcnt lgkmcnt(9)
    ds_read_b128 v[128:131], v8 offset:9216
    v_bfi_b32 v15, v15, s65, v14
    v_mfma_f32_16x16x32_bf16 v[88:91], v[96:99], v[76:79], v[88:91]
    v_add_u32 v15, v6, v15
    v_mfma_f32_16x16x32_bf16 v[92:95], v[100:103], v[76:79], v[92:95]
    v_cvt_pk_bf16_f32 v48, v80, v81
    v_cvt_pk_bf16_f32 v49, v82, v83
    v_cvt_pk_bf16_f32 v50, v84, v85
    v_cvt_pk_bf16_f32 v51, v86, v87
    v_min_u32 v48, s32, v48
    buffer_store_dwordx4 v[48:51], v3, s[4:7], s59 offen offset:0 sc1
    v_cvt_pk_bf16_f32 v52, v88, v89
    v_cvt_pk_bf16_f32 v53, v90, v91
    v_cvt_pk_bf16_f32 v54, v92, v93
    v_cvt_pk_bf16_f32 v55, v94, v95
    v_min_u32 v52, s32, v52
    buffer_store_dwordx4 v[52:55], v3, s[4:7], s59 offen offset:1024 sc1
    v_dot2_f32_bf16 v132, v48, s31, 0
    v_dot2_f32_bf16 v133, v48, v48, 0
    v_dot2_f32_bf16 v132, v49, s31, v132
    v_dot2_f32_bf16 v133, v49, v49, v133
    v_dot2_f32_bf16 v132, v50, s31, v132
    v_dot2_f32_bf16 v133, v50, v50, v133
    v_dot2_f32_bf16 v132, v51, s31, v132
    v_dot2_f32_bf16 v133, v51, v51, v133
    v_dot2_f32_bf16 v132, v52, s31, v132
    v_dot2_f32_bf16 v133, v52, v52, v133
    v_dot2_f32_bf16 v132, v53, s31, v132
    v_dot2_f32_bf16 v133, v53, v53, v133
    v_dot2_f32_bf16 v132, v54, s31, v132
    v_dot2_f32_bf16 v133, v54, v54, v133
    v_dot2_f32_bf16 v132, v55, s31, v132
    v_dot2_f32_bf16 v133, v55, v55, v133
    s_nop 2
    v_permlane16_swap_b32 v132, v133
    v_add_f32 v132, v132, v133
    v_mov_b32 v133, v132
    s_nop 1
    v_permlane32_swap_b32 v132, v133
    v_add_f32 v132, v132, v133
    v_min_u32 v132, s32, v132
    buffer_store_dword v132, v9, s[4:7], s41 offen sc1
    v_add_u32 v132, s45, v3
    v_lshlrev_b32 v133, 4, v13
    v_add_u32 v133, 0x26900, v133
    v_mfma_f32_16x16x32_bf16 a[160:163], v[144:147], a[172:175], 0
    buffer_load_dwordx4 v[16:19], v3, s[4:7], s58 offen offset:0 sc1
    v_mfma_f32_16x16x32_bf16 a[160:163], v[148:151], a[172:175], a[160:163]
    v_mfma_f32_16x16x32_bf16 a[160:163], v[152:155], a[172:175], a[160:163]
    buffer_load_dwordx4 v[20:23], v3, s[4:7], s58 offen offset:1024 sc1
    v_mfma_f32_16x16x32_bf16 a[160:163], v[156:159], a[172:175], a[160:163]
    s_waitcnt lgkmcnt(0)
    s_barrier
    v_mfma_f32_16x16x32_bf16 a[160:163], v[160:163], a[172:175], a[160:163]
    buffer_load_dwordx4 v[24:27], v3, s[4:7], s58 offen offset:2048 sc1
    v_mfma_f32_16x16x32_bf16 a[160:163], v[164:167], a[172:175], a[160:163]
    v_mfma_f32_16x16x32_bf16 a[160:163], v[168:171], a[172:175], a[160:163]
    buffer_load_dwordx4 v[28:31], v3, s[4:7], s58 offen offset:3072 sc1
    v_mfma_f32_16x16x32_bf16 a[160:163], v[172:175], a[172:175], a[160:163]
    v_mfma_f32_16x16x32_bf16 a[160:163], v[176:179], a[172:175], a[160:163]
    v_mfma_f32_16x16x32_bf16 a[160:163], v[180:183], a[172:175], a[160:163]
    buffer_load_dwordx4 v[32:35], v4, s[4:7], s58 offen offset:0 sc1
    v_mfma_f32_16x16x32_bf16 a[160:163], v[184:187], a[172:175], a[160:163]
    v_mfma_f32_16x16x32_bf16 a[160:163], v[188:191], a[172:175], a[160:163]
    buffer_load_dwordx4 v[36:39], v4, s[4:7], s58 offen offset:1024 sc1
    v_mfma_f32_16x16x32_bf16 a[160:163], v[192:195], a[172:175], a[160:163]
    v_mfma_f32_16x16x32_bf16 a[160:163], v[196:199], a[172:175], a[160:163]
    buffer_load_dwordx4 v[96:99], v3, s[4:7], s41 offen sc1
    v_mfma_f32_16x16x32_bf16 a[160:163], v[200:203], a[172:175], a[160:163]
    v_mfma_f32_16x16x32_bf16 a[160:163], v[204:207], a[172:175], a[160:163]
    s_waitcnt vmcnt(5)
    v_max_u32 v0, v16, v20
    v_cmp_eq_u32 vcc, -1, v0
    s_cbranch_vccz C_main_kernel_252
R_main_kernel_251:
    buffer_load_dwordx4 v[16:19], v3, s[4:7], s58 offen offset:0 sc1
    buffer_load_dwordx4 v[20:23], v3, s[4:7], s58 offen offset:1024 sc1
    buffer_load_dwordx4 v[24:27], v3, s[4:7], s58 offen offset:2048 sc1
    buffer_load_dwordx4 v[28:31], v3, s[4:7], s58 offen offset:3072 sc1
    buffer_load_dwordx4 v[32:35], v4, s[4:7], s58 offen offset:0 sc1
    buffer_load_dwordx4 v[36:39], v4, s[4:7], s58 offen offset:1024 sc1
    buffer_load_dwordx4 v[96:99], v3, s[4:7], s41 offen sc1
    s_add_u32 s33, s33, 1
    s_cmp_gt_u32 s33, 20000
    s_waitcnt vmcnt(5)
    v_max_u32 v0, v16, v20
    v_cmp_eq_u32 vcc, -1, v0
    s_cbranch_scc1 C_main_kernel_252
    s_cbranch_vccnz R_main_kernel_251
C_main_kernel_252:
    s_waitcnt lgkmcnt(8)
    v_mfma_f32_16x16x32_bf16 v[100:103], a[0:3], v[16:19], 0
    ds_read_b128 a[0:3], v8 offset:10240
    buffer_load_dwordx4 v[40:43], v4, s[4:7], s58 offen offset:2048 sc1
    v_mfma_f32_16x16x32_bf16 v[104:107], a[4:7], v[16:19], 0
    s_waitcnt lgkmcnt(5)
    ds_read_b128 a[4:7], v8 offset:11264
    v_mov_b32 v142, 0x3727c5ac
    v_mfma_f32_16x16x32_bf16 v[108:111], a[8:11], v[16:19], 0
    ds_read_b128 a[8:11], v8 offset:12288
    buffer_load_dwordx4 v[44:47], v4, s[4:7], s58 offen offset:3072 sc1
    v_mfma_f32_16x16x32_bf16 v[112:115], a[12:15], v[16:19], 0
    ds_read_b128 a[12:15], v8 offset:13312
    v_add_u32 v143, s69, v12
    v_mfma_f32_16x16x32_bf16 v[100:103], a[16:19], v[20:23], v[100:103]
    s_waitcnt vmcnt(5)
    ds_read_b128 a[16:19], v8 offset:14336
    v_max_u32 v0, v24, v28
    v_mfma_f32_16x16x32_bf16 v[104:107], a[20:23], v[20:23], v[104:107]
    s_waitcnt lgkmcnt(5)
    ds_read_b128 a[20:23], v8 offset:15360
    v_cmp_eq_u32 vcc, -1, v0
    v_mfma_f32_16x16x32_bf16 v[108:111], v[116:119], v[20:23], v[108:111]
    ds_read_b128 v[116:119], v8 offset:16384
    v_mfma_f32_16x16x32_bf16 v[112:115], v[120:123], v[20:23], v[112:115]
    s_cbranch_vccnz R_main_kernel_253
C_main_kernel_254:
    ds_read_b128 v[120:123], v8 offset:17408
    v_bfe_i32 v143, v143, 4, 1
    v_mfma_f32_16x16x32_bf16 v[100:103], v[124:127], v[24:27], v[100:103]
    ds_read_b128 v[124:127], v8 offset:18432
    buffer_load_dwordx4 v[48:51], v5, s[4:7], s58 offen offset:0 sc1
    v_mfma_f32_16x16x32_bf16 v[104:107], v[128:131], v[24:27], v[104:107]
    s_waitcnt lgkmcnt(5)
    ds_read_b128 v[128:131], v8 offset:19456
    v_mfma_f32_16x16x32_bf16 v[108:111], a[0:3], v[24:27], v[108:111]
    ds_read_b128 a[0:3], v8 offset:20480
    buffer_load_dwordx4 v[52:55], v5, s[4:7], s58 offen offset:1024 sc1
    v_mfma_f32_16x16x32_bf16 v[112:115], a[4:7], v[24:27], v[112:115]
    ds_read_b128 a[4:7], v8 offset:21504
    v_bfi_b32 v14, v143, s70, v14
    v_mfma_f32_16x16x32_bf16 v[100:103], a[8:11], v[28:31], v[100:103]
    s_waitcnt vmcnt(5)
    ds_read_b128 a[8:11], v8 offset:22528
    v_max_u32 v0, v32, v36
    v_mfma_f32_16x16x32_bf16 v[104:107], a[12:15], v[28:31], v[104:107]
    s_waitcnt lgkmcnt(5)
    ds_read_b128 a[12:15], v8 offset:23552
    v_cmp_eq_u32 vcc, -1, v0
    v_mfma_f32_16x16x32_bf16 v[108:111], a[16:19], v[28:31], v[108:111]
    ds_read_b128 a[16:19], v8 offset:24576
    v_mfma_f32_16x16x32_bf16 v[112:115], a[20:23], v[28:31], v[112:115]
    s_cbranch_vccnz R_main_kernel_255
C_main_kernel_256:
    ds_read_b128 a[20:23], v8 offset:25600
    v_xor_b32 v143, -1, v143
    v_mfma_f32_16x16x32_bf16 v[100:103], v[116:119], v[32:35], v[100:103]
    ds_read_b128 v[116:119], v8 offset:26624
    buffer_load_dwordx4 v[56:59], v5, s[4:7], s58 offen offset:2048 sc1
    v_mfma_f32_16x16x32_bf16 v[104:107], v[120:123], v[32:35], v[104:107]
    s_waitcnt lgkmcnt(5)
    ds_read_b128 v[120:123], v8 offset:27648
    v_mfma_f32_16x16x32_bf16 v[108:111], v[124:127], v[32:35], v[108:111]
    ds_read_b128 v[124:127], v8 offset:28672
    buffer_load_dwordx4 v[60:63], v5, s[4:7], s58 offen offset:3072 sc1
    v_mfma_f32_16x16x32_bf16 v[112:115], v[128:131], v[32:35], v[112:115]
    ds_read_b128 v[128:131], v8 offset:29696
    v_and_b32 v143, 0x80000000, v143
    v_mfma_f32_16x16x32_bf16 v[100:103], a[0:3], v[36:39], v[100:103]
    s_waitcnt vmcnt(4)
    ds_read_b128 a[0:3], v8 offset:30720
    v_max_u32 v0, v40, v44
    v_mfma_f32_16x16x32_bf16 v[104:107], a[4:7], v[36:39], v[104:107]
    s_waitcnt lgkmcnt(5)
    ds_read_b128 a[4:7], v8 offset:31744
    v_cmp_eq_u32 vcc, -1, v0
    v_mfma_f32_16x16x32_bf16 v[108:111], a[8:11], v[36:39], v[108:111]
    ds_read_b128 a[8:11], v8 offset:32768
    v_mfma_f32_16x16x32_bf16 v[112:115], a[12:15], v[36:39], v[112:115]
    s_cbranch_vccnz R_main_kernel_257
C_main_kernel_258:
    ds_read_b128 a[12:15], v8 offset:33792
    v_add_u32 v143, v143, v3
    v_mfma_f32_16x16x32_bf16 v[100:103], a[16:19], v[40:43], v[100:103]
    ds_read_b128 a[16:19], v8 offset:34816
    buffer_load_dwordx4 v[64:67], v6, s[4:7], s58 offen offset:0 sc1
    v_mfma_f32_16x16x32_bf16 v[104:107], a[20:23], v[40:43], v[104:107]
    s_waitcnt lgkmcnt(5)
    ds_read_b128 a[20:23], v8 offset:35840
    v_mfma_f32_16x16x32_bf16 v[108:111], v[116:119], v[40:43], v[108:111]
    ds_read_b128 v[116:119], v8 offset:36864
    buffer_load_dwordx4 v[68:71], v6, s[4:7], s58 offen offset:1024 sc1
    v_max_u32 v0, v96, v97
    v_mfma_f32_16x16x32_bf16 v[112:115], v[120:123], v[40:43], v[112:115]
    ds_read_b128 v[120:123], v8 offset:37888
    v_max3_u32 v0, v0, v98, v99
    v_mfma_f32_16x16x32_bf16 v[100:103], v[124:127], v[44:47], v[100:103]
    s_waitcnt vmcnt(4)
    ds_read_b128 v[124:127], v8 offset:38912
    v_max3_u32 v0, v0, v48, v52
    v_mfma_f32_16x16x32_bf16 v[104:107], v[128:131], v[44:47], v[104:107]
    s_waitcnt lgkmcnt(5)
    ds_read_b128 v[128:131], v8 offset:39936
    v_cmp_eq_u32 vcc, -1, v0
    v_mfma_f32_16x16x32_bf16 v[108:111], a[0:3], v[44:47], v[108:111]
    ds_read_b128 a[0:3], v8 offset:40960
    v_add_u32 v14, v14, v3
    v_mfma_f32_16x16x32_bf16 v[112:115], a[4:7], v[44:47], v[112:115]
    s_cbranch_vccnz R_main_kernel_259
C_main_kernel_260:
    ds_read_b128 a[4:7], v8 offset:41984
    v_add_f32 v96, v96, v98
    v_add_f32 v97, v97, v99
    v_mfma_f32_16x16x32_bf16 v[100:103], a[8:11], v[48:51], v[100:103]
    ds_read_b128 a[8:11], v8 offset:43008
    buffer_load_dwordx4 v[72:75], v6, s[4:7], s58 offen offset:2048 sc1
    v_mfma_f32_16x16x32_bf16 v[104:107], a[12:15], v[48:51], v[104:107]
    s_waitcnt lgkmcnt(5)
    ds_read_b128 a[12:15], v8 offset:44032
    v_mov_b32 v98, v96
    v_mfma_f32_16x16x32_bf16 v[108:111], a[16:19], v[48:51], v[108:111]
    ds_read_b128 a[16:19], v8 offset:45056
    buffer_load_dwordx4 v[76:79], v6, s[4:7], s58 offen offset:3072 sc1
    v_mfma_f32_16x16x32_bf16 v[112:115], a[20:23], v[48:51], v[112:115]
    ds_read_b128 a[20:23], v8 offset:46080
    v_mov_b32 v99, v97
    v_permlane16_swap_b32 v96, v98
    v_mfma_f32_16x16x32_bf16 v[100:103], v[116:119], v[52:55], v[100:103]
    s_waitcnt vmcnt(4)
    ds_read_b128 v[116:119], v8 offset:47104
    v_max_u32 v0, v56, v60
    v_mfma_f32_16x16x32_bf16 v[104:107], v[120:123], v[52:55], v[104:107]
    s_waitcnt lgkmcnt(5)
    ds_read_b128 v[120:123], v8 offset:48128
    v_cmp_eq_u32 vcc, -1, v0
    v_mfma_f32_16x16x32_bf16 v[108:111], v[124:127], v[52:55], v[108:111]
    ds_read_b128 v[124:127], v8 offset:49152
    v_permlane16_swap_b32 v97, v99
    v_mfma_f32_16x16x32_bf16 v[112:115], v[128:131], v[52:55], v[112:115]
    s_cbranch_vccnz R_main_kernel_261
C_main_kernel_262:
    ds_read_b128 v[128:131], v8 offset:50176
    v_add_f32 v96, v96, v98
    v_add_f32 v97, v97, v99
    v_mfma_f32_16x16x32_bf16 v[100:103], a[0:3], v[56:59], v[100:103]
    ds_read_b128 a[0:3], v8 offset:51200
    v_mov_b32 v98, v96
    v_mfma_f32_16x16x32_bf16 v[104:107], a[4:7], v[56:59], v[104:107]
    s_waitcnt lgkmcnt(5)
    ds_read_b128 a[4:7], v8 offset:52224
    v_mov_b32 v99, v97
    v_mfma_f32_16x16x32_bf16 v[108:111], a[8:11], v[56:59], v[108:111]
    ds_read_b128 a[8:11], v8 offset:53248
    v_permlane32_swap_b32 v96, v98
    v_permlane32_swap_b32 v97, v99
    v_mfma_f32_16x16x32_bf16 v[112:115], a[12:15], v[56:59], v[112:115]
    ds_read_b128 a[12:15], v8 offset:54272
    v_add_f32 v96, v96, v98
    v_mfma_f32_16x16x32_bf16 v[100:103], a[16:19], v[60:63], v[100:103]
    s_waitcnt vmcnt(2)
    ds_read_b128 a[16:19], v8 offset:55296
    v_max_u32 v0, v64, v68
    v_mfma_f32_16x16x32_bf16 v[104:107], a[20:23], v[60:63], v[104:107]
    s_waitcnt lgkmcnt(5)
    ds_read_b128 a[20:23], v8 offset:56320
    v_cmp_eq_u32 vcc, -1, v0
    v_mfma_f32_16x16x32_bf16 v[108:111], v[116:119], v[60:63], v[108:111]
    ds_read_b128 v[116:119], v8 offset:57344
    v_add_f32 v97, v97, v99
    v_mul_f32 v134, 0xbb000000, v96
    v_mfma_f32_16x16x32_bf16 v[112:115], v[120:123], v[60:63], v[112:115]
    s_cbranch_vccnz R_main_kernel_263
C_main_kernel_264:
    ds_read_b128 v[120:123], v8 offset:58368
    v_mul_f32 v97, 0x3b000000, v97
    v_mfma_f32_16x16x32_bf16 v[100:103], v[124:127], v[64:67], v[100:103]
    ds_read_b128 v[124:127], v8 offset:59392
    v_fma_f32 v97, -v134, v134, v97
    v_max_f32 v97, 0, v97
    v_mfma_f32_16x16x32_bf16 v[104:107], v[128:131], v[64:67], v[104:107]
    s_waitcnt lgkmcnt(5)
    ds_read_b128 v[128:131], v8 offset:60416
    v_add_f32 v140, 0x3727c5ac, v97
    v_mfma_f32_16x16x32_bf16 v[108:111], a[0:3], v[64:67], v[108:111]
    ds_read_b128 a[0:3], v8 offset:61440
    v_rsq_f32 v138, v140
    v_mfma_f32_16x16x32_bf16 v[112:115], a[4:7], v[64:67], v[112:115]
    ds_read_b128 a[4:7], v8 offset:62464
    v_mul_f32 v140, v138, v138
    v_fma_f32 v140, v140, v97, v142
    v_mfma_f32_16x16x32_bf16 v[100:103], a[8:11], v[68:71], v[100:103]
    s_waitcnt vmcnt(0)
    ds_read_b128 a[8:11], v8 offset:63488
    v_max_u32 v0, v72, v76
    v_mfma_f32_16x16x32_bf16 v[104:107], a[12:15], v[68:71], v[104:107]
    s_waitcnt lgkmcnt(5)
    ds_read_b128 a[12:15], v8 offset:64512
    v_cmp_eq_u32 vcc, -1, v0
    v_mfma_f32_16x16x32_bf16 v[108:111], a[16:19], v[68:71], v[108:111]
    ds_read_b128 a[16:19], v7 offset:0
    v_rsq_f32 v140, v140
    v_mfma_f32_16x16x32_bf16 v[112:115], a[20:23], v[68:71], v[112:115]
    s_cbranch_vccnz R_main_kernel_265
C_main_kernel_266:
    ds_read_b128 a[20:23], v7 offset:1024
    v_mul_f32 v139, v134, v138
    v_mul_f32 v141, v138, v140
    v_mfma_f32_16x16x32_bf16 v[100:103], v[116:119], v[72:75], v[100:103]
    ds_read_b128 v[116:119], v7 offset:2048
    ds_read_b128 v[16:19], v133 offset:0
    v_mfma_f32_16x16x32_bf16 v[104:107], v[120:123], v[72:75], v[104:107]
    s_waitcnt lgkmcnt(6)
    ds_read_b128 v[120:123], v7 offset:3072
    ds_read_b128 v[20:23], v133 offset:64
    v_mfma_f32_16x16x32_bf16 v[108:111], v[124:127], v[72:75], v[108:111]
    ds_read_b128 v[124:127], v7 offset:4096
    ds_read_b128 v[24:27], v133 offset:128
    v_mfma_f32_16x16x32_bf16 v[112:115], v[128:131], v[72:75], v[112:115]
    ds_read_b128 v[128:131], v7 offset:5120
    ds_read_b128 v[28:31], v133 offset:192
    v_mfma_f32_16x16x32_bf16 v[100:103], a[0:3], v[76:79], v[100:103]
    ds_read_b128 a[0:3], v7 offset:6144
    v_rcp_f32 v135, v141
    v_mfma_f32_16x16x32_bf16 v[104:107], a[4:7], v[76:79], v[104:107]
    s_waitcnt lgkmcnt(11)
    ds_read_b128 a[4:7], v7 offset:7168
    v_mul_f32 v136, v141, v141
    v_mul_f32 v137, 0xc0135761, v141
    v_mfma_f32_16x16x32_bf16 v[108:111], a[8:11], v[76:79], v[108:111]
    ds_read_b128 a[8:11], v7 offset:8192
    v_mul_f32 v136, v136, v141
    v_mfma_f32_16x16x32_bf16 v[112:115], a[12:15], v[76:79], v[112:115]
    ds_read_b128 a[12:15], v7 offset:9216
    v_mul_f32 v136, 0xbdd2d3e8, v136
    s_waitcnt lgkmcnt(4)
    s_cmp_lg_u32 s66, 0
    v_pk_fma_f32 v[100:101], v[16:17], v[134:135], v[100:101] op_sel_hi:[1,0,1]
    v_pk_fma_f32 v[102:103], v[18:19], v[134:135], v[102:103] op_sel_hi:[1,0,1]
    v_pk_fma_f32 v[104:105], v[20:21], v[134:135], v[104:105] op_sel_hi:[1,0,1]
    v_pk_fma_f32 v[106:107], v[22:23], v[134:135], v[106:107] op_sel_hi:[1,0,1]
    v_pk_mul_f32 v[32:33], v[100:101], v[100:101]
    v_pk_mul_f32 v[34:35], v[102:103], v[102:103]
    v_pk_mul_f32 v[36:37], v[104:105], v[104:105]
    v_pk_mul_f32 v[38:39], v[106:107], v[106:107]
    v_pk_fma_f32 v[32:33], v[32:33], v[136:137], v[136:137] op_sel:[0,0,1] op_sel_hi:[1,0,1]
    v_pk_fma_f32 v[34:35], v[34:35], v[136:137], v[136:137] op_sel:[0,0,1] op_sel_hi:[1,0,1]
    v_pk_fma_f32 v[36:37], v[36:37], v[136:137], v[136:137] op_sel:[0,0,1] op_sel_hi:[1,0,1]
    v_pk_fma_f32 v[38:39], v[38:39], v[136:137], v[136:137] op_sel:[0,0,1] op_sel_hi:[1,0,1]
    v_pk_mul_f32 v[32:33], v[32:33], v[100:101]
    v_pk_mul_f32 v[34:35], v[34:35], v[102:103]
    v_pk_mul_f32 v[36:37], v[36:37], v[104:105]
    v_pk_mul_f32 v[38:39], v[38:39], v[106:107]
    v_exp_f32 v32, v32
    v_exp_f32 v33, v33
    v_exp_f32 v34, v34
    v_exp_f32 v35, v35
    v_exp_f32 v36, v36
    v_exp_f32 v37, v37
    v_exp_f32 v38, v38
    v_exp_f32 v39, v39
    v_pk_fma_f32 v[32:33], v[32:33], v[134:135], v[134:135] op_sel:[0,1,1] op_sel_hi:[1,1,1]
    v_pk_fma_f32 v[34:35], v[34:35], v[134:135], v[134:135] op_sel:[0,1,1] op_sel_hi:[1,1,1]
    v_pk_fma_f32 v[36:37], v[36:37], v[134:135], v[134:135] op_sel:[0,1,1] op_sel_hi:[1,1,1]
    v_pk_fma_f32 v[38:39], v[38:39], v[134:135], v[134:135] op_sel:[0,1,1] op_sel_hi:[1,1,1]
    v_rcp_f32 v32, v32
    v_rcp_f32 v33, v33
    v_rcp_f32 v34, v34
    v_rcp_f32 v35, v35
    v_rcp_f32 v36, v36
    v_rcp_f32 v37, v37
    v_rcp_f32 v38, v38
    v_rcp_f32 v39, v39
    v_pk_mul_f32 v[100:101], v[100:101], v[32:33]
    v_pk_mul_f32 v[102:103], v[102:103], v[34:35]
    v_pk_mul_f32 v[104:105], v[104:105], v[36:37]
    v_pk_mul_f32 v[106:107], v[106:107], v[38:39]
    v_cvt_pk_bf16_f32 v48, v100, v101
    v_cvt_pk_bf16_f32 v49, v102, v103
    v_cvt_pk_bf16_f32 v50, v104, v105
    v_cvt_pk_bf16_f32 v51, v106, v107
    v_min_u32 v48, s32, v48
    s_cbranch_scc1 M_main_kernel_267
C_main_kernel_268:
    buffer_store_dwordx4 v[48:51], v14, s[4:7], s61 offen offset:0 sc1
    v_pk_fma_f32 v[108:109], v[24:25], v[134:135], v[108:109] op_sel_hi:[1,0,1]
    v_pk_fma_f32 v[110:111], v[26:27], v[134:135], v[110:111] op_sel_hi:[1,0,1]
    v_pk_fma_f32 v[112:113], v[28:29], v[134:135], v[112:113] op_sel_hi:[1,0,1]
    v_pk_fma_f32 v[114:115], v[30:31], v[134:135], v[114:115] op_sel_hi:[1,0,1]
    v_pk_mul_f32 v[40:41], v[108:109], v[108:109]
    v_pk_mul_f32 v[42:43], v[110:111], v[110:111]
    v_pk_mul_f32 v[44:45], v[112:113], v[112:113]
    v_pk_mul_f32 v[46:47], v[114:115], v[114:115]
    v_pk_fma_f32 v[40:41], v[40:41], v[136:137], v[136:137] op_sel:[0,0,1] op_sel_hi:[1,0,1]
    v_pk_fma_f32 v[42:43], v[42:43], v[136:137], v[136:137] op_sel:[0,0,1] op_sel_hi:[1,0,1]
    v_pk_fma_f32 v[44:45], v[44:45], v[136:137], v[136:137] op_sel:[0,0,1] op_sel_hi:[1,0,1]
    v_pk_fma_f32 v[46:47], v[46:47], v[136:137], v[136:137] op_sel:[0,0,1] op_sel_hi:[1,0,1]
    v_pk_mul_f32 v[40:41], v[40:41], v[108:109]
    v_pk_mul_f32 v[42:43], v[42:43], v[110:111]
    v_pk_mul_f32 v[44:45], v[44:45], v[112:113]
    v_pk_mul_f32 v[46:47], v[46:47], v[114:115]
    v_exp_f32 v40, v40
    v_exp_f32 v41, v41
    v_exp_f32 v42, v42
    v_exp_f32 v43, v43
    v_exp_f32 v44, v44
    v_exp_f32 v45, v45
    v_exp_f32 v46, v46
    v_exp_f32 v47, v47
    v_pk_fma_f32 v[40:41], v[40:41], v[134:135], v[134:135] op_sel:[0,1,1] op_sel_hi:[1,1,1]
    v_pk_fma_f32 v[42:43], v[42:43], v[134:135], v[134:135] op_sel:[0,1,1] op_sel_hi:[1,1,1]
    v_pk_fma_f32 v[44:45], v[44:45], v[134:135], v[134:135] op_sel:[0,1,1] op_sel_hi:[1,1,1]
    v_pk_fma_f32 v[46:47], v[46:47], v[134:135], v[134:135] op_sel:[0,1,1] op_sel_hi:[1,1,1]
    v_rcp_f32 v40, v40
    v_rcp_f32 v41, v41
    v_rcp_f32 v42, v42
    v_rcp_f32 v43, v43
    v_rcp_f32 v44, v44
    v_rcp_f32 v45, v45
    v_rcp_f32 v46, v46
    v_rcp_f32 v47, v47
    v_pk_mul_f32 v[108:109], v[108:109], v[40:41]
    v_pk_mul_f32 v[110:111], v[110:111], v[42:43]
    v_pk_mul_f32 v[112:113], v[112:113], v[44:45]
    v_pk_mul_f32 v[114:115], v[114:115], v[46:47]
    v_cvt_pk_bf16_f32 v52, v108, v109
    v_cvt_pk_bf16_f32 v53, v110, v111
    v_cvt_pk_bf16_f32 v54, v112, v113
    v_cvt_pk_bf16_f32 v55, v114, v115
    v_min_u32 v52, s32, v52
    s_cbranch_scc1 M_main_kernel_269
C_main_kernel_270:
    buffer_store_dwordx4 v[52:55], v14, s[4:7], s61 offen offset:1024 sc1
    v_pk_fma_f32 v[100:101], v[80:81], v[138:139], v[138:139] op_sel:[0,0,1] op_sel_hi:[1,0,1]
    v_pk_fma_f32 v[102:103], v[82:83], v[138:139], v[138:139] op_sel:[0,0,1] op_sel_hi:[1,0,1]
    v_pk_fma_f32 v[104:105], v[84:85], v[138:139], v[138:139] op_sel:[0,0,1] op_sel_hi:[1,0,1]
    v_pk_fma_f32 v[106:107], v[86:87], v[138:139], v[138:139] op_sel:[0,0,1] op_sel_hi:[1,0,1]
    v_pk_fma_f32 v[108:109], v[88:89], v[138:139], v[138:139] op_sel:[0,0,1] op_sel_hi:[1,0,1]
    v_pk_fma_f32 v[110:111], v[90:91], v[138:139], v[138:139] op_sel:[0,0,1] op_sel_hi:[1,0,1]
    v_pk_fma_f32 v[112:113], v[92:93], v[138:139], v[138:139] op_sel:[0,0,1] op_sel_hi:[1,0,1]
    v_pk_fma_f32 v[114:115], v[94:95], v[138:139], v[138:139] op_sel:[0,0,1] op_sel_hi:[1,0,1]
    v_mfma_f32_16x16x32_bf16 a[164:167], v[208:211], a[172:175], 0
    ds_write_b128 v132, a[24:27] offset:0
    v_mfma_f32_16x16x32_bf16 a[164:167], v[212:215], a[172:175], a[164:167]
    ds_write_b128 v132, a[28:31] offset:1024
    v_mfma_f32_16x16x32_bf16 a[164:167], v[216:219], a[172:175], a[164:167]
    ds_write_b128 v132, a[32:35] offset:2048
    v_mfma_f32_16x16x32_bf16 a[164:167], v[220:223], a[172:175], a[164:167]
    ds_write_b128 v132, a[36:39] offset:3072
    v_mfma_f32_16x16x32_bf16 a[164:167], v[224:227], a[172:175], a[164:167]
    buffer_load_dwordx4 v[16:19], v2, s[4:7], s60 offen offset:0 sc1
    ds_write_b128 v132, a[40:43] offset:4096
    v_mfma_f32_16x16x32_bf16 a[164:167], v[228:231], a[172:175], a[164:167]
    ds_write_b128 v132, a[44:47] offset:5120
    v_mfma_f32_16x16x32_bf16 a[164:167], v[232:235], a[172:175], a[164:167]
    buffer_load_dwordx4 v[20:23], v2, s[4:7], s60 offen offset:1024 sc1
    ds_write_b128 v132, a[48:51] offset:6144
    v_mfma_f32_16x16x32_bf16 a[164:167], v[236:239], a[172:175], a[164:167]
    ds_write_b128 v132, a[52:55] offset:7168
    v_mfma_f32_16x16x32_bf16 a[164:167], v[240:243], a[172:175], a[164:167]
    buffer_load_dwordx4 v[24:27], v2, s[4:7], s60 offen offset:2048 sc1
    ds_write_b128 v132, a[56:59] offset:8192
    v_mfma_f32_16x16x32_bf16 a[164:167], v[244:247], a[172:175], a[164:167]
    ds_write_b128 v132, a[60:63] offset:9216
    v_mfma_f32_16x16x32_bf16 a[164:167], v[248:251], a[172:175], a[164:167]
    buffer_load_dwordx4 v[28:31], v2, s[4:7], s60 offen offset:3072 sc1
    v_mfma_f32_16x16x32_bf16 a[164:167], v[252:255], a[172:175], a[164:167]
    v_mfma_f32_16x16x32_bf16 a[164:167], a[176:179], a[172:175], a[164:167]
    buffer_load_dwordx4 v[32:35], v10, s[4:7], s60 offen offset:0 sc1
    v_mfma_f32_16x16x32_bf16 a[164:167], a[180:183], a[172:175], a[164:167]
    v_mfma_f32_16x16x32_bf16 a[164:167], a[184:187], a[172:175], a[164:167]
    buffer_load_dwordx4 v[36:39], v10, s[4:7], s60 offen offset:1024 sc1
    v_mfma_f32_16x16x32_bf16 a[164:167], a[188:191], a[172:175], a[164:167]
    s_waitcnt lgkmcnt(0)
    s_barrier
    s_waitcnt vmcnt(4)
    v_max_u32 v0, v16, v20
    v_cmp_eq_u32 vcc, -1, v0
    s_cbranch_vccz C_main_kernel_289
R_main_kernel_288:
    buffer_load_dwordx4 v[16:19], v2, s[4:7], s60 offen offset:0 sc1
    buffer_load_dwordx4 v[20:23], v2, s[4:7], s60 offen offset:1024 sc1
    buffer_load_dwordx4 v[24:27], v2, s[4:7], s60 offen offset:2048 sc1
    buffer_load_dwordx4 v[28:31], v2, s[4:7], s60 offen offset:3072 sc1
    buffer_load_dwordx4 v[32:35], v10, s[4:7], s60 offen offset:0 sc1
    buffer_load_dwordx4 v[36:39], v10, s[4:7], s60 offen offset:1024 sc1
    s_add_u32 s33, s33, 1
    s_cmp_gt_u32 s33, 20000
    s_waitcnt vmcnt(4)
    v_max_u32 v0, v16, v20
    v_cmp_eq_u32 vcc, -1, v0
    s_cbranch_scc1 C_main_kernel_289
    s_cbranch_vccnz R_main_kernel_288
C_main_kernel_289:
    s_waitcnt lgkmcnt(15)
    v_mfma_f32_16x16x32_bf16 v[100:103], a[16:19], v[16:19], v[100:103]
    ds_read_b128 a[16:19], v7 offset:10240
    buffer_load_dwordx4 v[40:43], v10, s[4:7], s60 offen offset:2048 sc1
    v_mfma_f32_16x16x32_bf16 v[104:107], a[20:23], v[16:19], v[104:107]
    s_waitcnt lgkmcnt(15)
    ds_read_b128 a[20:23], v7 offset:11264
    v_mfma_f32_16x16x32_bf16 v[108:111], v[116:119], v[16:19], v[108:111]
    ds_read_b128 v[116:119], v7 offset:12288
    buffer_load_dwordx4 v[44:47], v10, s[4:7], s60 offen offset:3072 sc1
    v_mfma_f32_16x16x32_bf16 v[112:115], v[120:123], v[16:19], v[112:115]
    ds_read_b128 v[120:123], v7 offset:13312
    v_mfma_f32_16x16x32_bf16 v[100:103], v[124:127], v[20:23], v[100:103]
    s_waitcnt vmcnt(4)
    ds_read_b128 v[124:127], v7 offset:14336
    v_max_u32 v0, v24, v28
    v_mfma_f32_16x16x32_bf16 v[104:107], v[128:131], v[20:23], v[104:107]
    s_waitcnt lgkmcnt(15)
    ds_read_b128 v[128:131], v7 offset:15360
    v_cmp_eq_u32 vcc, -1, v0
    v_mfma_f32_16x16x32_bf16 v[108:111], a[0:3], v[20:23], v[108:111]
    ds_read_b128 a[0:3], v7 offset:16384
    v_mfma_f32_16x16x32_bf16 v[112:115], a[4:7], v[20:23], v[112:115]
    s_cbranch_vccnz R_main_kernel_290
C_main_kernel_291:
    ds_read_b128 a[4:7], v7 offset:17408
    v_mfma_f32_16x16x32_bf16 v[100:103], a[8:11], v[24:27], v[100:103]
    ds_read_b128 a[8:11], v7 offset:18432
    buffer_load_dwordx4 v[48:51], v11, s[4:7], s60 offen offset:0 sc1
    v_mfma_f32_16x16x32_bf16 v[104:107], a[12:15], v[24:27], v[104:107]
    s_waitcnt lgkmcnt(5)
    ds_read_b128 a[12:15], v7 offset:19456
    v_mfma_f32_16x16x32_bf16 v[108:111], a[16:19], v[24:27], v[108:111]
    ds_read_b128 a[16:19], v7 offset:20480
    buffer_load_dwordx4 v[52:55], v11, s[4:7], s60 offen offset:1024 sc1
    v_mfma_f32_16x16x32_bf16 v[112:115], a[20:23], v[24:27], v[112:115]
    ds_read_b128 a[20:23], v7 offset:21504
    v_mfma_f32_16x16x32_bf16 v[100:103], v[116:119], v[28:31], v[100:103]
    s_waitcnt vmcnt(4)
    ds_read_b128 v[116:119], v7 offset:22528
    v_max_u32 v0, v32, v36
    v_mfma_f32_16x16x32_bf16 v[104:107], v[120:123], v[28:31], v[104:107]
    s_waitcnt lgkmcnt(5)
    ds_read_b128 v[120:123], v7 offset:23552
    v_cmp_eq_u32 vcc, -1, v0
    v_mfma_f32_16x16x32_bf16 v[108:111], v[124:127], v[28:31], v[108:111]
    ds_read_b128 v[124:127], v3 offset:24576
    v_mfma_f32_16x16x32_bf16 v[112:115], v[128:131], v[28:31], v[112:115]
    s_cbranch_vccnz R_main_kernel_292
C_main_kernel_293:
    ds_read_b128 v[128:131], v3 offset:25600
    v_mfma_f32_16x16x32_bf16 v[100:103], a[0:3], v[32:35], v[100:103]
    ds_read_b128 a[0:3], v3 offset:26624
    buffer_load_dwordx4 v[56:59], v11, s[4:7], s60 offen offset:2048 sc1
    v_mfma_f32_16x16x32_bf16 v[104:107], a[4:7], v[32:35], v[104:107]
    s_waitcnt lgkmcnt(5)
    ds_read_b128 a[4:7], v3 offset:27648
    v_mfma_f32_16x16x32_bf16 v[108:111], a[8:11], v[32:35], v[108:111]
    ds_read_b128 a[8:11], v3 offset:28672
    buffer_load_dwordx4 v[60:63], v11, s[4:7], s60 offen offset:3072 sc1
    v_mfma_f32_16x16x32_bf16 v[112:115], a[12:15], v[32:35], v[112:115]
    ds_read_b128 a[12:15], v3 offset:29696
    v_mfma_f32_16x16x32_bf16 v[100:103], a[16:19], v[36:39], v[100:103]
    s_waitcnt vmcnt(4)
    ds_read_b128 a[16:19], v3 offset:30720
    v_max_u32 v0, v40, v44
    v_mfma_f32_16x16x32_bf16 v[104:107], a[20:23], v[36:39], v[104:107]
    s_waitcnt lgkmcnt(5)
    ds_read_b128 a[20:23], v3 offset:31744
    v_cmp_eq_u32 vcc, -1, v0
    v_mfma_f32_16x16x32_bf16 v[108:111], v[116:119], v[36:39], v[108:111]
    ds_read_b128 v[116:119], v3 offset:32768
    v_mfma_f32_16x16x32_bf16 v[112:115], v[120:123], v[36:39], v[112:115]
    s_cbranch_vccnz R_main_kernel_294
C_main_kernel_295:
    ds_read_b128 v[120:123], v3 offset:33792
    v_mfma_f32_16x16x32_bf16 v[100:103], v[124:127], v[40:43], v[100:103]
    ds_read_b128 v[124:127], v3 offset:34816
    buffer_load_dwordx4 v[64:67], v15, s[4:7], s60 offen offset:0 sc1
    v_mfma_f32_16x16x32_bf16 v[104:107], v[128:131], v[40:43], v[104:107]
    s_waitcnt lgkmcnt(5)
    ds_read_b128 v[128:131], v3 offset:35840
    v_mfma_f32_16x16x32_bf16 v[108:111], a[0:3], v[40:43], v[108:111]
    ds_read_b128 a[0:3], v3 offset:36864
    buffer_load_dwordx4 v[68:71], v15, s[4:7], s60 offen offset:1024 sc1
    v_mfma_f32_16x16x32_bf16 v[112:115], a[4:7], v[40:43], v[112:115]
    ds_read_b128 a[4:7], v3 offset:37888
    v_mfma_f32_16x16x32_bf16 v[100:103], a[8:11], v[44:47], v[100:103]
    s_waitcnt vmcnt(4)
    ds_read_b128 a[8:11], v3 offset:38912
    v_max_u32 v0, v48, v52
    v_mfma_f32_16x16x32_bf16 v[104:107], a[12:15], v[44:47], v[104:107]
    s_waitcnt lgkmcnt(5)
    ds_read_b128 a[12:15], v3 offset:39936
    v_cmp_eq_u32 vcc, -1, v0
    v_mfma_f32_16x16x32_bf16 v[108:111], a[16:19], v[44:47], v[108:111]
    ds_read_b128 a[16:19], v3 offset:40960
    v_mfma_f32_16x16x32_bf16 v[112:115], a[20:23], v[44:47], v[112:115]
    s_cbranch_vccnz R_main_kernel_296
C_main_kernel_297:
    ds_read_b128 a[20:23], v3 offset:41984
    v_lshl_add_u32 v14, v13, 2, v12
    v_mfma_f32_16x16x32_bf16 v[100:103], v[116:119], v[48:51], v[100:103]
    ds_read_b128 v[116:119], v3 offset:43008
    buffer_load_dwordx4 v[72:75], v15, s[4:7], s60 offen offset:2048 sc1
    v_mfma_f32_16x16x32_bf16 v[104:107], v[120:123], v[48:51], v[104:107]
    s_waitcnt lgkmcnt(5)
    ds_read_b128 v[120:123], v3 offset:44032
    v_mfma_f32_16x16x32_bf16 v[108:111], v[124:127], v[48:51], v[108:111]
    ds_read_b128 v[124:127], v3 offset:45056
    buffer_load_dwordx4 v[76:79], v15, s[4:7], s60 offen offset:3072 sc1
    v_mfma_f32_16x16x32_bf16 v[112:115], v[128:131], v[48:51], v[112:115]
    ds_read_b128 v[128:131], v3 offset:46080
    v_mfma_f32_16x16x32_bf16 v[100:103], a[0:3], v[52:55], v[100:103]
    s_waitcnt vmcnt(4)
    ds_read_b128 a[0:3], v3 offset:47104
    v_max_u32 v0, v56, v60
    v_mfma_f32_16x16x32_bf16 v[104:107], a[4:7], v[52:55], v[104:107]
    s_waitcnt lgkmcnt(5)
    ds_read_b128 a[4:7], v3 offset:48128
    v_cmp_eq_u32 vcc, -1, v0
    v_mfma_f32_16x16x32_bf16 v[108:111], a[8:11], v[52:55], v[108:111]
    ds_read_b128 a[8:11], v3 offset:49152
    v_and_b32 v14, 15, v14
    v_mfma_f32_16x16x32_bf16 v[112:115], a[12:15], v[52:55], v[112:115]
    s_cbranch_vccnz R_main_kernel_298
C_main_kernel_299:
    ds_read_b128 a[12:15], v3 offset:50176
    v_mfma_f32_16x16x32_bf16 v[100:103], a[16:19], v[56:59], v[100:103]
    ds_read_b128 a[16:19], v3 offset:51200
    v_mfma_f32_16x16x32_bf16 v[104:107], a[20:23], v[56:59], v[104:107]
    s_waitcnt lgkmcnt(5)
    ds_read_b128 a[20:23], v3 offset:52224
    v_mfma_f32_16x16x32_bf16 v[108:111], v[116:119], v[56:59], v[108:111]
    ds_read_b128 v[116:119], v3 offset:53248
    v_lshlrev_b32 v14, 4, v14
    v_mfma_f32_16x16x32_bf16 v[112:115], v[120:123], v[56:59], v[112:115]
    ds_read_b128 v[120:123], v3 offset:54272
    v_mfma_f32_16x16x32_bf16 v[100:103], v[124:127], v[60:63], v[100:103]
    s_waitcnt vmcnt(2)
    ds_read_b128 v[124:127], v3 offset:55296
    v_max_u32 v0, v64, v68
    v_mfma_f32_16x16x32_bf16 v[104:107], v[128:131], v[60:63], v[104:107]
    s_waitcnt lgkmcnt(5)
    ds_read_b128 v[128:131], v3 offset:56320
    v_cmp_eq_u32 vcc, -1, v0
    v_mfma_f32_16x16x32_bf16 v[108:111], a[0:3], v[60:63], v[108:111]
    ds_read_b128 a[0:3], v3 offset:57344
    v_mfma_f32_16x16x32_bf16 v[112:115], a[4:7], v[60:63], v[112:115]
    s_cbranch_vccnz R_main_kernel_300
C_main_kernel_301:
    ds_read_b128 a[4:7], v3 offset:58368
    v_lshl_add_u32 v14, v13, 8, v14
    v_mfma_f32_16x16x32_bf16 v[100:103], a[8:11], v[64:67], v[100:103]
    ds_read_b128 a[8:11], v3 offset:59392
    v_mfma_f32_16x16x32_bf16 v[104:107], a[12:15], v[64:67], v[104:107]
    s_waitcnt lgkmcnt(5)
    ds_read_b128 a[12:15], v3 offset:60416
    v_mfma_f32_16x16x32_bf16 v[108:111], a[16:19], v[64:67], v[108:111]
    ds_read_b128 a[16:19], v3 offset:61440
    v_mfma_f32_16x16x32_bf16 v[112:115], a[20:23], v[64:67], v[112:115]
    ds_read_b128 a[20:23], v3 offset:62464
    s_lshl_b32 s19, s18, 12
    v_mfma_f32_16x16x32_bf16 v[100:103], v[116:119], v[68:71], v[100:103]
    s_waitcnt vmcnt(0)
    ds_read_b128 v[116:119], v3 offset:63488
    v_max_u32 v0, v72, v76
    v_mfma_f32_16x16x32_bf16 v[104:107], v[120:123], v[68:71], v[104:107]
    s_waitcnt lgkmcnt(5)
    ds_read_b128 v[120:123], v3 offset:64512
    v_cmp_eq_u32 vcc, -1, v0
    v_mfma_f32_16x16x32_bf16 v[108:111], v[124:127], v[68:71], v[108:111]
    v_mfma_f32_16x16x32_bf16 v[112:115], v[128:131], v[68:71], v[112:115]
    s_cbranch_vccnz R_main_kernel_302
C_main_kernel_303:
    v_mfma_f32_16x16x32_bf16 v[100:103], a[0:3], v[72:75], v[100:103]
    v_add_u32 v14, s19, v14
    v_mfma_f32_16x16x32_bf16 v[104:107], a[4:7], v[72:75], v[104:107]
    s_waitcnt lgkmcnt(2)
    v_mfma_f32_16x16x32_bf16 v[108:111], a[8:11], v[72:75], v[108:111]
    v_mfma_f32_16x16x32_bf16 v[112:115], a[12:15], v[72:75], v[112:115]
    v_mfma_f32_16x16x32_bf16 v[100:103], a[16:19], v[76:79], v[100:103]
    v_add_u32 v7, s29, v8
    v_mfma_f32_16x16x32_bf16 v[104:107], a[20:23], v[76:79], v[104:107]
    s_waitcnt lgkmcnt(0)
    v_mfma_f32_16x16x32_bf16 v[108:111], v[116:119], v[76:79], v[108:111]
    v_mfma_f32_16x16x32_bf16 v[112:115], v[120:123], v[76:79], v[112:115]
    s_nop 2
    v_cvt_pk_bf16_f32 v48, v100, v101
    v_cvt_pk_bf16_f32 v49, v102, v103
    v_cvt_pk_bf16_f32 v50, v104, v105
    v_cvt_pk_bf16_f32 v51, v106, v107
    v_min_u32 v48, s32, v48
    buffer_store_dwordx4 v[48:51], v3, s[4:7], s63 offen offset:0 sc1
    v_cvt_pk_bf16_f32 v52, v108, v109
    v_cvt_pk_bf16_f32 v53, v110, v111
    v_cvt_pk_bf16_f32 v54, v112, v113
    v_cvt_pk_bf16_f32 v55, v114, v115
    v_min_u32 v52, s32, v52
    buffer_store_dwordx4 v[52:55], v3, s[4:7], s63 offen offset:1024 sc1
    v_dot2_f32_bf16 v132, v48, s31, 0
    v_dot2_f32_bf16 v133, v48, v48, 0
    v_dot2_f32_bf16 v132, v49, s31, v132
    v_dot2_f32_bf16 v133, v49, v49, v133
    v_dot2_f32_bf16 v132, v50, s31, v132
    v_dot2_f32_bf16 v133, v50, v50, v133
    v_dot2_f32_bf16 v132, v51, s31, v132
    v_dot2_f32_bf16 v133, v51, v51, v133
    v_dot2_f32_bf16 v132, v52, s31, v132
    v_dot2_f32_bf16 v133, v52, v52, v133
    v_dot2_f32_bf16 v132, v53, s31, v132
    v_dot2_f32_bf16 v133, v53, v53, v133
    v_dot2_f32_bf16 v132, v54, s31, v132
    v_dot2_f32_bf16 v133, v54, v54, v133
    v_dot2_f32_bf16 v132, v55, s31, v132
    v_dot2_f32_bf16 v133, v55, v55, v133
    s_nop 2
    v_permlane16_swap_b32 v132, v133
    v_add_f32 v132, v132, v133
    v_mov_b32 v133, v132
    s_nop 1
    v_permlane32_swap_b32 v132, v133
    v_add_f32 v132, v132, v133
    v_min_u32 v132, s32, v132
    buffer_store_dword v132, v9, s[4:7], s42 offen sc1
    v_pk_add_f32 v[80:81], v[80:81], v[100:101]
    v_pk_add_f32 v[82:83], v[82:83], v[102:103]
    v_pk_add_f32 v[84:85], v[84:85], v[104:105]
    v_pk_add_f32 v[86:87], v[86:87], v[106:107]
    v_pk_add_f32 v[88:89], v[88:89], v[108:109]
    v_pk_add_f32 v[90:91], v[90:91], v[110:111]
    v_pk_add_f32 v[92:93], v[92:93], v[112:113]
    v_pk_add_f32 v[94:95], v[94:95], v[114:115]
    ds_write_b128 v14, v[80:83] offset:0
    ds_write_b128 v14, v[84:87] offset:1024
    ds_write_b128 v14, v[88:91] offset:2048
    ds_write_b128 v14, v[92:95] offset:3072
    v_mfma_f32_16x16x32_bf16 a[168:171], a[192:195], a[172:175], 0
    buffer_load_dwordx4 v[16:19], v3, s[4:7], s62 offen offset:0 sc1
    v_accvgpr_read_b32 v108, a160
    v_accvgpr_read_b32 v109, a161
    v_mfma_f32_16x16x32_bf16 a[168:171], a[196:199], a[172:175], a[168:171]
    v_accvgpr_read_b32 v110, a162
    v_accvgpr_read_b32 v111, a163
    v_mfma_f32_16x16x32_bf16 a[168:171], a[200:203], a[172:175], a[168:171]
    buffer_load_dwordx4 v[20:23], v3, s[4:7], s62 offen offset:1024 sc1
    v_accvgpr_read_b32 v112, a164
    v_accvgpr_read_b32 v113, a165
    v_mfma_f32_16x16x32_bf16 a[168:171], a[204:207], a[172:175], a[168:171]
    v_accvgpr_read_b32 v114, a166
    v_accvgpr_read_b32 v115, a167
    v_mfma_f32_16x16x32_bf16 a[168:171], a[208:211], a[172:175], a[168:171]
    buffer_load_dwordx4 v[24:27], v3, s[4:7], s62 offen offset:2048 sc1
    s_lshl_b32 s19, s18, 8
    v_lshlrev_b32 v15, 4, v12
    v_mfma_f32_16x16x32_bf16 a[168:171], a[212:215], a[172:175], a[168:171]
    v_add_u32 v15, 0x26a00, v15
    v_mfma_f32_16x16x32_bf16 a[168:171], a[216:219], a[172:175], a[168:171]
    buffer_load_dwordx4 v[28:31], v3, s[4:7], s62 offen offset:3072 sc1
    v_add_u32 v2, s19, v15
    v_add_u32 v10, s3, v3
    v_mfma_f32_16x16x32_bf16 a[168:171], a[220:223], a[172:175], a[168:171]
    s_cmp_eq_u32 s18, 3
    s_cselect_b32 s19, 0x80000000, 0
    v_add_u32 v11, s19, v5
    v_mfma_f32_16x16x32_bf16 a[168:171], a[224:227], a[172:175], a[168:171]
    s_lshr_b32 s19, s19, 21
    v_subrev_u32 v12, s19, v5
    v_mfma_f32_16x16x32_bf16 a[168:171], a[228:231], a[172:175], a[168:171]
    buffer_load_dwordx4 v[32:35], v4, s[4:7], s62 offen offset:0 sc1
    s_lshl_b32 s19, s71, 14
    v_add_u32 v80, s19, v8
    v_mfma_f32_16x16x32_bf16 a[168:171], a[232:235], a[172:175], a[168:171]
    s_lshl_b32 s19, s71, 8
    v_mfma_f32_16x16x32_bf16 a[168:171], a[236:239], a[172:175], a[168:171]
    buffer_load_dwordx4 v[36:39], v4, s[4:7], s62 offen offset:1024 sc1
    v_add_u32 v83, s19, v15
    s_lshl_b32 s19, s72, 14
    v_mfma_f32_16x16x32_bf16 a[168:171], a[240:243], a[172:175], a[168:171]
    v_add_u32 v81, s19, v8
    s_lshl_b32 s19, s72, 8
    v_mfma_f32_16x16x32_bf16 a[168:171], a[244:247], a[172:175], a[168:171]
    buffer_load_dwordx4 v[136:139], v3, s[4:7], s42 offen sc1
    v_add_u32 v142, s19, v15
    s_lshl_b32 s19, s73, 14
    v_mfma_f32_16x16x32_bf16 a[168:171], a[248:251], a[172:175], a[168:171]
    v_add_u32 v82, s19, v8
    s_lshl_b32 s19, s73, 8
    v_mfma_f32_16x16x32_bf16 a[168:171], a[252:255], a[172:175], a[168:171]
    v_add_u32 v143, s19, v15
    s_waitcnt vmcnt(5)
    v_max_u32 v0, v16, v20
    v_cmp_eq_u32 vcc, -1, v0
    s_cbranch_vccz C_main_kernel_323
R_main_kernel_322:
    buffer_load_dwordx4 v[16:19], v3, s[4:7], s62 offen offset:0 sc1
    buffer_load_dwordx4 v[20:23], v3, s[4:7], s62 offen offset:1024 sc1
    buffer_load_dwordx4 v[24:27], v3, s[4:7], s62 offen offset:2048 sc1
    buffer_load_dwordx4 v[28:31], v3, s[4:7], s62 offen offset:3072 sc1
    buffer_load_dwordx4 v[32:35], v4, s[4:7], s62 offen offset:0 sc1
    buffer_load_dwordx4 v[36:39], v4, s[4:7], s62 offen offset:1024 sc1
    buffer_load_dwordx4 v[136:139], v3, s[4:7], s42 offen sc1
    s_add_u32 s33, s33, 1
    s_cmp_gt_u32 s33, 20000
    s_waitcnt vmcnt(5)
    v_max_u32 v0, v16, v20
    v_cmp_eq_u32 vcc, -1, v0
    s_cbranch_scc1 C_main_kernel_323
    s_cbranch_vccnz R_main_kernel_322
C_main_kernel_323:
    v_mfma_f32_16x16x32_bf16 v[84:87], v[144:147], v[16:19], 0
    ds_write_b128 v7, v[16:19] offset:0
    v_mfma_f32_16x16x32_bf16 v[88:91], v[208:211], v[16:19], 0
    ds_write_b128 v7, v[20:23] offset:1024
    v_mfma_f32_16x16x32_bf16 v[92:95], a[192:195], v[16:19], 0
    s_waitcnt vmcnt(3)
    v_max_u32 v0, v24, v28
    v_accvgpr_read_b32 v116, a168
    v_mfma_f32_16x16x32_bf16 v[84:87], v[148:151], v[20:23], v[84:87]
    v_cmp_eq_u32 vcc, -1, v0
    buffer_load_dwordx4 v[40:43], v4, s[4:7], s62 offen offset:2048 sc1
    v_mfma_f32_16x16x32_bf16 v[88:91], v[212:215], v[20:23], v[88:91]
    buffer_load_dwordx4 v[44:47], v4, s[4:7], s62 offen offset:3072 sc1
    v_mfma_f32_16x16x32_bf16 v[92:95], a[196:199], v[20:23], v[92:95]
    s_cbranch_vccnz R_main_kernel_324
C_main_kernel_325:
    v_mfma_f32_16x16x32_bf16 v[84:87], v[152:155], v[24:27], v[84:87]
    ds_write_b128 v7, v[24:27] offset:2048
    v_mfma_f32_16x16x32_bf16 v[88:91], v[216:219], v[24:27], v[88:91]
    ds_write_b128 v7, v[28:31] offset:3072
    v_accvgpr_read_b32 v117, a169
    v_mfma_f32_16x16x32_bf16 v[92:95], a[200:203], v[24:27], v[92:95]
    s_waitcnt vmcnt(3)
    v_max_u32 v0, v32, v36
    v_mfma_f32_16x16x32_bf16 v[84:87], v[156:159], v[28:31], v[84:87]
    v_cmp_eq_u32 vcc, -1, v0
    buffer_load_dwordx4 v[48:51], v5, s[4:7], s62 offen offset:0 sc1
    v_mfma_f32_16x16x32_bf16 v[88:91], v[220:223], v[28:31], v[88:91]
    buffer_load_dwordx4 v[52:55], v5, s[4:7], s62 offen offset:1024 sc1
    v_mfma_f32_16x16x32_bf16 v[92:95], a[204:207], v[28:31], v[92:95]
    s_cbranch_vccnz R_main_kernel_326
C_main_kernel_327:
    v_mfma_f32_16x16x32_bf16 v[84:87], v[160:163], v[32:35], v[84:87]
    ds_write_b128 v7, v[32:35] offset:4096
    v_mfma_f32_16x16x32_bf16 v[88:91], v[224:227], v[32:35], v[88:91]
    ds_write_b128 v7, v[36:39] offset:5120
    v_accvgpr_read_b32 v118, a170
    v_mfma_f32_16x16x32_bf16 v[92:95], a[208:211], v[32:35], v[92:95]
    s_waitcnt vmcnt(2)
    v_max_u32 v0, v40, v44
    v_mfma_f32_16x16x32_bf16 v[84:87], v[164:167], v[36:39], v[84:87]
    v_cmp_eq_u32 vcc, -1, v0
    buffer_load_dwordx4 v[56:59], v5, s[4:7], s62 offen offset:2048 sc1
    v_mfma_f32_16x16x32_bf16 v[88:91], v[228:231], v[36:39], v[88:91]
    buffer_load_dwordx4 v[60:63], v5, s[4:7], s62 offen offset:3072 sc1
    v_mfma_f32_16x16x32_bf16 v[92:95], a[212:215], v[36:39], v[92:95]
    s_cbranch_vccnz R_main_kernel_328
C_main_kernel_329:
    v_mfma_f32_16x16x32_bf16 v[84:87], v[168:171], v[40:43], v[84:87]
    ds_write_b128 v7, v[40:43] offset:6144
    v_max_u32 v0, v136, v137
    v_accvgpr_read_b32 v119, a171
    v_mfma_f32_16x16x32_bf16 v[88:91], v[232:235], v[40:43], v[88:91]
    ds_write_b128 v7, v[44:47] offset:7168
    v_max3_u32 v0, v0, v138, v139
    v_mfma_f32_16x16x32_bf16 v[92:95], a[216:219], v[40:43], v[92:95]
    s_waitcnt vmcnt(2)
    v_max3_u32 v0, v0, v48, v52
    v_mfma_f32_16x16x32_bf16 v[84:87], v[172:175], v[44:47], v[84:87]
    v_cmp_eq_u32 vcc, -1, v0
    buffer_load_dwordx4 v[64:67], v6, s[4:7], s62 offen offset:0 sc1
    v_mfma_f32_16x16x32_bf16 v[88:91], v[236:239], v[44:47], v[88:91]
    buffer_load_dwordx4 v[68:71], v6, s[4:7], s62 offen offset:1024 sc1
    v_mfma_f32_16x16x32_bf16 v[92:95], a[220:223], v[44:47], v[92:95]
    s_cbranch_vccnz R_main_kernel_330
C_main_kernel_331:
    v_mfma_f32_16x16x32_bf16 v[84:87], v[176:179], v[48:51], v[84:87]
    ds_write_b128 v7, v[48:51] offset:8192
    v_mfma_f32_16x16x32_bf16 v[88:91], v[240:243], v[48:51], v[88:91]
    ds_write_b128 v7, v[52:55] offset:9216
    v_mfma_f32_16x16x32_bf16 v[92:95], a[224:227], v[48:51], v[92:95]
    s_waitcnt vmcnt(2)
    v_max_u32 v0, v56, v60
    v_mfma_f32_16x16x32_bf16 v[84:87], v[180:183], v[52:55], v[84:87]
    v_cmp_eq_u32 vcc, -1, v0
    buffer_load_dwordx4 v[72:75], v6, s[4:7], s62 offen offset:2048 sc1
    v_add_f32 v136, v136, v138
    v_mfma_f32_16x16x32_bf16 v[88:91], v[244:247], v[52:55], v[88:91]
    buffer_load_dwordx4 v[76:79], v6, s[4:7], s62 offen offset:3072 sc1
    v_add_f32 v137, v137, v139
    v_mov_b32 v138, v136
    v_mfma_f32_16x16x32_bf16 v[92:95], a[228:231], v[52:55], v[92:95]
    s_cbranch_vccnz R_main_kernel_332
C_main_kernel_333:
    v_mov_b32 v139, v137
    v_mfma_f32_16x16x32_bf16 v[84:87], v[184:187], v[56:59], v[84:87]
    ds_write_b128 v7, v[56:59] offset:10240
    v_mfma_f32_16x16x32_bf16 v[88:91], v[248:251], v[56:59], v[88:91]
    ds_write_b128 v7, v[60:63] offset:11264
    v_mfma_f32_16x16x32_bf16 v[92:95], a[232:235], v[56:59], v[92:95]
    s_waitcnt vmcnt(2)
    v_max_u32 v0, v64, v68
    v_mfma_f32_16x16x32_bf16 v[84:87], v[188:191], v[60:63], v[84:87]
    v_cmp_eq_u32 vcc, -1, v0
    v_permlane16_swap_b32 v136, v138
    v_permlane16_swap_b32 v137, v139
    v_mfma_f32_16x16x32_bf16 v[88:91], v[252:255], v[60:63], v[88:91]
    v_add_f32 v136, v136, v138
    v_add_f32 v137, v137, v139
    v_mov_b32 v138, v136
    v_mfma_f32_16x16x32_bf16 v[92:95], a[236:239], v[60:63], v[92:95]
    s_cbranch_vccnz R_main_kernel_334
C_main_kernel_335:
    v_mov_b32 v139, v137
    v_mfma_f32_16x16x32_bf16 v[84:87], v[192:195], v[64:67], v[84:87]
    ds_write_b128 v7, v[64:67] offset:12288
    v_mfma_f32_16x16x32_bf16 v[88:91], a[176:179], v[64:67], v[88:91]
    ds_write_b128 v7, v[68:71] offset:13312
    v_mfma_f32_16x16x32_bf16 v[92:95], a[240:243], v[64:67], v[92:95]
    s_waitcnt vmcnt(0)
    v_max_u32 v0, v72, v76
    v_mfma_f32_16x16x32_bf16 v[84:87], v[196:199], v[68:71], v[84:87]
    v_cmp_eq_u32 vcc, -1, v0
    v_permlane32_swap_b32 v136, v138
    v_permlane32_swap_b32 v137, v139
    v_mfma_f32_16x16x32_bf16 v[88:91], a[180:183], v[68:71], v[88:91]
    v_add_f32 v136, v136, v138
    v_add_f32 v137, v137, v139
    v_mfma_f32_16x16x32_bf16 v[92:95], a[244:247], v[68:71], v[92:95]
    s_cbranch_vccnz R_main_kernel_336
C_main_kernel_337:
    v_mul_f32 v132, 0xbb000000, v136
    v_mfma_f32_16x16x32_bf16 v[84:87], v[200:203], v[72:75], v[84:87]
    ds_write_b128 v7, v[72:75] offset:14336
    v_mfma_f32_16x16x32_bf16 v[88:91], a[184:187], v[72:75], v[88:91]
    ds_write_b128 v7, v[76:79] offset:15360
    v_mfma_f32_16x16x32_bf16 v[92:95], a[248:251], v[72:75], v[92:95]
    v_mul_f32 v137, 0x3b000000, v137
    v_fma_f32 v137, -v132, v132, v137
    v_max_f32 v137, 0, v137
    v_mfma_f32_16x16x32_bf16 v[84:87], v[204:207], v[76:79], v[84:87]
    v_add_f32 v140, 0x3727c5ac, v137
    v_rsq_f32 v141, v140
    v_mfma_f32_16x16x32_bf16 v[88:91], a[188:191], v[76:79], v[88:91]
    v_rcp_f32 v133, v141
    v_mul_f32 v134, v141, v141
    v_mul_f32 v135, 0xc0135761, v141
    v_mfma_f32_16x16x32_bf16 v[92:95], a[252:255], v[76:79], v[92:95]
    v_mul_f32 v134, v134, v141
    v_mul_f32 v134, 0xbdd2d3e8, v134
    ds_write_b128 v2, v[132:135]
    s_waitcnt lgkmcnt(0)
    s_barrier
    ds_read_b128 v[16:19], v80 offset:0
    ds_read_b128 v[20:23], v80 offset:1024
    ds_read_b128 v[24:27], v80 offset:2048
    ds_read_b128 v[28:31], v80 offset:3072
    v_fma_f32 v84, v132, v108, v84
    v_fma_f32 v85, v132, v109, v85
    v_fma_f32 v86, v132, v110, v86
    v_fma_f32 v87, v132, v111, v87
    v_fma_f32 v88, v132, v112, v88
    v_fma_f32 v89, v132, v113, v89
    v_fma_f32 v90, v132, v114, v90
    v_fma_f32 v91, v132, v115, v91
    v_mul_f32 v120, v84, v84
    v_mul_f32 v121, v85, v85
    v_mul_f32 v122, v86, v86
    v_mul_f32 v123, v87, v87
    v_mul_f32 v124, v88, v88
    v_mul_f32 v125, v89, v89
    v_mul_f32 v126, v90, v90
    v_mul_f32 v127, v91, v91
    v_fma_f32 v120, v120, v134, v135
    v_fma_f32 v121, v121, v134, v135
    v_fma_f32 v122, v122, v134, v135
    v_fma_f32 v123, v123, v134, v135
    s_waitcnt lgkmcnt(3)
    v_mfma_f32_16x16x32_bf16 v[96:99], v[144:147], v[16:19], 0
    buffer_load_dwordx4 a[160:163], v5, s[4:7], s53 offen offset:0
    v_fma_f32 v124, v124, v134, v135
    v_fma_f32 v125, v125, v134, v135
    v_mfma_f32_16x16x32_bf16 v[100:103], v[208:211], v[16:19], 0
    v_fma_f32 v126, v126, v134, v135
    v_fma_f32 v127, v127, v134, v135
    v_mul_f32 v120, v120, v84
    v_mfma_f32_16x16x32_bf16 v[104:107], a[192:195], v[16:19], 0
    s_waitcnt lgkmcnt(2)
    ds_read_b128 v[16:19], v80 offset:4096
    v_mul_f32 v121, v121, v85
    v_mul_f32 v122, v122, v86
    v_mfma_f32_16x16x32_bf16 v[96:99], v[148:151], v[20:23], v[96:99]
    buffer_load_dwordx4 a[164:167], v5, s[4:7], s53 offen offset:1024
    v_mul_f32 v123, v123, v87
    v_mfma_f32_16x16x32_bf16 v[100:103], v[212:215], v[20:23], v[100:103]
    v_mul_f32 v124, v124, v88
    v_mul_f32 v125, v125, v89
    v_mul_f32 v126, v126, v90
    v_mul_f32 v127, v127, v91
    v_mfma_f32_16x16x32_bf16 v[104:107], a[196:199], v[20:23], v[104:107]
    s_waitcnt lgkmcnt(2)
    ds_read_b128 v[20:23], v80 offset:5120
    v_exp_f32 v120, v120
    v_mfma_f32_16x16x32_bf16 v[96:99], v[152:155], v[24:27], v[96:99]
    v_exp_f32 v121, v121
    v_mfma_f32_16x16x32_bf16 v[100:103], v[216:219], v[24:27], v[100:103]
    v_exp_f32 v122, v122
    v_exp_f32 v123, v123
    v_mfma_f32_16x16x32_bf16 v[104:107], a[200:203], v[24:27], v[104:107]
    s_waitcnt lgkmcnt(2)
    ds_read_b128 v[24:27], v80 offset:6144
    v_exp_f32 v124, v124
    v_mfma_f32_16x16x32_bf16 v[96:99], v[156:159], v[28:31], v[96:99]
    buffer_load_dwordx4 a[168:171], v5, s[4:7], s53 offen offset:2048
    v_mfma_f32_16x16x32_bf16 v[100:103], v[220:223], v[28:31], v[100:103]
    v_exp_f32 v125, v125
    v_exp_f32 v126, v126
    v_mfma_f32_16x16x32_bf16 v[104:107], a[204:207], v[28:31], v[104:107]
    s_waitcnt lgkmcnt(2)
    ds_read_b128 v[28:31], v80 offset:7168
    v_exp_f32 v127, v127
    v_mfma_f32_16x16x32_bf16 v[96:99], v[160:163], v[16:19], v[96:99]
    buffer_load_dwordx4 a[172:175], v5, s[4:7], s53 offen offset:3072
    v_fma_f32 v120, v120, v133, v133
    v_mfma_f32_16x16x32_bf16 v[100:103], v[224:227], v[16:19], v[100:103]
    v_fma_f32 v121, v121, v133, v133
    v_fma_f32 v122, v122, v133, v133
    v_fma_f32 v123, v123, v133, v133
    v_fma_f32 v124, v124, v133, v133
    v_mfma_f32_16x16x32_bf16 v[104:107], a[208:211], v[16:19], v[104:107]
    s_waitcnt lgkmcnt(2)
    ds_read_b128 v[16:19], v80 offset:8192
    v_fma_f32 v125, v125, v133, v133
    v_mfma_f32_16x16x32_bf16 v[96:99], v[164:167], v[20:23], v[96:99]
    v_fma_f32 v126, v126, v133, v133
    v_fma_f32 v127, v127, v133, v133
    v_rcp_f32 v120, v120
    v_mfma_f32_16x16x32_bf16 v[100:103], v[228:231], v[20:23], v[100:103]
    v_rcp_f32 v121, v121
    v_mfma_f32_16x16x32_bf16 v[104:107], a[212:215], v[20:23], v[104:107]
    s_waitcnt lgkmcnt(2)
    ds_read_b128 v[20:23], v80 offset:9216
    v_rcp_f32 v122, v122
    v_mfma_f32_16x16x32_bf16 v[96:99], v[168:171], v[24:27], v[96:99]
    buffer_load_dwordx4 a[0:3], v6, s[4:7], s53 offen offset:0
    v_rcp_f32 v123, v123
    v_mfma_f32_16x16x32_bf16 v[100:103], v[232:235], v[24:27], v[100:103]
    v_rcp_f32 v124, v124
    v_rcp_f32 v125, v125
    v_mfma_f32_16x16x32_bf16 v[104:107], a[216:219], v[24:27], v[104:107]
    s_waitcnt lgkmcnt(2)
    ds_read_b128 v[24:27], v80 offset:10240
    v_mfma_f32_16x16x32_bf16 v[96:99], v[172:175], v[28:31], v[96:99]
    v_rcp_f32 v126, v126
    v_rcp_f32 v127, v127
    v_mfma_f32_16x16x32_bf16 v[100:103], v[236:239], v[28:31], v[100:103]
    v_mul_f32 v84, v84, v120
    v_mul_f32 v85, v85, v121
    v_mul_f32 v86, v86, v122
    v_mfma_f32_16x16x32_bf16 v[104:107], a[220:223], v[28:31], v[104:107]
    s_waitcnt lgkmcnt(2)
    ds_read_b128 v[28:31], v80 offset:11264
    v_mul_f32 v87, v87, v123
    v_mul_f32 v88, v88, v124
    v_mfma_f32_16x16x32_bf16 v[96:99], v[176:179], v[16:19], v[96:99]
    buffer_load_dwordx4 a[4:7], v6, s[4:7], s53 offen offset:1024
    v_mul_f32 v89, v89, v125
    v_mfma_f32_16x16x32_bf16 v[100:103], v[240:243], v[16:19], v[100:103]
    v_mul_f32 v90, v90, v126
    v_mul_f32 v91, v91, v127
    v_cvt_pk_bf16_f32 v136, v84, v85
    v_cvt_pk_bf16_f32 v137, v86, v87
    v_mfma_f32_16x16x32_bf16 v[104:107], a[224:227], v[16:19], v[104:107]
    s_waitcnt lgkmcnt(2)
    ds_read_b128 v[16:19], v80 offset:12288
    v_cvt_pk_bf16_f32 v138, v88, v89
    v_mfma_f32_16x16x32_bf16 v[96:99], v[180:183], v[20:23], v[96:99]
    buffer_load_dwordx4 a[8:11], v6, s[4:7], s53 offen offset:2048
    v_cvt_pk_bf16_f32 v139, v90, v91
    v_min_u32 v136, s32, v136
    v_mfma_f32_16x16x32_bf16 v[100:103], v[244:247], v[20:23], v[100:103]
    v_min_u32 v138, s32, v138
    buffer_store_dwordx4 v[136:139], v3, s[4:7], s74 offen sc1
    v_fma_f32 v92, v132, v116, v92
    v_mfma_f32_16x16x32_bf16 v[104:107], a[228:231], v[20:23], v[104:107]
    s_waitcnt lgkmcnt(2)
    ds_read_b128 v[20:23], v80 offset:13312
    v_fma_f32 v93, v132, v117, v93
    v_mfma_f32_16x16x32_bf16 v[96:99], v[184:187], v[24:27], v[96:99]
    ds_read_b128 v[32:35], v83
    v_fma_f32 v94, v132, v118, v94
    v_fma_f32 v95, v132, v119, v95
    v_mfma_f32_16x16x32_bf16 v[100:103], v[248:251], v[24:27], v[100:103]
    v_mul_f32 v128, v92, v92
    v_mul_f32 v129, v93, v93
    v_mul_f32 v130, v94, v94
    v_mul_f32 v131, v95, v95
    v_mfma_f32_16x16x32_bf16 v[104:107], a[232:235], v[24:27], v[104:107]
    s_waitcnt lgkmcnt(3)
    ds_read_b128 v[24:27], v80 offset:14336
    v_fma_f32 v128, v128, v134, v135
    v_mfma_f32_16x16x32_bf16 v[96:99], v[188:191], v[28:31], v[96:99]
    buffer_load_dwordx4 a[12:15], v6, s[4:7], s53 offen offset:3072
    v_fma_f32 v129, v129, v134, v135
    v_fma_f32 v130, v130, v134, v135
    v_mfma_f32_16x16x32_bf16 v[100:103], v[252:255], v[28:31], v[100:103]
    v_fma_f32 v131, v131, v134, v135
    v_mul_f32 v128, v128, v92
    v_mul_f32 v129, v129, v93
    v_mfma_f32_16x16x32_bf16 v[104:107], a[236:239], v[28:31], v[104:107]
    s_waitcnt lgkmcnt(3)
    ds_read_b128 v[28:31], v80 offset:15360
    v_mul_f32 v130, v130, v94
    v_mul_f32 v131, v131, v95
    v_mfma_f32_16x16x32_bf16 v[96:99], v[192:195], v[16:19], v[96:99]
    buffer_load_dwordx4 a[16:19], v3, s[4:7], s54 offen offset:0
    v_exp_f32 v128, v128
    v_mfma_f32_16x16x32_bf16 v[100:103], a[176:179], v[16:19], v[100:103]
    v_exp_f32 v129, v129
    v_mfma_f32_16x16x32_bf16 v[104:107], a[240:243], v[16:19], v[104:107]
    s_waitcnt lgkmcnt(3)
    ds_read_b128 v[16:19], v81 offset:0
    v_exp_f32 v130, v130
    v_mfma_f32_16x16x32_bf16 v[96:99], v[196:199], v[20:23], v[96:99]
    v_exp_f32 v131, v131
    v_fma_f32 v128, v128, v133, v133
    v_mfma_f32_16x16x32_bf16 v[100:103], a[180:183], v[20:23], v[100:103]
    v_fma_f32 v129, v129, v133, v133
    v_fma_f32 v130, v130, v133, v133
    v_fma_f32 v131, v131, v133, v133
    v_mfma_f32_16x16x32_bf16 v[104:107], a[244:247], v[20:23], v[104:107]
    s_waitcnt lgkmcnt(2)
    ds_read_b128 v[20:23], v81 offset:1024
    v_rcp_f32 v128, v128
    v_mfma_f32_16x16x32_bf16 v[96:99], v[200:203], v[24:27], v[96:99]
    buffer_load_dwordx4 a[20:23], v3, s[4:7], s54 offen offset:1024
    v_rcp_f32 v129, v129
    v_mfma_f32_16x16x32_bf16 v[100:103], a[184:187], v[24:27], v[100:103]
    v_rcp_f32 v130, v130
    v_rcp_f32 v131, v131
    v_mfma_f32_16x16x32_bf16 v[104:107], a[248:251], v[24:27], v[104:107]
    s_waitcnt lgkmcnt(2)
    ds_read_b128 v[24:27], v81 offset:2048
    v_mul_f32 v92, v92, v128
    v_mfma_f32_16x16x32_bf16 v[96:99], v[204:207], v[28:31], v[96:99]
    v_mul_f32 v93, v93, v129
    v_mul_f32 v94, v94, v130
    v_mul_f32 v95, v95, v131
    v_mfma_f32_16x16x32_bf16 v[100:103], a[188:191], v[28:31], v[100:103]
    v_cvt_pk_bf16_f32 v140, v92, v93
    v_cvt_pk_bf16_f32 v141, v94, v95
    v_min_u32 v140, s32, v140
    v_mfma_f32_16x16x32_bf16 v[104:107], a[252:255], v[28:31], v[104:107]
    s_waitcnt lgkmcnt(2)
    ds_read_b128 v[28:31], v81 offset:3072
    buffer_store_dwordx2 v[140:141], v10, s[4:7], s74 offen sc1
    v_mfma_f32_16x16x32_bf16 v[84:87], v[144:147], v[16:19], 0
    buffer_load_dwordx4 a[24:27], v3, s[4:7], s54 offen offset:2048
    v_mfma_f32_16x16x32_bf16 v[88:91], v[208:211], v[16:19], 0
    v_mfma_f32_16x16x32_bf16 v[92:95], a[192:195], v[16:19], 0
    s_waitcnt lgkmcnt(2)
    ds_read_b128 v[16:19], v81 offset:4096
    v_fma_f32 v96, v32, v108, v96
    v_fma_f32 v97, v32, v109, v97
    v_mfma_f32_16x16x32_bf16 v[84:87], v[148:151], v[20:23], v[84:87]
    buffer_load_dwordx4 a[28:31], v3, s[4:7], s54 offen offset:3072
    v_fma_f32 v98, v32, v110, v98
    v_fma_f32 v99, v32, v111, v99
    v_mfma_f32_16x16x32_bf16 v[88:91], v[212:215], v[20:23], v[88:91]
    v_fma_f32 v100, v32, v112, v100
    v_fma_f32 v101, v32, v113, v101
    v_fma_f32 v102, v32, v114, v102
    v_fma_f32 v103, v32, v115, v103
    v_mfma_f32_16x16x32_bf16 v[92:95], a[196:199], v[20:23], v[92:95]
    s_waitcnt lgkmcnt(2)
    ds_read_b128 v[20:23], v81 offset:5120
    v_mul_f32 v120, v96, v96
    v_mul_f32 v121, v97, v97
    v_mfma_f32_16x16x32_bf16 v[84:87], v[152:155], v[24:27], v[84:87]
    v_mul_f32 v122, v98, v98
    v_mul_f32 v123, v99, v99
    v_mul_f32 v124, v100, v100
    v_mul_f32 v125, v101, v101
    v_mfma_f32_16x16x32_bf16 v[88:91], v[216:219], v[24:27], v[88:91]
    v_mul_f32 v126, v102, v102
    v_mul_f32 v127, v103, v103
    v_fma_f32 v120, v120, v34, v35
    v_fma_f32 v121, v121, v34, v35
    v_mfma_f32_16x16x32_bf16 v[92:95], a[200:203], v[24:27], v[92:95]
    s_waitcnt lgkmcnt(2)
    ds_read_b128 v[24:27], v81 offset:6144
    v_fma_f32 v122, v122, v34, v35
    v_fma_f32 v123, v123, v34, v35
    v_mfma_f32_16x16x32_bf16 v[84:87], v[156:159], v[28:31], v[84:87]
    buffer_load_dwordx4 a[32:35], v4, s[4:7], s54 offen offset:0
    v_fma_f32 v124, v124, v34, v35
    v_fma_f32 v125, v125, v34, v35
    v_mfma_f32_16x16x32_bf16 v[88:91], v[220:223], v[28:31], v[88:91]
    v_fma_f32 v126, v126, v34, v35
    v_fma_f32 v127, v127, v34, v35
    v_mul_f32 v120, v120, v96
    v_mul_f32 v121, v121, v97
    v_mfma_f32_16x16x32_bf16 v[92:95], a[204:207], v[28:31], v[92:95]
    s_waitcnt lgkmcnt(2)
    ds_read_b128 v[28:31], v81 offset:7168
    v_mul_f32 v122, v122, v98
    v_mul_f32 v123, v123, v99
    v_mfma_f32_16x16x32_bf16 v[84:87], v[160:163], v[16:19], v[84:87]
    buffer_load_dwordx4 a[36:39], v4, s[4:7], s54 offen offset:1024
    v_mul_f32 v124, v124, v100
    v_mul_f32 v125, v125, v101
    v_mfma_f32_16x16x32_bf16 v[88:91], v[224:227], v[16:19], v[88:91]
    v_mul_f32 v126, v126, v102
    v_mul_f32 v127, v127, v103
    v_exp_f32 v120, v120
    v_mfma_f32_16x16x32_bf16 v[92:95], a[208:211], v[16:19], v[92:95]
    s_waitcnt lgkmcnt(2)
    ds_read_b128 v[16:19], v81 offset:8192
    v_exp_f32 v121, v121
    v_mfma_f32_16x16x32_bf16 v[84:87], v[164:167], v[20:23], v[84:87]
    v_exp_f32 v122, v122
    v_exp_f32 v123, v123
    v_mfma_f32_16x16x32_bf16 v[88:91], v[228:231], v[20:23], v[88:91]
    v_exp_f32 v124, v124
    v_exp_f32 v125, v125
    v_mfma_f32_16x16x32_bf16 v[92:95], a[212:215], v[20:23], v[92:95]
    s_waitcnt lgkmcnt(2)
    ds_read_b128 v[20:23], v81 offset:9216
    v_exp_f32 v126, v126
    v_mfma_f32_16x16x32_bf16 v[84:87], v[168:171], v[24:27], v[84:87]
    buffer_load_dwordx4 a[40:43], v4, s[4:7], s54 offen offset:2048
    v_exp_f32 v127, v127
    v_mfma_f32_16x16x32_bf16 v[88:91], v[232:235], v[24:27], v[88:91]
    v_fma_f32 v120, v120, v33, v33
    v_fma_f32 v121, v121, v33, v33
    v_fma_f32 v122, v122, v33, v33
    v_fma_f32 v123, v123, v33, v33
    v_mfma_f32_16x16x32_bf16 v[92:95], a[216:219], v[24:27], v[92:95]
    s_waitcnt lgkmcnt(2)
    ds_read_b128 v[24:27], v81 offset:10240
    v_fma_f32 v124, v124, v33, v33
    v_fma_f32 v125, v125, v33, v33
    v_mfma_f32_16x16x32_bf16 v[84:87], v[172:175], v[28:31], v[84:87]
    v_fma_f32 v126, v126, v33, v33
    v_fma_f32 v127, v127, v33, v33
    v_rcp_f32 v120, v120
    v_mfma_f32_16x16x32_bf16 v[88:91], v[236:239], v[28:31], v[88:91]
    v_rcp_f32 v121, v121
    v_rcp_f32 v122, v122
    v_mfma_f32_16x16x32_bf16 v[92:95], a[220:223], v[28:31], v[92:95]
    s_waitcnt lgkmcnt(2)
    ds_read_b128 v[28:31], v81 offset:11264
    v_rcp_f32 v123, v123
    v_mfma_f32_16x16x32_bf16 v[84:87], v[176:179], v[16:19], v[84:87]
    buffer_load_dwordx4 a[44:47], v4, s[4:7], s54 offen offset:3072
    v_rcp_f32 v124, v124
    v_mfma_f32_16x16x32_bf16 v[88:91], v[240:243], v[16:19], v[88:91]
    v_rcp_f32 v125, v125
    v_rcp_f32 v126, v126
    v_mfma_f32_16x16x32_bf16 v[92:95], a[224:227], v[16:19], v[92:95]
    s_waitcnt lgkmcnt(2)
    ds_read_b128 v[16:19], v81 offset:12288
    v_rcp_f32 v127, v127
    v_mfma_f32_16x16x32_bf16 v[84:87], v[180:183], v[20:23], v[84:87]
    buffer_load_dwordx4 a[48:51], v11, s[4:7], s54 offen offset:0
    v_mul_f32 v96, v96, v120
    v_mul_f32 v97, v97, v121
    v_mfma_f32_16x16x32_bf16 v[88:91], v[244:247], v[20:23], v[88:91]
    v_mul_f32 v98, v98, v122
    v_mul_f32 v99, v99, v123
    v_mul_f32 v100, v100, v124
    v_mul_f32 v101, v101, v125
    v_mfma_f32_16x16x32_bf16 v[92:95], a[228:231], v[20:23], v[92:95]
    s_waitcnt lgkmcnt(2)
    ds_read_b128 v[20:23], v81 offset:13312
    v_mul_f32 v102, v102, v126
    v_mul_f32 v103, v103, v127
    v_mfma_f32_16x16x32_bf16 v[84:87], v[184:187], v[24:27], v[84:87]
    ds_read_b128 v[36:39], v142
    v_cvt_pk_bf16_f32 v136, v96, v97
    v_cvt_pk_bf16_f32 v137, v98, v99
    v_cvt_pk_bf16_f32 v138, v100, v101
    v_mfma_f32_16x16x32_bf16 v[88:91], v[248:251], v[24:27], v[88:91]
    v_cvt_pk_bf16_f32 v139, v102, v103
    v_min_u32 v136, s32, v136
    v_min_u32 v138, s32, v138
    v_mfma_f32_16x16x32_bf16 v[92:95], a[232:235], v[24:27], v[92:95]
    s_waitcnt lgkmcnt(3)
    ds_read_b128 v[24:27], v81 offset:14336
    buffer_store_dwordx4 v[136:139], v3, s[4:7], s75 offen sc1
    v_fma_f32 v104, v32, v116, v104
    v_mfma_f32_16x16x32_bf16 v[84:87], v[188:191], v[28:31], v[84:87]
    buffer_load_dwordx4 a[52:55], v11, s[4:7], s54 offen offset:1024
    v_fma_f32 v105, v32, v117, v105
    v_fma_f32 v106, v32, v118, v106
    v_mfma_f32_16x16x32_bf16 v[88:91], v[252:255], v[28:31], v[88:91]
    v_fma_f32 v107, v32, v119, v107
    v_mul_f32 v128, v104, v104
    v_mul_f32 v129, v105, v105
    v_mul_f32 v130, v106, v106
    v_mfma_f32_16x16x32_bf16 v[92:95], a[236:239], v[28:31], v[92:95]
    s_waitcnt lgkmcnt(3)
    ds_read_b128 v[28:31], v81 offset:15360
    v_mul_f32 v131, v107, v107
    v_fma_f32 v128, v128, v34, v35
    v_mfma_f32_16x16x32_bf16 v[84:87], v[192:195], v[16:19], v[84:87]
    buffer_load_dwordx4 a[56:59], v11, s[4:7], s54 offen offset:2048
    v_fma_f32 v129, v129, v34, v35
    v_fma_f32 v130, v130, v34, v35
    v_mfma_f32_16x16x32_bf16 v[88:91], a[176:179], v[16:19], v[88:91]
    v_fma_f32 v131, v131, v34, v35
    v_mul_f32 v128, v128, v104
    v_mul_f32 v129, v129, v105
    v_mul_f32 v130, v130, v106
    v_mfma_f32_16x16x32_bf16 v[92:95], a[240:243], v[16:19], v[92:95]
    s_waitcnt lgkmcnt(3)
    ds_read_b128 v[16:19], v82 offset:0
    v_mul_f32 v131, v131, v107
    v_exp_f32 v128, v128
    v_mfma_f32_16x16x32_bf16 v[84:87], v[196:199], v[20:23], v[84:87]
    v_exp_f32 v129, v129
    v_mfma_f32_16x16x32_bf16 v[88:91], a[180:183], v[20:23], v[88:91]
    v_exp_f32 v130, v130
    v_exp_f32 v131, v131
    v_fma_f32 v128, v128, v33, v33
    v_mfma_f32_16x16x32_bf16 v[92:95], a[244:247], v[20:23], v[92:95]
    s_waitcnt lgkmcnt(2)
    ds_read_b128 v[20:23], v82 offset:1024
    v_fma_f32 v129, v129, v33, v33
    v_fma_f32 v130, v130, v33, v33
    v_mfma_f32_16x16x32_bf16 v[84:87], v[200:203], v[24:27], v[84:87]
    buffer_load_dwordx4 a[60:63], v11, s[4:7], s54 offen offset:3072
    v_fma_f32 v131, v131, v33, v33
    v_rcp_f32 v128, v128
    v_mfma_f32_16x16x32_bf16 v[88:91], a[184:187], v[24:27], v[88:91]
    v_rcp_f32 v129, v129
    v_mfma_f32_16x16x32_bf16 v[92:95], a[248:251], v[24:27], v[92:95]
    s_waitcnt lgkmcnt(2)
    ds_read_b128 v[24:27], v82 offset:2048
    v_rcp_f32 v130, v130
    v_mfma_f32_16x16x32_bf16 v[84:87], v[204:207], v[28:31], v[84:87]
    v_rcp_f32 v131, v131
    v_mul_f32 v104, v104, v128
    v_mul_f32 v105, v105, v129
    v_mul_f32 v106, v106, v130
    v_mfma_f32_16x16x32_bf16 v[88:91], a[188:191], v[28:31], v[88:91]
    v_mul_f32 v107, v107, v131
    v_cvt_pk_bf16_f32 v140, v104, v105
    v_cvt_pk_bf16_f32 v141, v106, v107
    v_min_u32 v140, s32, v140
    v_mfma_f32_16x16x32_bf16 v[92:95], a[252:255], v[28:31], v[92:95]
    s_waitcnt lgkmcnt(2)
    ds_read_b128 v[28:31], v82 offset:3072
    buffer_store_dwordx2 v[140:141], v10, s[4:7], s75 offen sc1
    v_mfma_f32_16x16x32_bf16 v[96:99], v[144:147], v[16:19], 0
    v_mfma_f32_16x16x32_bf16 v[100:103], v[208:211], v[16:19], 0
    v_mfma_f32_16x16x32_bf16 v[104:107], a[192:195], v[16:19], 0
    s_waitcnt lgkmcnt(2)
    ds_read_b128 v[16:19], v82 offset:4096
    v_fma_f32 v84, v36, v108, v84
    v_fma_f32 v85, v36, v109, v85
    v_mfma_f32_16x16x32_bf16 v[96:99], v[148:151], v[20:23], v[96:99]
    v_fma_f32 v86, v36, v110, v86
    v_fma_f32 v87, v36, v111, v87
    v_fma_f32 v88, v36, v112, v88
    v_mfma_f32_16x16x32_bf16 v[100:103], v[212:215], v[20:23], v[100:103]
    v_fma_f32 v89, v36, v113, v89
    v_fma_f32 v90, v36, v114, v90
    v_fma_f32 v91, v36, v115, v91
    v_mul_f32 v120, v84, v84
    v_mfma_f32_16x16x32_bf16 v[104:107], a[196:199], v[20:23], v[104:107]
    s_waitcnt lgkmcnt(2)
    ds_read_b128 v[20:23], v82 offset:5120
    v_mul_f32 v121, v85, v85
    v_mul_f32 v122, v86, v86
    v_mfma_f32_16x16x32_bf16 v[96:99], v[152:155], v[24:27], v[96:99]
    v_mul_f32 v123, v87, v87
    v_mul_f32 v124, v88, v88
    v_mul_f32 v125, v89, v89
    v_mfma_f32_16x16x32_bf16 v[100:103], v[216:219], v[24:27], v[100:103]
    v_mul_f32 v126, v90, v90
    v_mul_f32 v127, v91, v91
    v_fma_f32 v120, v120, v38, v39
    v_fma_f32 v121, v121, v38, v39
    v_mfma_f32_16x16x32_bf16 v[104:107], a[200:203], v[24:27], v[104:107]
    s_waitcnt lgkmcnt(2)
    ds_read_b128 v[24:27], v82 offset:6144
    v_fma_f32 v122, v122, v38, v39
    v_fma_f32 v123, v123, v38, v39
    v_mfma_f32_16x16x32_bf16 v[96:99], v[156:159], v[28:31], v[96:99]
    v_fma_f32 v124, v124, v38, v39
    v_fma_f32 v125, v125, v38, v39
    v_fma_f32 v126, v126, v38, v39
    v_fma_f32 v127, v127, v38, v39
    v_mfma_f32_16x16x32_bf16 v[100:103], v[220:223], v[28:31], v[100:103]
    v_mul_f32 v120, v120, v84
    v_mul_f32 v121, v121, v85
    v_mul_f32 v122, v122, v86
    v_mfma_f32_16x16x32_bf16 v[104:107], a[204:207], v[28:31], v[104:107]
    s_waitcnt lgkmcnt(2)
    ds_read_b128 v[28:31], v82 offset:7168
    v_mul_f32 v123, v123, v87
    v_mul_f32 v124, v124, v88
    v_mfma_f32_16x16x32_bf16 v[96:99], v[160:163], v[16:19], v[96:99]
    v_mul_f32 v125, v125, v89
    v_mul_f32 v126, v126, v90
    v_mul_f32 v127, v127, v91
    v_mfma_f32_16x16x32_bf16 v[100:103], v[224:227], v[16:19], v[100:103]
    v_exp_f32 v120, v120
    v_exp_f32 v121, v121
    v_mfma_f32_16x16x32_bf16 v[104:107], a[208:211], v[16:19], v[104:107]
    s_waitcnt lgkmcnt(2)
    ds_read_b128 v[16:19], v82 offset:8192
    v_exp_f32 v122, v122
    v_mfma_f32_16x16x32_bf16 v[96:99], v[164:167], v[20:23], v[96:99]
    v_exp_f32 v123, v123
    v_exp_f32 v124, v124
    v_mfma_f32_16x16x32_bf16 v[100:103], v[228:231], v[20:23], v[100:103]
    v_exp_f32 v125, v125
    v_exp_f32 v126, v126
    v_mfma_f32_16x16x32_bf16 v[104:107], a[212:215], v[20:23], v[104:107]
    s_waitcnt lgkmcnt(2)
    ds_read_b128 v[20:23], v82 offset:9216
    v_exp_f32 v127, v127
    v_mfma_f32_16x16x32_bf16 v[96:99], v[168:171], v[24:27], v[96:99]
    buffer_load_dwordx4 v[40:43], v3, s[4:7], s37 offen offset:0 sc1
    v_fma_f32 v120, v120, v37, v37
    v_fma_f32 v121, v121, v37, v37
    v_mfma_f32_16x16x32_bf16 v[100:103], v[232:235], v[24:27], v[100:103]
    v_fma_f32 v122, v122, v37, v37
    v_fma_f32 v123, v123, v37, v37
    v_fma_f32 v124, v124, v37, v37
    v_fma_f32 v125, v125, v37, v37
    v_mfma_f32_16x16x32_bf16 v[104:107], a[216:219], v[24:27], v[104:107]
    s_waitcnt lgkmcnt(2)
    ds_read_b128 v[24:27], v82 offset:10240
    v_fma_f32 v126, v126, v37, v37
    v_mfma_f32_16x16x32_bf16 v[96:99], v[172:175], v[28:31], v[96:99]
    buffer_load_dwordx4 v[44:47], v3, s[4:7], s37 offen offset:1024 sc1
    v_fma_f32 v127, v127, v37, v37
    v_rcp_f32 v120, v120
    v_mfma_f32_16x16x32_bf16 v[100:103], v[236:239], v[28:31], v[100:103]
    v_rcp_f32 v121, v121
    v_rcp_f32 v122, v122
    v_mfma_f32_16x16x32_bf16 v[104:107], a[220:223], v[28:31], v[104:107]
    s_waitcnt lgkmcnt(2)
    ds_read_b128 v[28:31], v82 offset:11264
    v_rcp_f32 v123, v123
    v_mfma_f32_16x16x32_bf16 v[96:99], v[176:179], v[16:19], v[96:99]
    buffer_load_dwordx4 v[48:51], v3, s[4:7], s37 offen offset:2048 sc1
    v_rcp_f32 v124, v124
    v_mfma_f32_16x16x32_bf16 v[100:103], v[240:243], v[16:19], v[100:103]
    v_rcp_f32 v125, v125
    v_rcp_f32 v126, v126
    v_mfma_f32_16x16x32_bf16 v[104:107], a[224:227], v[16:19], v[104:107]
    s_waitcnt lgkmcnt(2)
    ds_read_b128 v[16:19], v82 offset:12288
    v_rcp_f32 v127, v127
    v_mfma_f32_16x16x32_bf16 v[96:99], v[180:183], v[20:23], v[96:99]
    buffer_load_dwordx4 v[52:55], v3, s[4:7], s37 offen offset:3072 sc1
    v_mul_f32 v84, v84, v120
    v_mul_f32 v85, v85, v121
    v_mfma_f32_16x16x32_bf16 v[100:103], v[244:247], v[20:23], v[100:103]
    v_mul_f32 v86, v86, v122
    v_mul_f32 v87, v87, v123
    v_mul_f32 v88, v88, v124
    v_mul_f32 v89, v89, v125
    v_mfma_f32_16x16x32_bf16 v[104:107], a[228:231], v[20:23], v[104:107]
    s_waitcnt lgkmcnt(2)
    ds_read_b128 v[20:23], v82 offset:13312
    v_mul_f32 v90, v90, v126
    v_mfma_f32_16x16x32_bf16 v[96:99], v[184:187], v[24:27], v[96:99]
    ds_read_b128 v[32:35], v143
    buffer_load_dwordx4 v[56:59], v4, s[4:7], s37 offen offset:0 sc1
    v_mul_f32 v91, v91, v127
    v_cvt_pk_bf16_f32 v136, v84, v85
    v_mfma_f32_16x16x32_bf16 v[100:103], v[248:251], v[24:27], v[100:103]
    v_cvt_pk_bf16_f32 v137, v86, v87
    v_cvt_pk_bf16_f32 v138, v88, v89
    v_cvt_pk_bf16_f32 v139, v90, v91
    v_min_u32 v136, s32, v136
    v_mfma_f32_16x16x32_bf16 v[104:107], a[232:235], v[24:27], v[104:107]
    s_waitcnt lgkmcnt(3)
    ds_read_b128 v[24:27], v82 offset:14336
    v_min_u32 v138, s32, v138
    v_mfma_f32_16x16x32_bf16 v[96:99], v[188:191], v[28:31], v[96:99]
    buffer_load_dwordx4 v[60:63], v4, s[4:7], s37 offen offset:1024 sc1
    buffer_store_dwordx4 v[136:139], v3, s[4:7], s76 offen sc1
    v_fma_f32 v92, v36, v116, v92
    v_fma_f32 v93, v36, v117, v93
    v_mfma_f32_16x16x32_bf16 v[100:103], v[252:255], v[28:31], v[100:103]
    v_fma_f32 v94, v36, v118, v94
    v_fma_f32 v95, v36, v119, v95
    v_mul_f32 v128, v92, v92
    v_mfma_f32_16x16x32_bf16 v[104:107], a[236:239], v[28:31], v[104:107]
    s_waitcnt lgkmcnt(3)
    ds_read_b128 v[28:31], v82 offset:15360
    v_mul_f32 v129, v93, v93
    v_mul_f32 v130, v94, v94
    v_mfma_f32_16x16x32_bf16 v[96:99], v[192:195], v[16:19], v[96:99]
    buffer_load_dwordx4 v[64:67], v4, s[4:7], s37 offen offset:2048 sc1
    v_mul_f32 v131, v95, v95
    v_fma_f32 v128, v128, v38, v39
    v_fma_f32 v129, v129, v38, v39
    v_mfma_f32_16x16x32_bf16 v[100:103], a[176:179], v[16:19], v[100:103]
    v_fma_f32 v130, v130, v38, v39
    v_fma_f32 v131, v131, v38, v39
    v_mul_f32 v128, v128, v92
    v_mul_f32 v129, v129, v93
    v_mfma_f32_16x16x32_bf16 v[104:107], a[240:243], v[16:19], v[104:107]
    s_waitcnt lgkmcnt(3)
    v_mul_f32 v130, v130, v94
    v_mul_f32 v131, v131, v95
    v_mfma_f32_16x16x32_bf16 v[96:99], v[196:199], v[20:23], v[96:99]
    buffer_load_dwordx4 v[68:71], v4, s[4:7], s37 offen offset:3072 sc1
    v_exp_f32 v128, v128
    v_mfma_f32_16x16x32_bf16 v[100:103], a[180:183], v[20:23], v[100:103]
    v_exp_f32 v129, v129
    v_exp_f32 v130, v130
    v_mfma_f32_16x16x32_bf16 v[104:107], a[244:247], v[20:23], v[104:107]
    s_waitcnt lgkmcnt(1)
    v_exp_f32 v131, v131
    v_fma_f32 v128, v128, v37, v37
    v_mfma_f32_16x16x32_bf16 v[96:99], v[200:203], v[24:27], v[96:99]
    buffer_load_dwordx4 v[72:75], v5, s[4:7], s37 offen offset:0 sc1
    v_fma_f32 v129, v129, v37, v37
    v_fma_f32 v130, v130, v37, v37
    v_fma_f32 v131, v131, v37, v37
    v_mfma_f32_16x16x32_bf16 v[100:103], a[184:187], v[24:27], v[100:103]
    v_rcp_f32 v128, v128
    v_rcp_f32 v129, v129
    v_mfma_f32_16x16x32_bf16 v[104:107], a[248:251], v[24:27], v[104:107]
    s_waitcnt lgkmcnt(0)
    v_rcp_f32 v130, v130
    v_mfma_f32_16x16x32_bf16 v[96:99], v[204:207], v[28:31], v[96:99]
    buffer_load_dwordx4 v[76:79], v5, s[4:7], s37 offen offset:1024 sc1
    v_rcp_f32 v131, v131
    v_mul_f32 v92, v92, v128
    v_mfma_f32_16x16x32_bf16 v[100:103], a[188:191], v[28:31], v[100:103]
    v_mul_f32 v93, v93, v129
    v_mul_f32 v94, v94, v130
    v_mul_f32 v95, v95, v131
    v_cvt_pk_bf16_f32 v140, v92, v93
    v_mfma_f32_16x16x32_bf16 v[104:107], a[252:255], v[28:31], v[104:107]
    v_cvt_pk_bf16_f32 v141, v94, v95
    v_min_u32 v140, s32, v140
    buffer_store_dwordx2 v[140:141], v10, s[4:7], s76 offen sc1
    buffer_load_dwordx4 v[80:83], v12, s[4:7], s37 offen offset:2048 sc1
    v_add_u32 v2, 0x20000, v14
    s_waitcnt vmcnt(11)
    v_max_u32 v0, v40, v42
    v_max3_u32 v0, v0, v44, v46
    v_cmp_eq_u32 vcc, -1, v0
    s_cbranch_vccnz R_main_kernel_338
C_main_kernel_339:
    s_waitcnt lgkmcnt(2)
    v_mfma_f32_16x16x32_bf16 v[232:235], a[64:67], v[40:43], 0
    v_mfma_f32_16x16x32_bf16 v[236:239], a[68:71], v[40:43], 0
    v_mfma_f32_16x16x32_bf16 v[240:243], a[72:75], v[40:43], 0
    v_fma_f32 v96, v32, v108, v96
    v_fma_f32 v97, v32, v109, v97
    v_fma_f32 v98, v32, v110, v98
    v_fma_f32 v99, v32, v111, v99
    v_mfma_f32_16x16x32_bf16 v[244:247], a[76:79], v[40:43], 0
    s_waitcnt vmcnt(9)
    v_max_u32 v0, v48, v50
    v_fma_f32 v100, v32, v112, v100
    v_fma_f32 v101, v32, v113, v101
    v_fma_f32 v102, v32, v114, v102
    v_mfma_f32_16x16x32_bf16 v[232:235], a[80:83], v[44:47], v[232:235]
    v_max3_u32 v0, v0, v52, v54
    v_fma_f32 v103, v32, v115, v103
    v_mul_f32 v120, v96, v96
    v_mul_f32 v121, v97, v97
    v_mfma_f32_16x16x32_bf16 v[236:239], a[84:87], v[44:47], v[236:239]
    v_cmp_eq_u32 vcc, -1, v0
    v_mul_f32 v122, v98, v98
    v_mul_f32 v123, v99, v99
    v_mul_f32 v124, v100, v100
    v_mfma_f32_16x16x32_bf16 v[240:243], a[88:91], v[44:47], v[240:243]
    v_mul_f32 v125, v101, v101
    v_mul_f32 v126, v102, v102
    v_mul_f32 v127, v103, v103
    v_fma_f32 v120, v120, v34, v35
    v_fma_f32 v121, v121, v34, v35
    v_mfma_f32_16x16x32_bf16 v[244:247], a[92:95], v[44:47], v[244:247]
    s_cbranch_vccnz R_main_kernel_340
C_main_kernel_341:
    v_fma_f32 v122, v122, v34, v35
    v_fma_f32 v123, v123, v34, v35
    v_fma_f32 v124, v124, v34, v35
    v_mfma_f32_16x16x32_bf16 v[232:235], a[96:99], v[48:51], v[232:235]
    v_fma_f32 v125, v125, v34, v35
    v_fma_f32 v126, v126, v34, v35
    v_fma_f32 v127, v127, v34, v35
    v_mul_f32 v120, v120, v96
    v_mfma_f32_16x16x32_bf16 v[236:239], a[100:103], v[48:51], v[236:239]
    v_mul_f32 v121, v121, v97
    v_mul_f32 v122, v122, v98
    v_mul_f32 v123, v123, v99
    v_mul_f32 v124, v124, v100
    v_mul_f32 v125, v125, v101
    v_mfma_f32_16x16x32_bf16 v[240:243], a[104:107], v[48:51], v[240:243]
    v_mul_f32 v126, v126, v102
    v_mul_f32 v127, v127, v103
    v_exp_f32 v120, v120
    v_mfma_f32_16x16x32_bf16 v[244:247], a[108:111], v[48:51], v[244:247]
    s_waitcnt vmcnt(7)
    v_max_u32 v0, v56, v58
    v_exp_f32 v121, v121
    v_mfma_f32_16x16x32_bf16 v[232:235], a[112:115], v[52:55], v[232:235]
    v_max3_u32 v0, v0, v60, v62
    v_exp_f32 v122, v122
    v_exp_f32 v123, v123
    v_mfma_f32_16x16x32_bf16 v[236:239], a[116:119], v[52:55], v[236:239]
    v_cmp_eq_u32 vcc, -1, v0
    v_exp_f32 v124, v124
    v_exp_f32 v125, v125
    v_mfma_f32_16x16x32_bf16 v[240:243], a[120:123], v[52:55], v[240:243]
    v_exp_f32 v126, v126
    v_exp_f32 v127, v127
    v_mfma_f32_16x16x32_bf16 v[244:247], a[124:127], v[52:55], v[244:247]
    s_cbranch_vccnz R_main_kernel_342
C_main_kernel_343:
    v_fma_f32 v120, v120, v33, v33
    v_fma_f32 v121, v121, v33, v33
    v_fma_f32 v122, v122, v33, v33
    v_mfma_f32_16x16x32_bf16 v[232:235], a[128:131], v[56:59], v[232:235]
    v_fma_f32 v123, v123, v33, v33
    v_fma_f32 v124, v124, v33, v33
    v_fma_f32 v125, v125, v33, v33
    v_fma_f32 v126, v126, v33, v33
    v_mfma_f32_16x16x32_bf16 v[236:239], a[132:135], v[56:59], v[236:239]
    v_fma_f32 v127, v127, v33, v33
    v_rcp_f32 v120, v120
    v_rcp_f32 v121, v121
    v_mfma_f32_16x16x32_bf16 v[240:243], a[136:139], v[56:59], v[240:243]
    buffer_load_dwordx4 v[144:147], v3, s[4:7], s30 offen offset:0 sc1
    v_rcp_f32 v122, v122
    v_mfma_f32_16x16x32_bf16 v[244:247], a[140:143], v[56:59], v[244:247]
    s_waitcnt vmcnt(5)
    v_max_u32 v0, v64, v66
    v_rcp_f32 v123, v123
    v_rcp_f32 v124, v124
    v_mfma_f32_16x16x32_bf16 v[232:235], a[144:147], v[60:63], v[232:235]
    v_max3_u32 v0, v0, v68, v70
    v_rcp_f32 v125, v125
    v_mfma_f32_16x16x32_bf16 v[236:239], a[148:151], v[60:63], v[236:239]
    v_cmp_eq_u32 vcc, -1, v0
    v_rcp_f32 v126, v126
    v_rcp_f32 v127, v127
    v_mfma_f32_16x16x32_bf16 v[240:243], a[152:155], v[60:63], v[240:243]
    s_waitcnt vmcnt(15)
    buffer_load_dwordx4 v[148:151], v3, s[4:7], s30 offen offset:1024 sc1
    v_mul_f32 v96, v96, v120
    v_mul_f32 v97, v97, v121
    v_mfma_f32_16x16x32_bf16 v[244:247], a[156:159], v[60:63], v[244:247]
    s_cbranch_vccnz R_main_kernel_344
C_main_kernel_345:
    v_mul_f32 v98, v98, v122
    v_mul_f32 v99, v99, v123
    v_mul_f32 v100, v100, v124
    v_mul_f32 v101, v101, v125
    v_mfma_f32_16x16x32_bf16 v[232:235], a[160:163], v[64:67], v[232:235]
    v_mul_f32 v102, v102, v126
    v_mul_f32 v103, v103, v127
    v_cvt_pk_bf16_f32 v136, v96, v97
    v_cvt_pk_bf16_f32 v137, v98, v99
    v_mfma_f32_16x16x32_bf16 v[236:239], a[164:167], v[64:67], v[236:239]
    v_cvt_pk_bf16_f32 v138, v100, v101
    v_cvt_pk_bf16_f32 v139, v102, v103
    v_min_u32 v136, s32, v136
    v_min_u32 v138, s32, v138
    v_mfma_f32_16x16x32_bf16 v[240:243], a[168:171], v[64:67], v[240:243]
    buffer_load_dwordx4 v[152:155], v3, s[4:7], s30 offen offset:2048 sc1
    buffer_store_dwordx4 v[136:139], v3, s[4:7], s77 offen sc1
    v_fma_f32 v104, v32, v116, v104
    v_fma_f32 v105, v32, v117, v105
    v_mfma_f32_16x16x32_bf16 v[244:247], a[172:175], v[64:67], v[244:247]
    s_waitcnt vmcnt(6)
    v_max_u32 v0, v72, v74
    v_fma_f32 v106, v32, v118, v106
    v_fma_f32 v107, v32, v119, v107
    v_mfma_f32_16x16x32_bf16 v[232:235], a[0:3], v[68:71], v[232:235]
    v_max3_u32 v0, v0, v76, v78
    v_mul_f32 v128, v104, v104
    v_mul_f32 v129, v105, v105
    v_mul_f32 v130, v106, v106
    v_mul_f32 v131, v107, v107
    v_mfma_f32_16x16x32_bf16 v[236:239], a[4:7], v[68:71], v[236:239]
    v_cmp_eq_u32 vcc, -1, v0
    v_fma_f32 v128, v128, v34, v35
    v_fma_f32 v129, v129, v34, v35
    v_fma_f32 v130, v130, v34, v35
    v_mfma_f32_16x16x32_bf16 v[240:243], a[8:11], v[68:71], v[240:243]
    buffer_load_dwordx4 v[156:159], v3, s[4:7], s30 offen offset:3072 sc1
    v_fma_f32 v131, v131, v34, v35
    v_mul_f32 v128, v128, v104
    v_mul_f32 v129, v129, v105
    v_mfma_f32_16x16x32_bf16 v[244:247], a[12:15], v[68:71], v[244:247]
    s_cbranch_vccnz R_main_kernel_346
C_main_kernel_347:
    v_mul_f32 v130, v130, v106
    v_mul_f32 v131, v131, v107
    v_exp_f32 v128, v128
    v_mfma_f32_16x16x32_bf16 v[232:235], a[16:19], v[72:75], v[232:235]
    v_exp_f32 v129, v129
    v_exp_f32 v130, v130
    v_mfma_f32_16x16x32_bf16 v[236:239], a[20:23], v[72:75], v[236:239]
    v_exp_f32 v131, v131
    v_fma_f32 v128, v128, v33, v33
    v_fma_f32 v129, v129, v33, v33
    v_mfma_f32_16x16x32_bf16 v[240:243], a[24:27], v[72:75], v[240:243]
    buffer_load_dwordx4 v[160:163], v4, s[4:7], s30 offen offset:0 sc1
    v_fma_f32 v130, v130, v33, v33
    v_fma_f32 v131, v131, v33, v33
    v_rcp_f32 v128, v128
    v_mfma_f32_16x16x32_bf16 v[244:247], a[28:31], v[72:75], v[244:247]
    v_rcp_f32 v129, v129
    v_rcp_f32 v130, v130
    v_mfma_f32_16x16x32_bf16 v[232:235], a[32:35], v[76:79], v[232:235]
    s_waitcnt vmcnt(6)
    v_max_u32 v0, v80, v82
    v_rcp_f32 v131, v131
    v_mfma_f32_16x16x32_bf16 v[236:239], a[36:39], v[76:79], v[236:239]
    v_cmp_eq_u32 vcc, -1, v0
    v_mul_f32 v104, v104, v128
    v_mul_f32 v105, v105, v129
    v_mul_f32 v106, v106, v130
    v_mul_f32 v107, v107, v131
    v_mfma_f32_16x16x32_bf16 v[240:243], a[40:43], v[76:79], v[240:243]
    buffer_load_dwordx4 v[164:167], v4, s[4:7], s30 offen offset:1024 sc1
    v_cvt_pk_bf16_f32 v140, v104, v105
    v_cvt_pk_bf16_f32 v141, v106, v107
    v_min_u32 v140, s32, v140
    v_mfma_f32_16x16x32_bf16 v[244:247], a[44:47], v[76:79], v[244:247]
    s_cbranch_vccnz R_main_kernel_348
C_main_kernel_349:
    s_waitcnt vmcnt(5)
    v_max_u32 v0, v144, v146
    buffer_store_dwordx2 v[140:141], v10, s[4:7], s77 offen sc1
    v_mfma_f32_16x16x32_bf16 v[232:235], a[48:51], v[80:83], v[232:235]
    v_max3_u32 v0, v0, v148, v150
    v_mfma_f32_16x16x32_bf16 v[236:239], a[52:55], v[80:83], v[236:239]
    v_cmp_eq_u32 vcc, -1, v0
    v_mfma_f32_16x16x32_bf16 v[240:243], a[56:59], v[80:83], v[240:243]
    buffer_load_dwordx4 v[168:171], v4, s[4:7], s30 offen offset:2048 sc1
    v_mfma_f32_16x16x32_bf16 v[244:247], a[60:63], v[80:83], v[244:247]
    s_cbranch_vccnz R_main_kernel_350
C_main_kernel_351:
    v_mfma_f32_16x16x32_bf16 v[16:19], a[64:67], v[144:147], 0
    v_mfma_f32_16x16x32_bf16 v[20:23], a[68:71], v[144:147], 0
    ds_write_b128 v2, v[232:235] offset:0
    v_mfma_f32_16x16x32_bf16 v[24:27], a[72:75], v[144:147], 0
    buffer_load_dwordx4 v[172:175], v4, s[4:7], s30 offen offset:3072 sc1
    v_mfma_f32_16x16x32_bf16 v[28:31], a[76:79], v[144:147], 0
    s_waitcnt vmcnt(5)
    v_max_u32 v0, v152, v154
    v_mfma_f32_16x16x32_bf16 v[16:19], a[80:83], v[148:151], v[16:19]
    v_max3_u32 v0, v0, v156, v158
    v_mfma_f32_16x16x32_bf16 v[20:23], a[84:87], v[148:151], v[20:23]
    v_cmp_eq_u32 vcc, -1, v0
    v_mfma_f32_16x16x32_bf16 v[24:27], a[88:91], v[148:151], v[24:27]
    buffer_load_dwordx4 v[176:179], v5, s[4:7], s30 offen offset:0 sc1
    v_mfma_f32_16x16x32_bf16 v[28:31], a[92:95], v[148:151], v[28:31]
    s_cbranch_vccnz R_main_kernel_352
C_main_kernel_353:
    v_mfma_f32_16x16x32_bf16 v[16:19], a[96:99], v[152:155], v[16:19]
    v_mfma_f32_16x16x32_bf16 v[20:23], a[100:103], v[152:155], v[20:23]
    ds_write_b128 v2, v[236:239] offset:1024
    v_mfma_f32_16x16x32_bf16 v[24:27], a[104:107], v[152:155], v[24:27]
    buffer_load_dwordx4 v[180:183], v5, s[4:7], s30 offen offset:1024 sc1
    v_mfma_f32_16x16x32_bf16 v[28:31], a[108:111], v[152:155], v[28:31]
    s_waitcnt vmcnt(5)
    v_max_u32 v0, v160, v162
    v_mfma_f32_16x16x32_bf16 v[16:19], a[112:115], v[156:159], v[16:19]
    v_max3_u32 v0, v0, v164, v166
    v_mfma_f32_16x16x32_bf16 v[20:23], a[116:119], v[156:159], v[20:23]
    v_cmp_eq_u32 vcc, -1, v0
    v_mfma_f32_16x16x32_bf16 v[24:27], a[120:123], v[156:159], v[24:27]
    buffer_load_dwordx4 v[184:187], v12, s[4:7], s30 offen offset:2048 sc1
    v_lshrrev_b32 v7, 2, v1
    v_and_b32 v8, 3, v1
    v_mfma_f32_16x16x32_bf16 v[28:31], a[124:127], v[156:159], v[28:31]
    s_cbranch_vccnz R_main_kernel_354
C_main_kernel_355:
    v_lshl_add_u32 v9, v8, 2, v7
    v_mfma_f32_16x16x32_bf16 v[16:19], a[128:131], v[160:163], v[16:19]
    v_and_b32 v9, 15, v9
    v_mfma_f32_16x16x32_bf16 v[20:23], a[132:135], v[160:163], v[20:23]
    ds_write_b128 v2, v[240:243] offset:2048
    v_lshlrev_b32 v9, 4, v9
    v_mfma_f32_16x16x32_bf16 v[24:27], a[136:139], v[160:163], v[24:27]
    buffer_load_dwordx4 v[188:191], v3, s[4:7], s78 offen offset:0 sc1
    v_lshl_add_u32 v9, v8, 8, v9
    v_mfma_f32_16x16x32_bf16 v[28:31], a[140:143], v[160:163], v[28:31]
    s_waitcnt vmcnt(4)
    v_max_u32 v0, v168, v170
    v_mfma_f32_16x16x32_bf16 v[16:19], a[144:147], v[164:167], v[16:19]
    v_max3_u32 v0, v0, v172, v174
    v_mfma_f32_16x16x32_bf16 v[20:23], a[148:151], v[164:167], v[20:23]
    v_cmp_eq_u32 vcc, -1, v0
    v_mfma_f32_16x16x32_bf16 v[24:27], a[152:155], v[164:167], v[24:27]
    buffer_load_dwordx4 v[192:195], v3, s[4:7], s78 offen offset:1024 sc1
    v_lshlrev_b32 v7, 10, v7
    v_mfma_f32_16x16x32_bf16 v[28:31], a[156:159], v[164:167], v[28:31]
    s_cbranch_vccnz R_main_kernel_356
C_main_kernel_357:
    v_lshl_add_u32 v7, v8, 4, v7
    v_mfma_f32_16x16x32_bf16 v[16:19], a[160:163], v[168:171], v[16:19]
    s_and_b32 s19, s18, 1
    v_mfma_f32_16x16x32_bf16 v[20:23], a[164:167], v[168:171], v[20:23]
    ds_write_b128 v2, v[244:247] offset:3072
    s_lshl_b32 s19, s19, 11
    v_mfma_f32_16x16x32_bf16 v[24:27], a[168:171], v[168:171], v[24:27]
    buffer_load_dwordx4 v[196:199], v3, s[4:7], s78 offen offset:2048 sc1
    v_add_u32 v9, s19, v9
    v_mfma_f32_16x16x32_bf16 v[28:31], a[172:175], v[168:171], v[28:31]
    s_waitcnt vmcnt(4)
    v_max_u32 v0, v176, v178
    v_mfma_f32_16x16x32_bf16 v[16:19], a[0:3], v[172:175], v[16:19]
    v_max3_u32 v0, v0, v180, v182
    v_mfma_f32_16x16x32_bf16 v[20:23], a[4:7], v[172:175], v[20:23]
    v_cmp_eq_u32 vcc, -1, v0
    v_mfma_f32_16x16x32_bf16 v[24:27], a[8:11], v[172:175], v[24:27]
    buffer_load_dwordx4 v[200:203], v3, s[4:7], s78 offen offset:3072 sc1
    s_mov_b32 s22, 16384
    v_mfma_f32_16x16x32_bf16 v[28:31], a[12:15], v[172:175], v[28:31]
    s_cbranch_vccnz R_main_kernel_358
C_main_kernel_359:
    s_cmp_lt_u32 s18, 2
    s_cselect_b32 s19, 0x20000, s22
    v_mfma_f32_16x16x32_bf16 v[16:19], a[16:19], v[176:179], v[16:19]
    v_add_u32 v8, s19, v9
    v_mfma_f32_16x16x32_bf16 v[20:23], a[20:23], v[176:179], v[20:23]
    s_lshr_b32 s22, s18, 1
    v_mfma_f32_16x16x32_bf16 v[24:27], a[24:27], v[176:179], v[24:27]
    buffer_load_dwordx4 v[204:207], v4, s[4:7], s78 offen offset:0 sc1
    s_lshl_b32 s19, s22, 14
    v_mfma_f32_16x16x32_bf16 v[28:31], a[28:31], v[176:179], v[28:31]
    s_add_u32 s19, s19, 0x8000
    v_mfma_f32_16x16x32_bf16 v[16:19], a[32:35], v[180:183], v[16:19]
    s_waitcnt vmcnt(5)
    v_max_u32 v0, v184, v186
    v_mfma_f32_16x16x32_bf16 v[20:23], a[36:39], v[180:183], v[20:23]
    v_cmp_eq_u32 vcc, -1, v0
    v_mfma_f32_16x16x32_bf16 v[24:27], a[40:43], v[180:183], v[24:27]
    buffer_load_dwordx4 v[208:211], v4, s[4:7], s78 offen offset:1024 sc1
    v_add_u32 v124, s19, v9
    v_mfma_f32_16x16x32_bf16 v[28:31], a[44:47], v[180:183], v[28:31]
    s_cbranch_vccnz R_main_kernel_360
C_main_kernel_361:
    s_waitcnt vmcnt(4)
    v_max_u32 v0, v188, v190
    v_mfma_f32_16x16x32_bf16 v[16:19], a[48:51], v[184:187], v[16:19]
    v_max3_u32 v0, v0, v192, v194
    v_mfma_f32_16x16x32_bf16 v[20:23], a[52:55], v[184:187], v[20:23]
    v_cmp_eq_u32 vcc, -1, v0
    v_mfma_f32_16x16x32_bf16 v[24:27], a[56:59], v[184:187], v[24:27]
    buffer_load_dwordx4 v[212:215], v4, s[4:7], s78 offen offset:2048 sc1
    s_lshl_b32 s19, s22, 12
    v_mfma_f32_16x16x32_bf16 v[28:31], a[60:63], v[184:187], v[28:31]
    s_cbranch_vccnz R_main_kernel_362
C_main_kernel_363:
    v_add_u32 v9, s19, v9
    v_mfma_f32_16x16x32_bf16 v[232:235], a[64:67], v[188:191], 0
    v_mfma_f32_16x16x32_bf16 v[236:239], a[68:71], v[188:191], 0
    ds_write_b128 v14, v[16:19] offset:16384
    v_mfma_f32_16x16x32_bf16 v[240:243], a[72:75], v[188:191], 0
    buffer_load_dwordx4 v[216:219], v4, s[4:7], s78 offen offset:3072 sc1
    v_mfma_f32_16x16x32_bf16 v[244:247], a[76:79], v[188:191], 0
    s_waitcnt vmcnt(4)
    v_max_u32 v0, v196, v198
    v_mfma_f32_16x16x32_bf16 v[232:235], a[80:83], v[192:195], v[232:235]
    v_max3_u32 v0, v0, v200, v202
    v_mfma_f32_16x16x32_bf16 v[236:239], a[84:87], v[192:195], v[236:239]
    v_cmp_eq_u32 vcc, -1, v0
    v_mfma_f32_16x16x32_bf16 v[240:243], a[88:91], v[192:195], v[240:243]
    buffer_load_dwordx4 v[220:223], v5, s[4:7], s78 offen offset:0 sc1
    v_mfma_f32_16x16x32_bf16 v[244:247], a[92:95], v[192:195], v[244:247]
    s_cbranch_vccnz R_main_kernel_364
C_main_kernel_365:
    v_mfma_f32_16x16x32_bf16 v[232:235], a[96:99], v[196:199], v[232:235]
    v_mfma_f32_16x16x32_bf16 v[236:239], a[100:103], v[196:199], v[236:239]
    ds_write_b128 v14, v[20:23] offset:17408
    v_mfma_f32_16x16x32_bf16 v[240:243], a[104:107], v[196:199], v[240:243]
    buffer_load_dwordx4 v[224:227], v5, s[4:7], s78 offen offset:1024 sc1
    v_mfma_f32_16x16x32_bf16 v[244:247], a[108:111], v[196:199], v[244:247]
    s_waitcnt vmcnt(4)
    v_max_u32 v0, v204, v206
    v_mfma_f32_16x16x32_bf16 v[232:235], a[112:115], v[200:203], v[232:235]
    v_max3_u32 v0, v0, v208, v210
    v_mfma_f32_16x16x32_bf16 v[236:239], a[116:119], v[200:203], v[236:239]
    v_cmp_eq_u32 vcc, -1, v0
    v_mfma_f32_16x16x32_bf16 v[240:243], a[120:123], v[200:203], v[240:243]
    buffer_load_dwordx4 v[228:231], v12, s[4:7], s78 offen offset:2048 sc1
    v_mfma_f32_16x16x32_bf16 v[244:247], a[124:127], v[200:203], v[244:247]
    s_cbranch_vccnz R_main_kernel_366
C_main_kernel_367:
    v_mfma_f32_16x16x32_bf16 v[232:235], a[128:131], v[204:207], v[232:235]
    v_mfma_f32_16x16x32_bf16 v[236:239], a[132:135], v[204:207], v[236:239]
    ds_write_b128 v14, v[24:27] offset:18432
    v_mfma_f32_16x16x32_bf16 v[240:243], a[136:139], v[204:207], v[240:243]
    buffer_load_dwordx4 v[40:43], v3, s[4:7], s79 offen offset:0 sc1
    v_mfma_f32_16x16x32_bf16 v[244:247], a[140:143], v[204:207], v[244:247]
    s_waitcnt vmcnt(4)
    v_max_u32 v0, v212, v214
    v_mfma_f32_16x16x32_bf16 v[232:235], a[144:147], v[208:211], v[232:235]
    v_max3_u32 v0, v0, v216, v218
    v_mfma_f32_16x16x32_bf16 v[236:239], a[148:151], v[208:211], v[236:239]
    v_cmp_eq_u32 vcc, -1, v0
    v_mfma_f32_16x16x32_bf16 v[240:243], a[152:155], v[208:211], v[240:243]
    buffer_load_dwordx4 v[44:47], v3, s[4:7], s79 offen offset:1024 sc1
    v_mfma_f32_16x16x32_bf16 v[244:247], a[156:159], v[208:211], v[244:247]
    s_cbranch_vccnz R_main_kernel_368
C_main_kernel_369:
    v_mfma_f32_16x16x32_bf16 v[232:235], a[160:163], v[212:215], v[232:235]
    v_mfma_f32_16x16x32_bf16 v[236:239], a[164:167], v[212:215], v[236:239]
    ds_write_b128 v14, v[28:31] offset:19456
    v_mfma_f32_16x16x32_bf16 v[240:243], a[168:171], v[212:215], v[240:243]
    buffer_load_dwordx4 v[48:51], v3, s[4:7], s79 offen offset:2048 sc1
    v_mfma_f32_16x16x32_bf16 v[244:247], a[172:175], v[212:215], v[244:247]
    s_waitcnt vmcnt(4)
    v_max_u32 v0, v220, v222
    v_mfma_f32_16x16x32_bf16 v[232:235], a[0:3], v[216:219], v[232:235]
    v_max3_u32 v0, v0, v224, v226
    v_mfma_f32_16x16x32_bf16 v[236:239], a[4:7], v[216:219], v[236:239]
    v_cmp_eq_u32 vcc, -1, v0
    v_mfma_f32_16x16x32_bf16 v[240:243], a[8:11], v[216:219], v[240:243]
    buffer_load_dwordx4 v[52:55], v3, s[4:7], s79 offen offset:3072 sc1
    v_mfma_f32_16x16x32_bf16 v[244:247], a[12:15], v[216:219], v[244:247]
    s_cbranch_vccnz R_main_kernel_370
C_main_kernel_371:
    v_mfma_f32_16x16x32_bf16 v[232:235], a[16:19], v[220:223], v[232:235]
    s_waitcnt lgkmcnt(0)
    s_barrier
    v_mfma_f32_16x16x32_bf16 v[236:239], a[20:23], v[220:223], v[236:239]
    v_mfma_f32_16x16x32_bf16 v[240:243], a[24:27], v[220:223], v[240:243]
    buffer_load_dwordx4 v[56:59], v4, s[4:7], s79 offen offset:0 sc1
    v_mfma_f32_16x16x32_bf16 v[244:247], a[28:31], v[220:223], v[244:247]
    v_mfma_f32_16x16x32_bf16 v[232:235], a[32:35], v[224:227], v[232:235]
    s_waitcnt vmcnt(5)
    v_max_u32 v0, v228, v230
    v_mfma_f32_16x16x32_bf16 v[236:239], a[36:39], v[224:227], v[236:239]
    v_cmp_eq_u32 vcc, -1, v0
    v_mfma_f32_16x16x32_bf16 v[240:243], a[40:43], v[224:227], v[240:243]
    buffer_load_dwordx4 v[60:63], v4, s[4:7], s79 offen offset:1024 sc1
    v_mfma_f32_16x16x32_bf16 v[244:247], a[44:47], v[224:227], v[244:247]
    s_cbranch_vccnz R_main_kernel_372
C_main_kernel_373:
    s_waitcnt vmcnt(4)
    v_max_u32 v0, v40, v42
    v_mfma_f32_16x16x32_bf16 v[232:235], a[48:51], v[228:231], v[232:235]
    v_max3_u32 v0, v0, v44, v46
    v_mfma_f32_16x16x32_bf16 v[236:239], a[52:55], v[228:231], v[236:239]
    v_cmp_eq_u32 vcc, -1, v0
    v_mfma_f32_16x16x32_bf16 v[240:243], a[56:59], v[228:231], v[240:243]
    buffer_load_dwordx4 v[64:67], v4, s[4:7], s79 offen offset:2048 sc1
    v_mfma_f32_16x16x32_bf16 v[244:247], a[60:63], v[228:231], v[244:247]
    s_cbranch_vccnz R_main_kernel_374
C_main_kernel_375:
    v_mfma_f32_16x16x32_bf16 v[16:19], a[64:67], v[40:43], 0
    ds_read_b128 v[84:87], v8 offset:0
    ds_read_b128 v[88:91], v8 offset:1024
    v_mfma_f32_16x16x32_bf16 v[20:23], a[68:71], v[40:43], 0
    ds_write_b128 v14, v[232:235] offset:32768
    ds_read_b128 v[92:95], v8 offset:4096
    ds_read_b128 v[96:99], v8 offset:5120
    v_mfma_f32_16x16x32_bf16 v[24:27], a[72:75], v[40:43], 0
    buffer_load_dwordx4 v[68:71], v4, s[4:7], s79 offen offset:3072 sc1
    ds_read_b128 v[100:103], v8 offset:8192
    v_mfma_f32_16x16x32_bf16 v[28:31], a[76:79], v[40:43], 0
    s_waitcnt vmcnt(4)
    v_max_u32 v0, v48, v50
    v_mfma_f32_16x16x32_bf16 v[16:19], a[80:83], v[44:47], v[16:19]
    v_max3_u32 v0, v0, v52, v54
    v_mfma_f32_16x16x32_bf16 v[20:23], a[84:87], v[44:47], v[20:23]
    v_cmp_eq_u32 vcc, -1, v0
    v_mfma_f32_16x16x32_bf16 v[24:27], a[88:91], v[44:47], v[24:27]
    buffer_load_dwordx4 v[72:75], v5, s[4:7], s79 offen offset:0 sc1
    ds_read_b128 v[104:107], v8 offset:9216
    ds_read_b128 v[108:111], v8 offset:12288
    v_mfma_f32_16x16x32_bf16 v[28:31], a[92:95], v[44:47], v[28:31]
    s_cbranch_vccnz R_main_kernel_376
C_main_kernel_377:
    ds_read_b128 v[112:115], v8 offset:13312
    ds_read_b128 v[116:119], v9 offset:0
    v_mfma_f32_16x16x32_bf16 v[16:19], a[96:99], v[48:51], v[16:19]
    ds_read_b128 v[120:123], v9 offset:1024
    v_mfma_f32_16x16x32_bf16 v[20:23], a[100:103], v[48:51], v[20:23]
    ds_write_b128 v14, v[236:239] offset:33792
    s_waitcnt lgkmcnt(7)
    v_add_f32 v84, v84, v92
    v_mfma_f32_16x16x32_bf16 v[24:27], a[104:107], v[48:51], v[24:27]
    buffer_load_dwordx4 v[76:79], v5, s[4:7], s79 offen offset:1024 sc1
    v_add_f32 v85, v85, v93
    v_add_f32 v86, v86, v94
    v_mfma_f32_16x16x32_bf16 v[28:31], a[108:111], v[48:51], v[28:31]
    s_waitcnt vmcnt(4)
    v_max_u32 v0, v56, v58
    v_mfma_f32_16x16x32_bf16 v[16:19], a[112:115], v[52:55], v[16:19]
    v_max3_u32 v0, v0, v60, v62
    v_mfma_f32_16x16x32_bf16 v[20:23], a[116:119], v[52:55], v[20:23]
    v_cmp_eq_u32 vcc, -1, v0
    v_mfma_f32_16x16x32_bf16 v[24:27], a[120:123], v[52:55], v[24:27]
    buffer_load_dwordx4 v[80:83], v12, s[4:7], s79 offen offset:2048 sc1
    v_add_f32 v87, v87, v95
    v_mfma_f32_16x16x32_bf16 v[28:31], a[124:127], v[52:55], v[28:31]
    s_cbranch_vccnz R_main_kernel_378
C_main_kernel_379:
    v_add_f32 v88, v88, v96
    v_add_f32 v89, v89, v97
    v_mfma_f32_16x16x32_bf16 v[16:19], a[128:131], v[56:59], v[16:19]
    v_add_f32 v90, v90, v98
    v_add_f32 v91, v91, v99
    v_mfma_f32_16x16x32_bf16 v[20:23], a[132:135], v[56:59], v[20:23]
    ds_write_b128 v14, v[240:243] offset:34816
    s_waitcnt lgkmcnt(4)
    v_mfma_f32_16x16x32_bf16 v[24:27], a[136:139], v[56:59], v[24:27]
    v_add_f32 v100, v100, v108
    v_add_f32 v101, v101, v109
    v_mfma_f32_16x16x32_bf16 v[28:31], a[140:143], v[56:59], v[28:31]
    s_waitcnt vmcnt(3)
    v_max_u32 v0, v64, v66
    v_mfma_f32_16x16x32_bf16 v[16:19], a[144:147], v[60:63], v[16:19]
    v_max3_u32 v0, v0, v68, v70
    v_mfma_f32_16x16x32_bf16 v[20:23], a[148:151], v[60:63], v[20:23]
    v_cmp_eq_u32 vcc, -1, v0
    v_mfma_f32_16x16x32_bf16 v[24:27], a[152:155], v[60:63], v[24:27]
    v_add_f32 v102, v102, v110
    v_add_f32 v103, v103, v111
    v_mfma_f32_16x16x32_bf16 v[28:31], a[156:159], v[60:63], v[28:31]
    s_cbranch_vccnz R_main_kernel_380
C_main_kernel_381:
    v_add_f32 v104, v104, v112
    v_mfma_f32_16x16x32_bf16 v[16:19], a[160:163], v[64:67], v[16:19]
    v_add_f32 v105, v105, v113
    v_add_f32 v106, v106, v114
    v_mfma_f32_16x16x32_bf16 v[20:23], a[164:167], v[64:67], v[20:23]
    ds_write_b128 v14, v[244:247] offset:35840
    v_add_f32 v107, v107, v115
    s_waitcnt lgkmcnt(3)
    v_mfma_f32_16x16x32_bf16 v[24:27], a[168:171], v[64:67], v[24:27]
    v_add_f32 v84, v84, v116
    v_mfma_f32_16x16x32_bf16 v[28:31], a[172:175], v[64:67], v[28:31]
    s_waitcnt vmcnt(1)
    v_max_u32 v0, v72, v74
    v_mfma_f32_16x16x32_bf16 v[16:19], a[0:3], v[68:71], v[16:19]
    v_max3_u32 v0, v0, v76, v78
    v_mfma_f32_16x16x32_bf16 v[20:23], a[4:7], v[68:71], v[20:23]
    v_cmp_eq_u32 vcc, -1, v0
    v_mfma_f32_16x16x32_bf16 v[24:27], a[8:11], v[68:71], v[24:27]
    v_add_f32 v85, v85, v117
    v_add_f32 v86, v86, v118
    v_mfma_f32_16x16x32_bf16 v[28:31], a[12:15], v[68:71], v[28:31]
    s_cbranch_vccnz R_main_kernel_382
C_main_kernel_383:
    v_add_f32 v87, v87, v119
    v_add_f32 v88, v88, v120
    v_mfma_f32_16x16x32_bf16 v[16:19], a[16:19], v[72:75], v[16:19]
    v_add_f32 v89, v89, v121
    v_mfma_f32_16x16x32_bf16 v[20:23], a[20:23], v[72:75], v[20:23]
    v_add_f32 v90, v90, v122
    v_add_f32 v91, v91, v123
    v_mfma_f32_16x16x32_bf16 v[24:27], a[24:27], v[72:75], v[24:27]
    v_add_f32 v84, v84, v100
    v_add_f32 v85, v85, v101
    v_mfma_f32_16x16x32_bf16 v[28:31], a[28:31], v[72:75], v[28:31]
    v_add_f32 v86, v86, v102
    v_mfma_f32_16x16x32_bf16 v[16:19], a[32:35], v[76:79], v[16:19]
    s_waitcnt vmcnt(0)
    v_max_u32 v0, v80, v82
    v_mfma_f32_16x16x32_bf16 v[20:23], a[36:39], v[76:79], v[20:23]
    v_cmp_eq_u32 vcc, -1, v0
    v_mfma_f32_16x16x32_bf16 v[24:27], a[40:43], v[76:79], v[24:27]
    v_add_f32 v87, v87, v103
    v_add_f32 v88, v88, v104
    v_mfma_f32_16x16x32_bf16 v[28:31], a[44:47], v[76:79], v[28:31]
    s_cbranch_vccnz R_main_kernel_384
C_main_kernel_385:
    v_add_f32 v89, v89, v105
    v_add_f32 v90, v90, v106
    v_mfma_f32_16x16x32_bf16 v[16:19], a[48:51], v[80:83], v[16:19]
    v_add_f32 v91, v91, v107
    v_mfma_f32_16x16x32_bf16 v[20:23], a[52:55], v[80:83], v[20:23]
    v_cvt_pk_bf16_f32 v92, v84, v85
    v_cvt_pk_bf16_f32 v93, v86, v87
    v_mfma_f32_16x16x32_bf16 v[24:27], a[56:59], v[80:83], v[24:27]
    v_cvt_pk_bf16_f32 v94, v88, v89
    v_cvt_pk_bf16_f32 v95, v90, v91
    v_mfma_f32_16x16x32_bf16 v[28:31], a[60:63], v[80:83], v[28:31]
    buffer_store_dwordx4 v[92:95], v7, s[12:15], s28 offen
    ds_write_b128 v14, v[16:19] offset:49152
    ds_write_b128 v14, v[20:23] offset:50176
    s_nop 1
    ds_write_b128 v14, v[24:27] offset:51200
    s_nop 1
    ds_write_b128 v14, v[28:31] offset:52224
    s_waitcnt lgkmcnt(0)
    s_barrier
    ds_read_b128 v[84:87], v124 offset:0
    ds_read_b128 v[88:91], v124 offset:1024
    ds_read_b128 v[92:95], v124 offset:4096
    ds_read_b128 v[96:99], v124 offset:5120
    ds_read_b128 v[100:103], v124 offset:8192
    ds_read_b128 v[104:107], v124 offset:9216
    ds_read_b128 v[108:111], v124 offset:12288
    ds_read_b128 v[112:115], v124 offset:13312
    ds_read_b128 v[116:119], v9 offset:8192
    ds_read_b128 v[120:123], v9 offset:9216
    s_waitcnt lgkmcnt(6)
    v_pk_add_f32 v[84:85], v[84:85], v[92:93]
    v_pk_add_f32 v[86:87], v[86:87], v[94:95]
    v_pk_add_f32 v[88:89], v[88:89], v[96:97]
    v_pk_add_f32 v[90:91], v[90:91], v[98:99]
    s_waitcnt lgkmcnt(2)
    v_pk_add_f32 v[100:101], v[100:101], v[108:109]
    v_pk_add_f32 v[102:103], v[102:103], v[110:111]
    v_pk_add_f32 v[104:105], v[104:105], v[112:113]
    v_pk_add_f32 v[106:107], v[106:107], v[114:115]
    s_waitcnt lgkmcnt(0)
    v_pk_add_f32 v[84:85], v[84:85], v[116:117]
    v_pk_add_f32 v[86:87], v[86:87], v[118:119]
    v_pk_add_f32 v[88:89], v[88:89], v[120:121]
    v_pk_add_f32 v[90:91], v[90:91], v[122:123]
    v_pk_add_f32 v[84:85], v[84:85], v[100:101]
    v_pk_add_f32 v[86:87], v[86:87], v[102:103]
    v_pk_add_f32 v[88:89], v[88:89], v[104:105]
    v_pk_add_f32 v[90:91], v[90:91], v[106:107]
    v_cvt_pk_bf16_f32 v92, v84, v85
    v_cvt_pk_bf16_f32 v93, v86, v87
    v_cvt_pk_bf16_f32 v94, v88, v89
    v_cvt_pk_bf16_f32 v95, v90, v91
    buffer_store_dwordx4 v[92:95], v7, s[12:15], s27 offen
    s_endpgm
R_main_kernel_219:
    buffer_load_dwordx4 v[24:27], v3, s[4:7], s57 offen offset:2048 sc1
    buffer_load_dwordx4 v[28:31], v3, s[4:7], s57 offen offset:3072 sc1
    buffer_load_dwordx4 v[32:35], v4, s[4:7], s57 offen offset:0 sc1
    buffer_load_dwordx4 v[36:39], v4, s[4:7], s57 offen offset:1024 sc1
    buffer_load_dwordx4 v[40:43], v4, s[4:7], s57 offen offset:2048 sc1
    buffer_load_dwordx4 v[44:47], v4, s[4:7], s57 offen offset:3072 sc1
    s_add_u32 s33, s33, 1
    s_cmp_gt_u32 s33, 20000
    s_waitcnt vmcnt(4)
    v_max_u32 v0, v24, v28
    v_cmp_eq_u32 vcc, -1, v0
    s_cbranch_scc1 C_main_kernel_220
    s_cbranch_vccnz R_main_kernel_219
    s_branch C_main_kernel_220
R_main_kernel_221:
    buffer_load_dwordx4 v[32:35], v4, s[4:7], s57 offen offset:0 sc1
    buffer_load_dwordx4 v[36:39], v4, s[4:7], s57 offen offset:1024 sc1
    buffer_load_dwordx4 v[40:43], v4, s[4:7], s57 offen offset:2048 sc1
    buffer_load_dwordx4 v[44:47], v4, s[4:7], s57 offen offset:3072 sc1
    buffer_load_dwordx4 v[48:51], v5, s[4:7], s57 offen offset:0 sc1
    buffer_load_dwordx4 v[52:55], v5, s[4:7], s57 offen offset:1024 sc1
    s_add_u32 s33, s33, 1
    s_cmp_gt_u32 s33, 20000
    s_waitcnt vmcnt(4)
    v_max_u32 v0, v32, v36
    v_cmp_eq_u32 vcc, -1, v0
    s_cbranch_scc1 C_main_kernel_222
    s_cbranch_vccnz R_main_kernel_221
    s_branch C_main_kernel_222
R_main_kernel_223:
    buffer_load_dwordx4 v[40:43], v4, s[4:7], s57 offen offset:2048 sc1
    buffer_load_dwordx4 v[44:47], v4, s[4:7], s57 offen offset:3072 sc1
    buffer_load_dwordx4 v[48:51], v5, s[4:7], s57 offen offset:0 sc1
    buffer_load_dwordx4 v[52:55], v5, s[4:7], s57 offen offset:1024 sc1
    buffer_load_dwordx4 v[56:59], v5, s[4:7], s57 offen offset:2048 sc1
    buffer_load_dwordx4 v[60:63], v5, s[4:7], s57 offen offset:3072 sc1
    s_add_u32 s33, s33, 1
    s_cmp_gt_u32 s33, 20000
    s_waitcnt vmcnt(4)
    v_max_u32 v0, v40, v44
    v_cmp_eq_u32 vcc, -1, v0
    s_cbranch_scc1 C_main_kernel_224
    s_cbranch_vccnz R_main_kernel_223
    s_branch C_main_kernel_224
R_main_kernel_225:
    buffer_load_dwordx4 v[48:51], v5, s[4:7], s57 offen offset:0 sc1
    buffer_load_dwordx4 v[52:55], v5, s[4:7], s57 offen offset:1024 sc1
    buffer_load_dwordx4 v[56:59], v5, s[4:7], s57 offen offset:2048 sc1
    buffer_load_dwordx4 v[60:63], v5, s[4:7], s57 offen offset:3072 sc1
    buffer_load_dwordx4 v[64:67], v6, s[4:7], s57 offen offset:0 sc1
    buffer_load_dwordx4 v[68:71], v6, s[4:7], s57 offen offset:1024 sc1
    s_add_u32 s33, s33, 1
    s_cmp_gt_u32 s33, 20000
    s_waitcnt vmcnt(4)
    v_max_u32 v0, v48, v52
    v_cmp_eq_u32 vcc, -1, v0
    s_cbranch_scc1 C_main_kernel_226
    s_cbranch_vccnz R_main_kernel_225
    s_branch C_main_kernel_226
R_main_kernel_227:
    buffer_load_dwordx4 v[56:59], v5, s[4:7], s57 offen offset:2048 sc1
    buffer_load_dwordx4 v[60:63], v5, s[4:7], s57 offen offset:3072 sc1
    buffer_load_dwordx4 v[64:67], v6, s[4:7], s57 offen offset:0 sc1
    buffer_load_dwordx4 v[68:71], v6, s[4:7], s57 offen offset:1024 sc1
    buffer_load_dwordx4 v[72:75], v6, s[4:7], s57 offen offset:2048 sc1
    buffer_load_dwordx4 v[76:79], v6, s[4:7], s57 offen offset:3072 sc1
    s_add_u32 s33, s33, 1
    s_cmp_gt_u32 s33, 20000
    s_waitcnt vmcnt(4)
    v_max_u32 v0, v56, v60
    v_cmp_eq_u32 vcc, -1, v0
    s_cbranch_scc1 C_main_kernel_228
    s_cbranch_vccnz R_main_kernel_227
    s_branch C_main_kernel_228
R_main_kernel_229:
    buffer_load_dwordx4 v[64:67], v6, s[4:7], s57 offen offset:0 sc1
    buffer_load_dwordx4 v[68:71], v6, s[4:7], s57 offen offset:1024 sc1
    buffer_load_dwordx4 v[72:75], v6, s[4:7], s57 offen offset:2048 sc1
    buffer_load_dwordx4 v[76:79], v6, s[4:7], s57 offen offset:3072 sc1
    s_add_u32 s33, s33, 1
    s_cmp_gt_u32 s33, 20000
    s_waitcnt vmcnt(2)
    v_max_u32 v0, v64, v68
    v_cmp_eq_u32 vcc, -1, v0
    s_cbranch_scc1 C_main_kernel_230
    s_cbranch_vccnz R_main_kernel_229
    s_branch C_main_kernel_230
R_main_kernel_231:
    buffer_load_dwordx4 v[72:75], v6, s[4:7], s57 offen offset:2048 sc1
    buffer_load_dwordx4 v[76:79], v6, s[4:7], s57 offen offset:3072 sc1
    s_add_u32 s33, s33, 1
    s_cmp_gt_u32 s33, 20000
    s_waitcnt vmcnt(0)
    v_max_u32 v0, v72, v76
    v_cmp_eq_u32 vcc, -1, v0
    s_cbranch_scc1 C_main_kernel_232
    s_cbranch_vccnz R_main_kernel_231
    s_branch C_main_kernel_232
R_main_kernel_253:
    buffer_load_dwordx4 v[24:27], v3, s[4:7], s58 offen offset:2048 sc1
    buffer_load_dwordx4 v[28:31], v3, s[4:7], s58 offen offset:3072 sc1
    buffer_load_dwordx4 v[32:35], v4, s[4:7], s58 offen offset:0 sc1
    buffer_load_dwordx4 v[36:39], v4, s[4:7], s58 offen offset:1024 sc1
    buffer_load_dwordx4 v[96:99], v3, s[4:7], s41 offen sc1
    buffer_load_dwordx4 v[40:43], v4, s[4:7], s58 offen offset:2048 sc1
    buffer_load_dwordx4 v[44:47], v4, s[4:7], s58 offen offset:3072 sc1
    s_add_u32 s33, s33, 1
    s_cmp_gt_u32 s33, 20000
    s_waitcnt vmcnt(5)
    v_max_u32 v0, v24, v28
    v_cmp_eq_u32 vcc, -1, v0
    s_cbranch_scc1 C_main_kernel_254
    s_cbranch_vccnz R_main_kernel_253
    s_branch C_main_kernel_254
R_main_kernel_255:
    buffer_load_dwordx4 v[32:35], v4, s[4:7], s58 offen offset:0 sc1
    buffer_load_dwordx4 v[36:39], v4, s[4:7], s58 offen offset:1024 sc1
    buffer_load_dwordx4 v[96:99], v3, s[4:7], s41 offen sc1
    buffer_load_dwordx4 v[40:43], v4, s[4:7], s58 offen offset:2048 sc1
    buffer_load_dwordx4 v[44:47], v4, s[4:7], s58 offen offset:3072 sc1
    buffer_load_dwordx4 v[48:51], v5, s[4:7], s58 offen offset:0 sc1
    buffer_load_dwordx4 v[52:55], v5, s[4:7], s58 offen offset:1024 sc1
    s_add_u32 s33, s33, 1
    s_cmp_gt_u32 s33, 20000
    s_waitcnt vmcnt(5)
    v_max_u32 v0, v32, v36
    v_cmp_eq_u32 vcc, -1, v0
    s_cbranch_scc1 C_main_kernel_256
    s_cbranch_vccnz R_main_kernel_255
    s_branch C_main_kernel_256
R_main_kernel_257:
    buffer_load_dwordx4 v[40:43], v4, s[4:7], s58 offen offset:2048 sc1
    buffer_load_dwordx4 v[44:47], v4, s[4:7], s58 offen offset:3072 sc1
    buffer_load_dwordx4 v[48:51], v5, s[4:7], s58 offen offset:0 sc1
    buffer_load_dwordx4 v[52:55], v5, s[4:7], s58 offen offset:1024 sc1
    buffer_load_dwordx4 v[56:59], v5, s[4:7], s58 offen offset:2048 sc1
    buffer_load_dwordx4 v[60:63], v5, s[4:7], s58 offen offset:3072 sc1
    s_add_u32 s33, s33, 1
    s_cmp_gt_u32 s33, 20000
    s_waitcnt vmcnt(4)
    v_max_u32 v0, v40, v44
    v_cmp_eq_u32 vcc, -1, v0
    s_cbranch_scc1 C_main_kernel_258
    s_cbranch_vccnz R_main_kernel_257
    s_branch C_main_kernel_258
R_main_kernel_259:
    buffer_load_dwordx4 v[96:99], v3, s[4:7], s41 offen sc1
    buffer_load_dwordx4 v[48:51], v5, s[4:7], s58 offen offset:0 sc1
    buffer_load_dwordx4 v[52:55], v5, s[4:7], s58 offen offset:1024 sc1
    buffer_load_dwordx4 v[56:59], v5, s[4:7], s58 offen offset:2048 sc1
    buffer_load_dwordx4 v[60:63], v5, s[4:7], s58 offen offset:3072 sc1
    buffer_load_dwordx4 v[64:67], v6, s[4:7], s58 offen offset:0 sc1
    buffer_load_dwordx4 v[68:71], v6, s[4:7], s58 offen offset:1024 sc1
    s_add_u32 s33, s33, 1
    s_cmp_gt_u32 s33, 20000
    s_waitcnt vmcnt(4)
    v_max_u32 v0, v96, v97
    v_max3_u32 v0, v0, v98, v99
    v_max3_u32 v0, v0, v48, v52
    v_cmp_eq_u32 vcc, -1, v0
    s_cbranch_scc1 C_main_kernel_260
    s_cbranch_vccnz R_main_kernel_259
    s_branch C_main_kernel_260
R_main_kernel_261:
    buffer_load_dwordx4 v[56:59], v5, s[4:7], s58 offen offset:2048 sc1
    buffer_load_dwordx4 v[60:63], v5, s[4:7], s58 offen offset:3072 sc1
    buffer_load_dwordx4 v[64:67], v6, s[4:7], s58 offen offset:0 sc1
    buffer_load_dwordx4 v[68:71], v6, s[4:7], s58 offen offset:1024 sc1
    buffer_load_dwordx4 v[72:75], v6, s[4:7], s58 offen offset:2048 sc1
    buffer_load_dwordx4 v[76:79], v6, s[4:7], s58 offen offset:3072 sc1
    s_add_u32 s33, s33, 1
    s_cmp_gt_u32 s33, 20000
    s_waitcnt vmcnt(4)
    v_max_u32 v0, v56, v60
    v_cmp_eq_u32 vcc, -1, v0
    s_cbranch_scc1 C_main_kernel_262
    s_cbranch_vccnz R_main_kernel_261
    s_branch C_main_kernel_262
R_main_kernel_263:
    buffer_load_dwordx4 v[64:67], v6, s[4:7], s58 offen offset:0 sc1
    buffer_load_dwordx4 v[68:71], v6, s[4:7], s58 offen offset:1024 sc1
    buffer_load_dwordx4 v[72:75], v6, s[4:7], s58 offen offset:2048 sc1
    buffer_load_dwordx4 v[76:79], v6, s[4:7], s58 offen offset:3072 sc1
    s_add_u32 s33, s33, 1
    s_cmp_gt_u32 s33, 20000
    s_waitcnt vmcnt(2)
    v_max_u32 v0, v64, v68
    v_cmp_eq_u32 vcc, -1, v0
    s_cbranch_scc1 C_main_kernel_264
    s_cbranch_vccnz R_main_kernel_263
    s_branch C_main_kernel_264
R_main_kernel_265:
    buffer_load_dwordx4 v[72:75], v6, s[4:7], s58 offen offset:2048 sc1
    buffer_load_dwordx4 v[76:79], v6, s[4:7], s58 offen offset:3072 sc1
    s_add_u32 s33, s33, 1
    s_cmp_gt_u32 s33, 20000
    s_waitcnt vmcnt(0)
    v_max_u32 v0, v72, v76
    v_cmp_eq_u32 vcc, -1, v0
    s_cbranch_scc1 C_main_kernel_266
    s_cbranch_vccnz R_main_kernel_265
    s_branch C_main_kernel_266
M_main_kernel_267:
    buffer_store_dwordx4 v[48:51], v143, s[4:7], s66 offen offset:0 sc1
    s_branch C_main_kernel_268
M_main_kernel_269:
    buffer_store_dwordx4 v[52:55], v143, s[4:7], s66 offen offset:1024 sc1
    s_branch C_main_kernel_270
R_main_kernel_290:
    buffer_load_dwordx4 v[24:27], v2, s[4:7], s60 offen offset:2048 sc1
    buffer_load_dwordx4 v[28:31], v2, s[4:7], s60 offen offset:3072 sc1
    buffer_load_dwordx4 v[32:35], v10, s[4:7], s60 offen offset:0 sc1
    buffer_load_dwordx4 v[36:39], v10, s[4:7], s60 offen offset:1024 sc1
    buffer_load_dwordx4 v[40:43], v10, s[4:7], s60 offen offset:2048 sc1
    buffer_load_dwordx4 v[44:47], v10, s[4:7], s60 offen offset:3072 sc1
    s_add_u32 s33, s33, 1
    s_cmp_gt_u32 s33, 20000
    s_waitcnt vmcnt(4)
    v_max_u32 v0, v24, v28
    v_cmp_eq_u32 vcc, -1, v0
    s_cbranch_scc1 C_main_kernel_291
    s_cbranch_vccnz R_main_kernel_290
    s_branch C_main_kernel_291
R_main_kernel_292:
    buffer_load_dwordx4 v[32:35], v10, s[4:7], s60 offen offset:0 sc1
    buffer_load_dwordx4 v[36:39], v10, s[4:7], s60 offen offset:1024 sc1
    buffer_load_dwordx4 v[40:43], v10, s[4:7], s60 offen offset:2048 sc1
    buffer_load_dwordx4 v[44:47], v10, s[4:7], s60 offen offset:3072 sc1
    buffer_load_dwordx4 v[48:51], v11, s[4:7], s60 offen offset:0 sc1
    buffer_load_dwordx4 v[52:55], v11, s[4:7], s60 offen offset:1024 sc1
    s_add_u32 s33, s33, 1
    s_cmp_gt_u32 s33, 20000
    s_waitcnt vmcnt(4)
    v_max_u32 v0, v32, v36
    v_cmp_eq_u32 vcc, -1, v0
    s_cbranch_scc1 C_main_kernel_293
    s_cbranch_vccnz R_main_kernel_292
    s_branch C_main_kernel_293
R_main_kernel_294:
    buffer_load_dwordx4 v[40:43], v10, s[4:7], s60 offen offset:2048 sc1
    buffer_load_dwordx4 v[44:47], v10, s[4:7], s60 offen offset:3072 sc1
    buffer_load_dwordx4 v[48:51], v11, s[4:7], s60 offen offset:0 sc1
    buffer_load_dwordx4 v[52:55], v11, s[4:7], s60 offen offset:1024 sc1
    buffer_load_dwordx4 v[56:59], v11, s[4:7], s60 offen offset:2048 sc1
    buffer_load_dwordx4 v[60:63], v11, s[4:7], s60 offen offset:3072 sc1
    s_add_u32 s33, s33, 1
    s_cmp_gt_u32 s33, 20000
    s_waitcnt vmcnt(4)
    v_max_u32 v0, v40, v44
    v_cmp_eq_u32 vcc, -1, v0
    s_cbranch_scc1 C_main_kernel_295
    s_cbranch_vccnz R_main_kernel_294
    s_branch C_main_kernel_295
R_main_kernel_296:
    buffer_load_dwordx4 v[48:51], v11, s[4:7], s60 offen offset:0 sc1
    buffer_load_dwordx4 v[52:55], v11, s[4:7], s60 offen offset:1024 sc1
    buffer_load_dwordx4 v[56:59], v11, s[4:7], s60 offen offset:2048 sc1
    buffer_load_dwordx4 v[60:63], v11, s[4:7], s60 offen offset:3072 sc1
    buffer_load_dwordx4 v[64:67], v15, s[4:7], s60 offen offset:0 sc1
    buffer_load_dwordx4 v[68:71], v15, s[4:7], s60 offen offset:1024 sc1
    s_add_u32 s33, s33, 1
    s_cmp_gt_u32 s33, 20000
    s_waitcnt vmcnt(4)
    v_max_u32 v0, v48, v52
    v_cmp_eq_u32 vcc, -1, v0
    s_cbranch_scc1 C_main_kernel_297
    s_cbranch_vccnz R_main_kernel_296
    s_branch C_main_kernel_297
R_main_kernel_298:
    buffer_load_dwordx4 v[56:59], v11, s[4:7], s60 offen offset:2048 sc1
    buffer_load_dwordx4 v[60:63], v11, s[4:7], s60 offen offset:3072 sc1
    buffer_load_dwordx4 v[64:67], v15, s[4:7], s60 offen offset:0 sc1
    buffer_load_dwordx4 v[68:71], v15, s[4:7], s60 offen offset:1024 sc1
    buffer_load_dwordx4 v[72:75], v15, s[4:7], s60 offen offset:2048 sc1
    buffer_load_dwordx4 v[76:79], v15, s[4:7], s60 offen offset:3072 sc1
    s_add_u32 s33, s33, 1
    s_cmp_gt_u32 s33, 20000
    s_waitcnt vmcnt(4)
    v_max_u32 v0, v56, v60
    v_cmp_eq_u32 vcc, -1, v0
    s_cbranch_scc1 C_main_kernel_299
    s_cbranch_vccnz R_main_kernel_298
    s_branch C_main_kernel_299
R_main_kernel_300:
    buffer_load_dwordx4 v[64:67], v15, s[4:7], s60 offen offset:0 sc1
    buffer_load_dwordx4 v[68:71], v15, s[4:7], s60 offen offset:1024 sc1
    buffer_load_dwordx4 v[72:75], v15, s[4:7], s60 offen offset:2048 sc1
    buffer_load_dwordx4 v[76:79], v15, s[4:7], s60 offen offset:3072 sc1
    s_add_u32 s33, s33, 1
    s_cmp_gt_u32 s33, 20000
    s_waitcnt vmcnt(2)
    v_max_u32 v0, v64, v68
    v_cmp_eq_u32 vcc, -1, v0
    s_cbranch_scc1 C_main_kernel_301
    s_cbranch_vccnz R_main_kernel_300
    s_branch C_main_kernel_301
R_main_kernel_302:
    buffer_load_dwordx4 v[72:75], v15, s[4:7], s60 offen offset:2048 sc1
    buffer_load_dwordx4 v[76:79], v15, s[4:7], s60 offen offset:3072 sc1
    s_add_u32 s33, s33, 1
    s_cmp_gt_u32 s33, 20000
    s_waitcnt vmcnt(0)
    v_max_u32 v0, v72, v76
    v_cmp_eq_u32 vcc, -1, v0
    s_cbranch_scc1 C_main_kernel_303
    s_cbranch_vccnz R_main_kernel_302
    s_branch C_main_kernel_303
R_main_kernel_324:
    buffer_load_dwordx4 v[24:27], v3, s[4:7], s62 offen offset:2048 sc1
    buffer_load_dwordx4 v[28:31], v3, s[4:7], s62 offen offset:3072 sc1
    buffer_load_dwordx4 v[32:35], v4, s[4:7], s62 offen offset:0 sc1
    buffer_load_dwordx4 v[36:39], v4, s[4:7], s62 offen offset:1024 sc1
    buffer_load_dwordx4 v[136:139], v3, s[4:7], s42 offen sc1
    buffer_load_dwordx4 v[40:43], v4, s[4:7], s62 offen offset:2048 sc1
    buffer_load_dwordx4 v[44:47], v4, s[4:7], s62 offen offset:3072 sc1
    s_add_u32 s33, s33, 1
    s_cmp_gt_u32 s33, 20000
    s_waitcnt vmcnt(5)
    v_max_u32 v0, v24, v28
    v_cmp_eq_u32 vcc, -1, v0
    s_cbranch_scc1 C_main_kernel_325
    s_cbranch_vccnz R_main_kernel_324
    s_branch C_main_kernel_325
R_main_kernel_326:
    buffer_load_dwordx4 v[32:35], v4, s[4:7], s62 offen offset:0 sc1
    buffer_load_dwordx4 v[36:39], v4, s[4:7], s62 offen offset:1024 sc1
    buffer_load_dwordx4 v[136:139], v3, s[4:7], s42 offen sc1
    buffer_load_dwordx4 v[40:43], v4, s[4:7], s62 offen offset:2048 sc1
    buffer_load_dwordx4 v[44:47], v4, s[4:7], s62 offen offset:3072 sc1
    buffer_load_dwordx4 v[48:51], v5, s[4:7], s62 offen offset:0 sc1
    buffer_load_dwordx4 v[52:55], v5, s[4:7], s62 offen offset:1024 sc1
    s_add_u32 s33, s33, 1
    s_cmp_gt_u32 s33, 20000
    s_waitcnt vmcnt(5)
    v_max_u32 v0, v32, v36
    v_cmp_eq_u32 vcc, -1, v0
    s_cbranch_scc1 C_main_kernel_327
    s_cbranch_vccnz R_main_kernel_326
    s_branch C_main_kernel_327
R_main_kernel_328:
    buffer_load_dwordx4 v[40:43], v4, s[4:7], s62 offen offset:2048 sc1
    buffer_load_dwordx4 v[44:47], v4, s[4:7], s62 offen offset:3072 sc1
    buffer_load_dwordx4 v[48:51], v5, s[4:7], s62 offen offset:0 sc1
    buffer_load_dwordx4 v[52:55], v5, s[4:7], s62 offen offset:1024 sc1
    buffer_load_dwordx4 v[56:59], v5, s[4:7], s62 offen offset:2048 sc1
    buffer_load_dwordx4 v[60:63], v5, s[4:7], s62 offen offset:3072 sc1
    s_add_u32 s33, s33, 1
    s_cmp_gt_u32 s33, 20000
    s_waitcnt vmcnt(4)
    v_max_u32 v0, v40, v44
    v_cmp_eq_u32 vcc, -1, v0
    s_cbranch_scc1 C_main_kernel_329
    s_cbranch_vccnz R_main_kernel_328
    s_branch C_main_kernel_329
R_main_kernel_330:
    buffer_load_dwordx4 v[136:139], v3, s[4:7], s42 offen sc1
    buffer_load_dwordx4 v[48:51], v5, s[4:7], s62 offen offset:0 sc1
    buffer_load_dwordx4 v[52:55], v5, s[4:7], s62 offen offset:1024 sc1
    buffer_load_dwordx4 v[56:59], v5, s[4:7], s62 offen offset:2048 sc1
    buffer_load_dwordx4 v[60:63], v5, s[4:7], s62 offen offset:3072 sc1
    buffer_load_dwordx4 v[64:67], v6, s[4:7], s62 offen offset:0 sc1
    buffer_load_dwordx4 v[68:71], v6, s[4:7], s62 offen offset:1024 sc1
    s_add_u32 s33, s33, 1
    s_cmp_gt_u32 s33, 20000
    s_waitcnt vmcnt(4)
    v_max_u32 v0, v136, v137
    v_max3_u32 v0, v0, v138, v139
    v_max3_u32 v0, v0, v48, v52
    v_cmp_eq_u32 vcc, -1, v0
    s_cbranch_scc1 C_main_kernel_331
    s_cbranch_vccnz R_main_kernel_330
    s_branch C_main_kernel_331
R_main_kernel_332:
    buffer_load_dwordx4 v[56:59], v5, s[4:7], s62 offen offset:2048 sc1
    buffer_load_dwordx4 v[60:63], v5, s[4:7], s62 offen offset:3072 sc1
    buffer_load_dwordx4 v[64:67], v6, s[4:7], s62 offen offset:0 sc1
    buffer_load_dwordx4 v[68:71], v6, s[4:7], s62 offen offset:1024 sc1
    buffer_load_dwordx4 v[72:75], v6, s[4:7], s62 offen offset:2048 sc1
    buffer_load_dwordx4 v[76:79], v6, s[4:7], s62 offen offset:3072 sc1
    s_add_u32 s33, s33, 1
    s_cmp_gt_u32 s33, 20000
    s_waitcnt vmcnt(4)
    v_max_u32 v0, v56, v60
    v_cmp_eq_u32 vcc, -1, v0
    s_cbranch_scc1 C_main_kernel_333
    s_cbranch_vccnz R_main_kernel_332
    s_branch C_main_kernel_333
R_main_kernel_334:
    buffer_load_dwordx4 v[64:67], v6, s[4:7], s62 offen offset:0 sc1
    buffer_load_dwordx4 v[68:71], v6, s[4:7], s62 offen offset:1024 sc1
    buffer_load_dwordx4 v[72:75], v6, s[4:7], s62 offen offset:2048 sc1
    buffer_load_dwordx4 v[76:79], v6, s[4:7], s62 offen offset:3072 sc1
    s_add_u32 s33, s33, 1
    s_cmp_gt_u32 s33, 20000
    s_waitcnt vmcnt(2)
    v_max_u32 v0, v64, v68
    v_cmp_eq_u32 vcc, -1, v0
    s_cbranch_scc1 C_main_kernel_335
    s_cbranch_vccnz R_main_kernel_334
    s_branch C_main_kernel_335
R_main_kernel_336:
    buffer_load_dwordx4 v[72:75], v6, s[4:7], s62 offen offset:2048 sc1
    buffer_load_dwordx4 v[76:79], v6, s[4:7], s62 offen offset:3072 sc1
    s_add_u32 s33, s33, 1
    s_cmp_gt_u32 s33, 20000
    s_waitcnt vmcnt(0)
    v_max_u32 v0, v72, v76
    v_cmp_eq_u32 vcc, -1, v0
    s_cbranch_scc1 C_main_kernel_337
    s_cbranch_vccnz R_main_kernel_336
    s_branch C_main_kernel_337
R_main_kernel_338:
    buffer_load_dwordx4 v[40:43], v3, s[4:7], s37 offen offset:0 sc1
    buffer_load_dwordx4 v[44:47], v3, s[4:7], s37 offen offset:1024 sc1
    buffer_load_dwordx4 v[48:51], v3, s[4:7], s37 offen offset:2048 sc1
    buffer_load_dwordx4 v[52:55], v3, s[4:7], s37 offen offset:3072 sc1
    buffer_load_dwordx4 v[56:59], v4, s[4:7], s37 offen offset:0 sc1
    buffer_load_dwordx4 v[60:63], v4, s[4:7], s37 offen offset:1024 sc1
    buffer_load_dwordx4 v[64:67], v4, s[4:7], s37 offen offset:2048 sc1
    buffer_load_dwordx4 v[68:71], v4, s[4:7], s37 offen offset:3072 sc1
    buffer_load_dwordx4 v[72:75], v5, s[4:7], s37 offen offset:0 sc1
    buffer_load_dwordx4 v[76:79], v5, s[4:7], s37 offen offset:1024 sc1
    buffer_load_dwordx4 v[80:83], v12, s[4:7], s37 offen offset:2048 sc1
    s_add_u32 s33, s33, 1
    s_cmp_gt_u32 s33, 20000
    s_waitcnt vmcnt(1)
    v_max_u32 v0, v40, v42
    v_max3_u32 v0, v0, v44, v46
    v_cmp_eq_u32 vcc, -1, v0
    s_cbranch_scc1 C_main_kernel_339
    s_cbranch_vccnz R_main_kernel_338
    s_branch C_main_kernel_339
R_main_kernel_340:
    buffer_load_dwordx4 v[48:51], v3, s[4:7], s37 offen offset:2048 sc1
    buffer_load_dwordx4 v[52:55], v3, s[4:7], s37 offen offset:3072 sc1
    buffer_load_dwordx4 v[56:59], v4, s[4:7], s37 offen offset:0 sc1
    buffer_load_dwordx4 v[60:63], v4, s[4:7], s37 offen offset:1024 sc1
    buffer_load_dwordx4 v[64:67], v4, s[4:7], s37 offen offset:2048 sc1
    buffer_load_dwordx4 v[68:71], v4, s[4:7], s37 offen offset:3072 sc1
    buffer_load_dwordx4 v[72:75], v5, s[4:7], s37 offen offset:0 sc1
    buffer_load_dwordx4 v[76:79], v5, s[4:7], s37 offen offset:1024 sc1
    buffer_load_dwordx4 v[80:83], v12, s[4:7], s37 offen offset:2048 sc1
    s_add_u32 s33, s33, 1
    s_cmp_gt_u32 s33, 20000
    s_waitcnt vmcnt(1)
    v_max_u32 v0, v48, v50
    v_max3_u32 v0, v0, v52, v54
    v_cmp_eq_u32 vcc, -1, v0
    s_cbranch_scc1 C_main_kernel_341
    s_cbranch_vccnz R_main_kernel_340
    s_branch C_main_kernel_341
R_main_kernel_342:
    buffer_load_dwordx4 v[56:59], v4, s[4:7], s37 offen offset:0 sc1
    buffer_load_dwordx4 v[60:63], v4, s[4:7], s37 offen offset:1024 sc1
    buffer_load_dwordx4 v[64:67], v4, s[4:7], s37 offen offset:2048 sc1
    buffer_load_dwordx4 v[68:71], v4, s[4:7], s37 offen offset:3072 sc1
    buffer_load_dwordx4 v[72:75], v5, s[4:7], s37 offen offset:0 sc1
    buffer_load_dwordx4 v[76:79], v5, s[4:7], s37 offen offset:1024 sc1
    buffer_load_dwordx4 v[80:83], v12, s[4:7], s37 offen offset:2048 sc1
    s_add_u32 s33, s33, 1
    s_cmp_gt_u32 s33, 20000
    s_waitcnt vmcnt(1)
    v_max_u32 v0, v56, v58
    v_max3_u32 v0, v0, v60, v62
    v_cmp_eq_u32 vcc, -1, v0
    s_cbranch_scc1 C_main_kernel_343
    s_cbranch_vccnz R_main_kernel_342
    s_branch C_main_kernel_343
R_main_kernel_344:
    buffer_load_dwordx4 v[64:67], v4, s[4:7], s37 offen offset:2048 sc1
    buffer_load_dwordx4 v[68:71], v4, s[4:7], s37 offen offset:3072 sc1
    buffer_load_dwordx4 v[72:75], v5, s[4:7], s37 offen offset:0 sc1
    buffer_load_dwordx4 v[76:79], v5, s[4:7], s37 offen offset:1024 sc1
    buffer_load_dwordx4 v[80:83], v12, s[4:7], s37 offen offset:2048 sc1
    buffer_load_dwordx4 v[144:147], v3, s[4:7], s30 offen offset:0 sc1
    buffer_load_dwordx4 v[148:151], v3, s[4:7], s30 offen offset:1024 sc1
    s_add_u32 s33, s33, 1
    s_cmp_gt_u32 s33, 20000
    s_waitcnt vmcnt(3)
    v_max_u32 v0, v64, v66
    v_max3_u32 v0, v0, v68, v70
    v_cmp_eq_u32 vcc, -1, v0
    s_cbranch_scc1 C_main_kernel_345
    s_cbranch_vccnz R_main_kernel_344
    s_branch C_main_kernel_345
R_main_kernel_346:
    buffer_load_dwordx4 v[72:75], v5, s[4:7], s37 offen offset:0 sc1
    buffer_load_dwordx4 v[76:79], v5, s[4:7], s37 offen offset:1024 sc1
    buffer_load_dwordx4 v[80:83], v12, s[4:7], s37 offen offset:2048 sc1
    buffer_load_dwordx4 v[144:147], v3, s[4:7], s30 offen offset:0 sc1
    buffer_load_dwordx4 v[148:151], v3, s[4:7], s30 offen offset:1024 sc1
    buffer_load_dwordx4 v[152:155], v3, s[4:7], s30 offen offset:2048 sc1
    buffer_load_dwordx4 v[156:159], v3, s[4:7], s30 offen offset:3072 sc1
    s_add_u32 s33, s33, 1
    s_cmp_gt_u32 s33, 20000
    s_waitcnt vmcnt(1)
    v_max_u32 v0, v72, v74
    v_max3_u32 v0, v0, v76, v78
    v_cmp_eq_u32 vcc, -1, v0
    s_cbranch_scc1 C_main_kernel_347
    s_cbranch_vccnz R_main_kernel_346
    s_branch C_main_kernel_347
R_main_kernel_348:
    buffer_load_dwordx4 v[80:83], v12, s[4:7], s37 offen offset:2048 sc1
    buffer_load_dwordx4 v[144:147], v3, s[4:7], s30 offen offset:0 sc1
    buffer_load_dwordx4 v[148:151], v3, s[4:7], s30 offen offset:1024 sc1
    buffer_load_dwordx4 v[152:155], v3, s[4:7], s30 offen offset:2048 sc1
    buffer_load_dwordx4 v[156:159], v3, s[4:7], s30 offen offset:3072 sc1
    buffer_load_dwordx4 v[160:163], v4, s[4:7], s30 offen offset:0 sc1
    buffer_load_dwordx4 v[164:167], v4, s[4:7], s30 offen offset:1024 sc1
    s_add_u32 s33, s33, 1
    s_cmp_gt_u32 s33, 20000
    s_waitcnt vmcnt(3)
    v_max_u32 v0, v80, v82
    v_cmp_eq_u32 vcc, -1, v0
    s_cbranch_scc1 C_main_kernel_349
    s_cbranch_vccnz R_main_kernel_348
    s_branch C_main_kernel_349
R_main_kernel_350:
    buffer_load_dwordx4 v[144:147], v3, s[4:7], s30 offen offset:0 sc1
    buffer_load_dwordx4 v[148:151], v3, s[4:7], s30 offen offset:1024 sc1
    buffer_load_dwordx4 v[152:155], v3, s[4:7], s30 offen offset:2048 sc1
    buffer_load_dwordx4 v[156:159], v3, s[4:7], s30 offen offset:3072 sc1
    buffer_load_dwordx4 v[160:163], v4, s[4:7], s30 offen offset:0 sc1
    buffer_load_dwordx4 v[164:167], v4, s[4:7], s30 offen offset:1024 sc1
    buffer_load_dwordx4 v[168:171], v4, s[4:7], s30 offen offset:2048 sc1
    s_add_u32 s33, s33, 1
    s_cmp_gt_u32 s33, 20000
    s_waitcnt vmcnt(1)
    v_max_u32 v0, v144, v146
    v_max3_u32 v0, v0, v148, v150
    v_cmp_eq_u32 vcc, -1, v0
    s_cbranch_scc1 C_main_kernel_351
    s_cbranch_vccnz R_main_kernel_350
    s_branch C_main_kernel_351
R_main_kernel_352:
    buffer_load_dwordx4 v[152:155], v3, s[4:7], s30 offen offset:2048 sc1
    buffer_load_dwordx4 v[156:159], v3, s[4:7], s30 offen offset:3072 sc1
    buffer_load_dwordx4 v[160:163], v4, s[4:7], s30 offen offset:0 sc1
    buffer_load_dwordx4 v[164:167], v4, s[4:7], s30 offen offset:1024 sc1
    buffer_load_dwordx4 v[168:171], v4, s[4:7], s30 offen offset:2048 sc1
    buffer_load_dwordx4 v[172:175], v4, s[4:7], s30 offen offset:3072 sc1
    buffer_load_dwordx4 v[176:179], v5, s[4:7], s30 offen offset:0 sc1
    s_add_u32 s33, s33, 1
    s_cmp_gt_u32 s33, 20000
    s_waitcnt vmcnt(3)
    v_max_u32 v0, v152, v154
    v_max3_u32 v0, v0, v156, v158
    v_cmp_eq_u32 vcc, -1, v0
    s_cbranch_scc1 C_main_kernel_353
    s_cbranch_vccnz R_main_kernel_352
    s_branch C_main_kernel_353
R_main_kernel_354:
    buffer_load_dwordx4 v[160:163], v4, s[4:7], s30 offen offset:0 sc1
    buffer_load_dwordx4 v[164:167], v4, s[4:7], s30 offen offset:1024 sc1
    buffer_load_dwordx4 v[168:171], v4, s[4:7], s30 offen offset:2048 sc1
    buffer_load_dwordx4 v[172:175], v4, s[4:7], s30 offen offset:3072 sc1
    buffer_load_dwordx4 v[176:179], v5, s[4:7], s30 offen offset:0 sc1
    buffer_load_dwordx4 v[180:183], v5, s[4:7], s30 offen offset:1024 sc1
    buffer_load_dwordx4 v[184:187], v12, s[4:7], s30 offen offset:2048 sc1
    s_add_u32 s33, s33, 1
    s_cmp_gt_u32 s33, 20000
    s_waitcnt vmcnt(5)
    v_max_u32 v0, v160, v162
    v_max3_u32 v0, v0, v164, v166
    v_cmp_eq_u32 vcc, -1, v0
    s_cbranch_scc1 C_main_kernel_355
    s_cbranch_vccnz R_main_kernel_354
    s_branch C_main_kernel_355
R_main_kernel_356:
    buffer_load_dwordx4 v[168:171], v4, s[4:7], s30 offen offset:2048 sc1
    buffer_load_dwordx4 v[172:175], v4, s[4:7], s30 offen offset:3072 sc1
    buffer_load_dwordx4 v[176:179], v5, s[4:7], s30 offen offset:0 sc1
    buffer_load_dwordx4 v[180:183], v5, s[4:7], s30 offen offset:1024 sc1
    buffer_load_dwordx4 v[184:187], v12, s[4:7], s30 offen offset:2048 sc1
    buffer_load_dwordx4 v[188:191], v3, s[4:7], s78 offen offset:0 sc1
    buffer_load_dwordx4 v[192:195], v3, s[4:7], s78 offen offset:1024 sc1
    s_add_u32 s33, s33, 1
    s_cmp_gt_u32 s33, 20000
    s_waitcnt vmcnt(5)
    v_max_u32 v0, v168, v170
    v_max3_u32 v0, v0, v172, v174
    v_cmp_eq_u32 vcc, -1, v0
    s_cbranch_scc1 C_main_kernel_357
    s_cbranch_vccnz R_main_kernel_356
    s_branch C_main_kernel_357
R_main_kernel_358:
    buffer_load_dwordx4 v[176:179], v5, s[4:7], s30 offen offset:0 sc1
    buffer_load_dwordx4 v[180:183], v5, s[4:7], s30 offen offset:1024 sc1
    buffer_load_dwordx4 v[184:187], v12, s[4:7], s30 offen offset:2048 sc1
    buffer_load_dwordx4 v[188:191], v3, s[4:7], s78 offen offset:0 sc1
    buffer_load_dwordx4 v[192:195], v3, s[4:7], s78 offen offset:1024 sc1
    buffer_load_dwordx4 v[196:199], v3, s[4:7], s78 offen offset:2048 sc1
    buffer_load_dwordx4 v[200:203], v3, s[4:7], s78 offen offset:3072 sc1
    s_add_u32 s33, s33, 1
    s_cmp_gt_u32 s33, 20000
    s_waitcnt vmcnt(5)
    v_max_u32 v0, v176, v178
    v_max3_u32 v0, v0, v180, v182
    v_cmp_eq_u32 vcc, -1, v0
    s_cbranch_scc1 C_main_kernel_359
    s_cbranch_vccnz R_main_kernel_358
    s_branch C_main_kernel_359
R_main_kernel_360:
    buffer_load_dwordx4 v[184:187], v12, s[4:7], s30 offen offset:2048 sc1
    buffer_load_dwordx4 v[188:191], v3, s[4:7], s78 offen offset:0 sc1
    buffer_load_dwordx4 v[192:195], v3, s[4:7], s78 offen offset:1024 sc1
    buffer_load_dwordx4 v[196:199], v3, s[4:7], s78 offen offset:2048 sc1
    buffer_load_dwordx4 v[200:203], v3, s[4:7], s78 offen offset:3072 sc1
    buffer_load_dwordx4 v[204:207], v4, s[4:7], s78 offen offset:0 sc1
    buffer_load_dwordx4 v[208:211], v4, s[4:7], s78 offen offset:1024 sc1
    s_add_u32 s33, s33, 1
    s_cmp_gt_u32 s33, 20000
    s_waitcnt vmcnt(6)
    v_max_u32 v0, v184, v186
    v_cmp_eq_u32 vcc, -1, v0
    s_cbranch_scc1 C_main_kernel_361
    s_cbranch_vccnz R_main_kernel_360
    s_branch C_main_kernel_361
R_main_kernel_362:
    buffer_load_dwordx4 v[188:191], v3, s[4:7], s78 offen offset:0 sc1
    buffer_load_dwordx4 v[192:195], v3, s[4:7], s78 offen offset:1024 sc1
    buffer_load_dwordx4 v[196:199], v3, s[4:7], s78 offen offset:2048 sc1
    buffer_load_dwordx4 v[200:203], v3, s[4:7], s78 offen offset:3072 sc1
    buffer_load_dwordx4 v[204:207], v4, s[4:7], s78 offen offset:0 sc1
    buffer_load_dwordx4 v[208:211], v4, s[4:7], s78 offen offset:1024 sc1
    buffer_load_dwordx4 v[212:215], v4, s[4:7], s78 offen offset:2048 sc1
    s_add_u32 s33, s33, 1
    s_cmp_gt_u32 s33, 20000
    s_waitcnt vmcnt(5)
    v_max_u32 v0, v188, v190
    v_max3_u32 v0, v0, v192, v194
    v_cmp_eq_u32 vcc, -1, v0
    s_cbranch_scc1 C_main_kernel_363
    s_cbranch_vccnz R_main_kernel_362
    s_branch C_main_kernel_363
R_main_kernel_364:
    buffer_load_dwordx4 v[196:199], v3, s[4:7], s78 offen offset:2048 sc1
    buffer_load_dwordx4 v[200:203], v3, s[4:7], s78 offen offset:3072 sc1
    buffer_load_dwordx4 v[204:207], v4, s[4:7], s78 offen offset:0 sc1
    buffer_load_dwordx4 v[208:211], v4, s[4:7], s78 offen offset:1024 sc1
    buffer_load_dwordx4 v[212:215], v4, s[4:7], s78 offen offset:2048 sc1
    buffer_load_dwordx4 v[216:219], v4, s[4:7], s78 offen offset:3072 sc1
    buffer_load_dwordx4 v[220:223], v5, s[4:7], s78 offen offset:0 sc1
    s_add_u32 s33, s33, 1
    s_cmp_gt_u32 s33, 20000
    s_waitcnt vmcnt(5)
    v_max_u32 v0, v196, v198
    v_max3_u32 v0, v0, v200, v202
    v_cmp_eq_u32 vcc, -1, v0
    s_cbranch_scc1 C_main_kernel_365
    s_cbranch_vccnz R_main_kernel_364
    s_branch C_main_kernel_365
R_main_kernel_366:
    buffer_load_dwordx4 v[204:207], v4, s[4:7], s78 offen offset:0 sc1
    buffer_load_dwordx4 v[208:211], v4, s[4:7], s78 offen offset:1024 sc1
    buffer_load_dwordx4 v[212:215], v4, s[4:7], s78 offen offset:2048 sc1
    buffer_load_dwordx4 v[216:219], v4, s[4:7], s78 offen offset:3072 sc1
    buffer_load_dwordx4 v[220:223], v5, s[4:7], s78 offen offset:0 sc1
    buffer_load_dwordx4 v[224:227], v5, s[4:7], s78 offen offset:1024 sc1
    buffer_load_dwordx4 v[228:231], v12, s[4:7], s78 offen offset:2048 sc1
    s_add_u32 s33, s33, 1
    s_cmp_gt_u32 s33, 20000
    s_waitcnt vmcnt(5)
    v_max_u32 v0, v204, v206
    v_max3_u32 v0, v0, v208, v210
    v_cmp_eq_u32 vcc, -1, v0
    s_cbranch_scc1 C_main_kernel_367
    s_cbranch_vccnz R_main_kernel_366
    s_branch C_main_kernel_367
R_main_kernel_368:
    buffer_load_dwordx4 v[212:215], v4, s[4:7], s78 offen offset:2048 sc1
    buffer_load_dwordx4 v[216:219], v4, s[4:7], s78 offen offset:3072 sc1
    buffer_load_dwordx4 v[220:223], v5, s[4:7], s78 offen offset:0 sc1
    buffer_load_dwordx4 v[224:227], v5, s[4:7], s78 offen offset:1024 sc1
    buffer_load_dwordx4 v[228:231], v12, s[4:7], s78 offen offset:2048 sc1
    buffer_load_dwordx4 v[40:43], v3, s[4:7], s79 offen offset:0 sc1
    buffer_load_dwordx4 v[44:47], v3, s[4:7], s79 offen offset:1024 sc1
    s_add_u32 s33, s33, 1
    s_cmp_gt_u32 s33, 20000
    s_waitcnt vmcnt(5)
    v_max_u32 v0, v212, v214
    v_max3_u32 v0, v0, v216, v218
    v_cmp_eq_u32 vcc, -1, v0
    s_cbranch_scc1 C_main_kernel_369
    s_cbranch_vccnz R_main_kernel_368
    s_branch C_main_kernel_369
R_main_kernel_370:
    buffer_load_dwordx4 v[220:223], v5, s[4:7], s78 offen offset:0 sc1
    buffer_load_dwordx4 v[224:227], v5, s[4:7], s78 offen offset:1024 sc1
    buffer_load_dwordx4 v[228:231], v12, s[4:7], s78 offen offset:2048 sc1
    buffer_load_dwordx4 v[40:43], v3, s[4:7], s79 offen offset:0 sc1
    buffer_load_dwordx4 v[44:47], v3, s[4:7], s79 offen offset:1024 sc1
    buffer_load_dwordx4 v[48:51], v3, s[4:7], s79 offen offset:2048 sc1
    buffer_load_dwordx4 v[52:55], v3, s[4:7], s79 offen offset:3072 sc1
    s_add_u32 s33, s33, 1
    s_cmp_gt_u32 s33, 20000
    s_waitcnt vmcnt(5)
    v_max_u32 v0, v220, v222
    v_max3_u32 v0, v0, v224, v226
    v_cmp_eq_u32 vcc, -1, v0
    s_cbranch_scc1 C_main_kernel_371
    s_cbranch_vccnz R_main_kernel_370
    s_branch C_main_kernel_371
R_main_kernel_372:
    buffer_load_dwordx4 v[228:231], v12, s[4:7], s78 offen offset:2048 sc1
    buffer_load_dwordx4 v[40:43], v3, s[4:7], s79 offen offset:0 sc1
    buffer_load_dwordx4 v[44:47], v3, s[4:7], s79 offen offset:1024 sc1
    buffer_load_dwordx4 v[48:51], v3, s[4:7], s79 offen offset:2048 sc1
    buffer_load_dwordx4 v[52:55], v3, s[4:7], s79 offen offset:3072 sc1
    buffer_load_dwordx4 v[56:59], v4, s[4:7], s79 offen offset:0 sc1
    buffer_load_dwordx4 v[60:63], v4, s[4:7], s79 offen offset:1024 sc1
    s_add_u32 s33, s33, 1
    s_cmp_gt_u32 s33, 20000
    s_waitcnt vmcnt(6)
    v_max_u32 v0, v228, v230
    v_cmp_eq_u32 vcc, -1, v0
    s_cbranch_scc1 C_main_kernel_373
    s_cbranch_vccnz R_main_kernel_372
    s_branch C_main_kernel_373
R_main_kernel_374:
    buffer_load_dwordx4 v[40:43], v3, s[4:7], s79 offen offset:0 sc1
    buffer_load_dwordx4 v[44:47], v3, s[4:7], s79 offen offset:1024 sc1
    buffer_load_dwordx4 v[48:51], v3, s[4:7], s79 offen offset:2048 sc1
    buffer_load_dwordx4 v[52:55], v3, s[4:7], s79 offen offset:3072 sc1
    buffer_load_dwordx4 v[56:59], v4, s[4:7], s79 offen offset:0 sc1
    buffer_load_dwordx4 v[60:63], v4, s[4:7], s79 offen offset:1024 sc1
    buffer_load_dwordx4 v[64:67], v4, s[4:7], s79 offen offset:2048 sc1
    s_add_u32 s33, s33, 1
    s_cmp_gt_u32 s33, 20000
    s_waitcnt vmcnt(5)
    v_max_u32 v0, v40, v42
    v_max3_u32 v0, v0, v44, v46
    v_cmp_eq_u32 vcc, -1, v0
    s_cbranch_scc1 C_main_kernel_375
    s_cbranch_vccnz R_main_kernel_374
    s_branch C_main_kernel_375
R_main_kernel_376:
    buffer_load_dwordx4 v[48:51], v3, s[4:7], s79 offen offset:2048 sc1
    buffer_load_dwordx4 v[52:55], v3, s[4:7], s79 offen offset:3072 sc1
    buffer_load_dwordx4 v[56:59], v4, s[4:7], s79 offen offset:0 sc1
    buffer_load_dwordx4 v[60:63], v4, s[4:7], s79 offen offset:1024 sc1
    buffer_load_dwordx4 v[64:67], v4, s[4:7], s79 offen offset:2048 sc1
    buffer_load_dwordx4 v[68:71], v4, s[4:7], s79 offen offset:3072 sc1
    buffer_load_dwordx4 v[72:75], v5, s[4:7], s79 offen offset:0 sc1
    s_add_u32 s33, s33, 1
    s_cmp_gt_u32 s33, 20000
    s_waitcnt vmcnt(5)
    v_max_u32 v0, v48, v50
    v_max3_u32 v0, v0, v52, v54
    v_cmp_eq_u32 vcc, -1, v0
    s_cbranch_scc1 C_main_kernel_377
    s_cbranch_vccnz R_main_kernel_376
    s_branch C_main_kernel_377
R_main_kernel_378:
    buffer_load_dwordx4 v[56:59], v4, s[4:7], s79 offen offset:0 sc1
    buffer_load_dwordx4 v[60:63], v4, s[4:7], s79 offen offset:1024 sc1
    buffer_load_dwordx4 v[64:67], v4, s[4:7], s79 offen offset:2048 sc1
    buffer_load_dwordx4 v[68:71], v4, s[4:7], s79 offen offset:3072 sc1
    buffer_load_dwordx4 v[72:75], v5, s[4:7], s79 offen offset:0 sc1
    buffer_load_dwordx4 v[76:79], v5, s[4:7], s79 offen offset:1024 sc1
    buffer_load_dwordx4 v[80:83], v12, s[4:7], s79 offen offset:2048 sc1
    s_add_u32 s33, s33, 1
    s_cmp_gt_u32 s33, 20000
    s_waitcnt vmcnt(5)
    v_max_u32 v0, v56, v58
    v_max3_u32 v0, v0, v60, v62
    v_cmp_eq_u32 vcc, -1, v0
    s_cbranch_scc1 C_main_kernel_379
    s_cbranch_vccnz R_main_kernel_378
    s_branch C_main_kernel_379
R_main_kernel_380:
    buffer_load_dwordx4 v[64:67], v4, s[4:7], s79 offen offset:2048 sc1
    buffer_load_dwordx4 v[68:71], v4, s[4:7], s79 offen offset:3072 sc1
    buffer_load_dwordx4 v[72:75], v5, s[4:7], s79 offen offset:0 sc1
    buffer_load_dwordx4 v[76:79], v5, s[4:7], s79 offen offset:1024 sc1
    buffer_load_dwordx4 v[80:83], v12, s[4:7], s79 offen offset:2048 sc1
    s_add_u32 s33, s33, 1
    s_cmp_gt_u32 s33, 20000
    s_waitcnt vmcnt(3)
    v_max_u32 v0, v64, v66
    v_max3_u32 v0, v0, v68, v70
    v_cmp_eq_u32 vcc, -1, v0
    s_cbranch_scc1 C_main_kernel_381
    s_cbranch_vccnz R_main_kernel_380
    s_branch C_main_kernel_381
R_main_kernel_382:
    buffer_load_dwordx4 v[72:75], v5, s[4:7], s79 offen offset:0 sc1
    buffer_load_dwordx4 v[76:79], v5, s[4:7], s79 offen offset:1024 sc1
    buffer_load_dwordx4 v[80:83], v12, s[4:7], s79 offen offset:2048 sc1
    s_add_u32 s33, s33, 1
    s_cmp_gt_u32 s33, 20000
    s_waitcnt vmcnt(1)
    v_max_u32 v0, v72, v74
    v_max3_u32 v0, v0, v76, v78
    v_cmp_eq_u32 vcc, -1, v0
    s_cbranch_scc1 C_main_kernel_383
    s_cbranch_vccnz R_main_kernel_382
    s_branch C_main_kernel_383
R_main_kernel_384:
    buffer_load_dwordx4 v[80:83], v12, s[4:7], s79 offen offset:2048 sc1
    s_add_u32 s33, s33, 1
    s_cmp_gt_u32 s33, 20000
    s_waitcnt vmcnt(0)
    v_max_u32 v0, v80, v82
    v_cmp_eq_u32 vcc, -1, v0
    s_cbranch_scc1 C_main_kernel_385
    s_cbranch_vccnz R_main_kernel_384
    s_branch C_main_kernel_385
Z_main_kernel_2:
    buffer_store_dwordx4 a[168:171], v3, s[4:7], s36 offen offset:0 sc1
    buffer_store_dwordx4 a[168:171], v3, s[4:7], s36 offen offset:1024 sc1
    s_branch C_main_kernel_3
Z_main_kernel_4:
    buffer_store_dwordx4 a[168:171], v3, s[4:7], s36 offen offset:2048 sc1
    buffer_store_dwordx4 a[168:171], v3, s[4:7], s36 offen offset:3072 sc1
    s_branch C_main_kernel_5
Z_main_kernel_6:
    buffer_store_dwordx4 a[168:171], v4, s[4:7], s36 offen offset:0 sc1
    buffer_store_dwordx4 a[168:171], v4, s[4:7], s36 offen offset:1024 sc1
    s_branch C_main_kernel_7
Z_main_kernel_8:
    buffer_store_dwordx4 a[168:171], v4, s[4:7], s36 offen offset:2048 sc1
    buffer_store_dwordx4 a[168:171], v4, s[4:7], s36 offen offset:3072 sc1
    s_branch C_main_kernel_9
Z_main_kernel_10:
    buffer_store_dwordx4 a[168:171], v5, s[4:7], s36 offen offset:0 sc1
    buffer_store_dwordx4 a[168:171], v5, s[4:7], s36 offen offset:1024 sc1
    s_branch C_main_kernel_11
Z_main_kernel_12:
    buffer_store_dwordx4 a[168:171], v5, s[4:7], s36 offen offset:2048 sc1
    buffer_store_dwordx4 a[168:171], v5, s[4:7], s36 offen offset:3072 sc1
    s_branch C_main_kernel_13
L_attn_slow:
    s_waitcnt vmcnt(0)
    v_mov_b32 v24, 0xff61b1e6
    v_mov_b32 v25, 0xff61b1e6
    v_mov_b32 v88, 0
    v_mov_b32 v89, 0
    v_mov_b32 v90, 0
    v_mov_b32 v91, 0
    v_mov_b32 v92, 0
    v_mov_b32 v93, 0
    v_mov_b32 v94, 0
    v_mov_b32 v95, 0
    v_mov_b32 v96, 0
    v_mov_b32 v97, 0
    v_mov_b32 v98, 0
    v_mov_b32 v99, 0
    v_mov_b32 v100, 0
    v_mov_b32 v101, 0
    v_mov_b32 v102, 0
    v_mov_b32 v103, 0
    v_mov_b32 v104, 0
    v_mov_b32 v105, 0
    v_mov_b32 v106, 0
    v_mov_b32 v107, 0
    v_mov_b32 v108, 0
    v_mov_b32 v109, 0
    v_mov_b32 v110, 0
    v_mov_b32 v111, 0
    v_mov_b32 v112, 0
    v_mov_b32 v113, 0
    v_mov_b32 v114, 0
    v_mov_b32 v115, 0
    v_mov_b32 v116, 0
    v_mov_b32 v117, 0
    v_mov_b32 v118, 0
    v_mov_b32 v119, 0
    v_mov_b32 v124, s31
    v_mov_b32 v125, s31
    v_mov_b32 v126, s31
    v_mov_b32 v127, s31
    v_mov_b32 v128, s31
    v_mov_b32 v129, s31
    v_mov_b32 v130, s31
    v_mov_b32 v131, s31
    s_lshl_b32 s23, s17, 17
    s_add_u32 s23, s23, 0x200000
    s_mov_b32 s24, 64
    s_mov_b32 s20, 0x0000ffff
    s_mov_b32 s21, 0x0000ffff
L_attn_sloop:
    buffer_load_dwordx4 v[120:123], v3, s[4:7], s23 offen
    s_mov_b64 exec, s[20:21]
    buffer_load_dwordx4 v[124:127], v14, s[4:7], s23 offen offset:1024
    buffer_load_dwordx4 v[128:131], v14, s[4:7], s23 offen offset:1536
    s_mov_b64 exec, -1
    s_waitcnt vmcnt(0)
    v_mfma_f32_32x32x16_bf16 v[40:55], v[120:123], v[16:19], 0
    s_nop 11
    v_max_f32 v26, v40, v41
    v_max3_f32 v26, v26, v42, v43
    v_max3_f32 v26, v26, v44, v45
    v_max3_f32 v26, v26, v46, v47
    v_max3_f32 v26, v26, v48, v49
    v_max3_f32 v26, v26, v50, v51
    v_max3_f32 v26, v26, v52, v53
    v_max3_f32 v26, v26, v54, v55
    v_mov_b32 v27, v26
    s_nop 1
    v_permlane32_swap_b32 v26, v27
    v_max3_f32 v26, v26, v27, v24
    v_sub_f32 v28, v24, v26
    v_exp_f32 v28, v28
    v_mov_b32 v24, v26
    v_mul_f32 v88, v88, v28
    v_mul_f32 v89, v89, v28
    v_mul_f32 v90, v90, v28
    v_mul_f32 v91, v91, v28
    v_mul_f32 v92, v92, v28
    v_mul_f32 v93, v93, v28
    v_mul_f32 v94, v94, v28
    v_mul_f32 v95, v95, v28
    v_mul_f32 v96, v96, v28
    v_mul_f32 v97, v97, v28
    v_mul_f32 v98, v98, v28
    v_mul_f32 v99, v99, v28
    v_mul_f32 v100, v100, v28
    v_mul_f32 v101, v101, v28
    v_mul_f32 v102, v102, v28
    v_mul_f32 v103, v103, v28
    v_sub_f32 v40, v40, v26
    v_sub_f32 v41, v41, v26
    v_sub_f32 v42, v42, v26
    v_sub_f32 v43, v43, v26
    v_sub_f32 v44, v44, v26
    v_sub_f32 v45, v45, v26
    v_sub_f32 v46, v46, v26
    v_sub_f32 v47, v47, v26
    v_sub_f32 v48, v48, v26
    v_sub_f32 v49, v49, v26
    v_sub_f32 v50, v50, v26
    v_sub_f32 v51, v51, v26
    v_sub_f32 v52, v52, v26
    v_sub_f32 v53, v53, v26
    v_sub_f32 v54, v54, v26
    v_sub_f32 v55, v55, v26
    v_exp_f32 v40, v40
    v_exp_f32 v41, v41
    v_exp_f32 v42, v42
    v_exp_f32 v43, v43
    v_exp_f32 v44, v44
    v_exp_f32 v45, v45
    v_exp_f32 v46, v46
    v_exp_f32 v47, v47
    v_exp_f32 v48, v48
    v_exp_f32 v49, v49
    v_exp_f32 v50, v50
    v_exp_f32 v51, v51
    v_exp_f32 v52, v52
    v_exp_f32 v53, v53
    v_exp_f32 v54, v54
    v_exp_f32 v55, v55
    v_cvt_pk_bf16_f32 v72, v40, v41
    v_cvt_pk_bf16_f32 v73, v42, v43
    v_cvt_pk_bf16_f32 v74, v44, v45
    v_cvt_pk_bf16_f32 v75, v46, v47
    v_cvt_pk_bf16_f32 v76, v48, v49
    v_cvt_pk_bf16_f32 v77, v50, v51
    v_cvt_pk_bf16_f32 v78, v52, v53
    v_cvt_pk_bf16_f32 v79, v54, v55
    v_mfma_f32_32x32x16_bf16 v[88:103], v[124:127], v[72:75], v[88:103]
    s_nop 0
    v_mfma_f32_32x32x16_bf16 v[88:103], v[128:131], v[76:79], v[88:103]
    v_mfma_f32_32x32x16_bf16 v[56:71], v[120:123], v[20:23], 0
    s_nop 11
    v_max_f32 v26, v56, v57
    v_max3_f32 v26, v26, v58, v59
    v_max3_f32 v26, v26, v60, v61
    v_max3_f32 v26, v26, v62, v63
    v_max3_f32 v26, v26, v64, v65
    v_max3_f32 v26, v26, v66, v67
    v_max3_f32 v26, v26, v68, v69
    v_max3_f32 v26, v26, v70, v71
    v_mov_b32 v27, v26
    s_nop 1
    v_permlane32_swap_b32 v26, v27
    v_max3_f32 v26, v26, v27, v25
    v_sub_f32 v28, v25, v26
    v_exp_f32 v28, v28
    v_mov_b32 v25, v26
    v_mul_f32 v104, v104, v28
    v_mul_f32 v105, v105, v28
    v_mul_f32 v106, v106, v28
    v_mul_f32 v107, v107, v28
    v_mul_f32 v108, v108, v28
    v_mul_f32 v109, v109, v28
    v_mul_f32 v110, v110, v28
    v_mul_f32 v111, v111, v28
    v_mul_f32 v112, v112, v28
    v_mul_f32 v113, v113, v28
    v_mul_f32 v114, v114, v28
    v_mul_f32 v115, v115, v28
    v_mul_f32 v116, v116, v28
    v_mul_f32 v117, v117, v28
    v_mul_f32 v118, v118, v28
    v_mul_f32 v119, v119, v28
    v_sub_f32 v56, v56, v26
    v_sub_f32 v57, v57, v26
    v_sub_f32 v58, v58, v26
    v_sub_f32 v59, v59, v26
    v_sub_f32 v60, v60, v26
    v_sub_f32 v61, v61, v26
    v_sub_f32 v62, v62, v26
    v_sub_f32 v63, v63, v26
    v_sub_f32 v64, v64, v26
    v_sub_f32 v65, v65, v26
    v_sub_f32 v66, v66, v26
    v_sub_f32 v67, v67, v26
    v_sub_f32 v68, v68, v26
    v_sub_f32 v69, v69, v26
    v_sub_f32 v70, v70, v26
    v_sub_f32 v71, v71, v26
    v_exp_f32 v56, v56
    v_exp_f32 v57, v57
    v_exp_f32 v58, v58
    v_exp_f32 v59, v59
    v_exp_f32 v60, v60
    v_exp_f32 v61, v61
    v_exp_f32 v62, v62
    v_exp_f32 v63, v63
    v_exp_f32 v64, v64
    v_exp_f32 v65, v65
    v_exp_f32 v66, v66
    v_exp_f32 v67, v67
    v_exp_f32 v68, v68
    v_exp_f32 v69, v69
    v_exp_f32 v70, v70
    v_exp_f32 v71, v71
    v_cvt_pk_bf16_f32 v80, v56, v57
    v_cvt_pk_bf16_f32 v81, v58, v59
    v_cvt_pk_bf16_f32 v82, v60, v61
    v_cvt_pk_bf16_f32 v83, v62, v63
    v_cvt_pk_bf16_f32 v84, v64, v65
    v_cvt_pk_bf16_f32 v85, v66, v67
    v_cvt_pk_bf16_f32 v86, v68, v69
    v_cvt_pk_bf16_f32 v87, v70, v71
    v_mfma_f32_32x32x16_bf16 v[104:119], v[124:127], v[80:83], v[104:119]
    s_nop 0
    v_mfma_f32_32x32x16_bf16 v[104:119], v[128:131], v[84:87], v[104:119]
    s_nop 15
    s_add_u32 s23, s23, 2048
    s_sub_u32 s24, s24, 1
    s_cmp_lg_u32 s24, 0
    s_cbranch_scc1 L_attn_sloop
    v_rcp_f32 v44, v96
    v_rcp_f32 v46, v112
    v_pk_mul_f32 v[88:89], v[88:89], v[44:45] op_sel_hi:[1,0]
    v_pk_mul_f32 v[90:91], v[90:91], v[44:45] op_sel_hi:[1,0]
    v_pk_mul_f32 v[92:93], v[92:93], v[44:45] op_sel_hi:[1,0]
    v_pk_mul_f32 v[94:95], v[94:95], v[44:45] op_sel_hi:[1,0]
    v_cvt_pk_bf16_f32 v72, v88, v89
    v_cvt_pk_bf16_f32 v73, v90, v91
    v_cvt_pk_bf16_f32 v74, v92, v93
    v_cvt_pk_bf16_f32 v75, v94, v95
    v_min_u32 v72, s32, v72
    s_nop 3
    s_branch L_attn_fin
.section .rodata,"a"
.p2align 6
.amdhsa_kernel qkv_kernel
  .amdhsa_next_free_vgpr 200
  .amdhsa_next_free_sgpr 102
  .amdhsa_accum_offset 200
  .amdhsa_group_segment_fixed_size 0
  .amdhsa_kernarg_size 88
  .amdhsa_user_sgpr_count 2
  .amdhsa_user_sgpr_kernarg_segment_ptr 1
  .amdhsa_system_sgpr_workgroup_id_x 1
.end_amdhsa_kernel
.p2align 6
.amdhsa_kernel main_kernel
  .amdhsa_next_free_vgpr 512
  .amdhsa_next_free_sgpr 102
  .amdhsa_accum_offset 256
  .amdhsa_group_segment_fixed_size 0
  .amdhsa_kernarg_size 88
  .amdhsa_user_sgpr_count 2
  .amdhsa_user_sgpr_kernarg_segment_ptr 1
  .amdhsa_system_sgpr_workgroup_id_x 1
.end_amdhsa_kernel
```
